```python
import torch

def _softmax(x, axis=-1):
    return torch.softmax(x, dim=axis)
def _gelu(x):
    return torch.nn.functional.gelu(x, approximate="tanh")
def _silu(x):
    return torch.nn.functional.silu(x)
def _sigmoid(x):
    return torch.sigmoid(x)
def _layernorm(x, axis=-1, eps=1e-5):
    m = x.mean(dim=axis, keepdim=True)
    v = x.var(dim=axis, keepdim=True, unbiased=False)
    return (x - m) / torch.sqrt(v + eps)
def _scatter_add(tgt, idx, src, axis=0):
    return tgt.clone().index_add_(axis, idx, src)
def _segment_sum(src, seg, n):
    out = torch.zeros((n,) + src.shape[1:], dtype=src.dtype)
    return out.index_add_(0, seg, src)
def _pad(x, pw):
    flat = tuple(v for pair in reversed(pw) for v in pair)
    return torch.nn.functional.pad(x, flat)

kernel_name = 'parallel_sum__compressed_kv_cla__dense_activation_relu__prompt'

def setup_inputs():

    _w = (lambda a: (lambda t: t.to(torch.bfloat16) if t.is_floating_point() else t)(torch.as_tensor(a)))
    def _A_setup():
        B, H, Sq, Sk, D, M = 1, 32, 2048, 2048, 128, 640
        Dc = 4 * D
        return {
            "x": _w((lambda *s: torch.randn(*s, dtype=torch.bfloat16) * 0.05)(B, Sq, M)),
            "c_kv": _w((lambda *s: torch.randn(*s, dtype=torch.bfloat16) * 1.6)(B, Sk, Dc)),
            "w_q": _w((lambda *s: torch.randn(*s, dtype=torch.bfloat16) * 0.8)(M, H, D) * (M ** -0.5)),
            "w_uk": _w((lambda *s: torch.randn(*s, dtype=torch.bfloat16) * 0.8)(Dc, H, D) * (Dc ** -0.5)),
            "w_uv": _w((lambda *s: torch.randn(*s, dtype=torch.bfloat16) * 1.6)(Dc, H, D) * (Dc ** -0.5)),
            "w_o": _w((lambda *s: torch.randn(*s, dtype=torch.bfloat16) * 1.6)(H, D, M) * ((H * D) ** -0.5)),
        }
    _A_in = _A_setup()

    def _B_setup():
        B, S, D, Dff = 1, 2048, 640, 1728
        return {
            "x": _w((lambda *s: torch.randn(*s, dtype=torch.bfloat16) * 0.05)(B, S, D)),
            "w1": _w((lambda *s: torch.randn(*s, dtype=torch.bfloat16) * 0.05)(D, Dff)),
            "w2": _w((lambda *s: torch.randn(*s, dtype=torch.bfloat16) * 0.05)(Dff, D)),
        }
    _B_in = _B_setup()

    return {
        "A_x": _A_in["x"],
        "A_c_kv": _A_in["c_kv"],
        "A_w_q": _A_in["w_q"],
        "A_w_uk": _A_in["w_uk"],
        "A_w_uv": _A_in["w_uv"],
        "A_w_o": _A_in["w_o"],
        "B_x": _B_in["x"],
        "B_w1": _B_in["w1"],
        "B_w2": _B_in["w2"],
    }

def reference(A_x, A_c_kv, A_w_q, A_w_uk, A_w_uv, A_w_o, B_x, B_w1, B_w2):
    def _A_ref(x, c_kv, w_q, w_uk, w_uv, w_o):
        B, Sq, M = x.shape[0], x.shape[1], x.shape[2]
        Sk = c_kv.shape[1]
        H, D = w_q.shape[1], w_q.shape[2]
        q = torch.einsum("bqm,mhd->bhqd", x, w_q)
        k = torch.einsum("bkc,chd->bhkd", c_kv, w_uk)
        v = torch.einsum("bkc,chd->bhkd", c_kv, w_uv)
        scores = torch.einsum("bhqd,bhkd->bhqk", q, k) * (D ** -0.5)
        off = Sk - Sq
        qi = torch.arange(Sq)[:, None]
        kj = torch.arange(Sk)[None, :]
        cmask = kj <= (qi + off)
        scores = torch.where(cmask[None, None], scores, -1e9)
        p = _softmax(scores, axis=-1)
        ctx = torch.einsum("bhqk,bhkd->bhqd", p, v)
        return torch.einsum("bhqd,hdm->bqm", ctx, w_o)

    def _B_ref(x, w1, w2):
        h = torch.einsum("bsd,df->bsf", x, w1)
        zero = torch.zeros_like(h)
        h = torch.maximum(h, zero)
        return torch.einsum("bsf,fd->bsd", h, w2)

    x = A_x
    xn = _layernorm(x, axis=-1)
    return x + _A_ref(xn, A_c_kv, A_w_q, A_w_uk, A_w_uv, A_w_o) + _B_ref(xn, B_w1, B_w2)
```

```asm
; @launch grid=(256,1,1) block=(256,1,1) lds=163840
.amdgcn_target "amdgcn-amd-amdhsa--gfx950"
.text
.globl parallel_sum__compressed_kv_cla__dense_activation_relu__prompt_kernel
.p2align 8
.type parallel_sum__compressed_kv_cla__dense_activation_relu__prompt_kernel,@function
parallel_sum__compressed_kv_cla__dense_activation_relu__prompt_kernel:
  s_cmp_ge_u32 s2, 256
  s_cbranch_scc1 L_end
  s_load_dwordx16 s[68:83], s[0:1], 0
  s_load_dwordx8 s[84:91], s[0:1], 64
  v_lshrrev_b32 v17, 6, v0
  v_and_b32 v16, 63, v0
  v_readfirstlane_b32 s40, v17
  s_getpc_b64 s[24:25]
L_pc:
  s_and_b32 s25, s25, 0xffff
  s_mov_b32 s26, L_end-L_pc
  s_mov_b32 s27, 0x20000
  v_lshlrev_b32 v17, 7, v16
  s_lshr_b32 s43, s2, 3
  s_lshl_b32 s43, s43, 2
  s_add_u32 s43, s43, s40
  s_lshl_b32 s3, s43, 10
  s_lshl_b32 s43, s43, 13
  buffer_load_dword a250, v17, s[24:27], s43 offen
  v_lshlrev_b32 v1, 4, v16
  s_and_b32 s43, s2, 7
  s_lshl_b32 s43, s43, 2
  s_lshr_b32 s44, s2, 3
  s_and_b32 s44, s44, 3
  s_add_u32 s41, s43, s44
  s_lshr_b32 s42, s2, 5
  s_lshr_b32 s54, s40, 1
  s_and_b32 s55, s40, 1
  v_lshrrev_b32 v17, 3, v16
  v_and_b32 v18, 7, v16
  v_lshrrev_b32 v19, 4, v16
  v_xor_b32 v20, v18, v19
  v_lshlrev_b32 v20, 4, v20
  v_lshl_add_u32 v2, v17, 10, v20
  v_xor_b32 v3, 64, v2
  v_lshlrev_b32 v19, 1, v19
  v_xor_b32 v20, v18, v19
  v_lshlrev_b32 v20, 4, v20
  v_and_b32 v18, 3, v17
  v_lshrrev_b32 v19, 2, v17
  v_lshl_add_u32 v18, v19, 3, v18
  v_lshl_add_u32 v4, v18, 13, v20
  v_mul_u32_u24 v18, 3456, v18
  v_add_u32 v5, v18, v20
  v_mul_u32_u24 v18, 1280, v17
  v_add_u32 v12, v18, v20
  s_lshl_b32 s46, s42, 18
  s_lshl_b32 s43, s40, 16
  s_add_u32 s46, s46, s43
  s_lshl_b32 s47, s41, 8
  s_lshl_b32 s43, s55, 7
  s_add_u32 s47, s47, s43
  s_lshl_b32 s49, s40, 13
  s_add_u32 s48, s49, 0x10000
  s_and_b32 s43, s41, 3
  s_lshl_b32 s43, s43, 2
  s_add_u32 s43, s43, s40
  s_lshl_b32 s44, s42, 4
  s_add_u32 s43, s43, s44
  s_lshl_b32 s43, s43, 14
  v_and_b32 v17, 15, v16
  v_lshlrev_b32 v17, 10, v17
  v_lshrrev_b32 v18, 4, v16
  v_lshl_add_u32 v17, v18, 7, v17
  v_add_u32 v17, s43, v17
  v_mov_b32 v19, 0x40000000
  v_cmp_gt_u32 vcc, 32, v16
  s_nop 1
  v_cndmask_b32 v24, v19, v17, vcc
  v_bfe_u32 v17, v16, 1, 2
  v_lshrrev_b32 v18, 3, v16
  v_lshl_add_u32 v17, v18, 6, v17
  v_lshlrev_b32 v17, 13, v17
  v_and_b32 v18, 1, v16
  v_lshl_add_u32 v17, v18, 7, v17
  s_lshl_b32 s43, s42, 1
  s_add_u32 s43, s43, s55
  s_lshl_b32 s43, s43, 15
  s_lshl_b32 s44, s41, 8
  s_add_u32 s43, s43, s44
  v_add_u32 v17, s43, v17
  v_cmp_gt_u32 vcc, 16, v16
  s_nop 1
  v_cndmask_b32 v25, v19, v17, vcc
  s_mov_b32 s6, 0x280000
  s_mov_b32 s7, 0x20000
  s_mov_b32 s10, 0x200000
  s_mov_b32 s11, 0x20000
  s_mov_b32 s14, 0x400000
  s_mov_b32 s15, 0x20000
  s_mov_b32 s18, 0x500000
  s_mov_b32 s19, 0x20000
  s_mov_b32 s22, 0x21c000
  s_mov_b32 s23, 0x20000
  s_mov_b32 s34, 0x280000
  s_mov_b32 s35, 0x20000
  s_mov_b32 s38, 0x100
  s_mov_b32 s39, 0x20000
  s_mov_b32 s30, 0x10000000
  s_mov_b32 s31, 0x20000
  s_waitcnt lgkmcnt(0)
  s_mov_b32 s8, s70
  s_and_b32 s9, s71, 0xffff
  s_cmp_lt_u32 s40, 2
  s_cselect_b32 s12, s74, s76
  s_cselect_b32 s13, s75, s77
  s_and_b32 s13, s13, 0xffff
  buffer_load_dword a240, v25, s[12:15], 0 offen
  buffer_load_dword a241, v24, s[8:11], 0 offen
  s_mov_b32 s43, 0x100000
  buffer_load_dword a242, v25, s[12:15], s43 offen
  buffer_load_dword a243, v24, s[8:11], 0 offen offset:256
  s_mov_b32 s4, s68
  s_and_b32 s5, s69, 0xffff
  s_mov_b32 s16, s72
  s_and_b32 s17, s73, 0xffff
  s_mov_b32 s20, s82
  s_and_b32 s21, s83, 0xffff
  s_mov_b32 s32, s86
  s_and_b32 s33, s87, 0xffff
  s_mov_b32 s36, s88
  s_and_b32 s37, s89, 0xffff
  s_mov_b32 s28, s90
  s_and_b32 s29, s91, 0xffff
  s_lshl_b32 s43, s42, 2
  s_add_u32 s43, s43, s40
  s_lshl_b32 s43, s43, 1
  v_lshrrev_b32 v17, 2, v16
  v_bfe_u32 v18, v16, 1, 1
  v_lshl_add_u32 v17, v17, 6, v18
  v_add_u32 v17, s43, v17
  v_lshlrev_b32 v17, 13, v17
  v_and_b32 v18, 1, v16
  v_lshl_add_u32 v17, v18, 7, v17
  s_lshl_b32 s44, s41, 8
  v_add_u32 v17, s44, v17
  v_cndmask_b32 v26, v19, v17, vcc
  v_lshrrev_b32 v17, 1, v16
  v_and_b32 v18, 1, v16
  v_lshl_add_u32 v17, v17, 6, v18
  v_add_u32 v17, s43, v17
  v_mul_u32_u24 v17, 3456, v17
  s_lshl_b32 s44, s41, 7
  v_add_u32 v17, s44, v17
  v_cmp_gt_u32 vcc, 8, v16
  s_nop 1
  v_cndmask_b32 v27, v19, v17, vcc
  v_and_b32 v17, 15, v16
  v_lshrrev_b32 v18, 4, v16
  v_lshrrev_b32 v19, 1, v17
  v_xor_b32 v19, v18, v19
  v_lshlrev_b32 v19, 4, v19
  v_lshl_add_u32 v19, v17, 7, v19
  s_lshl_b32 s43, s54, 14
  s_add_u32 s43, s43, 0x10000
  v_add_u32 v6, s43, v19
  v_xor_b32 v7, 64, v6
  v_bfe_u32 v17, v16, 2, 3
  v_lshrrev_b32 v18, 5, v16
  v_and_b32 v19, 3, v16
  v_lshlrev_b32 v19, 3, v19
  v_lshl_add_u32 v19, v17, 7, v19
  v_lshl_add_u32 v19, v18, 11, v19
  v_lshrrev_b32 v17, 1, v17
  s_lshl_b32 s43, s55, 13
  v_xor_b32 v18, 0, v17
  v_lshl_add_u32 v18, v18, 5, v19
  v_add_u32 v8, s43, v18
  v_xor_b32 v18, 1, v17
  v_lshl_add_u32 v18, v18, 5, v19
  v_add_u32 v9, s43, v18
  v_xor_b32 v18, 2, v17
  v_lshl_add_u32 v18, v18, 5, v19
  v_add_u32 v10, s43, v18
  v_xor_b32 v18, 3, v17
  v_lshl_add_u32 v18, v18, 5, v19
  v_add_u32 v11, s43, v18
  v_mov_b32 v15, 1
  v_mov_b32 v17, 0x40000000
  v_cmp_eq_u32 vcc, 0, v0
  s_nop 1
  v_cndmask_b32_e64 v14, v17, 0, vcc
  s_lshl_b32 s50, s41, 20
  s_lshl_b32 s43, s42, 17
  s_add_u32 s50, s50, s43
  s_lshl_b32 s43, s54, 16
  s_add_u32 s50, s50, s43
  s_add_u32 s50, s50, 0x400000
  s_lshl_b32 s43, s55, 11
  s_add_u32 s51, s50, s43
  s_lshl_b32 s43, s55, 13
  s_add_u32 s52, s50, s43
  s_add_u32 s52, s52, 0x4000
  v_lshlrev_b32 v18, 3, v1
  v_cmp_gt_u32 vcc, 8, v16
  s_nop 1
  v_cndmask_b32 v28, v17, v18, vcc
  v_lshlrev_b32 v18, 8, v0
  v_cmp_gt_u32 vcc, 7, v0
  s_nop 1
  v_cndmask_b32 v18, v17, v18, vcc
  v_mov_b32 v17, 0
  s_mul_i32 s43, s2, 1792
  s_add_u32 s43, s43, 0x5400000
  s_cmp_lt_u32 s2, 8
  s_cselect_b32 s43, s43, 0x40000000
  buffer_store_dword v17, v18, s[28:31], s43 offen sc1
  s_sub_u32 s43, 15, s42
  s_cmp_lt_u32 s41, 16
  s_cselect_b32 s43, s43, s42
  s_lshl_b32 s43, s43, 4
  s_and_b32 s44, s41, 15
  s_add_u32 s63, s43, s44
  s_lshl_b32 s43, s63, 3
  s_lshl_b32 s44, s40, 1
  s_add_u32 s62, s43, s44
  v_lshrrev_b32 v18, 5, v16
  v_add_u32 v18, s62, v18
  v_mul_u32_u24 v21, 1280, v18
  v_and_b32 v18, 31, v16
  v_lshl_add_u32 v21, v18, 4, v21
  s_mov_b32 s60, 0xffff
  s_mov_b32 s61, 0xffff
  v_mov_b32 v18, 0x40000000
  v_cndmask_b32 v22, v18, v21, s[60:61]
  s_add_u32 m0, s49, 0x0
  s_add_u32 s57, s47, 0x0
  buffer_load_dwordx4 v4, s[12:15], s57 offen lds
  s_add_u32 m0, s49, 0x400
  s_add_u32 s58, s47, 0x8000
  buffer_load_dwordx4 v4, s[12:15], s58 offen lds
  s_add_u32 m0, s49, 0x800
  s_add_u32 s59, s47, 0x20000
  buffer_load_dwordx4 v4, s[12:15], s59 offen lds
  s_add_u32 m0, s49, 0xc00
  s_add_u32 s56, s47, 0x28000
  buffer_load_dwordx4 v4, s[12:15], s56 offen lds
  s_add_u32 m0, s49, 0x1000
  s_add_u32 s57, s47, 0x40000
  buffer_load_dwordx4 v4, s[12:15], s57 offen lds
  s_add_u32 m0, s49, 0x1400
  s_add_u32 s58, s47, 0x48000
  buffer_load_dwordx4 v4, s[12:15], s58 offen lds
  s_add_u32 m0, s49, 0x1800
  s_add_u32 s59, s47, 0x60000
  buffer_load_dwordx4 v4, s[12:15], s59 offen lds
  s_add_u32 m0, s49, 0x1c00
  s_add_u32 s56, s47, 0x68000
  buffer_load_dwordx4 v4, s[12:15], s56 offen lds
  s_add_u32 m0, s48, 0x0
  s_add_u32 s57, s46, 0x0
  buffer_load_dwordx4 v2, s[8:11], s57 offen lds
  s_add_u32 m0, s48, 0x400
  s_add_u32 s58, s46, 0x2000
  buffer_load_dwordx4 v3, s[8:11], s58 offen lds
  s_add_u32 m0, s48, 0x800
  s_add_u32 s59, s46, 0x4000
  buffer_load_dwordx4 v2, s[8:11], s59 offen lds
  s_add_u32 m0, s48, 0xc00
  s_add_u32 s56, s46, 0x6000
  buffer_load_dwordx4 v3, s[8:11], s56 offen lds
  s_add_u32 m0, s48, 0x1000
  s_add_u32 s57, s46, 0x8000
  buffer_load_dwordx4 v2, s[8:11], s57 offen lds
  s_add_u32 m0, s48, 0x1400
  s_add_u32 s58, s46, 0xa000
  buffer_load_dwordx4 v3, s[8:11], s58 offen lds
  s_add_u32 m0, s48, 0x1800
  s_add_u32 s59, s46, 0xc000
  buffer_load_dwordx4 v2, s[8:11], s59 offen lds
  s_add_u32 m0, s48, 0x1c00
  s_add_u32 s56, s46, 0xe000
  buffer_load_dwordx4 v3, s[8:11], s56 offen lds
  s_add_u32 m0, s49, 0x8000
  s_add_u32 s57, s47, 0x80000
  buffer_load_dwordx4 v4, s[12:15], s57 offen lds
  s_add_u32 m0, s49, 0x8400
  s_add_u32 s58, s47, 0x88000
  buffer_load_dwordx4 v4, s[12:15], s58 offen lds
  s_add_u32 m0, s49, 0x8800
  s_add_u32 s59, s47, 0xa0000
  buffer_load_dwordx4 v4, s[12:15], s59 offen lds
  s_add_u32 m0, s49, 0x8c00
  s_add_u32 s56, s47, 0xa8000
  buffer_load_dwordx4 v4, s[12:15], s56 offen lds
  s_add_u32 m0, s49, 0x9000
  s_add_u32 s57, s47, 0xc0000
  buffer_load_dwordx4 v4, s[12:15], s57 offen lds
  s_add_u32 m0, s49, 0x9400
  s_add_u32 s58, s47, 0xc8000
  buffer_load_dwordx4 v4, s[12:15], s58 offen lds
  s_add_u32 m0, s49, 0x9800
  s_add_u32 s59, s47, 0xe0000
  buffer_load_dwordx4 v4, s[12:15], s59 offen lds
  s_add_u32 m0, s49, 0x9c00
  s_add_u32 s56, s47, 0xe8000
  buffer_load_dwordx4 v4, s[12:15], s56 offen lds
  s_waitcnt vmcnt(8) lgkmcnt(0)
  s_barrier
  ds_read_b64_tr_b16 a[32:33], v8
  ds_read_b64_tr_b16 a[34:35], v8 offset:1024
  ds_read_b64_tr_b16 a[36:37], v8 offset:4096
  ds_read_b64_tr_b16 a[38:39], v8 offset:5120
  ds_read_b64_tr_b16 a[40:41], v9
  ds_read_b64_tr_b16 a[42:43], v9 offset:1024
  ds_read_b64_tr_b16 a[44:45], v9 offset:4096
  ds_read_b64_tr_b16 a[46:47], v9 offset:5120
  ds_read_b64_tr_b16 a[48:49], v10
  ds_read_b64_tr_b16 a[50:51], v10 offset:1024
  ds_read_b64_tr_b16 a[52:53], v10 offset:4096
  ds_read_b64_tr_b16 a[54:55], v10 offset:5120
  ds_read_b64_tr_b16 a[56:57], v11
  ds_read_b64_tr_b16 a[58:59], v11 offset:1024
  ds_read_b64_tr_b16 a[60:61], v11 offset:4096
  ds_read_b64_tr_b16 a[62:63], v11 offset:5120
  ds_read_b64_tr_b16 a[64:65], v8 offset:16384
  ds_read_b64_tr_b16 a[66:67], v8 offset:17408
  ds_read_b64_tr_b16 a[68:69], v8 offset:20480
  ds_read_b64_tr_b16 a[70:71], v8 offset:21504
  ds_read_b64_tr_b16 a[72:73], v9 offset:16384
  ds_read_b64_tr_b16 a[74:75], v9 offset:17408
  ds_read_b64_tr_b16 a[76:77], v9 offset:20480
  ds_read_b64_tr_b16 a[78:79], v9 offset:21504
  ds_read_b64_tr_b16 a[80:81], v10 offset:16384
  ds_read_b64_tr_b16 a[82:83], v10 offset:17408
  ds_read_b64_tr_b16 a[84:85], v10 offset:20480
  ds_read_b64_tr_b16 a[86:87], v10 offset:21504
  ds_read_b64_tr_b16 a[88:89], v11 offset:16384
  ds_read_b64_tr_b16 a[90:91], v11 offset:17408
  ds_read_b64_tr_b16 a[92:93], v11 offset:20480
  ds_read_b64_tr_b16 a[94:95], v11 offset:21504
  s_waitcnt vmcnt(0) lgkmcnt(0)
  s_barrier
  ds_read_b128 a[160:163], v6
  s_waitcnt lgkmcnt(0)
  v_mfma_f32_16x16x32_bf16 a[0:3], a[32:35], a[160:163], 0
  s_add_u32 m0, s48, 0x8000
  ds_read_b128 a[164:167], v7
  ds_read_b128 a[168:171], v6 offset:2048
  s_waitcnt lgkmcnt(1)
  v_mfma_f32_16x16x32_bf16 a[0:3], a[36:39], a[164:167], a[0:3]
  s_add_u32 s57, s46, 0x80
  buffer_load_dwordx4 v2, s[8:11], s57 offen lds
  v_mfma_f32_16x16x32_bf16 a[4:7], a[40:43], a[160:163], 0
  s_add_u32 m0, s48, 0x8400
  ds_read_b128 a[172:175], v7 offset:2048
  ds_read_b128 a[176:179], v6 offset:4096
  v_mfma_f32_16x16x32_bf16 a[4:7], a[44:47], a[164:167], a[4:7]
  s_add_u32 s58, s46, 0x2080
  buffer_load_dwordx4 v3, s[8:11], s58 offen lds
  v_mfma_f32_16x16x32_bf16 a[8:11], a[48:51], a[160:163], 0
  s_add_u32 m0, s48, 0x8800
  ds_read_b128 a[180:183], v7 offset:4096
  v_mov_b32 v31, 0
  v_mfma_f32_16x16x32_bf16 a[8:11], a[52:55], a[164:167], a[8:11]
  s_add_u32 s59, s46, 0x4080
  v_add_u32 v13, 4096, v1
  v_mfma_f32_16x16x32_bf16 a[12:15], a[56:59], a[160:163], 0
  s_sub_u32 s76, 15, s42
  buffer_load_dwordx4 v2, s[8:11], s59 offen lds
  v_mfma_f32_16x16x32_bf16 a[12:15], a[60:63], a[164:167], a[12:15]
  s_add_u32 m0, s48, 0x8c00
  v_mfma_f32_16x16x32_bf16 a[16:19], a[160:163], a[64:67], 0
  s_add_u32 s56, s46, 0x6080
  v_mfma_f32_16x16x32_bf16 a[16:19], a[164:167], a[68:71], a[16:19]
  s_and_b32 s43, s2, 1
  s_cselect_b32 s76, s76, s42
  buffer_load_dwordx4 v3, s[8:11], s56 offen lds
  v_mfma_f32_16x16x32_bf16 a[20:23], a[160:163], a[72:75], 0
  s_add_u32 m0, s48, 0x9000
  v_mfma_f32_16x16x32_bf16 a[20:23], a[164:167], a[76:79], a[20:23]
  s_add_u32 s57, s46, 0x8080
  v_mfma_f32_16x16x32_bf16 a[24:27], a[160:163], a[80:83], 0
  s_lshl_b32 s68, s76, 1
  buffer_load_dwordx4 v2, s[8:11], s57 offen lds
  v_mfma_f32_16x16x32_bf16 a[24:27], a[164:167], a[84:87], a[24:27]
  s_add_u32 m0, s48, 0x9400
  v_mfma_f32_16x16x32_bf16 a[28:31], a[160:163], a[88:91], 0
  s_add_u32 s58, s46, 0xa080
  ds_read_b128 a[160:163], v6 offset:6144
  v_mfma_f32_16x16x32_bf16 a[28:31], a[164:167], a[92:95], a[28:31]
  s_waitcnt lgkmcnt(1)
  buffer_load_dwordx4 v3, s[8:11], s58 offen lds
  v_mfma_f32_16x16x32_bf16 v[32:35], a[32:35], a[168:171], 0
  s_add_u32 m0, s48, 0x9800
  ds_read_b128 a[164:167], v7 offset:6144
  ds_read_b64_tr_b16 a[96:97], v8 offset:32768
  v_mfma_f32_16x16x32_bf16 v[32:35], a[36:39], a[172:175], v[32:35]
  s_add_u32 s59, s46, 0xc080
  v_mfma_f32_16x16x32_bf16 v[36:39], a[40:43], a[168:171], 0
  s_lshr_b32 s43, s40, 1
  buffer_load_dwordx4 v2, s[8:11], s59 offen lds
  v_mfma_f32_16x16x32_bf16 v[36:39], a[44:47], a[172:175], v[36:39]
  s_add_u32 m0, s48, 0x9c00
  ds_read_b64_tr_b16 a[98:99], v8 offset:33792
  v_mfma_f32_16x16x32_bf16 v[40:43], a[48:51], a[168:171], 0
  s_add_u32 s56, s46, 0xe080
  v_mfma_f32_16x16x32_bf16 v[40:43], a[52:55], a[172:175], v[40:43]
  s_add_u32 s68, s68, s43
  buffer_load_dwordx4 v3, s[8:11], s56 offen lds
  v_mfma_f32_16x16x32_bf16 v[44:47], a[56:59], a[168:171], 0
  s_add_u32 m0, s49, 0x0
  ds_read_b64_tr_b16 a[100:101], v8 offset:36864
  v_mfma_f32_16x16x32_bf16 v[44:47], a[60:63], a[172:175], v[44:47]
  s_add_u32 s57, s47, 0x100000
  v_mfma_f32_16x16x32_bf16 v[48:51], a[168:171], a[64:67], 0
  s_mul_i32 s68, s68, 364
  buffer_load_dwordx4 v4, s[12:15], s57 offen lds
  v_mfma_f32_16x16x32_bf16 v[48:51], a[172:175], a[68:71], v[48:51]
  s_add_u32 m0, s49, 0x400
  ds_read_b64_tr_b16 a[102:103], v8 offset:37888
  v_mfma_f32_16x16x32_bf16 v[52:55], a[168:171], a[72:75], 0
  s_add_u32 s58, s47, 0x108000
  v_mfma_f32_16x16x32_bf16 v[52:55], a[172:175], a[76:79], v[52:55]
  s_and_b32 s43, s40, 1
  buffer_load_dwordx4 v4, s[12:15], s58 offen lds
  v_mfma_f32_16x16x32_bf16 v[56:59], a[168:171], a[80:83], 0
  s_add_u32 m0, s49, 0x800
  ds_read_b64_tr_b16 a[104:105], v9 offset:32768
  v_mfma_f32_16x16x32_bf16 v[56:59], a[172:175], a[84:87], v[56:59]
  s_add_u32 s59, s47, 0x120000
  v_mfma_f32_16x16x32_bf16 v[60:63], a[168:171], a[88:91], 0
  s_bfe_u32 s77, s2, 0x20003
  buffer_load_dwordx4 v4, s[12:15], s59 offen lds
  v_mfma_f32_16x16x32_bf16 v[60:63], a[172:175], a[92:95], v[60:63]
  s_add_u32 m0, s49, 0xc00
  ds_read_b128 a[168:171], v6 offset:8192
  ds_read_b128 a[172:175], v7 offset:8192
  v_mfma_f32_16x16x32_bf16 v[64:67], a[32:35], a[176:179], 0
  s_add_u32 s56, s47, 0x128000
  ds_read_b64_tr_b16 a[106:107], v9 offset:33792
  v_mfma_f32_16x16x32_bf16 v[64:67], a[36:39], a[180:183], v[64:67]
  s_add_u32 s68, s68, s43
  buffer_load_dwordx4 v4, s[12:15], s56 offen lds
  v_mfma_f32_16x16x32_bf16 v[68:71], a[40:43], a[176:179], 0
  s_add_u32 m0, s49, 0x1000
  ds_read_b64_tr_b16 a[108:109], v9 offset:36864
  v_mfma_f32_16x16x32_bf16 v[68:71], a[44:47], a[180:183], v[68:71]
  s_add_u32 s57, s47, 0x140000
  v_mfma_f32_16x16x32_bf16 v[72:75], a[48:51], a[176:179], 0
  s_mul_i32 s69, s40, 20480
  buffer_load_dwordx4 v4, s[12:15], s57 offen lds
  v_mfma_f32_16x16x32_bf16 v[72:75], a[52:55], a[180:183], v[72:75]
  s_add_u32 m0, s49, 0x1400
  ds_read_b64_tr_b16 a[110:111], v9 offset:37888
  v_mfma_f32_16x16x32_bf16 v[76:79], a[56:59], a[176:179], 0
  s_add_u32 s58, s47, 0x148000
  v_mfma_f32_16x16x32_bf16 v[76:79], a[60:63], a[180:183], v[76:79]
  s_cmp_lt_u32 s2, 8
  s_cselect_b32 s57, 0, 0x40000000
  buffer_load_dwordx4 v4, s[12:15], s58 offen lds
  v_mfma_f32_16x16x32_bf16 v[80:83], a[176:179], a[64:67], 0
  s_add_u32 m0, s49, 0x1800
  ds_read_b64_tr_b16 a[112:113], v10 offset:32768
  v_mfma_f32_16x16x32_bf16 v[80:83], a[180:183], a[68:71], v[80:83]
  s_add_u32 s59, s47, 0x160000
  v_mfma_f32_16x16x32_bf16 v[84:87], a[176:179], a[72:75], 0
  s_mul_i32 s43, s77, 320
  buffer_load_dwordx4 v4, s[12:15], s59 offen lds
  v_mfma_f32_16x16x32_bf16 v[84:87], a[180:183], a[76:79], v[84:87]
  s_add_u32 m0, s49, 0x1c00
  ds_read_b64_tr_b16 a[114:115], v10 offset:33792
  v_mfma_f32_16x16x32_bf16 v[88:91], a[176:179], a[80:83], 0
  s_add_u32 s56, s47, 0x168000
  v_mfma_f32_16x16x32_bf16 v[88:91], a[180:183], a[84:87], v[88:91]
  s_add_u32 s69, s69, s43
  buffer_load_dwordx4 v4, s[12:15], s56 offen lds
  v_mfma_f32_16x16x32_bf16 v[92:95], a[176:179], a[88:91], 0
  s_and_b32 s43, s77, 1
  ds_read_b128 a[176:179], v6 offset:10240
  ds_read_b64_tr_b16 a[116:117], v10 offset:36864
  v_mfma_f32_16x16x32_bf16 v[92:95], a[180:183], a[92:95], v[92:95]
  s_waitcnt lgkmcnt(3)
  ds_read_b128 a[180:183], v7 offset:10240
  v_mfma_f32_16x16x32_bf16 v[96:99], a[32:35], a[160:163], 0
  s_lshl_b32 s80, s43, 6
  v_mfma_f32_16x16x32_bf16 v[96:99], a[36:39], a[164:167], v[96:99]
  s_add_u32 s69, s69, s80
  ds_read_b64_tr_b16 a[118:119], v10 offset:37888
  v_mfma_f32_16x16x32_bf16 v[100:103], a[40:43], a[160:163], 0
  s_mul_i32 s43, s43, 320
  v_mfma_f32_16x16x32_bf16 v[100:103], a[44:47], a[164:167], v[100:103]
  s_sub_u32 s80, 256, s43
  v_mfma_f32_16x16x32_bf16 v[104:107], a[48:51], a[160:163], 0
  s_lshl_b32 s43, s40, 5
  ds_read_b64_tr_b16 a[120:121], v11 offset:32768
  v_mfma_f32_16x16x32_bf16 v[104:107], a[52:55], a[164:167], v[104:107]
  s_add_u32 s43, s43, 0x20000
  v_mfma_f32_16x16x32_bf16 v[108:111], a[56:59], a[160:163], 0
  s_bfe_u32 s44, s63, 0x20001
  v_mfma_f32_16x16x32_bf16 v[108:111], a[60:63], a[164:167], v[108:111]
  s_lshl_b32 s82, s41, 8
  ds_read_b64_tr_b16 a[122:123], v11 offset:33792
  v_mfma_f32_16x16x32_bf16 v[112:115], a[160:163], a[64:67], 0
  s_mul_i32 s83, s40, 55296
  buffer_load_dwordx4 a[216:219], v21, s[4:7], 0 offen
  v_mfma_f32_16x16x32_bf16 v[112:115], a[164:167], a[68:71], v[112:115]
  s_lshl_b32 s64, s42, 8
  buffer_load_dwordx4 a[220:223], v21, s[4:7], 0 offen offset:512
  v_mfma_f32_16x16x32_bf16 v[116:119], a[160:163], a[72:75], 0
  s_add_u32 s64, s64, 0x5403000
  buffer_load_dwordx4 a[224:227], v22, s[4:7], 0 offen offset:1024
  v_mfma_f32_16x16x32_bf16 v[116:119], a[164:167], a[76:79], v[116:119]
  s_lshl_b32 s86, s40, 12
  ds_read_b64_tr_b16 a[124:125], v11 offset:36864
  v_mfma_f32_16x16x32_bf16 v[120:123], a[160:163], a[80:83], 0
  s_lshl_b32 s87, s40, 11
  v_mfma_f32_16x16x32_bf16 v[120:123], a[164:167], a[84:87], v[120:123]
  s_lshl_b32 s53, s41, 8
  ds_read_b64_tr_b16 a[126:127], v11 offset:37888
  v_mfma_f32_16x16x32_bf16 v[124:127], a[160:163], a[88:91], 0
  s_add_u32 s53, s53, 0x5400000
  ds_read_b128 a[160:163], v6 offset:12288
  v_mfma_f32_16x16x32_bf16 v[124:127], a[164:167], a[92:95], v[124:127]
  s_bfe_u32 s72, s2, 0x20001
  ds_read_b128 a[164:167], v7 offset:12288
  v_mfma_f32_16x16x32_bf16 v[128:131], a[32:35], a[168:171], 0
  s_lshl_b32 s68, s68, 11
  ds_read_b64_tr_b16 a[128:129], v8 offset:49152
  v_mfma_f32_16x16x32_bf16 v[128:131], a[36:39], a[172:175], v[128:131]
  s_add_u32 s68, s68, 0x2400000
  v_mfma_f32_16x16x32_bf16 v[132:135], a[40:43], a[168:171], 0
  s_lshl_b32 s74, s76, 2
  v_mfma_f32_16x16x32_bf16 v[132:135], a[44:47], a[172:175], v[132:135]
  s_add_u32 s74, s74, s77
  ds_read_b64_tr_b16 a[130:131], v8 offset:50176
  v_mfma_f32_16x16x32_bf16 v[136:139], a[48:51], a[168:171], 0
  s_lshl_b32 s75, s74, 17
  v_mfma_f32_16x16x32_bf16 v[136:139], a[52:55], a[172:175], v[136:139]
  s_add_u32 s75, s75, 0x3c00000
  v_mfma_f32_16x16x32_bf16 v[140:143], a[56:59], a[168:171], 0
  s_lshl_b32 s74, s72, 15
  ds_read_b64_tr_b16 a[132:133], v8 offset:53248
  v_mfma_f32_16x16x32_bf16 v[140:143], a[60:63], a[172:175], v[140:143]
  s_add_u32 s74, s74, s75
  v_mfma_f32_16x16x32_bf16 v[144:147], a[168:171], a[64:67], 0
  s_lshl_b32 s73, s42, 8
  v_mfma_f32_16x16x32_bf16 v[144:147], a[172:175], a[68:71], v[144:147]
  s_add_u32 s73, s73, 0x5402800
  ds_read_b64_tr_b16 a[134:135], v8 offset:54272
  v_mfma_f32_16x16x32_bf16 v[148:151], a[168:171], a[72:75], 0
  s_mul_i32 s71, s40, 5120
  v_mfma_f32_16x16x32_bf16 v[148:151], a[172:175], a[76:79], v[148:151]
  s_mov_b32 s92, 1
  v_mfma_f32_16x16x32_bf16 v[152:155], a[168:171], a[80:83], 0
  ds_read_b64_tr_b16 a[136:137], v9 offset:49152
  v_mfma_f32_16x16x32_bf16 v[152:155], a[172:175], a[84:87], v[152:155]
  v_mfma_f32_16x16x32_bf16 v[156:159], a[168:171], a[88:91], 0
  ds_read_b128 a[168:171], v6 offset:14336
  v_mfma_f32_16x16x32_bf16 v[156:159], a[172:175], a[92:95], v[156:159]
  s_waitcnt lgkmcnt(3)
  ds_read_b128 a[172:175], v7 offset:14336
  ds_read_b64_tr_b16 a[138:139], v9 offset:50176
  v_mfma_f32_16x16x32_bf16 v[160:163], a[32:35], a[176:179], 0
  v_mfma_f32_16x16x32_bf16 v[160:163], a[36:39], a[180:183], v[160:163]
  v_mfma_f32_16x16x32_bf16 v[164:167], a[40:43], a[176:179], 0
  ds_read_b64_tr_b16 a[140:141], v9 offset:53248
  v_mfma_f32_16x16x32_bf16 v[164:167], a[44:47], a[180:183], v[164:167]
  v_mfma_f32_16x16x32_bf16 v[168:171], a[48:51], a[176:179], 0
  v_mfma_f32_16x16x32_bf16 v[168:171], a[52:55], a[180:183], v[168:171]
  ds_read_b64_tr_b16 a[142:143], v9 offset:54272
  v_mfma_f32_16x16x32_bf16 v[172:175], a[56:59], a[176:179], 0
  v_mfma_f32_16x16x32_bf16 v[172:175], a[60:63], a[180:183], v[172:175]
  v_mfma_f32_16x16x32_bf16 v[176:179], a[176:179], a[64:67], 0
  ds_read_b64_tr_b16 a[144:145], v10 offset:49152
  v_mfma_f32_16x16x32_bf16 v[176:179], a[180:183], a[68:71], v[176:179]
  v_mfma_f32_16x16x32_bf16 v[180:183], a[176:179], a[72:75], 0
  v_mfma_f32_16x16x32_bf16 v[180:183], a[180:183], a[76:79], v[180:183]
  ds_read_b64_tr_b16 a[146:147], v10 offset:50176
  v_mfma_f32_16x16x32_bf16 v[184:187], a[176:179], a[80:83], 0
  v_mfma_f32_16x16x32_bf16 v[184:187], a[180:183], a[84:87], v[184:187]
  v_mfma_f32_16x16x32_bf16 v[188:191], a[176:179], a[88:91], 0
  ds_read_b64_tr_b16 a[148:149], v10 offset:53248
  v_mfma_f32_16x16x32_bf16 v[188:191], a[180:183], a[92:95], v[188:191]
  v_mfma_f32_16x16x32_bf16 v[192:195], a[32:35], a[160:163], 0
  v_mfma_f32_16x16x32_bf16 v[192:195], a[36:39], a[164:167], v[192:195]
  ds_read_b64_tr_b16 a[150:151], v10 offset:54272
  v_mfma_f32_16x16x32_bf16 v[196:199], a[40:43], a[160:163], 0
  v_mfma_f32_16x16x32_bf16 v[196:199], a[44:47], a[164:167], v[196:199]
  v_mfma_f32_16x16x32_bf16 v[200:203], a[48:51], a[160:163], 0
  ds_read_b64_tr_b16 a[152:153], v11 offset:49152
  v_mfma_f32_16x16x32_bf16 v[200:203], a[52:55], a[164:167], v[200:203]
  v_mfma_f32_16x16x32_bf16 v[204:207], a[56:59], a[160:163], 0
  v_mfma_f32_16x16x32_bf16 v[204:207], a[60:63], a[164:167], v[204:207]
  ds_read_b64_tr_b16 a[154:155], v11 offset:50176
  v_mfma_f32_16x16x32_bf16 v[208:211], a[160:163], a[64:67], 0
  v_mfma_f32_16x16x32_bf16 v[208:211], a[164:167], a[68:71], v[208:211]
  v_mfma_f32_16x16x32_bf16 v[212:215], a[160:163], a[72:75], 0
  ds_read_b64_tr_b16 a[156:157], v11 offset:53248
  v_mfma_f32_16x16x32_bf16 v[212:215], a[164:167], a[76:79], v[212:215]
  v_mfma_f32_16x16x32_bf16 v[216:219], a[160:163], a[80:83], 0
  v_mfma_f32_16x16x32_bf16 v[216:219], a[164:167], a[84:87], v[216:219]
  ds_read_b64_tr_b16 a[158:159], v11 offset:54272
  v_mfma_f32_16x16x32_bf16 v[220:223], a[160:163], a[88:91], 0
  s_add_u32 m0, s48, 0x0
  v_mfma_f32_16x16x32_bf16 v[220:223], a[164:167], a[92:95], v[220:223]
  s_waitcnt vmcnt(3) lgkmcnt(0)
  s_barrier
  v_mfma_f32_16x16x32_bf16 v[224:227], a[32:35], a[168:171], 0
  s_add_u32 s58, s46, 0x100
  buffer_atomic_add v15, v14, s[36:39], s57 offen sc1
  v_mfma_f32_16x16x32_bf16 v[224:227], a[36:39], a[172:175], v[224:227]
  s_add_u32 s59, s46, 0x2100
  buffer_load_dwordx4 v2, s[8:11], s58 offen lds
  v_mfma_f32_16x16x32_bf16 v[228:231], a[40:43], a[168:171], 0
  s_add_u32 m0, s48, 0x400
  ds_read_b128 a[176:179], v6 offset:32768
  ds_read_b128 a[180:183], v7 offset:32768
  v_mfma_f32_16x16x32_bf16 v[228:231], a[44:47], a[172:175], v[228:231]
  buffer_load_dwordx4 v3, s[8:11], s59 offen lds
  v_mfma_f32_16x16x32_bf16 v[232:235], a[48:51], a[168:171], 0
  s_add_u32 m0, s48, 0x800
  ds_read_b128 a[160:163], v6 offset:34816
  ds_read_b128 a[164:167], v7 offset:34816
  v_mfma_f32_16x16x32_bf16 v[232:235], a[52:55], a[172:175], v[232:235]
  s_add_u32 s56, s46, 0x4100
  v_mfma_f32_16x16x32_bf16 v[236:239], a[56:59], a[168:171], 0
  buffer_load_dwordx4 v2, s[8:11], s56 offen lds
  v_mfma_f32_16x16x32_bf16 v[236:239], a[60:63], a[172:175], v[236:239]
  s_add_u32 m0, s48, 0xc00
  v_mfma_f32_16x16x32_bf16 v[240:243], a[168:171], a[64:67], 0
  s_add_u32 s57, s46, 0x6100
  v_mfma_f32_16x16x32_bf16 v[240:243], a[172:175], a[68:71], v[240:243]
  buffer_load_dwordx4 v3, s[8:11], s57 offen lds
  v_mfma_f32_16x16x32_bf16 v[244:247], a[168:171], a[72:75], 0
  s_add_u32 m0, s48, 0x1000
  v_mfma_f32_16x16x32_bf16 v[244:247], a[172:175], a[76:79], v[244:247]
  s_add_u32 s58, s46, 0x8100
  v_mfma_f32_16x16x32_bf16 v[248:251], a[168:171], a[80:83], 0
  buffer_load_dwordx4 v2, s[8:11], s58 offen lds
  v_mfma_f32_16x16x32_bf16 v[248:251], a[172:175], a[84:87], v[248:251]
  s_add_u32 m0, s48, 0x1400
  v_mfma_f32_16x16x32_bf16 v[252:255], a[168:171], a[88:91], 0
  s_add_u32 s59, s46, 0xa100
  ds_read_b128 a[168:171], v6 offset:36864
  v_mfma_f32_16x16x32_bf16 v[252:255], a[172:175], a[92:95], v[252:255]
  s_waitcnt lgkmcnt(1)
  buffer_load_dwordx4 v3, s[8:11], s59 offen lds
  v_mfma_f32_16x16x32_bf16 a[0:3], a[96:99], a[176:179], a[0:3]
  s_add_u32 m0, s48, 0x1800
  ds_read_b128 a[172:175], v7 offset:36864
  ds_read_b64_tr_b16 a[32:33], v8
  v_mfma_f32_16x16x32_bf16 a[0:3], a[100:103], a[180:183], a[0:3]
  s_add_u32 s56, s46, 0xc100
  v_mfma_f32_16x16x32_bf16 a[4:7], a[104:107], a[176:179], a[4:7]
  buffer_load_dwordx4 v2, s[8:11], s56 offen lds
  v_mfma_f32_16x16x32_bf16 a[4:7], a[108:111], a[180:183], a[4:7]
  s_add_u32 m0, s48, 0x1c00
  ds_read_b64_tr_b16 a[34:35], v8 offset:1024
  v_mfma_f32_16x16x32_bf16 a[8:11], a[112:115], a[176:179], a[8:11]
  s_add_u32 s57, s46, 0xe100
  v_mfma_f32_16x16x32_bf16 a[8:11], a[116:119], a[180:183], a[8:11]
  buffer_load_dwordx4 v3, s[8:11], s57 offen lds
  v_mfma_f32_16x16x32_bf16 a[12:15], a[120:123], a[176:179], a[12:15]
  s_add_u32 m0, s49, 0x8000
  ds_read_b64_tr_b16 a[36:37], v8 offset:4096
  v_mfma_f32_16x16x32_bf16 a[12:15], a[124:127], a[180:183], a[12:15]
  s_add_u32 s58, s47, 0x180000
  v_mfma_f32_16x16x32_bf16 a[16:19], a[176:179], a[128:131], a[16:19]
  buffer_load_dwordx4 v4, s[12:15], s58 offen lds
  v_mfma_f32_16x16x32_bf16 a[16:19], a[180:183], a[132:135], a[16:19]
  s_add_u32 m0, s49, 0x8400
  ds_read_b64_tr_b16 a[38:39], v8 offset:5120
  v_mfma_f32_16x16x32_bf16 a[20:23], a[176:179], a[136:139], a[20:23]
  s_add_u32 s59, s47, 0x188000
  v_mfma_f32_16x16x32_bf16 a[20:23], a[180:183], a[140:143], a[20:23]
  buffer_load_dwordx4 v4, s[12:15], s59 offen lds
  v_mfma_f32_16x16x32_bf16 a[24:27], a[176:179], a[144:147], a[24:27]
  s_add_u32 m0, s49, 0x8800
  ds_read_b64_tr_b16 a[40:41], v9
  v_mfma_f32_16x16x32_bf16 a[24:27], a[180:183], a[148:151], a[24:27]
  s_add_u32 s56, s47, 0x1a0000
  v_mfma_f32_16x16x32_bf16 a[28:31], a[176:179], a[152:155], a[28:31]
  buffer_load_dwordx4 v4, s[12:15], s56 offen lds
  v_mfma_f32_16x16x32_bf16 a[28:31], a[180:183], a[156:159], a[28:31]
  s_add_u32 m0, s49, 0x8c00
  ds_read_b128 a[176:179], v6 offset:38912
  ds_read_b128 a[180:183], v7 offset:38912
  v_mfma_f32_16x16x32_bf16 v[32:35], a[96:99], a[160:163], v[32:35]
  s_add_u32 s57, s47, 0x1a8000
  ds_read_b64_tr_b16 a[42:43], v9 offset:1024
  v_mfma_f32_16x16x32_bf16 v[32:35], a[100:103], a[164:167], v[32:35]
  buffer_load_dwordx4 v4, s[12:15], s57 offen lds
  v_mfma_f32_16x16x32_bf16 v[36:39], a[104:107], a[160:163], v[36:39]
  s_add_u32 m0, s49, 0x9000
  ds_read_b64_tr_b16 a[44:45], v9 offset:4096
  v_mfma_f32_16x16x32_bf16 v[36:39], a[108:111], a[164:167], v[36:39]
  s_add_u32 s58, s47, 0x1c0000
  v_mfma_f32_16x16x32_bf16 v[40:43], a[112:115], a[160:163], v[40:43]
  buffer_load_dwordx4 v4, s[12:15], s58 offen lds
  v_mfma_f32_16x16x32_bf16 v[40:43], a[116:119], a[164:167], v[40:43]
  s_add_u32 m0, s49, 0x9400
  ds_read_b64_tr_b16 a[46:47], v9 offset:5120
  v_mfma_f32_16x16x32_bf16 v[44:47], a[120:123], a[160:163], v[44:47]
  s_add_u32 s59, s47, 0x1c8000
  v_mfma_f32_16x16x32_bf16 v[44:47], a[124:127], a[164:167], v[44:47]
  s_mov_b32 s58, 0x200000
  buffer_load_dwordx4 v4, s[12:15], s59 offen lds
  v_mfma_f32_16x16x32_bf16 v[48:51], a[160:163], a[128:131], v[48:51]
  s_add_u32 m0, s49, 0x9800
  ds_read_b64_tr_b16 a[48:49], v10
  v_mfma_f32_16x16x32_bf16 v[48:51], a[164:167], a[132:135], v[48:51]
  s_add_u32 s56, s47, 0x1e0000
  v_mfma_f32_16x16x32_bf16 v[52:55], a[160:163], a[136:139], v[52:55]
  buffer_load_dwordx4 v4, s[12:15], s56 offen lds
  v_mfma_f32_16x16x32_bf16 v[52:55], a[164:167], a[140:143], v[52:55]
  s_add_u32 m0, s49, 0x9c00
  ds_read_b64_tr_b16 a[50:51], v10 offset:1024
  v_mfma_f32_16x16x32_bf16 v[56:59], a[160:163], a[144:147], v[56:59]
  s_add_u32 s57, s47, 0x1e8000
  v_mfma_f32_16x16x32_bf16 v[56:59], a[164:167], a[148:151], v[56:59]
  buffer_load_dwordx4 v4, s[12:15], s57 offen lds
  v_mfma_f32_16x16x32_bf16 v[60:63], a[160:163], a[152:155], v[60:63]
  s_nop 0
  ds_read_b128 a[160:163], v6 offset:40960
  ds_read_b64_tr_b16 a[52:53], v10 offset:4096
  v_mfma_f32_16x16x32_bf16 v[60:63], a[164:167], a[156:159], v[60:63]
  s_waitcnt lgkmcnt(3)
  ds_read_b128 a[164:167], v7 offset:40960
  v_mfma_f32_16x16x32_bf16 v[64:67], a[96:99], a[168:171], v[64:67]
  v_mfma_f32_16x16x32_bf16 v[64:67], a[100:103], a[172:175], v[64:67]
  ds_read_b64_tr_b16 a[54:55], v10 offset:5120
  v_mfma_f32_16x16x32_bf16 v[68:71], a[104:107], a[168:171], v[68:71]
  v_mfma_f32_16x16x32_bf16 v[68:71], a[108:111], a[172:175], v[68:71]
  v_mfma_f32_16x16x32_bf16 v[72:75], a[112:115], a[168:171], v[72:75]
  ds_read_b64_tr_b16 a[56:57], v11
  v_mfma_f32_16x16x32_bf16 v[72:75], a[116:119], a[172:175], v[72:75]
  v_mfma_f32_16x16x32_bf16 v[76:79], a[120:123], a[168:171], v[76:79]
  v_mfma_f32_16x16x32_bf16 v[76:79], a[124:127], a[172:175], v[76:79]
  ds_read_b64_tr_b16 a[58:59], v11 offset:1024
  v_mfma_f32_16x16x32_bf16 v[80:83], a[168:171], a[128:131], v[80:83]
  buffer_load_dword a244, v25, s[12:15], s58 offen
  v_mfma_f32_16x16x32_bf16 v[80:83], a[172:175], a[132:135], v[80:83]
  buffer_load_dword a245, v24, s[8:11], 0 offen offset:512
  v_mfma_f32_16x16x32_bf16 v[84:87], a[168:171], a[136:139], v[84:87]
  ds_read_b64_tr_b16 a[60:61], v11 offset:4096
  v_mfma_f32_16x16x32_bf16 v[84:87], a[172:175], a[140:143], v[84:87]
  v_mfma_f32_16x16x32_bf16 v[88:91], a[168:171], a[144:147], v[88:91]
  v_mfma_f32_16x16x32_bf16 v[88:91], a[172:175], a[148:151], v[88:91]
  ds_read_b64_tr_b16 a[62:63], v11 offset:5120
  v_mfma_f32_16x16x32_bf16 v[92:95], a[168:171], a[152:155], v[92:95]
  ds_read_b128 a[168:171], v6 offset:43008
  v_mfma_f32_16x16x32_bf16 v[92:95], a[172:175], a[156:159], v[92:95]
  ds_read_b128 a[172:175], v7 offset:43008
  v_mfma_f32_16x16x32_bf16 v[96:99], a[96:99], a[176:179], v[96:99]
  ds_read_b64_tr_b16 a[64:65], v8 offset:16384
  v_mfma_f32_16x16x32_bf16 v[96:99], a[100:103], a[180:183], v[96:99]
  v_mfma_f32_16x16x32_bf16 v[100:103], a[104:107], a[176:179], v[100:103]
  v_mfma_f32_16x16x32_bf16 v[100:103], a[108:111], a[180:183], v[100:103]
  ds_read_b64_tr_b16 a[66:67], v8 offset:17408
  v_mfma_f32_16x16x32_bf16 v[104:107], a[112:115], a[176:179], v[104:107]
  v_mfma_f32_16x16x32_bf16 v[104:107], a[116:119], a[180:183], v[104:107]
  v_mfma_f32_16x16x32_bf16 v[108:111], a[120:123], a[176:179], v[108:111]
  ds_read_b64_tr_b16 a[68:69], v8 offset:20480
  v_mfma_f32_16x16x32_bf16 v[108:111], a[124:127], a[180:183], v[108:111]
  v_mfma_f32_16x16x32_bf16 v[112:115], a[176:179], a[128:131], v[112:115]
  v_mfma_f32_16x16x32_bf16 v[112:115], a[180:183], a[132:135], v[112:115]
  ds_read_b64_tr_b16 a[70:71], v8 offset:21504
  v_mfma_f32_16x16x32_bf16 v[116:119], a[176:179], a[136:139], v[116:119]
  v_mfma_f32_16x16x32_bf16 v[116:119], a[180:183], a[140:143], v[116:119]
  v_mfma_f32_16x16x32_bf16 v[120:123], a[176:179], a[144:147], v[120:123]
  ds_read_b64_tr_b16 a[72:73], v9 offset:16384
  v_mfma_f32_16x16x32_bf16 v[120:123], a[180:183], a[148:151], v[120:123]
  v_mfma_f32_16x16x32_bf16 v[124:127], a[176:179], a[152:155], v[124:127]
  ds_read_b128 a[176:179], v6 offset:45056
  v_mfma_f32_16x16x32_bf16 v[124:127], a[180:183], a[156:159], v[124:127]
  s_waitcnt lgkmcnt(3)
  ds_read_b128 a[180:183], v7 offset:45056
  ds_read_b64_tr_b16 a[74:75], v9 offset:17408
  v_mfma_f32_16x16x32_bf16 v[128:131], a[96:99], a[160:163], v[128:131]
  v_mfma_f32_16x16x32_bf16 v[128:131], a[100:103], a[164:167], v[128:131]
  v_mfma_f32_16x16x32_bf16 v[132:135], a[104:107], a[160:163], v[132:135]
  ds_read_b64_tr_b16 a[76:77], v9 offset:20480
  v_mfma_f32_16x16x32_bf16 v[132:135], a[108:111], a[164:167], v[132:135]
  v_mfma_f32_16x16x32_bf16 v[136:139], a[112:115], a[160:163], v[136:139]
  v_mfma_f32_16x16x32_bf16 v[136:139], a[116:119], a[164:167], v[136:139]
  ds_read_b64_tr_b16 a[78:79], v9 offset:21504
  v_mfma_f32_16x16x32_bf16 v[140:143], a[120:123], a[160:163], v[140:143]
  v_mfma_f32_16x16x32_bf16 v[140:143], a[124:127], a[164:167], v[140:143]
  v_mfma_f32_16x16x32_bf16 v[144:147], a[160:163], a[128:131], v[144:147]
  ds_read_b64_tr_b16 a[80:81], v10 offset:16384
  v_mfma_f32_16x16x32_bf16 v[144:147], a[164:167], a[132:135], v[144:147]
  v_mfma_f32_16x16x32_bf16 v[148:151], a[160:163], a[136:139], v[148:151]
  v_mfma_f32_16x16x32_bf16 v[148:151], a[164:167], a[140:143], v[148:151]
  ds_read_b64_tr_b16 a[82:83], v10 offset:17408
  v_mfma_f32_16x16x32_bf16 v[152:155], a[160:163], a[144:147], v[152:155]
  v_mfma_f32_16x16x32_bf16 v[152:155], a[164:167], a[148:151], v[152:155]
  v_mfma_f32_16x16x32_bf16 v[156:159], a[160:163], a[152:155], v[156:159]
  s_nop 0
  ds_read_b128 a[160:163], v6 offset:47104
  ds_read_b64_tr_b16 a[84:85], v10 offset:20480
  v_mfma_f32_16x16x32_bf16 v[156:159], a[164:167], a[156:159], v[156:159]
  ds_read_b128 a[164:167], v7 offset:47104
  v_mfma_f32_16x16x32_bf16 v[160:163], a[96:99], a[168:171], v[160:163]
  v_mfma_f32_16x16x32_bf16 v[160:163], a[100:103], a[172:175], v[160:163]
  ds_read_b64_tr_b16 a[86:87], v10 offset:21504
  v_mfma_f32_16x16x32_bf16 v[164:167], a[104:107], a[168:171], v[164:167]
  v_mfma_f32_16x16x32_bf16 v[164:167], a[108:111], a[172:175], v[164:167]
  v_mfma_f32_16x16x32_bf16 v[168:171], a[112:115], a[168:171], v[168:171]
  ds_read_b64_tr_b16 a[88:89], v11 offset:16384
  v_mfma_f32_16x16x32_bf16 v[168:171], a[116:119], a[172:175], v[168:171]
  v_mfma_f32_16x16x32_bf16 v[172:175], a[120:123], a[168:171], v[172:175]
  v_mfma_f32_16x16x32_bf16 v[172:175], a[124:127], a[172:175], v[172:175]
  ds_read_b64_tr_b16 a[90:91], v11 offset:17408
  v_mfma_f32_16x16x32_bf16 v[176:179], a[168:171], a[128:131], v[176:179]
  v_mfma_f32_16x16x32_bf16 v[176:179], a[172:175], a[132:135], v[176:179]
  v_mfma_f32_16x16x32_bf16 v[180:183], a[168:171], a[136:139], v[180:183]
  ds_read_b64_tr_b16 a[92:93], v11 offset:20480
  v_mfma_f32_16x16x32_bf16 v[180:183], a[172:175], a[140:143], v[180:183]
  v_mfma_f32_16x16x32_bf16 v[184:187], a[168:171], a[144:147], v[184:187]
  v_mfma_f32_16x16x32_bf16 v[184:187], a[172:175], a[148:151], v[184:187]
  ds_read_b64_tr_b16 a[94:95], v11 offset:21504
  v_mfma_f32_16x16x32_bf16 v[188:191], a[168:171], a[152:155], v[188:191]
  v_mfma_f32_16x16x32_bf16 v[188:191], a[172:175], a[156:159], v[188:191]
  s_waitcnt lgkmcnt(2)
  v_mfma_f32_16x16x32_bf16 v[192:195], a[96:99], a[176:179], v[192:195]
  v_mfma_f32_16x16x32_bf16 v[192:195], a[100:103], a[180:183], v[192:195]
  v_mfma_f32_16x16x32_bf16 v[196:199], a[104:107], a[176:179], v[196:199]
  v_mfma_f32_16x16x32_bf16 v[196:199], a[108:111], a[180:183], v[196:199]
  v_mfma_f32_16x16x32_bf16 v[200:203], a[112:115], a[176:179], v[200:203]
  v_mfma_f32_16x16x32_bf16 v[200:203], a[116:119], a[180:183], v[200:203]
  v_mfma_f32_16x16x32_bf16 v[204:207], a[120:123], a[176:179], v[204:207]
  v_mfma_f32_16x16x32_bf16 v[204:207], a[124:127], a[180:183], v[204:207]
  v_mfma_f32_16x16x32_bf16 v[208:211], a[176:179], a[128:131], v[208:211]
  v_mfma_f32_16x16x32_bf16 v[208:211], a[180:183], a[132:135], v[208:211]
  v_mfma_f32_16x16x32_bf16 v[212:215], a[176:179], a[136:139], v[212:215]
  v_mfma_f32_16x16x32_bf16 v[212:215], a[180:183], a[140:143], v[212:215]
  v_mfma_f32_16x16x32_bf16 v[216:219], a[176:179], a[144:147], v[216:219]
  v_mfma_f32_16x16x32_bf16 v[216:219], a[180:183], a[148:151], v[216:219]
  v_mfma_f32_16x16x32_bf16 v[220:223], a[176:179], a[152:155], v[220:223]
  s_add_u32 m0, s48, 0x8000
  v_mfma_f32_16x16x32_bf16 v[220:223], a[180:183], a[156:159], v[220:223]
  s_waitcnt vmcnt(2) lgkmcnt(0)
  s_barrier
  v_mfma_f32_16x16x32_bf16 v[224:227], a[96:99], a[160:163], v[224:227]
  s_add_u32 s59, s46, 0x180
  buffer_load_dwordx4 v2, s[8:11], s59 offen lds
  v_mfma_f32_16x16x32_bf16 v[224:227], a[100:103], a[164:167], v[224:227]
  s_add_u32 m0, s48, 0x8400
  ds_read_b128 a[168:171], v6
  ds_read_b128 a[172:175], v7
  v_mfma_f32_16x16x32_bf16 v[228:231], a[104:107], a[160:163], v[228:231]
  s_add_u32 s56, s46, 0x2180
  ds_read_b128 a[176:179], v6 offset:2048
  ds_read_b128 a[180:183], v7 offset:2048
  v_mfma_f32_16x16x32_bf16 v[228:231], a[108:111], a[164:167], v[228:231]
  buffer_load_dwordx4 v3, s[8:11], s56 offen lds
  v_mfma_f32_16x16x32_bf16 v[232:235], a[112:115], a[160:163], v[232:235]
  s_add_u32 m0, s48, 0x8800
  v_accvgpr_read_b32 v16, a216
  v_lshlrev_b32 v17, 16, v16
  v_mfma_f32_16x16x32_bf16 v[232:235], a[116:119], a[164:167], v[232:235]
  s_add_u32 s57, s46, 0x4180
  v_and_b32 v18, 0xffff0000, v16
  v_add_f32 v19, v17, v18
  v_mfma_f32_16x16x32_bf16 v[236:239], a[120:123], a[160:163], v[236:239]
  buffer_load_dwordx4 v2, s[8:11], s57 offen lds
  v_mfma_f32_16x16x32_bf16 v[236:239], a[124:127], a[164:167], v[236:239]
  s_add_u32 m0, s48, 0x8c00
  v_accvgpr_read_b32 v16, a217
  v_lshlrev_b32 v17, 16, v16
  v_mfma_f32_16x16x32_bf16 v[240:243], a[160:163], a[128:131], v[240:243]
  s_add_u32 s58, s46, 0x6180
  v_and_b32 v18, 0xffff0000, v16
  v_add_f32 v19, v19, v17
  v_mfma_f32_16x16x32_bf16 v[240:243], a[164:167], a[132:135], v[240:243]
  buffer_load_dwordx4 v3, s[8:11], s58 offen lds
  v_mfma_f32_16x16x32_bf16 v[244:247], a[160:163], a[136:139], v[244:247]
  s_add_u32 m0, s48, 0x9000
  v_add_f32 v19, v19, v18
  v_accvgpr_read_b32 v16, a218
  v_mfma_f32_16x16x32_bf16 v[244:247], a[164:167], a[140:143], v[244:247]
  s_add_u32 s59, s46, 0x8180
  v_lshlrev_b32 v17, 16, v16
  v_and_b32 v18, 0xffff0000, v16
  v_mfma_f32_16x16x32_bf16 v[248:251], a[160:163], a[144:147], v[248:251]
  buffer_load_dwordx4 v2, s[8:11], s59 offen lds
  v_mfma_f32_16x16x32_bf16 v[248:251], a[164:167], a[148:151], v[248:251]
  s_add_u32 m0, s48, 0x9400
  v_add_f32 v19, v19, v17
  v_accvgpr_read_b32 v16, a219
  v_mfma_f32_16x16x32_bf16 v[252:255], a[160:163], a[152:155], v[252:255]
  s_add_u32 s56, s46, 0xa180
  ds_read_b128 a[160:163], v6 offset:4096
  v_add_f32 v19, v19, v18
  v_mfma_f32_16x16x32_bf16 v[252:255], a[164:167], a[156:159], v[252:255]
  s_waitcnt lgkmcnt(1)
  buffer_load_dwordx4 v3, s[8:11], s56 offen lds
  v_mfma_f32_16x16x32_bf16 a[0:3], a[32:35], a[168:171], a[0:3]
  s_add_u32 m0, s48, 0x9800
  ds_read_b128 a[164:167], v7 offset:4096
  ds_read_b64_tr_b16 a[96:97], v8 offset:32768
  v_mfma_f32_16x16x32_bf16 a[0:3], a[36:39], a[172:175], a[0:3]
  s_add_u32 s57, s46, 0xc180
  v_lshlrev_b32 v17, 16, v16
  v_and_b32 v18, 0xffff0000, v16
  v_mfma_f32_16x16x32_bf16 a[4:7], a[40:43], a[168:171], a[4:7]
  buffer_load_dwordx4 v2, s[8:11], s57 offen lds
  v_mfma_f32_16x16x32_bf16 a[4:7], a[44:47], a[172:175], a[4:7]
  s_add_u32 m0, s48, 0x9c00
  ds_read_b64_tr_b16 a[98:99], v8 offset:33792
  v_add_f32 v19, v19, v17
  v_mfma_f32_16x16x32_bf16 a[8:11], a[48:51], a[168:171], a[8:11]
  s_add_u32 s58, s46, 0xe180
  v_add_f32 v19, v19, v18
  v_accvgpr_read_b32 v16, a220
  v_mfma_f32_16x16x32_bf16 a[8:11], a[52:55], a[172:175], a[8:11]
  buffer_load_dwordx4 v3, s[8:11], s58 offen lds
  v_mfma_f32_16x16x32_bf16 a[12:15], a[56:59], a[168:171], a[12:15]
  s_add_u32 m0, s49, 0x0
  ds_read_b64_tr_b16 a[100:101], v8 offset:36864
  v_lshlrev_b32 v17, 16, v16
  v_mfma_f32_16x16x32_bf16 a[12:15], a[60:63], a[172:175], a[12:15]
  s_add_u32 s59, s47, 0x200000
  v_and_b32 v18, 0xffff0000, v16
  v_add_f32 v19, v19, v17
  v_mfma_f32_16x16x32_bf16 a[16:19], a[168:171], a[64:67], a[16:19]
  buffer_load_dwordx4 v4, s[12:15], s59 offen lds
  v_mfma_f32_16x16x32_bf16 a[16:19], a[172:175], a[68:71], a[16:19]
  s_add_u32 m0, s49, 0x400
  ds_read_b64_tr_b16 a[102:103], v8 offset:37888
  v_accvgpr_read_b32 v16, a221
  v_mfma_f32_16x16x32_bf16 a[20:23], a[168:171], a[72:75], a[20:23]
  s_add_u32 s56, s47, 0x208000
  v_add_f32 v19, v19, v18
  v_lshlrev_b32 v17, 16, v16
  v_mfma_f32_16x16x32_bf16 a[20:23], a[172:175], a[76:79], a[20:23]
  buffer_load_dwordx4 v4, s[12:15], s56 offen lds
  v_mfma_f32_16x16x32_bf16 a[24:27], a[168:171], a[80:83], a[24:27]
  s_add_u32 m0, s49, 0x800
  ds_read_b64_tr_b16 a[104:105], v9 offset:32768
  v_and_b32 v18, 0xffff0000, v16
  v_mfma_f32_16x16x32_bf16 a[24:27], a[172:175], a[84:87], a[24:27]
  s_add_u32 s57, s47, 0x220000
  v_add_f32 v19, v19, v17
  v_add_f32 v19, v19, v18
  v_mfma_f32_16x16x32_bf16 a[28:31], a[168:171], a[88:91], a[28:31]
  buffer_load_dwordx4 v4, s[12:15], s57 offen lds
  v_mfma_f32_16x16x32_bf16 a[28:31], a[172:175], a[92:95], a[28:31]
  s_add_u32 m0, s49, 0xc00
  ds_read_b128 a[168:171], v6 offset:6144
  ds_read_b128 a[172:175], v7 offset:6144
  v_mfma_f32_16x16x32_bf16 v[32:35], a[32:35], a[176:179], v[32:35]
  s_add_u32 s58, s47, 0x228000
  ds_read_b64_tr_b16 a[106:107], v9 offset:33792
  v_accvgpr_read_b32 v16, a222
  v_mfma_f32_16x16x32_bf16 v[32:35], a[36:39], a[180:183], v[32:35]
  buffer_load_dwordx4 v4, s[12:15], s58 offen lds
  v_mfma_f32_16x16x32_bf16 v[36:39], a[40:43], a[176:179], v[36:39]
  s_add_u32 m0, s49, 0x1000
  ds_read_b64_tr_b16 a[108:109], v9 offset:36864
  v_lshlrev_b32 v17, 16, v16
  v_mfma_f32_16x16x32_bf16 v[36:39], a[44:47], a[180:183], v[36:39]
  s_add_u32 s59, s47, 0x240000
  v_and_b32 v18, 0xffff0000, v16
  v_add_f32 v19, v19, v17
  v_mfma_f32_16x16x32_bf16 v[40:43], a[48:51], a[176:179], v[40:43]
  buffer_load_dwordx4 v4, s[12:15], s59 offen lds
  v_mfma_f32_16x16x32_bf16 v[40:43], a[52:55], a[180:183], v[40:43]
  s_add_u32 m0, s49, 0x1400
  ds_read_b64_tr_b16 a[110:111], v9 offset:37888
  v_accvgpr_read_b32 v16, a223
  v_mfma_f32_16x16x32_bf16 v[44:47], a[56:59], a[176:179], v[44:47]
  s_add_u32 s56, s47, 0x248000
  v_add_f32 v19, v19, v18
  v_lshlrev_b32 v17, 16, v16
  v_mfma_f32_16x16x32_bf16 v[44:47], a[60:63], a[180:183], v[44:47]
  s_mov_b32 s59, 0x300000
  buffer_load_dwordx4 v4, s[12:15], s56 offen lds
  v_mfma_f32_16x16x32_bf16 v[48:51], a[176:179], a[64:67], v[48:51]
  s_add_u32 m0, s49, 0x1800
  ds_read_b64_tr_b16 a[112:113], v10 offset:32768
  v_and_b32 v18, 0xffff0000, v16
  v_mfma_f32_16x16x32_bf16 v[48:51], a[180:183], a[68:71], v[48:51]
  s_add_u32 s57, s47, 0x260000
  v_add_f32 v19, v19, v17
  v_add_f32 v19, v19, v18
  v_mfma_f32_16x16x32_bf16 v[52:55], a[176:179], a[72:75], v[52:55]
  buffer_load_dwordx4 v4, s[12:15], s57 offen lds
  v_mfma_f32_16x16x32_bf16 v[52:55], a[180:183], a[76:79], v[52:55]
  s_add_u32 m0, s49, 0x1c00
  ds_read_b64_tr_b16 a[114:115], v10 offset:33792
  v_accvgpr_read_b32 v16, a224
  v_mfma_f32_16x16x32_bf16 v[56:59], a[176:179], a[80:83], v[56:59]
  s_add_u32 s58, s47, 0x268000
  v_lshlrev_b32 v17, 16, v16
  v_and_b32 v18, 0xffff0000, v16
  v_mfma_f32_16x16x32_bf16 v[56:59], a[180:183], a[84:87], v[56:59]
  buffer_load_dwordx4 v4, s[12:15], s58 offen lds
  v_mfma_f32_16x16x32_bf16 v[60:63], a[176:179], a[88:91], v[60:63]
  s_nop 0
  ds_read_b128 a[176:179], v6 offset:8192
  ds_read_b64_tr_b16 a[116:117], v10 offset:36864
  v_mfma_f32_16x16x32_bf16 v[60:63], a[180:183], a[92:95], v[60:63]
  s_waitcnt lgkmcnt(3)
  ds_read_b128 a[180:183], v7 offset:8192
  v_add_f32 v19, v19, v17
  v_mfma_f32_16x16x32_bf16 v[64:67], a[32:35], a[160:163], v[64:67]
  v_accvgpr_read_b32 v16, a225
  v_add_f32 v19, v19, v18
  v_mfma_f32_16x16x32_bf16 v[64:67], a[36:39], a[164:167], v[64:67]
  ds_read_b64_tr_b16 a[118:119], v10 offset:37888
  v_lshlrev_b32 v17, 16, v16
  v_mfma_f32_16x16x32_bf16 v[68:71], a[40:43], a[160:163], v[68:71]
  v_and_b32 v18, 0xffff0000, v16
  v_add_f32 v19, v19, v17
  v_mfma_f32_16x16x32_bf16 v[68:71], a[44:47], a[164:167], v[68:71]
  v_add_f32 v19, v19, v18
  v_accvgpr_read_b32 v16, a226
  v_mfma_f32_16x16x32_bf16 v[72:75], a[48:51], a[160:163], v[72:75]
  ds_read_b64_tr_b16 a[120:121], v11 offset:32768
  v_lshlrev_b32 v17, 16, v16
  v_mfma_f32_16x16x32_bf16 v[72:75], a[52:55], a[164:167], v[72:75]
  v_and_b32 v18, 0xffff0000, v16
  v_add_f32 v19, v19, v17
  v_mfma_f32_16x16x32_bf16 v[76:79], a[56:59], a[160:163], v[76:79]
  v_accvgpr_read_b32 v16, a227
  v_add_f32 v19, v19, v18
  v_mfma_f32_16x16x32_bf16 v[76:79], a[60:63], a[164:167], v[76:79]
  ds_read_b64_tr_b16 a[122:123], v11 offset:33792
  v_lshlrev_b32 v17, 16, v16
  v_mfma_f32_16x16x32_bf16 v[80:83], a[160:163], a[64:67], v[80:83]
  buffer_load_dword a246, v25, s[12:15], s59 offen
  v_mfma_f32_16x16x32_bf16 v[80:83], a[164:167], a[68:71], v[80:83]
  buffer_load_dword a247, v24, s[8:11], 0 offen offset:768
  v_mfma_f32_16x16x32_bf16 v[84:87], a[160:163], a[72:75], v[84:87]
  ds_read_b64_tr_b16 a[124:125], v11 offset:36864
  v_and_b32 v18, 0xffff0000, v16
  v_mfma_f32_16x16x32_bf16 v[84:87], a[164:167], a[76:79], v[84:87]
  v_add_f32 v19, v19, v17
  v_add_f32 v19, v19, v18
  v_mfma_f32_16x16x32_bf16 v[88:91], a[160:163], a[80:83], v[88:91]
  v_accvgpr_read_b32 v16, a216
  v_add_f32_dpp v19, v19, v19 quad_perm:[1,0,3,2] row_mask:0xf bank_mask:0xf
  v_mfma_f32_16x16x32_bf16 v[88:91], a[164:167], a[84:87], v[88:91]
  ds_read_b64_tr_b16 a[126:127], v11 offset:37888
  v_add_f32_dpp v19, v19, v19 quad_perm:[2,3,0,1] row_mask:0xf bank_mask:0xf
  v_mfma_f32_16x16x32_bf16 v[92:95], a[160:163], a[88:91], v[92:95]
  ds_read_b128 a[160:163], v6 offset:10240
  v_add_f32_dpp v19, v19, v19 row_half_mirror row_mask:0xf bank_mask:0xf
  v_mfma_f32_16x16x32_bf16 v[92:95], a[164:167], a[92:95], v[92:95]
  ds_read_b128 a[164:167], v7 offset:10240
  v_add_f32_dpp v19, v19, v19 row_mirror row_mask:0xf bank_mask:0xf
  v_mfma_f32_16x16x32_bf16 v[96:99], a[32:35], a[168:171], v[96:99]
  ds_read_b64_tr_b16 a[128:129], v8 offset:49152
  v_mov_b32 v21, v19
  v_mfma_f32_16x16x32_bf16 v[96:99], a[36:39], a[172:175], v[96:99]
  v_lshlrev_b32 v17, 16, v16
  v_permlane16_swap_b32 v19, v21
  v_mfma_f32_16x16x32_bf16 v[100:103], a[40:43], a[168:171], v[100:103]
  v_add_f32 v19, v19, v21
  v_mul_f32 v20, 0x3acccccd, v19
  v_mfma_f32_16x16x32_bf16 v[100:103], a[44:47], a[172:175], v[100:103]
  ds_read_b64_tr_b16 a[130:131], v8 offset:50176
  v_and_b32 v18, 0xffff0000, v16
  v_mfma_f32_16x16x32_bf16 v[104:107], a[48:51], a[168:171], v[104:107]
  v_sub_f32 v17, v17, v20
  v_sub_f32 v18, v18, v20
  v_mfma_f32_16x16x32_bf16 v[104:107], a[52:55], a[172:175], v[104:107]
  v_mul_f32 v19, v17, v17
  v_accvgpr_read_b32 v16, a217
  v_mfma_f32_16x16x32_bf16 v[108:111], a[56:59], a[168:171], v[108:111]
  ds_read_b64_tr_b16 a[132:133], v8 offset:53248
  v_fmac_f32 v19, v18, v18
  v_mfma_f32_16x16x32_bf16 v[108:111], a[60:63], a[172:175], v[108:111]
  v_lshlrev_b32 v17, 16, v16
  v_and_b32 v18, 0xffff0000, v16
  v_mfma_f32_16x16x32_bf16 v[112:115], a[168:171], a[64:67], v[112:115]
  v_sub_f32 v17, v17, v20
  v_sub_f32 v18, v18, v20
  v_mfma_f32_16x16x32_bf16 v[112:115], a[172:175], a[68:71], v[112:115]
  ds_read_b64_tr_b16 a[134:135], v8 offset:54272
  v_fmac_f32 v19, v17, v17
  v_mfma_f32_16x16x32_bf16 v[116:119], a[168:171], a[72:75], v[116:119]
  v_accvgpr_read_b32 v16, a218
  v_fmac_f32 v19, v18, v18
  v_mfma_f32_16x16x32_bf16 v[116:119], a[172:175], a[76:79], v[116:119]
  v_lshlrev_b32 v17, 16, v16
  v_and_b32 v18, 0xffff0000, v16
  v_mfma_f32_16x16x32_bf16 v[120:123], a[168:171], a[80:83], v[120:123]
  ds_read_b64_tr_b16 a[136:137], v9 offset:49152
  v_sub_f32 v17, v17, v20
  v_mfma_f32_16x16x32_bf16 v[120:123], a[172:175], a[84:87], v[120:123]
  v_sub_f32 v18, v18, v20
  v_fmac_f32 v19, v17, v17
  v_mfma_f32_16x16x32_bf16 v[124:127], a[168:171], a[88:91], v[124:127]
  ds_read_b128 a[168:171], v6 offset:12288
  v_accvgpr_read_b32 v16, a219
  v_mfma_f32_16x16x32_bf16 v[124:127], a[172:175], a[92:95], v[124:127]
  s_waitcnt lgkmcnt(3)
  ds_read_b128 a[172:175], v7 offset:12288
  ds_read_b64_tr_b16 a[138:139], v9 offset:50176
  v_mfma_f32_16x16x32_bf16 v[128:131], a[32:35], a[176:179], v[128:131]
  v_fmac_f32 v19, v18, v18
  v_lshlrev_b32 v17, 16, v16
  v_mfma_f32_16x16x32_bf16 v[128:131], a[36:39], a[180:183], v[128:131]
  v_and_b32 v18, 0xffff0000, v16
  v_sub_f32 v17, v17, v20
  v_mfma_f32_16x16x32_bf16 v[132:135], a[40:43], a[176:179], v[132:135]
  ds_read_b64_tr_b16 a[140:141], v9 offset:53248
  v_sub_f32 v18, v18, v20
  v_mfma_f32_16x16x32_bf16 v[132:135], a[44:47], a[180:183], v[132:135]
  v_fmac_f32 v19, v17, v17
  v_accvgpr_read_b32 v16, a220
  v_mfma_f32_16x16x32_bf16 v[136:139], a[48:51], a[176:179], v[136:139]
  v_fmac_f32 v19, v18, v18
  v_lshlrev_b32 v17, 16, v16
  v_mfma_f32_16x16x32_bf16 v[136:139], a[52:55], a[180:183], v[136:139]
  ds_read_b64_tr_b16 a[142:143], v9 offset:54272
  v_and_b32 v18, 0xffff0000, v16
  v_mfma_f32_16x16x32_bf16 v[140:143], a[56:59], a[176:179], v[140:143]
  v_sub_f32 v17, v17, v20
  v_sub_f32 v18, v18, v20
  v_mfma_f32_16x16x32_bf16 v[140:143], a[60:63], a[180:183], v[140:143]
  v_fmac_f32 v19, v17, v17
  v_accvgpr_read_b32 v16, a221
  v_mfma_f32_16x16x32_bf16 v[144:147], a[176:179], a[64:67], v[144:147]
  ds_read_b64_tr_b16 a[144:145], v10 offset:49152
  v_fmac_f32 v19, v18, v18
  v_mfma_f32_16x16x32_bf16 v[144:147], a[180:183], a[68:71], v[144:147]
  v_lshlrev_b32 v17, 16, v16
  v_and_b32 v18, 0xffff0000, v16
  v_mfma_f32_16x16x32_bf16 v[148:151], a[176:179], a[72:75], v[148:151]
  v_sub_f32 v17, v17, v20
  v_sub_f32 v18, v18, v20
  v_mfma_f32_16x16x32_bf16 v[148:151], a[180:183], a[76:79], v[148:151]
  ds_read_b64_tr_b16 a[146:147], v10 offset:50176
  v_fmac_f32 v19, v17, v17
  v_mfma_f32_16x16x32_bf16 v[152:155], a[176:179], a[80:83], v[152:155]
  v_accvgpr_read_b32 v16, a222
  v_fmac_f32 v19, v18, v18
  v_mfma_f32_16x16x32_bf16 v[152:155], a[180:183], a[84:87], v[152:155]
  v_lshlrev_b32 v17, 16, v16
  v_and_b32 v18, 0xffff0000, v16
  v_mfma_f32_16x16x32_bf16 v[156:159], a[176:179], a[88:91], v[156:159]
  s_nop 0
  ds_read_b128 a[176:179], v6 offset:14336
  ds_read_b64_tr_b16 a[148:149], v10 offset:53248
  v_mfma_f32_16x16x32_bf16 v[156:159], a[180:183], a[92:95], v[156:159]
  ds_read_b128 a[180:183], v7 offset:14336
  v_sub_f32 v17, v17, v20
  v_mfma_f32_16x16x32_bf16 v[160:163], a[32:35], a[160:163], v[160:163]
  v_sub_f32 v18, v18, v20
  v_fmac_f32 v19, v17, v17
  v_mfma_f32_16x16x32_bf16 v[160:163], a[36:39], a[164:167], v[160:163]
  ds_read_b64_tr_b16 a[150:151], v10 offset:54272
  v_accvgpr_read_b32 v16, a223
  v_mfma_f32_16x16x32_bf16 v[164:167], a[40:43], a[160:163], v[164:167]
  v_fmac_f32 v19, v18, v18
  v_lshlrev_b32 v17, 16, v16
  v_mfma_f32_16x16x32_bf16 v[164:167], a[44:47], a[164:167], v[164:167]
  v_and_b32 v18, 0xffff0000, v16
  v_sub_f32 v17, v17, v20
  v_mfma_f32_16x16x32_bf16 v[168:171], a[48:51], a[160:163], v[168:171]
  ds_read_b64_tr_b16 a[152:153], v11 offset:49152
  v_sub_f32 v18, v18, v20
  v_mfma_f32_16x16x32_bf16 v[168:171], a[52:55], a[164:167], v[168:171]
  v_fmac_f32 v19, v17, v17
  v_accvgpr_read_b32 v16, a224
  v_mfma_f32_16x16x32_bf16 v[172:175], a[56:59], a[160:163], v[172:175]
  v_fmac_f32 v19, v18, v18
  v_lshlrev_b32 v17, 16, v16
  v_mfma_f32_16x16x32_bf16 v[172:175], a[60:63], a[164:167], v[172:175]
  ds_read_b64_tr_b16 a[154:155], v11 offset:50176
  v_and_b32 v18, 0xffff0000, v16
  v_mfma_f32_16x16x32_bf16 v[176:179], a[160:163], a[64:67], v[176:179]
  v_sub_f32 v17, v17, v20
  v_sub_f32 v18, v18, v20
  v_mfma_f32_16x16x32_bf16 v[176:179], a[164:167], a[68:71], v[176:179]
  v_cndmask_b32 v17, 0, v17, s[60:61]
  v_cndmask_b32 v18, 0, v18, s[60:61]
  v_mfma_f32_16x16x32_bf16 v[180:183], a[160:163], a[72:75], v[180:183]
  ds_read_b64_tr_b16 a[156:157], v11 offset:53248
  v_fmac_f32 v19, v17, v17
  v_mfma_f32_16x16x32_bf16 v[180:183], a[164:167], a[76:79], v[180:183]
  v_accvgpr_read_b32 v16, a225
  v_fmac_f32 v19, v18, v18
  v_mfma_f32_16x16x32_bf16 v[184:187], a[160:163], a[80:83], v[184:187]
  v_lshlrev_b32 v17, 16, v16
  v_and_b32 v18, 0xffff0000, v16
  v_mfma_f32_16x16x32_bf16 v[184:187], a[164:167], a[84:87], v[184:187]
  ds_read_b64_tr_b16 a[158:159], v11 offset:54272
  v_sub_f32 v17, v17, v20
  v_mfma_f32_16x16x32_bf16 v[188:191], a[160:163], a[88:91], v[188:191]
  v_sub_f32 v18, v18, v20
  v_cndmask_b32 v17, 0, v17, s[60:61]
  v_mfma_f32_16x16x32_bf16 v[188:191], a[164:167], a[92:95], v[188:191]
  s_waitcnt lgkmcnt(2)
  v_cndmask_b32 v18, 0, v18, s[60:61]
  v_fmac_f32 v19, v17, v17
  v_mfma_f32_16x16x32_bf16 v[192:195], a[32:35], a[168:171], v[192:195]
  v_accvgpr_read_b32 v16, a226
  v_fmac_f32 v19, v18, v18
  v_mfma_f32_16x16x32_bf16 v[192:195], a[36:39], a[172:175], v[192:195]
  v_lshlrev_b32 v17, 16, v16
  v_and_b32 v18, 0xffff0000, v16
  v_mfma_f32_16x16x32_bf16 v[196:199], a[40:43], a[168:171], v[196:199]
  v_sub_f32 v17, v17, v20
  v_sub_f32 v18, v18, v20
  v_mfma_f32_16x16x32_bf16 v[196:199], a[44:47], a[172:175], v[196:199]
  v_cndmask_b32 v17, 0, v17, s[60:61]
  v_cndmask_b32 v18, 0, v18, s[60:61]
  v_mfma_f32_16x16x32_bf16 v[200:203], a[48:51], a[168:171], v[200:203]
  v_fmac_f32 v19, v17, v17
  v_accvgpr_read_b32 v16, a227
  v_mfma_f32_16x16x32_bf16 v[200:203], a[52:55], a[172:175], v[200:203]
  v_fmac_f32 v19, v18, v18
  v_lshlrev_b32 v17, 16, v16
  v_mfma_f32_16x16x32_bf16 v[204:207], a[56:59], a[168:171], v[204:207]
  v_and_b32 v18, 0xffff0000, v16
  v_sub_f32 v17, v17, v20
  v_mfma_f32_16x16x32_bf16 v[204:207], a[60:63], a[172:175], v[204:207]
  v_sub_f32 v18, v18, v20
  v_cndmask_b32 v17, 0, v17, s[60:61]
  v_mfma_f32_16x16x32_bf16 v[208:211], a[168:171], a[64:67], v[208:211]
  v_cndmask_b32 v18, 0, v18, s[60:61]
  v_fmac_f32 v19, v17, v17
  v_mfma_f32_16x16x32_bf16 v[208:211], a[172:175], a[68:71], v[208:211]
  v_fmac_f32 v19, v18, v18
  v_bfe_u32 v18, v0, 5, 1
  v_mfma_f32_16x16x32_bf16 v[212:215], a[168:171], a[72:75], v[212:215]
  v_add_f32_dpp v19, v19, v19 quad_perm:[1,0,3,2] row_mask:0xf bank_mask:0xf
  v_accvgpr_read_b32 v16, a216
  v_mfma_f32_16x16x32_bf16 v[212:215], a[172:175], a[76:79], v[212:215]
  v_add_f32_dpp v19, v19, v19 quad_perm:[2,3,0,1] row_mask:0xf bank_mask:0xf
  v_mfma_f32_16x16x32_bf16 v[216:219], a[168:171], a[80:83], v[216:219]
  v_mfma_f32_16x16x32_bf16 v[216:219], a[172:175], a[84:87], v[216:219]
  v_add_f32_dpp v19, v19, v19 row_half_mirror row_mask:0xf bank_mask:0xf
  v_mfma_f32_16x16x32_bf16 v[220:223], a[168:171], a[88:91], v[220:223]
  s_add_u32 m0, s48, 0x0
  v_add_f32_dpp v19, v19, v19 row_mirror row_mask:0xf bank_mask:0xf
  v_mov_b32 v21, v19
  v_mfma_f32_16x16x32_bf16 v[220:223], a[172:175], a[92:95], v[220:223]
  s_waitcnt vmcnt(2) lgkmcnt(0)
  s_barrier
  v_mfma_f32_16x16x32_bf16 v[224:227], a[32:35], a[176:179], v[224:227]
  s_add_u32 s56, s46, 0x200
  buffer_load_dwordx4 v2, s[8:11], s56 offen lds
  v_mfma_f32_16x16x32_bf16 v[224:227], a[36:39], a[180:183], v[224:227]
  s_add_u32 m0, s48, 0x400
  ds_read_b128 a[160:163], v6 offset:32768
  ds_read_b128 a[164:167], v7 offset:32768
  v_mfma_f32_16x16x32_bf16 v[228:231], a[40:43], a[176:179], v[228:231]
  s_add_u32 s57, s46, 0x2200
  ds_read_b128 a[168:171], v6 offset:34816
  ds_read_b128 a[172:175], v7 offset:34816
  v_mfma_f32_16x16x32_bf16 v[228:231], a[44:47], a[180:183], v[228:231]
  buffer_load_dwordx4 v3, s[8:11], s57 offen lds
  v_mfma_f32_16x16x32_bf16 v[232:235], a[48:51], a[176:179], v[232:235]
  s_add_u32 m0, s48, 0x800
  v_permlane16_swap_b32 v19, v21
  v_add_f32 v19, v19, v21
  v_mfma_f32_16x16x32_bf16 v[232:235], a[52:55], a[180:183], v[232:235]
  s_add_u32 s58, s46, 0x4200
  v_mul_f32 v19, 0x3acccccd, v19
  v_cvt_pk_bf16_f32 v21, v20, v19
  v_mfma_f32_16x16x32_bf16 v[236:239], a[56:59], a[176:179], v[236:239]
  buffer_load_dwordx4 v2, s[8:11], s58 offen lds
  v_mfma_f32_16x16x32_bf16 v[236:239], a[60:63], a[180:183], v[236:239]
  s_add_u32 m0, s48, 0xc00
  v_and_b32 v19, 0xffff0000, v21
  v_lshlrev_b32 v22, 16, v21
  v_mfma_f32_16x16x32_bf16 v[240:243], a[176:179], a[64:67], v[240:243]
  s_add_u32 s59, s46, 0x6200
  v_add_f32 v19, 0x3727c5ac, v19
  v_cvt_pk_bf16_f32 v21, v19, v19
  v_mfma_f32_16x16x32_bf16 v[240:243], a[180:183], a[68:71], v[240:243]
  buffer_load_dwordx4 v3, s[8:11], s59 offen lds
  v_mfma_f32_16x16x32_bf16 v[244:247], a[176:179], a[72:75], v[244:247]
  s_add_u32 m0, s48, 0x1000
  v_lshlrev_b32 v19, 16, v21
  v_mfma_f32_16x16x32_bf16 v[244:247], a[180:183], a[76:79], v[244:247]
  s_add_u32 s56, s46, 0x8200
  v_sqrt_f32 v17, v19
  v_mfma_f32_16x16x32_bf16 v[248:251], a[176:179], a[80:83], v[248:251]
  buffer_load_dwordx4 v2, s[8:11], s56 offen lds
  v_mfma_f32_16x16x32_bf16 v[248:251], a[180:183], a[84:87], v[248:251]
  s_add_u32 m0, s48, 0x1400
  v_cvt_pk_bf16_f32 v21, v17, v17
  v_lshlrev_b32 v17, 16, v21
  v_mfma_f32_16x16x32_bf16 v[252:255], a[176:179], a[88:91], v[252:255]
  s_add_u32 s57, s46, 0xa200
  ds_read_b128 a[176:179], v6 offset:36864
  v_mfma_f32_16x16x32_bf16 v[252:255], a[180:183], a[92:95], v[252:255]
  s_waitcnt lgkmcnt(1)
  buffer_load_dwordx4 v3, s[8:11], s57 offen lds
  v_mfma_f32_16x16x32_bf16 a[0:3], a[96:99], a[160:163], a[0:3]
  s_add_u32 m0, s48, 0x1800
  ds_read_b128 a[180:183], v7 offset:36864
  ds_read_b64_tr_b16 a[32:33], v8
  v_mfma_f32_16x16x32_bf16 a[0:3], a[100:103], a[164:167], a[0:3]
  s_add_u32 s58, s46, 0xc200
  v_rcp_f32 v23, v17
  v_mfma_f32_16x16x32_bf16 a[4:7], a[104:107], a[160:163], a[4:7]
  buffer_load_dwordx4 v2, s[8:11], s58 offen lds
  v_mfma_f32_16x16x32_bf16 a[4:7], a[108:111], a[164:167], a[4:7]
  s_add_u32 m0, s48, 0x1c00
  v_fma_f32 v21, -v17, v23, 1.0
  v_and_b32 v17, 31, v0
  v_mfma_f32_16x16x32_bf16 a[8:11], a[112:115], a[160:163], a[8:11]
  s_add_u32 s59, s46, 0xe200
  v_mul_u32_u24 v17, 144, v17
  v_lshl_add_u32 v17, v18, 4, v17
  v_mfma_f32_16x16x32_bf16 a[8:11], a[116:119], a[164:167], a[8:11]
  buffer_load_dwordx4 v3, s[8:11], s59 offen lds
  v_mfma_f32_16x16x32_bf16 a[12:15], a[120:123], a[160:163], a[12:15]
  s_add_u32 m0, s49, 0x8000
  v_add_u32 v20, s43, v17
  v_mov_b32 v18, 0x30000
  v_mfma_f32_16x16x32_bf16 a[12:15], a[124:127], a[164:167], a[12:15]
  s_add_u32 s56, s47, 0x280000
  v_cndmask_b32 v19, v18, v20, s[60:61]
  v_lshlrev_b32 v17, 16, v16
  v_mfma_f32_16x16x32_bf16 a[16:19], a[160:163], a[128:131], a[16:19]
  s_lshr_b32 s43, s63, 3
  buffer_load_dwordx4 v4, s[12:15], s56 offen lds
  v_mfma_f32_16x16x32_bf16 a[16:19], a[164:167], a[132:135], a[16:19]
  s_add_u32 m0, s49, 0x8400
  v_and_b32 v18, 0xffff0000, v16
  v_fmac_f32 v23, v21, v23
  v_mfma_f32_16x16x32_bf16 a[20:23], a[160:163], a[136:139], a[20:23]
  s_add_u32 s57, s47, 0x288000
  v_sub_f32 v17, v17, v22
  v_sub_f32 v18, v18, v22
  v_mfma_f32_16x16x32_bf16 a[20:23], a[164:167], a[140:143], a[20:23]
  s_mul_i32 s43, s43, 80
  buffer_load_dwordx4 v4, s[12:15], s57 offen lds
  v_mfma_f32_16x16x32_bf16 a[24:27], a[160:163], a[144:147], a[24:27]
  s_add_u32 m0, s49, 0x8800
  v_cvt_pk_bf16_f32 v21, v17, v18
  v_lshlrev_b32 v17, 16, v21
  v_mfma_f32_16x16x32_bf16 a[24:27], a[164:167], a[148:151], a[24:27]
  s_add_u32 s58, s47, 0x2a0000
  v_and_b32 v18, 0xffff0000, v21
  v_mul_f32 v17, v17, v23
  v_mfma_f32_16x16x32_bf16 a[28:31], a[160:163], a[152:155], a[28:31]
  s_add_u32 s43, s43, s44
  buffer_load_dwordx4 v4, s[12:15], s58 offen lds
  v_mfma_f32_16x16x32_bf16 a[28:31], a[164:167], a[156:159], a[28:31]
  s_add_u32 m0, s49, 0x8c00
  ds_read_b128 a[160:163], v6 offset:38912
  ds_read_b128 a[164:167], v7 offset:38912
  v_mfma_f32_16x16x32_bf16 v[32:35], a[96:99], a[168:171], v[32:35]
  s_add_u32 s59, s47, 0x2a8000
  v_mul_f32 v18, v18, v23
  v_cvt_pk_bf16_f32 v21, v17, v18
  v_mfma_f32_16x16x32_bf16 v[32:35], a[100:103], a[172:175], v[32:35]
  s_lshl_b32 s43, s43, 3
  buffer_load_dwordx4 v4, s[12:15], s59 offen lds
  v_mfma_f32_16x16x32_bf16 v[36:39], a[104:107], a[168:171], v[36:39]
  s_add_u32 m0, s49, 0x9000
  v_accvgpr_read_b32 v16, a217
  v_lshlrev_b32 v17, 16, v16
  v_mfma_f32_16x16x32_bf16 v[36:39], a[108:111], a[172:175], v[36:39]
  s_add_u32 s56, s47, 0x2c0000
  v_and_b32 v18, 0xffff0000, v16
  v_accvgpr_write_b32 a216, v21
  v_mfma_f32_16x16x32_bf16 v[40:43], a[112:115], a[168:171], v[40:43]
  s_and_b32 s44, s63, 1
  buffer_load_dwordx4 v4, s[12:15], s56 offen lds
  v_mfma_f32_16x16x32_bf16 v[40:43], a[116:119], a[172:175], v[40:43]
  s_add_u32 m0, s49, 0x9400
  v_sub_f32 v17, v17, v22
  v_sub_f32 v18, v18, v22
  v_mfma_f32_16x16x32_bf16 v[44:47], a[120:123], a[168:171], v[44:47]
  s_add_u32 s57, s47, 0x2c8000
  v_cvt_pk_bf16_f32 v21, v17, v18
  v_lshlrev_b32 v17, 16, v21
  v_mfma_f32_16x16x32_bf16 v[44:47], a[124:127], a[172:175], v[44:47]
  s_mov_b32 s56, 0x0
  buffer_load_dwordx4 v4, s[12:15], s57 offen lds
  v_mfma_f32_16x16x32_bf16 v[48:51], a[168:171], a[128:131], v[48:51]
  s_add_u32 m0, s49, 0x9800
  v_and_b32 v18, 0xffff0000, v21
  v_mul_f32 v17, v17, v23
  v_mfma_f32_16x16x32_bf16 v[48:51], a[172:175], a[132:135], v[48:51]
  s_add_u32 s58, s47, 0x2e0000
  v_mul_f32 v18, v18, v23
  v_cvt_pk_bf16_f32 v21, v17, v18
  v_mfma_f32_16x16x32_bf16 v[52:55], a[168:171], a[136:139], v[52:55]
  s_mov_b32 s57, 0x0
  buffer_load_dwordx4 v4, s[12:15], s58 offen lds
  v_mfma_f32_16x16x32_bf16 v[52:55], a[172:175], a[140:143], v[52:55]
  s_add_u32 m0, s49, 0x9c00
  v_accvgpr_read_b32 v16, a218
  v_lshlrev_b32 v17, 16, v16
  v_mfma_f32_16x16x32_bf16 v[56:59], a[168:171], a[144:147], v[56:59]
  s_add_u32 s59, s47, 0x2e8000
  v_and_b32 v18, 0xffff0000, v16
  v_accvgpr_write_b32 a217, v21
  v_mfma_f32_16x16x32_bf16 v[56:59], a[172:175], a[148:151], v[56:59]
  s_add_u32 s43, s43, s44
  buffer_load_dwordx4 v4, s[12:15], s59 offen lds
  v_mfma_f32_16x16x32_bf16 v[60:63], a[168:171], a[152:155], v[60:63]
  s_lshl_b32 s43, s43, 7
  ds_read_b128 a[168:171], v6 offset:40960
  v_sub_f32 v17, v17, v22
  v_mfma_f32_16x16x32_bf16 v[60:63], a[172:175], a[156:159], v[60:63]
  s_waitcnt lgkmcnt(1)
  ds_read_b128 a[172:175], v7 offset:40960
  v_sub_f32 v18, v18, v22
  v_mfma_f32_16x16x32_bf16 v[64:67], a[96:99], a[176:179], v[64:67]
  s_lshl_b32 s44, s40, 13
  v_cvt_pk_bf16_f32 v21, v17, v18
  v_lshlrev_b32 v17, 16, v21
  v_mfma_f32_16x16x32_bf16 v[64:67], a[100:103], a[180:183], v[64:67]
  s_add_u32 s62, s43, s44
  v_and_b32 v18, 0xffff0000, v21
  v_mul_f32 v17, v17, v23
  v_mfma_f32_16x16x32_bf16 v[68:71], a[104:107], a[176:179], v[68:71]
  s_mul_i32 s44, s40, 1152
  v_mul_f32 v18, v18, v23
  v_cvt_pk_bf16_f32 v21, v17, v18
  v_mfma_f32_16x16x32_bf16 v[68:71], a[108:111], a[180:183], v[68:71]
  s_add_u32 s44, s44, 0x20000
  v_accvgpr_read_b32 v16, a219
  v_lshlrev_b32 v17, 16, v16
  v_mfma_f32_16x16x32_bf16 v[72:75], a[112:115], a[176:179], v[72:75]
  s_sub_u32 s43, 15, s42
  v_and_b32 v18, 0xffff0000, v16
  v_accvgpr_write_b32 a218, v21
  v_mfma_f32_16x16x32_bf16 v[72:75], a[116:119], a[180:183], v[72:75]
  s_lshl_b32 s43, s43, 1
  v_sub_f32 v17, v17, v22
  v_sub_f32 v18, v18, v22
  v_mfma_f32_16x16x32_bf16 v[76:79], a[120:123], a[176:179], v[76:79]
  v_cvt_pk_bf16_f32 v21, v17, v18
  v_lshlrev_b32 v17, 16, v21
  v_mfma_f32_16x16x32_bf16 v[76:79], a[124:127], a[180:183], v[76:79]
  v_and_b32 v18, 0xffff0000, v21
  v_mul_f32 v17, v17, v23
  v_mfma_f32_16x16x32_bf16 v[80:83], a[176:179], a[128:131], v[80:83]
  buffer_load_dword a248, v26, s[16:19], s56 offen
  v_mfma_f32_16x16x32_bf16 v[80:83], a[180:183], a[132:135], v[80:83]
  buffer_load_dword a248, v27, s[20:23], s57 offen
  v_mfma_f32_16x16x32_bf16 v[84:87], a[176:179], a[136:139], v[84:87]
  v_mul_f32 v18, v18, v23
  v_cvt_pk_bf16_f32 v21, v17, v18
  v_mfma_f32_16x16x32_bf16 v[84:87], a[180:183], a[140:143], v[84:87]
  v_accvgpr_read_b32 v16, a220
  v_lshlrev_b32 v17, 16, v16
  v_mfma_f32_16x16x32_bf16 v[88:91], a[176:179], a[144:147], v[88:91]
  v_and_b32 v18, 0xffff0000, v16
  v_accvgpr_write_b32 a219, v21
  v_mfma_f32_16x16x32_bf16 v[88:91], a[180:183], a[148:151], v[88:91]
  v_sub_f32 v17, v17, v22
  v_sub_f32 v18, v18, v22
  v_mfma_f32_16x16x32_bf16 v[92:95], a[176:179], a[152:155], v[92:95]
  ds_read_b128 a[176:179], v6 offset:43008
  v_cvt_pk_bf16_f32 v21, v17, v18
  v_mfma_f32_16x16x32_bf16 v[92:95], a[180:183], a[156:159], v[92:95]
  ds_read_b128 a[180:183], v7 offset:43008
  v_lshlrev_b32 v17, 16, v21
  v_mfma_f32_16x16x32_bf16 v[96:99], a[96:99], a[160:163], v[96:99]
  v_and_b32 v18, 0xffff0000, v21
  v_mul_f32 v17, v17, v23
  v_mfma_f32_16x16x32_bf16 v[96:99], a[100:103], a[164:167], v[96:99]
  v_mul_f32 v18, v18, v23
  v_cvt_pk_bf16_f32 v21, v17, v18
  v_mfma_f32_16x16x32_bf16 v[100:103], a[104:107], a[160:163], v[100:103]
  v_accvgpr_read_b32 v16, a221
  v_lshlrev_b32 v17, 16, v16
  v_mfma_f32_16x16x32_bf16 v[100:103], a[108:111], a[164:167], v[100:103]
  v_and_b32 v18, 0xffff0000, v16
  v_accvgpr_write_b32 a220, v21
  v_mfma_f32_16x16x32_bf16 v[104:107], a[112:115], a[160:163], v[104:107]
  v_sub_f32 v17, v17, v22
  v_sub_f32 v18, v18, v22
  v_mfma_f32_16x16x32_bf16 v[104:107], a[116:119], a[164:167], v[104:107]
  v_cvt_pk_bf16_f32 v21, v17, v18
  v_lshlrev_b32 v17, 16, v21
  v_mfma_f32_16x16x32_bf16 v[108:111], a[120:123], a[160:163], v[108:111]
  v_and_b32 v18, 0xffff0000, v21
  v_mul_f32 v17, v17, v23
  v_mfma_f32_16x16x32_bf16 v[108:111], a[124:127], a[164:167], v[108:111]
  v_mul_f32 v18, v18, v23
  v_cvt_pk_bf16_f32 v21, v17, v18
  v_mfma_f32_16x16x32_bf16 v[112:115], a[160:163], a[128:131], v[112:115]
  v_accvgpr_read_b32 v16, a222
  v_lshlrev_b32 v17, 16, v16
  v_mfma_f32_16x16x32_bf16 v[112:115], a[164:167], a[132:135], v[112:115]
  v_and_b32 v18, 0xffff0000, v16
  v_accvgpr_write_b32 a221, v21
  v_mfma_f32_16x16x32_bf16 v[116:119], a[160:163], a[136:139], v[116:119]
  v_sub_f32 v17, v17, v22
  v_sub_f32 v18, v18, v22
  v_mfma_f32_16x16x32_bf16 v[116:119], a[164:167], a[140:143], v[116:119]
  v_cvt_pk_bf16_f32 v21, v17, v18
  v_lshlrev_b32 v17, 16, v21
  v_mfma_f32_16x16x32_bf16 v[120:123], a[160:163], a[144:147], v[120:123]
  v_and_b32 v18, 0xffff0000, v21
  v_mul_f32 v17, v17, v23
  v_mfma_f32_16x16x32_bf16 v[120:123], a[164:167], a[148:151], v[120:123]
  v_mul_f32 v18, v18, v23
  v_cvt_pk_bf16_f32 v21, v17, v18
  v_mfma_f32_16x16x32_bf16 v[124:127], a[160:163], a[152:155], v[124:127]
  ds_read_b128 a[160:163], v6 offset:45056
  v_accvgpr_read_b32 v16, a223
  v_mfma_f32_16x16x32_bf16 v[124:127], a[164:167], a[156:159], v[124:127]
  s_waitcnt lgkmcnt(1)
  ds_read_b128 a[164:167], v7 offset:45056
  v_lshlrev_b32 v17, 16, v16
  v_mfma_f32_16x16x32_bf16 v[128:131], a[96:99], a[168:171], v[128:131]
  v_and_b32 v18, 0xffff0000, v16
  v_accvgpr_write_b32 a222, v21
  v_mfma_f32_16x16x32_bf16 v[128:131], a[100:103], a[172:175], v[128:131]
  v_sub_f32 v17, v17, v22
  v_sub_f32 v18, v18, v22
  v_mfma_f32_16x16x32_bf16 v[132:135], a[104:107], a[168:171], v[132:135]
  v_cvt_pk_bf16_f32 v21, v17, v18
  v_lshlrev_b32 v17, 16, v21
  v_mfma_f32_16x16x32_bf16 v[132:135], a[108:111], a[172:175], v[132:135]
  v_and_b32 v18, 0xffff0000, v21
  v_mul_f32 v17, v17, v23
  v_mfma_f32_16x16x32_bf16 v[136:139], a[112:115], a[168:171], v[136:139]
  v_mul_f32 v18, v18, v23
  v_cvt_pk_bf16_f32 v21, v17, v18
  v_mfma_f32_16x16x32_bf16 v[136:139], a[116:119], a[172:175], v[136:139]
  v_accvgpr_read_b32 v16, a224
  v_lshlrev_b32 v17, 16, v16
  v_mfma_f32_16x16x32_bf16 v[140:143], a[120:123], a[168:171], v[140:143]
  v_and_b32 v18, 0xffff0000, v16
  v_accvgpr_write_b32 a223, v21
  v_mfma_f32_16x16x32_bf16 v[140:143], a[124:127], a[172:175], v[140:143]
  ds_read_b64_tr_b16 a[34:35], v8 offset:1024
  v_sub_f32 v17, v17, v22
  v_mfma_f32_16x16x32_bf16 v[144:147], a[168:171], a[128:131], v[144:147]
  ds_read_b64_tr_b16 a[36:37], v8 offset:4096
  v_sub_f32 v18, v18, v22
  v_mfma_f32_16x16x32_bf16 v[144:147], a[172:175], a[132:135], v[144:147]
  ds_read_b64_tr_b16 a[38:39], v8 offset:5120
  v_cvt_pk_bf16_f32 v21, v17, v18
  v_mfma_f32_16x16x32_bf16 v[148:151], a[168:171], a[136:139], v[148:151]
  ds_read_b64_tr_b16 a[40:41], v9
  v_lshlrev_b32 v17, 16, v21
  v_mfma_f32_16x16x32_bf16 v[148:151], a[172:175], a[140:143], v[148:151]
  ds_read_b64_tr_b16 a[42:43], v9 offset:1024
  v_and_b32 v18, 0xffff0000, v21
  v_mfma_f32_16x16x32_bf16 v[152:155], a[168:171], a[144:147], v[152:155]
  ds_read_b64_tr_b16 a[44:45], v9 offset:4096
  v_mul_f32 v17, v17, v23
  v_mfma_f32_16x16x32_bf16 v[152:155], a[172:175], a[148:151], v[152:155]
  ds_read_b64_tr_b16 a[46:47], v9 offset:5120
  v_mul_f32 v18, v18, v23
  v_mfma_f32_16x16x32_bf16 v[156:159], a[168:171], a[152:155], v[156:159]
  ds_read_b128 a[168:171], v6 offset:47104
  v_cvt_pk_bf16_f32 v21, v17, v18
  v_mfma_f32_16x16x32_bf16 v[156:159], a[172:175], a[156:159], v[156:159]
  ds_read_b128 a[172:175], v7 offset:47104
  v_accvgpr_read_b32 v16, a225
  v_mfma_f32_16x16x32_bf16 v[160:163], a[96:99], a[176:179], v[160:163]
  ds_read_b64_tr_b16 a[48:49], v10
  v_lshlrev_b32 v17, 16, v16
  v_mfma_f32_16x16x32_bf16 v[160:163], a[100:103], a[180:183], v[160:163]
  ds_read_b64_tr_b16 a[50:51], v10 offset:1024
  v_and_b32 v18, 0xffff0000, v16
  v_mfma_f32_16x16x32_bf16 v[164:167], a[104:107], a[176:179], v[164:167]
  ds_read_b64_tr_b16 a[52:53], v10 offset:4096
  v_accvgpr_write_b32 a224, v21
  v_mfma_f32_16x16x32_bf16 v[164:167], a[108:111], a[180:183], v[164:167]
  ds_read_b64_tr_b16 a[54:55], v10 offset:5120
  v_sub_f32 v17, v17, v22
  v_mfma_f32_16x16x32_bf16 v[168:171], a[112:115], a[176:179], v[168:171]
  ds_read_b64_tr_b16 a[56:57], v11
  v_sub_f32 v18, v18, v22
  v_mfma_f32_16x16x32_bf16 v[168:171], a[116:119], a[180:183], v[168:171]
  ds_read_b64_tr_b16 a[58:59], v11 offset:1024
  v_cvt_pk_bf16_f32 v21, v17, v18
  v_mfma_f32_16x16x32_bf16 v[172:175], a[120:123], a[176:179], v[172:175]
  ds_read_b64_tr_b16 a[60:61], v11 offset:4096
  v_lshlrev_b32 v17, 16, v21
  v_mfma_f32_16x16x32_bf16 v[172:175], a[124:127], a[180:183], v[172:175]
  ds_read_b64_tr_b16 a[62:63], v11 offset:5120
  v_and_b32 v18, 0xffff0000, v21
  v_mfma_f32_16x16x32_bf16 v[176:179], a[176:179], a[128:131], v[176:179]
  ds_read_b64_tr_b16 a[64:65], v8 offset:16384
  v_mul_f32 v17, v17, v23
  v_mfma_f32_16x16x32_bf16 v[176:179], a[180:183], a[132:135], v[176:179]
  ds_read_b64_tr_b16 a[66:67], v8 offset:17408
  v_mul_f32 v18, v18, v23
  v_mfma_f32_16x16x32_bf16 v[180:183], a[176:179], a[136:139], v[180:183]
  ds_read_b64_tr_b16 a[68:69], v8 offset:20480
  v_cvt_pk_bf16_f32 v21, v17, v18
  v_mfma_f32_16x16x32_bf16 v[180:183], a[180:183], a[140:143], v[180:183]
  ds_read_b64_tr_b16 a[70:71], v8 offset:21504
  v_accvgpr_read_b32 v16, a226
  v_mfma_f32_16x16x32_bf16 v[184:187], a[176:179], a[144:147], v[184:187]
  ds_read_b64_tr_b16 a[72:73], v9 offset:16384
  v_lshlrev_b32 v17, 16, v16
  v_mfma_f32_16x16x32_bf16 v[184:187], a[180:183], a[148:151], v[184:187]
  ds_read_b64_tr_b16 a[74:75], v9 offset:17408
  v_and_b32 v18, 0xffff0000, v16
  v_mfma_f32_16x16x32_bf16 v[188:191], a[176:179], a[152:155], v[188:191]
  ds_read_b64_tr_b16 a[76:77], v9 offset:20480
  v_accvgpr_write_b32 a225, v21
  v_mfma_f32_16x16x32_bf16 v[188:191], a[180:183], a[156:159], v[188:191]
  s_waitcnt lgkmcnt(6)
  ds_read_b64_tr_b16 a[78:79], v9 offset:21504
  v_sub_f32 v17, v17, v22
  v_mfma_f32_16x16x32_bf16 v[192:195], a[96:99], a[160:163], v[192:195]
  ds_read_b64_tr_b16 a[80:81], v10 offset:16384
  v_sub_f32 v18, v18, v22
  v_mfma_f32_16x16x32_bf16 v[192:195], a[100:103], a[164:167], v[192:195]
  ds_read_b64_tr_b16 a[82:83], v10 offset:17408
  v_cvt_pk_bf16_f32 v21, v17, v18
  v_mfma_f32_16x16x32_bf16 v[196:199], a[104:107], a[160:163], v[196:199]
  ds_read_b64_tr_b16 a[84:85], v10 offset:20480
  v_lshlrev_b32 v17, 16, v21
  v_mfma_f32_16x16x32_bf16 v[196:199], a[108:111], a[164:167], v[196:199]
  ds_read_b64_tr_b16 a[86:87], v10 offset:21504
  v_and_b32 v18, 0xffff0000, v21
  v_mfma_f32_16x16x32_bf16 v[200:203], a[112:115], a[160:163], v[200:203]
  ds_read_b64_tr_b16 a[88:89], v11 offset:16384
  v_mul_f32 v17, v17, v23
  v_mfma_f32_16x16x32_bf16 v[200:203], a[116:119], a[164:167], v[200:203]
  ds_read_b64_tr_b16 a[90:91], v11 offset:17408
  v_mul_f32 v18, v18, v23
  v_mfma_f32_16x16x32_bf16 v[204:207], a[120:123], a[160:163], v[204:207]
  ds_read_b64_tr_b16 a[92:93], v11 offset:20480
  v_cvt_pk_bf16_f32 v21, v17, v18
  v_mfma_f32_16x16x32_bf16 v[204:207], a[124:127], a[164:167], v[204:207]
  ds_read_b64_tr_b16 a[94:95], v11 offset:21504
  v_accvgpr_read_b32 v16, a227
  v_mfma_f32_16x16x32_bf16 v[208:211], a[160:163], a[128:131], v[208:211]
  v_lshlrev_b32 v17, 16, v16
  v_and_b32 v18, 0xffff0000, v16
  v_mfma_f32_16x16x32_bf16 v[208:211], a[164:167], a[132:135], v[208:211]
  v_accvgpr_write_b32 a226, v21
  v_sub_f32 v17, v17, v22
  v_mfma_f32_16x16x32_bf16 v[212:215], a[160:163], a[136:139], v[212:215]
  v_sub_f32 v18, v18, v22
  v_cvt_pk_bf16_f32 v21, v17, v18
  v_mfma_f32_16x16x32_bf16 v[212:215], a[164:167], a[140:143], v[212:215]
  v_lshlrev_b32 v17, 16, v21
  v_and_b32 v18, 0xffff0000, v21
  v_mfma_f32_16x16x32_bf16 v[216:219], a[160:163], a[144:147], v[216:219]
  v_mul_f32 v17, v17, v23
  v_mul_f32 v18, v18, v23
  v_mfma_f32_16x16x32_bf16 v[216:219], a[164:167], a[148:151], v[216:219]
  v_cvt_pk_bf16_f32 v21, v17, v18
  v_accvgpr_write_b32 a227, v21
  v_mfma_f32_16x16x32_bf16 v[220:223], a[160:163], a[152:155], v[220:223]
  s_add_u32 m0, s48, 0x8000
  ds_write_b128 v20, a[216:219]
  v_mfma_f32_16x16x32_bf16 v[220:223], a[164:167], a[156:159], v[220:223]
  ds_write_b128 v20, a[220:223] offset:4608
  ds_write_b128 v19, a[224:227] offset:9216
  s_waitcnt vmcnt(2) lgkmcnt(0)
  s_barrier
  v_mfma_f32_16x16x32_bf16 v[224:227], a[96:99], a[168:171], v[224:227]
  s_add_u32 s58, s46, 0x280
  buffer_load_dword v30, v31, s[36:39], 0 offen sc1
  v_mfma_f32_16x16x32_bf16 v[224:227], a[100:103], a[172:175], v[224:227]
  s_add_u32 s59, s46, 0x2280
  buffer_load_dwordx4 v2, s[8:11], s58 offen lds
  v_mfma_f32_16x16x32_bf16 v[228:231], a[104:107], a[168:171], v[228:231]
  s_add_u32 m0, s48, 0x8400
  ds_read_b128 a[176:179], v6
  ds_read_b128 a[180:183], v7
  v_mfma_f32_16x16x32_bf16 v[228:231], a[108:111], a[172:175], v[228:231]
  buffer_load_dwordx4 v3, s[8:11], s59 offen lds
  v_mfma_f32_16x16x32_bf16 v[232:235], a[112:115], a[168:171], v[232:235]
  s_add_u32 m0, s48, 0x8800
  ds_read_b128 a[160:163], v6 offset:2048
  ds_read_b128 a[164:167], v7 offset:2048
  v_mfma_f32_16x16x32_bf16 v[232:235], a[116:119], a[172:175], v[232:235]
  s_add_u32 s56, s46, 0x4280
  v_bfe_u32 v17, v0, 3, 3
  v_lshl_add_u32 v17, v17, 4, v1
  v_mfma_f32_16x16x32_bf16 v[236:239], a[120:123], a[168:171], v[236:239]
  buffer_load_dwordx4 v2, s[8:11], s56 offen lds
  v_mfma_f32_16x16x32_bf16 v[236:239], a[124:127], a[172:175], v[236:239]
  s_add_u32 m0, s48, 0x8c00
  v_add_u32 v21, s44, v17
  v_bfe_u32 v17, v0, 5, 1
  v_mfma_f32_16x16x32_bf16 v[240:243], a[168:171], a[128:131], v[240:243]
  s_add_u32 s57, s46, 0x6280
  ds_read_b128 a[216:219], v21
  ds_read_b128 a[220:223], v21 offset:4608
  v_mfma_f32_16x16x32_bf16 v[240:243], a[172:175], a[132:135], v[240:243]
  s_lshl_b32 s44, s42, 1
  buffer_load_dwordx4 v3, s[8:11], s57 offen lds
  v_mfma_f32_16x16x32_bf16 v[244:247], a[168:171], a[136:139], v[244:247]
  s_add_u32 m0, s48, 0x9000
  ds_read_b128 a[224:227], v21 offset:9216
  v_bfe_u32 v18, v0, 3, 2
  v_mfma_f32_16x16x32_bf16 v[244:247], a[172:175], a[140:143], v[244:247]
  s_add_u32 s58, s46, 0x8280
  v_lshlrev_b32 v17, 12, v17
  v_lshl_add_u32 v17, v18, 8, v17
  v_mfma_f32_16x16x32_bf16 v[248:251], a[168:171], a[144:147], v[248:251]
  s_cmp_lt_u32 s40, 2
  s_cselect_b32 s95, s43, s44
  buffer_load_dwordx4 v2, s[8:11], s58 offen lds
  v_mfma_f32_16x16x32_bf16 v[248:251], a[172:175], a[148:151], v[248:251]
  s_add_u32 m0, s48, 0x9400
  v_and_b32 v18, 7, v0
  v_lshl_add_u32 v16, v18, 4, v17
  v_mfma_f32_16x16x32_bf16 v[252:255], a[168:171], a[152:155], v[252:255]
  s_add_u32 s59, s46, 0xa280
  ds_read_b128 a[168:171], v6 offset:4096
  v_mfma_f32_16x16x32_bf16 v[252:255], a[172:175], a[156:159], v[252:255]
  s_waitcnt lgkmcnt(2)
  buffer_load_dwordx4 v3, s[8:11], s59 offen lds
  v_mfma_f32_16x16x32_bf16 a[0:3], a[32:35], a[176:179], a[0:3]
  s_add_u32 m0, s48, 0x9800
  ds_read_b128 a[172:175], v7 offset:4096
  ds_read_b64_tr_b16 a[96:97], v8 offset:32768
  v_mfma_f32_16x16x32_bf16 a[0:3], a[36:39], a[180:183], a[0:3]
  s_add_u32 s56, s46, 0xc280
  v_mfma_f32_16x16x32_bf16 a[4:7], a[40:43], a[176:179], a[4:7]
  s_and_b32 s43, s40, 1
  buffer_load_dwordx4 v2, s[8:11], s56 offen lds
  v_mfma_f32_16x16x32_bf16 a[4:7], a[44:47], a[180:183], a[4:7]
  s_add_u32 m0, s48, 0x9c00
  ds_read_b64_tr_b16 a[98:99], v8 offset:33792
  v_mfma_f32_16x16x32_bf16 a[8:11], a[48:51], a[176:179], a[8:11]
  s_add_u32 s57, s46, 0xe280
  v_mfma_f32_16x16x32_bf16 a[8:11], a[52:55], a[180:183], a[8:11]
  s_lshr_b32 s44, s40, 1
  buffer_load_dwordx4 v3, s[8:11], s57 offen lds
  v_mfma_f32_16x16x32_bf16 a[12:15], a[56:59], a[176:179], a[12:15]
  s_add_u32 m0, s49, 0x0
  ds_read_b64_tr_b16 a[100:101], v8 offset:36864
  v_mfma_f32_16x16x32_bf16 a[12:15], a[60:63], a[180:183], a[12:15]
  s_add_u32 s58, s47, 0x300000
  v_mfma_f32_16x16x32_bf16 a[16:19], a[176:179], a[64:67], a[16:19]
  s_add_u32 s95, s95, s43
  buffer_load_dwordx4 v4, s[12:15], s58 offen lds
  v_mfma_f32_16x16x32_bf16 a[16:19], a[180:183], a[68:71], a[16:19]
  s_add_u32 m0, s49, 0x400
  ds_read_b64_tr_b16 a[102:103], v8 offset:37888
  v_mfma_f32_16x16x32_bf16 a[20:23], a[176:179], a[72:75], a[20:23]
  s_add_u32 s59, s47, 0x308000
  v_mfma_f32_16x16x32_bf16 a[20:23], a[180:183], a[76:79], a[20:23]
  s_lshl_b32 s44, s44, 7
  buffer_load_dwordx4 v4, s[12:15], s59 offen lds
  v_mfma_f32_16x16x32_bf16 a[24:27], a[176:179], a[80:83], a[24:27]
  s_add_u32 m0, s49, 0x800
  ds_read_b64_tr_b16 a[104:105], v9 offset:32768
  v_mfma_f32_16x16x32_bf16 a[24:27], a[180:183], a[84:87], a[24:27]
  s_add_u32 s56, s47, 0x320000
  v_mfma_f32_16x16x32_bf16 a[28:31], a[176:179], a[88:91], a[28:31]
  s_add_u32 s82, s82, s44
  buffer_load_dwordx4 v4, s[12:15], s56 offen lds
  v_mfma_f32_16x16x32_bf16 a[28:31], a[180:183], a[92:95], a[28:31]
  s_add_u32 m0, s49, 0xc00
  ds_read_b128 a[176:179], v6 offset:6144
  ds_read_b128 a[180:183], v7 offset:6144
  v_mfma_f32_16x16x32_bf16 v[32:35], a[32:35], a[160:163], v[32:35]
  s_add_u32 s57, s47, 0x328000
  ds_read_b64_tr_b16 a[106:107], v9 offset:33792
  v_mfma_f32_16x16x32_bf16 v[32:35], a[36:39], a[164:167], v[32:35]
  s_lshl_b32 s43, s43, 18
  buffer_load_dwordx4 v4, s[12:15], s57 offen lds
  v_mfma_f32_16x16x32_bf16 v[36:39], a[40:43], a[160:163], v[36:39]
  s_add_u32 m0, s49, 0x1000
  ds_read_b64_tr_b16 a[108:109], v9 offset:36864
  v_mfma_f32_16x16x32_bf16 v[36:39], a[44:47], a[164:167], v[36:39]
  s_add_u32 s58, s47, 0x340000
  v_mfma_f32_16x16x32_bf16 v[40:43], a[48:51], a[160:163], v[40:43]
  s_add_u32 s82, s82, s43
  buffer_load_dwordx4 v4, s[12:15], s58 offen lds
  v_mfma_f32_16x16x32_bf16 v[40:43], a[52:55], a[164:167], v[40:43]
  s_add_u32 m0, s49, 0x1400
  ds_read_b64_tr_b16 a[110:111], v9 offset:37888
  v_mfma_f32_16x16x32_bf16 v[44:47], a[56:59], a[160:163], v[44:47]
  s_add_u32 s59, s47, 0x348000
  v_mfma_f32_16x16x32_bf16 v[44:47], a[60:63], a[164:167], v[44:47]
  s_mov_b32 s58, 0x200000
  buffer_load_dwordx4 v4, s[12:15], s59 offen lds
  v_mfma_f32_16x16x32_bf16 v[48:51], a[160:163], a[64:67], v[48:51]
  s_add_u32 m0, s49, 0x1800
  ds_read_b64_tr_b16 a[112:113], v10 offset:32768
  v_mfma_f32_16x16x32_bf16 v[48:51], a[164:167], a[68:71], v[48:51]
  s_add_u32 s56, s47, 0x360000
  v_mfma_f32_16x16x32_bf16 v[52:55], a[160:163], a[72:75], v[52:55]
  s_mov_b32 s59, 0xd8000
  buffer_load_dwordx4 v4, s[12:15], s56 offen lds
  v_mfma_f32_16x16x32_bf16 v[52:55], a[164:167], a[76:79], v[52:55]
  s_add_u32 m0, s49, 0x1c00
  ds_read_b64_tr_b16 a[114:115], v10 offset:33792
  v_mfma_f32_16x16x32_bf16 v[56:59], a[160:163], a[80:83], v[56:59]
  s_add_u32 s57, s47, 0x368000
  v_mfma_f32_16x16x32_bf16 v[56:59], a[164:167], a[84:87], v[56:59]
  s_add_u32 s56, s62, 0x0
  buffer_load_dwordx4 v4, s[12:15], s57 offen lds
  v_mfma_f32_16x16x32_bf16 v[60:63], a[160:163], a[88:91], v[60:63]
  s_add_u32 s57, s62, 0x8000
  ds_read_b128 a[160:163], v6 offset:8192
  ds_read_b64_tr_b16 a[116:117], v10 offset:36864
  v_mfma_f32_16x16x32_bf16 v[60:63], a[164:167], a[92:95], v[60:63]
  s_waitcnt lgkmcnt(3)
  ds_read_b128 a[164:167], v7 offset:8192
  v_mfma_f32_16x16x32_bf16 v[64:67], a[32:35], a[168:171], v[64:67]
  s_lshl_b32 s43, s41, 7
  v_mfma_f32_16x16x32_bf16 v[64:67], a[36:39], a[172:175], v[64:67]
  s_add_u32 s83, s83, s43
  ds_read_b64_tr_b16 a[118:119], v10 offset:37888
  v_mfma_f32_16x16x32_bf16 v[68:71], a[40:43], a[168:171], v[68:71]
  s_cmp_lt_u32 s41, 27
  s_cselect_b32 s83, s83, 0x40000000
  v_mfma_f32_16x16x32_bf16 v[68:71], a[44:47], a[172:175], v[68:71]
  s_mul_i32 s81, s95, 81920
  v_mfma_f32_16x16x32_bf16 v[72:75], a[48:51], a[168:171], v[72:75]
  s_add_u32 s94, s81, 0x0
  ds_read_b64_tr_b16 a[120:121], v11 offset:32768
  v_mfma_f32_16x16x32_bf16 v[72:75], a[52:55], a[172:175], v[72:75]
  s_add_u32 s93, s81, 0x1000
  v_mfma_f32_16x16x32_bf16 v[76:79], a[56:59], a[168:171], v[76:79]
  s_lshl_b32 s44, s55, 13
  v_mfma_f32_16x16x32_bf16 v[76:79], a[60:63], a[172:175], v[76:79]
  s_mul_i32 s50, s95, 745472
  ds_read_b64_tr_b16 a[122:123], v11 offset:33792
  v_mfma_f32_16x16x32_bf16 v[80:83], a[168:171], a[64:67], v[80:83]
  buffer_load_dword a249, v26, s[16:19], s58 offen
  v_mfma_f32_16x16x32_bf16 v[80:83], a[172:175], a[68:71], v[80:83]
  s_add_u32 s58, s62, 0x10000
  buffer_load_dword a249, v27, s[20:23], s59 offen
  v_mfma_f32_16x16x32_bf16 v[84:87], a[168:171], a[72:75], v[84:87]
  s_cmp_lt_u32 s40, 2
  s_cselect_b32 s58, s58, 0x40000000
  ds_read_b64_tr_b16 a[124:125], v11 offset:36864
  v_mfma_f32_16x16x32_bf16 v[84:87], a[172:175], a[76:79], v[84:87]
  v_mfma_f32_16x16x32_bf16 v[88:91], a[168:171], a[80:83], v[88:91]
  v_mfma_f32_16x16x32_bf16 v[88:91], a[172:175], a[84:87], v[88:91]
  ds_read_b64_tr_b16 a[126:127], v11 offset:37888
  v_mfma_f32_16x16x32_bf16 v[92:95], a[168:171], a[88:91], v[92:95]
  ds_read_b128 a[168:171], v6 offset:10240
  v_mfma_f32_16x16x32_bf16 v[92:95], a[172:175], a[92:95], v[92:95]
  ds_read_b128 a[172:175], v7 offset:10240
  v_mfma_f32_16x16x32_bf16 v[96:99], a[32:35], a[176:179], v[96:99]
  ds_read_b64_tr_b16 a[128:129], v8 offset:49152
  v_mfma_f32_16x16x32_bf16 v[96:99], a[36:39], a[180:183], v[96:99]
  v_mfma_f32_16x16x32_bf16 v[100:103], a[40:43], a[176:179], v[100:103]
  v_mfma_f32_16x16x32_bf16 v[100:103], a[44:47], a[180:183], v[100:103]
  ds_read_b64_tr_b16 a[130:131], v8 offset:50176
  v_mfma_f32_16x16x32_bf16 v[104:107], a[48:51], a[176:179], v[104:107]
  buffer_store_dwordx4 a[216:219], v16, s[28:31], s56 offen sc1
  v_mfma_f32_16x16x32_bf16 v[104:107], a[52:55], a[180:183], v[104:107]
  v_mfma_f32_16x16x32_bf16 v[108:111], a[56:59], a[176:179], v[108:111]
  buffer_store_dwordx4 a[220:223], v16, s[28:31], s57 offen sc1
  v_mfma_f32_16x16x32_bf16 v[108:111], a[60:63], a[180:183], v[108:111]
  ds_read_b64_tr_b16 a[132:133], v8 offset:53248
  v_mfma_f32_16x16x32_bf16 v[112:115], a[176:179], a[64:67], v[112:115]
  buffer_store_dwordx4 a[224:227], v16, s[28:31], s58 offen sc1
  v_mfma_f32_16x16x32_bf16 v[112:115], a[180:183], a[68:71], v[112:115]
  ds_read_b64_tr_b16 a[134:135], v8 offset:54272
  v_mfma_f32_16x16x32_bf16 v[116:119], a[176:179], a[72:75], v[116:119]
  v_mfma_f32_16x16x32_bf16 v[116:119], a[180:183], a[76:79], v[116:119]
  v_mfma_f32_16x16x32_bf16 v[120:123], a[176:179], a[80:83], v[120:123]
  ds_read_b64_tr_b16 a[136:137], v9 offset:49152
  v_mfma_f32_16x16x32_bf16 v[120:123], a[180:183], a[84:87], v[120:123]
  v_mfma_f32_16x16x32_bf16 v[124:127], a[176:179], a[88:91], v[124:127]
  ds_read_b128 a[176:179], v6 offset:12288
  v_mfma_f32_16x16x32_bf16 v[124:127], a[180:183], a[92:95], v[124:127]
  s_waitcnt lgkmcnt(3)
  ds_read_b128 a[180:183], v7 offset:12288
  ds_read_b64_tr_b16 a[138:139], v9 offset:50176
  v_mfma_f32_16x16x32_bf16 v[128:131], a[32:35], a[160:163], v[128:131]
  v_mfma_f32_16x16x32_bf16 v[128:131], a[36:39], a[164:167], v[128:131]
  v_mfma_f32_16x16x32_bf16 v[132:135], a[40:43], a[160:163], v[132:135]
  ds_read_b64_tr_b16 a[140:141], v9 offset:53248
  v_mfma_f32_16x16x32_bf16 v[132:135], a[44:47], a[164:167], v[132:135]
  v_mfma_f32_16x16x32_bf16 v[136:139], a[48:51], a[160:163], v[136:139]
  v_mfma_f32_16x16x32_bf16 v[136:139], a[52:55], a[164:167], v[136:139]
  ds_read_b64_tr_b16 a[142:143], v9 offset:54272
  v_mfma_f32_16x16x32_bf16 v[140:143], a[56:59], a[160:163], v[140:143]
  v_mfma_f32_16x16x32_bf16 v[140:143], a[60:63], a[164:167], v[140:143]
  v_mfma_f32_16x16x32_bf16 v[144:147], a[160:163], a[64:67], v[144:147]
  ds_read_b64_tr_b16 a[144:145], v10 offset:49152
  v_mfma_f32_16x16x32_bf16 v[144:147], a[164:167], a[68:71], v[144:147]
  v_mfma_f32_16x16x32_bf16 v[148:151], a[160:163], a[72:75], v[148:151]
  v_mfma_f32_16x16x32_bf16 v[148:151], a[164:167], a[76:79], v[148:151]
  ds_read_b64_tr_b16 a[146:147], v10 offset:50176
  v_mfma_f32_16x16x32_bf16 v[152:155], a[160:163], a[80:83], v[152:155]
  v_mfma_f32_16x16x32_bf16 v[152:155], a[164:167], a[84:87], v[152:155]
  v_mfma_f32_16x16x32_bf16 v[156:159], a[160:163], a[88:91], v[156:159]
  s_nop 0
  ds_read_b128 a[160:163], v6 offset:14336
  ds_read_b64_tr_b16 a[148:149], v10 offset:53248
  v_mfma_f32_16x16x32_bf16 v[156:159], a[164:167], a[92:95], v[156:159]
  ds_read_b128 a[164:167], v7 offset:14336
  v_mfma_f32_16x16x32_bf16 v[160:163], a[32:35], a[168:171], v[160:163]
  v_mfma_f32_16x16x32_bf16 v[160:163], a[36:39], a[172:175], v[160:163]
  ds_read_b64_tr_b16 a[150:151], v10 offset:54272
  v_mfma_f32_16x16x32_bf16 v[164:167], a[40:43], a[168:171], v[164:167]
  v_mfma_f32_16x16x32_bf16 v[164:167], a[44:47], a[172:175], v[164:167]
  v_mfma_f32_16x16x32_bf16 v[168:171], a[48:51], a[168:171], v[168:171]
  ds_read_b64_tr_b16 a[152:153], v11 offset:49152
  v_mfma_f32_16x16x32_bf16 v[168:171], a[52:55], a[172:175], v[168:171]
  v_mfma_f32_16x16x32_bf16 v[172:175], a[56:59], a[168:171], v[172:175]
  v_mfma_f32_16x16x32_bf16 v[172:175], a[60:63], a[172:175], v[172:175]
  ds_read_b64_tr_b16 a[154:155], v11 offset:50176
  v_mfma_f32_16x16x32_bf16 v[176:179], a[168:171], a[64:67], v[176:179]
  v_mfma_f32_16x16x32_bf16 v[176:179], a[172:175], a[68:71], v[176:179]
  v_mfma_f32_16x16x32_bf16 v[180:183], a[168:171], a[72:75], v[180:183]
  ds_read_b64_tr_b16 a[156:157], v11 offset:53248
  v_mfma_f32_16x16x32_bf16 v[180:183], a[172:175], a[76:79], v[180:183]
  v_mfma_f32_16x16x32_bf16 v[184:187], a[168:171], a[80:83], v[184:187]
  v_mfma_f32_16x16x32_bf16 v[184:187], a[172:175], a[84:87], v[184:187]
  ds_read_b64_tr_b16 a[158:159], v11 offset:54272
  v_mfma_f32_16x16x32_bf16 v[188:191], a[168:171], a[88:91], v[188:191]
  v_mfma_f32_16x16x32_bf16 v[188:191], a[172:175], a[92:95], v[188:191]
  s_waitcnt lgkmcnt(2)
  v_mfma_f32_16x16x32_bf16 v[192:195], a[32:35], a[176:179], v[192:195]
  v_mfma_f32_16x16x32_bf16 v[192:195], a[36:39], a[180:183], v[192:195]
  v_mfma_f32_16x16x32_bf16 v[196:199], a[40:43], a[176:179], v[196:199]
  v_mfma_f32_16x16x32_bf16 v[196:199], a[44:47], a[180:183], v[196:199]
  v_mfma_f32_16x16x32_bf16 v[200:203], a[48:51], a[176:179], v[200:203]
  v_mfma_f32_16x16x32_bf16 v[200:203], a[52:55], a[180:183], v[200:203]
  v_mfma_f32_16x16x32_bf16 v[204:207], a[56:59], a[176:179], v[204:207]
  v_mfma_f32_16x16x32_bf16 v[204:207], a[60:63], a[180:183], v[204:207]
  v_mfma_f32_16x16x32_bf16 v[208:211], a[176:179], a[64:67], v[208:211]
  v_mfma_f32_16x16x32_bf16 v[208:211], a[180:183], a[68:71], v[208:211]
  v_mfma_f32_16x16x32_bf16 v[212:215], a[176:179], a[72:75], v[212:215]
  v_mfma_f32_16x16x32_bf16 v[212:215], a[180:183], a[76:79], v[212:215]
  v_mfma_f32_16x16x32_bf16 v[216:219], a[176:179], a[80:83], v[216:219]
  v_mfma_f32_16x16x32_bf16 v[216:219], a[180:183], a[84:87], v[216:219]
  v_mfma_f32_16x16x32_bf16 v[220:223], a[176:179], a[88:91], v[220:223]
  s_add_u32 m0, s48, 0x0
  v_mfma_f32_16x16x32_bf16 v[220:223], a[180:183], a[92:95], v[220:223]
  s_waitcnt vmcnt(5) lgkmcnt(0)
  s_barrier
  v_mfma_f32_16x16x32_bf16 v[224:227], a[32:35], a[160:163], v[224:227]
  s_add_u32 s59, s46, 0x300
  buffer_load_dwordx4 v2, s[8:11], s59 offen lds
  v_mfma_f32_16x16x32_bf16 v[224:227], a[36:39], a[164:167], v[224:227]
  s_add_u32 m0, s48, 0x400
  ds_read_b128 a[168:171], v6 offset:32768
  ds_read_b128 a[172:175], v7 offset:32768
  v_mfma_f32_16x16x32_bf16 v[228:231], a[40:43], a[160:163], v[228:231]
  s_add_u32 s56, s46, 0x2300
  ds_read_b128 a[176:179], v6 offset:34816
  ds_read_b128 a[180:183], v7 offset:34816
  v_mfma_f32_16x16x32_bf16 v[228:231], a[44:47], a[164:167], v[228:231]
  buffer_load_dwordx4 v3, s[8:11], s56 offen lds
  v_mfma_f32_16x16x32_bf16 v[232:235], a[48:51], a[160:163], v[232:235]
  s_add_u32 m0, s48, 0x800
  v_mfma_f32_16x16x32_bf16 v[232:235], a[52:55], a[164:167], v[232:235]
  s_add_u32 s57, s46, 0x4300
  v_mfma_f32_16x16x32_bf16 v[236:239], a[56:59], a[160:163], v[236:239]
  buffer_load_dwordx4 v2, s[8:11], s57 offen lds
  v_mfma_f32_16x16x32_bf16 v[236:239], a[60:63], a[164:167], v[236:239]
  s_add_u32 m0, s48, 0xc00
  v_mfma_f32_16x16x32_bf16 v[240:243], a[160:163], a[64:67], v[240:243]
  s_add_u32 s58, s46, 0x6300
  v_mfma_f32_16x16x32_bf16 v[240:243], a[164:167], a[68:71], v[240:243]
  buffer_load_dwordx4 v3, s[8:11], s58 offen lds
  v_mfma_f32_16x16x32_bf16 v[244:247], a[160:163], a[72:75], v[244:247]
  s_add_u32 m0, s48, 0x1000
  v_mfma_f32_16x16x32_bf16 v[244:247], a[164:167], a[76:79], v[244:247]
  s_add_u32 s59, s46, 0x8300
  v_mfma_f32_16x16x32_bf16 v[248:251], a[160:163], a[80:83], v[248:251]
  buffer_load_dwordx4 v2, s[8:11], s59 offen lds
  v_mfma_f32_16x16x32_bf16 v[248:251], a[164:167], a[84:87], v[248:251]
  s_add_u32 m0, s48, 0x1400
  v_mfma_f32_16x16x32_bf16 v[252:255], a[160:163], a[88:91], v[252:255]
  s_add_u32 s56, s46, 0xa300
  ds_read_b128 a[160:163], v6 offset:36864
  v_mfma_f32_16x16x32_bf16 v[252:255], a[164:167], a[92:95], v[252:255]
  s_waitcnt lgkmcnt(1)
  buffer_load_dwordx4 v3, s[8:11], s56 offen lds
  v_mfma_f32_16x16x32_bf16 a[0:3], a[96:99], a[168:171], a[0:3]
  s_add_u32 m0, s48, 0x1800
  ds_read_b128 a[164:167], v7 offset:36864
  ds_read_b64_tr_b16 a[32:33], v8
  v_mfma_f32_16x16x32_bf16 a[0:3], a[100:103], a[172:175], a[0:3]
  s_add_u32 s57, s46, 0xc300
  v_mfma_f32_16x16x32_bf16 a[4:7], a[104:107], a[168:171], a[4:7]
  buffer_load_dwordx4 v2, s[8:11], s57 offen lds
  v_mfma_f32_16x16x32_bf16 a[4:7], a[108:111], a[172:175], a[4:7]
  s_add_u32 m0, s48, 0x1c00
  ds_read_b64_tr_b16 a[34:35], v8 offset:1024
  v_mfma_f32_16x16x32_bf16 a[8:11], a[112:115], a[168:171], a[8:11]
  s_add_u32 s58, s46, 0xe300
  v_mfma_f32_16x16x32_bf16 a[8:11], a[116:119], a[172:175], a[8:11]
  buffer_load_dwordx4 v3, s[8:11], s58 offen lds
  v_mfma_f32_16x16x32_bf16 a[12:15], a[120:123], a[168:171], a[12:15]
  s_add_u32 m0, s49, 0x8000
  ds_read_b64_tr_b16 a[36:37], v8 offset:4096
  v_mfma_f32_16x16x32_bf16 a[12:15], a[124:127], a[172:175], a[12:15]
  s_add_u32 s59, s47, 0x380000
  v_mfma_f32_16x16x32_bf16 a[16:19], a[168:171], a[128:131], a[16:19]
  buffer_load_dwordx4 v4, s[12:15], s59 offen lds
  v_mfma_f32_16x16x32_bf16 a[16:19], a[172:175], a[132:135], a[16:19]
  s_add_u32 m0, s49, 0x8400
  ds_read_b64_tr_b16 a[38:39], v8 offset:5120
  v_mfma_f32_16x16x32_bf16 a[20:23], a[168:171], a[136:139], a[20:23]
  s_add_u32 s56, s47, 0x388000
  v_mfma_f32_16x16x32_bf16 a[20:23], a[172:175], a[140:143], a[20:23]
  buffer_load_dwordx4 v4, s[12:15], s56 offen lds
  v_mfma_f32_16x16x32_bf16 a[24:27], a[168:171], a[144:147], a[24:27]
  s_add_u32 m0, s49, 0x8800
  ds_read_b64_tr_b16 a[40:41], v9
  v_mfma_f32_16x16x32_bf16 a[24:27], a[172:175], a[148:151], a[24:27]
  s_add_u32 s57, s47, 0x3a0000
  v_mfma_f32_16x16x32_bf16 a[28:31], a[168:171], a[152:155], a[28:31]
  buffer_load_dwordx4 v4, s[12:15], s57 offen lds
  v_mfma_f32_16x16x32_bf16 a[28:31], a[172:175], a[156:159], a[28:31]
  s_add_u32 m0, s49, 0x8c00
  ds_read_b128 a[168:171], v6 offset:38912
  ds_read_b128 a[172:175], v7 offset:38912
  v_mfma_f32_16x16x32_bf16 v[32:35], a[96:99], a[176:179], v[32:35]
  s_add_u32 s58, s47, 0x3a8000
  ds_read_b64_tr_b16 a[42:43], v9 offset:1024
  v_mfma_f32_16x16x32_bf16 v[32:35], a[100:103], a[180:183], v[32:35]
  buffer_load_dwordx4 v4, s[12:15], s58 offen lds
  v_mfma_f32_16x16x32_bf16 v[36:39], a[104:107], a[176:179], v[36:39]
  s_add_u32 m0, s49, 0x9000
  ds_read_b64_tr_b16 a[44:45], v9 offset:4096
  v_mfma_f32_16x16x32_bf16 v[36:39], a[108:111], a[180:183], v[36:39]
  s_add_u32 s59, s47, 0x3c0000
  v_mfma_f32_16x16x32_bf16 v[40:43], a[112:115], a[176:179], v[40:43]
  buffer_load_dwordx4 v4, s[12:15], s59 offen lds
  v_mfma_f32_16x16x32_bf16 v[40:43], a[116:119], a[180:183], v[40:43]
  s_add_u32 m0, s49, 0x9400
  ds_read_b64_tr_b16 a[46:47], v9 offset:5120
  v_mfma_f32_16x16x32_bf16 v[44:47], a[120:123], a[176:179], v[44:47]
  s_add_u32 s56, s47, 0x3c8000
  v_mfma_f32_16x16x32_bf16 v[44:47], a[124:127], a[180:183], v[44:47]
  s_mov_b32 s59, 0x400000
  buffer_load_dwordx4 v4, s[12:15], s56 offen lds
  v_mfma_f32_16x16x32_bf16 v[48:51], a[176:179], a[128:131], v[48:51]
  s_add_u32 m0, s49, 0x9800
  ds_read_b64_tr_b16 a[48:49], v10
  v_mfma_f32_16x16x32_bf16 v[48:51], a[180:183], a[132:135], v[48:51]
  s_add_u32 s57, s47, 0x3e0000
  v_mfma_f32_16x16x32_bf16 v[52:55], a[176:179], a[136:139], v[52:55]
  s_mov_b32 s56, 0x1b0000
  buffer_load_dwordx4 v4, s[12:15], s57 offen lds
  v_mfma_f32_16x16x32_bf16 v[52:55], a[180:183], a[140:143], v[52:55]
  s_add_u32 m0, s49, 0x9c00
  ds_read_b64_tr_b16 a[50:51], v10 offset:1024
  v_mfma_f32_16x16x32_bf16 v[56:59], a[176:179], a[144:147], v[56:59]
  s_add_u32 s58, s47, 0x3e8000
  v_mfma_f32_16x16x32_bf16 v[56:59], a[180:183], a[148:151], v[56:59]
  buffer_load_dwordx4 v4, s[12:15], s58 offen lds
  v_mfma_f32_16x16x32_bf16 v[60:63], a[176:179], a[152:155], v[60:63]
  s_mov_b32 s12, s84
  ds_read_b128 a[176:179], v6 offset:40960
  ds_read_b64_tr_b16 a[52:53], v10 offset:4096
  v_mfma_f32_16x16x32_bf16 v[60:63], a[180:183], a[156:159], v[60:63]
  s_waitcnt lgkmcnt(3)
  ds_read_b128 a[180:183], v7 offset:40960
  v_mfma_f32_16x16x32_bf16 v[64:67], a[96:99], a[160:163], v[64:67]
  s_and_b32 s13, s85, 0xffff
  v_mfma_f32_16x16x32_bf16 v[64:67], a[100:103], a[164:167], v[64:67]
  s_mov_b32 s14, 0x21c000
  ds_read_b64_tr_b16 a[54:55], v10 offset:5120
  v_mfma_f32_16x16x32_bf16 v[68:71], a[104:107], a[160:163], v[68:71]
  v_mfma_f32_16x16x32_bf16 v[68:71], a[108:111], a[164:167], v[68:71]
  v_mfma_f32_16x16x32_bf16 v[72:75], a[112:115], a[160:163], v[72:75]
  ds_read_b64_tr_b16 a[56:57], v11
  v_mfma_f32_16x16x32_bf16 v[72:75], a[116:119], a[164:167], v[72:75]
  v_mfma_f32_16x16x32_bf16 v[76:79], a[120:123], a[160:163], v[76:79]
  v_mfma_f32_16x16x32_bf16 v[76:79], a[124:127], a[164:167], v[76:79]
  ds_read_b64_tr_b16 a[58:59], v11 offset:1024
  v_mfma_f32_16x16x32_bf16 v[80:83], a[160:163], a[128:131], v[80:83]
  buffer_load_dword a250, v26, s[16:19], s59 offen
  v_mfma_f32_16x16x32_bf16 v[80:83], a[164:167], a[132:135], v[80:83]
  buffer_load_dword a250, v27, s[20:23], s56 offen
  v_mfma_f32_16x16x32_bf16 v[84:87], a[160:163], a[136:139], v[84:87]
  ds_read_b64_tr_b16 a[60:61], v11 offset:4096
  v_mfma_f32_16x16x32_bf16 v[84:87], a[164:167], a[140:143], v[84:87]
  v_mfma_f32_16x16x32_bf16 v[88:91], a[160:163], a[144:147], v[88:91]
  v_mfma_f32_16x16x32_bf16 v[88:91], a[164:167], a[148:151], v[88:91]
  ds_read_b64_tr_b16 a[62:63], v11 offset:5120
  v_mfma_f32_16x16x32_bf16 v[92:95], a[160:163], a[152:155], v[92:95]
  ds_read_b128 a[160:163], v6 offset:43008
  v_mfma_f32_16x16x32_bf16 v[92:95], a[164:167], a[156:159], v[92:95]
  ds_read_b128 a[164:167], v7 offset:43008
  v_mfma_f32_16x16x32_bf16 v[96:99], a[96:99], a[168:171], v[96:99]
  ds_read_b64_tr_b16 a[64:65], v8 offset:16384
  v_mfma_f32_16x16x32_bf16 v[96:99], a[100:103], a[172:175], v[96:99]
  v_mfma_f32_16x16x32_bf16 v[100:103], a[104:107], a[168:171], v[100:103]
  v_mfma_f32_16x16x32_bf16 v[100:103], a[108:111], a[172:175], v[100:103]
  ds_read_b64_tr_b16 a[66:67], v8 offset:17408
  v_mfma_f32_16x16x32_bf16 v[104:107], a[112:115], a[168:171], v[104:107]
  v_mfma_f32_16x16x32_bf16 v[104:107], a[116:119], a[172:175], v[104:107]
  v_mfma_f32_16x16x32_bf16 v[108:111], a[120:123], a[168:171], v[108:111]
  ds_read_b64_tr_b16 a[68:69], v8 offset:20480
  v_mfma_f32_16x16x32_bf16 v[108:111], a[124:127], a[172:175], v[108:111]
  v_mfma_f32_16x16x32_bf16 v[112:115], a[168:171], a[128:131], v[112:115]
  v_mfma_f32_16x16x32_bf16 v[112:115], a[172:175], a[132:135], v[112:115]
  ds_read_b64_tr_b16 a[70:71], v8 offset:21504
  v_mfma_f32_16x16x32_bf16 v[116:119], a[168:171], a[136:139], v[116:119]
  v_mfma_f32_16x16x32_bf16 v[116:119], a[172:175], a[140:143], v[116:119]
  v_mfma_f32_16x16x32_bf16 v[120:123], a[168:171], a[144:147], v[120:123]
  ds_read_b64_tr_b16 a[72:73], v9 offset:16384
  v_mfma_f32_16x16x32_bf16 v[120:123], a[172:175], a[148:151], v[120:123]
  v_mfma_f32_16x16x32_bf16 v[124:127], a[168:171], a[152:155], v[124:127]
  ds_read_b128 a[168:171], v6 offset:45056
  v_mfma_f32_16x16x32_bf16 v[124:127], a[172:175], a[156:159], v[124:127]
  s_waitcnt lgkmcnt(3)
  ds_read_b128 a[172:175], v7 offset:45056
  ds_read_b64_tr_b16 a[74:75], v9 offset:17408
  v_mfma_f32_16x16x32_bf16 v[128:131], a[96:99], a[176:179], v[128:131]
  v_mfma_f32_16x16x32_bf16 v[128:131], a[100:103], a[180:183], v[128:131]
  v_mfma_f32_16x16x32_bf16 v[132:135], a[104:107], a[176:179], v[132:135]
  ds_read_b64_tr_b16 a[76:77], v9 offset:20480
  v_mfma_f32_16x16x32_bf16 v[132:135], a[108:111], a[180:183], v[132:135]
  v_mfma_f32_16x16x32_bf16 v[136:139], a[112:115], a[176:179], v[136:139]
  v_mfma_f32_16x16x32_bf16 v[136:139], a[116:119], a[180:183], v[136:139]
  ds_read_b64_tr_b16 a[78:79], v9 offset:21504
  v_mfma_f32_16x16x32_bf16 v[140:143], a[120:123], a[176:179], v[140:143]
  v_mfma_f32_16x16x32_bf16 v[140:143], a[124:127], a[180:183], v[140:143]
  v_mfma_f32_16x16x32_bf16 v[144:147], a[176:179], a[128:131], v[144:147]
  ds_read_b64_tr_b16 a[80:81], v10 offset:16384
  v_mfma_f32_16x16x32_bf16 v[144:147], a[180:183], a[132:135], v[144:147]
  v_mfma_f32_16x16x32_bf16 v[148:151], a[176:179], a[136:139], v[148:151]
  v_mfma_f32_16x16x32_bf16 v[148:151], a[180:183], a[140:143], v[148:151]
  ds_read_b64_tr_b16 a[82:83], v10 offset:17408
  v_mfma_f32_16x16x32_bf16 v[152:155], a[176:179], a[144:147], v[152:155]
  v_mfma_f32_16x16x32_bf16 v[152:155], a[180:183], a[148:151], v[152:155]
  v_mfma_f32_16x16x32_bf16 v[156:159], a[176:179], a[152:155], v[156:159]
  s_nop 0
  ds_read_b128 a[176:179], v6 offset:47104
  ds_read_b64_tr_b16 a[84:85], v10 offset:20480
  v_mfma_f32_16x16x32_bf16 v[156:159], a[180:183], a[156:159], v[156:159]
  ds_read_b128 a[180:183], v7 offset:47104
  v_mfma_f32_16x16x32_bf16 v[160:163], a[96:99], a[160:163], v[160:163]
  v_mfma_f32_16x16x32_bf16 v[160:163], a[100:103], a[164:167], v[160:163]
  ds_read_b64_tr_b16 a[86:87], v10 offset:21504
  v_mfma_f32_16x16x32_bf16 v[164:167], a[104:107], a[160:163], v[164:167]
  v_mfma_f32_16x16x32_bf16 v[164:167], a[108:111], a[164:167], v[164:167]
  v_mfma_f32_16x16x32_bf16 v[168:171], a[112:115], a[160:163], v[168:171]
  ds_read_b64_tr_b16 a[88:89], v11 offset:16384
  v_mfma_f32_16x16x32_bf16 v[168:171], a[116:119], a[164:167], v[168:171]
  v_mfma_f32_16x16x32_bf16 v[172:175], a[120:123], a[160:163], v[172:175]
  v_mfma_f32_16x16x32_bf16 v[172:175], a[124:127], a[164:167], v[172:175]
  ds_read_b64_tr_b16 a[90:91], v11 offset:17408
  v_mfma_f32_16x16x32_bf16 v[176:179], a[160:163], a[128:131], v[176:179]
  v_mfma_f32_16x16x32_bf16 v[176:179], a[164:167], a[132:135], v[176:179]
  v_mfma_f32_16x16x32_bf16 v[180:183], a[160:163], a[136:139], v[180:183]
  ds_read_b64_tr_b16 a[92:93], v11 offset:20480
  v_mfma_f32_16x16x32_bf16 v[180:183], a[164:167], a[140:143], v[180:183]
  v_mfma_f32_16x16x32_bf16 v[184:187], a[160:163], a[144:147], v[184:187]
  v_mfma_f32_16x16x32_bf16 v[184:187], a[164:167], a[148:151], v[184:187]
  ds_read_b64_tr_b16 a[94:95], v11 offset:21504
  v_mfma_f32_16x16x32_bf16 v[188:191], a[160:163], a[152:155], v[188:191]
  v_mfma_f32_16x16x32_bf16 v[188:191], a[164:167], a[156:159], v[188:191]
  s_waitcnt lgkmcnt(2)
  v_mfma_f32_16x16x32_bf16 v[192:195], a[96:99], a[168:171], v[192:195]
  v_mfma_f32_16x16x32_bf16 v[192:195], a[100:103], a[172:175], v[192:195]
  v_mfma_f32_16x16x32_bf16 v[196:199], a[104:107], a[168:171], v[196:199]
  v_mfma_f32_16x16x32_bf16 v[196:199], a[108:111], a[172:175], v[196:199]
  v_mfma_f32_16x16x32_bf16 v[200:203], a[112:115], a[168:171], v[200:203]
  v_mfma_f32_16x16x32_bf16 v[200:203], a[116:119], a[172:175], v[200:203]
  v_mfma_f32_16x16x32_bf16 v[204:207], a[120:123], a[168:171], v[204:207]
  v_mfma_f32_16x16x32_bf16 v[204:207], a[124:127], a[172:175], v[204:207]
  v_mfma_f32_16x16x32_bf16 v[208:211], a[168:171], a[128:131], v[208:211]
  v_mfma_f32_16x16x32_bf16 v[208:211], a[172:175], a[132:135], v[208:211]
  v_mfma_f32_16x16x32_bf16 v[212:215], a[168:171], a[136:139], v[212:215]
  v_mfma_f32_16x16x32_bf16 v[212:215], a[172:175], a[140:143], v[212:215]
  v_mfma_f32_16x16x32_bf16 v[216:219], a[168:171], a[144:147], v[216:219]
  v_mfma_f32_16x16x32_bf16 v[216:219], a[172:175], a[148:151], v[216:219]
  v_mfma_f32_16x16x32_bf16 v[220:223], a[168:171], a[152:155], v[220:223]
  s_add_u32 m0, s48, 0x8000
  v_mfma_f32_16x16x32_bf16 v[220:223], a[172:175], a[156:159], v[220:223]
  s_waitcnt vmcnt(2) lgkmcnt(0)
  s_barrier
  v_readfirstlane_b32 s43, v30
  s_nop 3
  s_cmp_ge_u32 s43, 8
  s_cbranch_scc1 L_pd_Z
  v_mov_b32 v31, 0
  s_mov_b32 s45, 0x30d40
L_poll_Z:
  buffer_load_dword v30, v31, s[36:39], 0 offen sc1
  s_waitcnt vmcnt(0)
  v_readfirstlane_b32 s43, v30
  s_nop 3
  s_cmp_ge_u32 s43, 8
  s_cbranch_scc1 L_pd_Z
  s_sleep 6
  s_sub_u32 s45, s45, 1
  s_cmp_lg_u32 s45, 0
  s_cbranch_scc1 L_poll_Z
L_pd_Z:
  v_mfma_f32_16x16x32_bf16 v[224:227], a[96:99], a[176:179], v[224:227]
  s_add_u32 s57, s46, 0x380
  buffer_atomic_add v15, v14, s[28:31], s64 offen sc1
  v_mfma_f32_16x16x32_bf16 v[224:227], a[100:103], a[180:183], v[224:227]
  s_add_u32 s58, s46, 0x2380
  buffer_load_dwordx4 v2, s[8:11], s57 offen lds
  v_mfma_f32_16x16x32_bf16 v[228:231], a[104:107], a[176:179], v[228:231]
  s_add_u32 m0, s48, 0x8400
  ds_read_b128 a[160:163], v6
  ds_read_b128 a[164:167], v7
  v_mfma_f32_16x16x32_bf16 v[228:231], a[108:111], a[180:183], v[228:231]
  buffer_load_dwordx4 v3, s[8:11], s58 offen lds
  v_mfma_f32_16x16x32_bf16 v[232:235], a[112:115], a[176:179], v[232:235]
  s_add_u32 m0, s48, 0x8800
  ds_read_b128 a[168:171], v6 offset:2048
  ds_read_b128 a[172:175], v7 offset:2048
  v_mfma_f32_16x16x32_bf16 v[232:235], a[116:119], a[180:183], v[232:235]
  s_add_u32 s59, s46, 0x4380
  v_mov_b32 v31, 0
  v_mfma_f32_16x16x32_bf16 v[236:239], a[120:123], a[176:179], v[236:239]
  buffer_load_dwordx4 v2, s[8:11], s59 offen lds
  v_mfma_f32_16x16x32_bf16 v[236:239], a[124:127], a[180:183], v[236:239]
  s_add_u32 m0, s48, 0x8c00
  v_mfma_f32_16x16x32_bf16 v[240:243], a[176:179], a[128:131], v[240:243]
  s_add_u32 s56, s46, 0x6380
  v_mfma_f32_16x16x32_bf16 v[240:243], a[180:183], a[132:135], v[240:243]
  buffer_load_dwordx4 v3, s[8:11], s56 offen lds
  v_mfma_f32_16x16x32_bf16 v[244:247], a[176:179], a[136:139], v[244:247]
  s_add_u32 m0, s48, 0x9000
  v_mfma_f32_16x16x32_bf16 v[244:247], a[180:183], a[140:143], v[244:247]
  s_add_u32 s57, s46, 0x8380
  v_mfma_f32_16x16x32_bf16 v[248:251], a[176:179], a[144:147], v[248:251]
  buffer_load_dwordx4 v2, s[8:11], s57 offen lds
  v_mfma_f32_16x16x32_bf16 v[248:251], a[180:183], a[148:151], v[248:251]
  s_add_u32 m0, s48, 0x9400
  v_mfma_f32_16x16x32_bf16 v[252:255], a[176:179], a[152:155], v[252:255]
  s_add_u32 s58, s46, 0xa380
  ds_read_b128 a[176:179], v6 offset:4096
  v_mfma_f32_16x16x32_bf16 v[252:255], a[180:183], a[156:159], v[252:255]
  s_waitcnt lgkmcnt(1)
  buffer_load_dwordx4 v3, s[8:11], s58 offen lds
  v_mfma_f32_16x16x32_bf16 a[0:3], a[32:35], a[160:163], a[0:3]
  s_add_u32 m0, s48, 0x9800
  ds_read_b128 a[180:183], v7 offset:4096
  ds_read_b64_tr_b16 a[96:97], v8 offset:32768
  v_mfma_f32_16x16x32_bf16 a[0:3], a[36:39], a[164:167], a[0:3]
  s_add_u32 s59, s46, 0xc380
  v_mfma_f32_16x16x32_bf16 a[4:7], a[40:43], a[160:163], a[4:7]
  buffer_load_dwordx4 v2, s[8:11], s59 offen lds
  v_mfma_f32_16x16x32_bf16 a[4:7], a[44:47], a[164:167], a[4:7]
  s_add_u32 m0, s48, 0x9c00
  ds_read_b64_tr_b16 a[98:99], v8 offset:33792
  v_subrev_u32 v2, s44, v10
  v_mfma_f32_16x16x32_bf16 a[8:11], a[48:51], a[160:163], a[8:11]
  s_add_u32 s56, s46, 0xe380
  v_mfma_f32_16x16x32_bf16 a[8:11], a[52:55], a[164:167], a[8:11]
  s_lshl_b32 s46, s41, 20
  buffer_load_dwordx4 v3, s[8:11], s56 offen lds
  v_mfma_f32_16x16x32_bf16 a[12:15], a[56:59], a[160:163], a[12:15]
  s_mov_b32 s8, s78
  ds_read_b64_tr_b16 a[100:101], v8 offset:36864
  v_subrev_u32 v3, s44, v11
  v_mfma_f32_16x16x32_bf16 a[12:15], a[60:63], a[164:167], a[12:15]
  s_and_b32 s9, s79, 0xffff
  v_mfma_f32_16x16x32_bf16 a[16:19], a[160:163], a[64:67], a[16:19]
  s_mov_b32 s10, 0x500000
  v_mfma_f32_16x16x32_bf16 a[16:19], a[164:167], a[68:71], a[16:19]
  s_add_u32 s46, s46, 0x400000
  ds_read_b64_tr_b16 a[102:103], v8 offset:37888
  v_mfma_f32_16x16x32_bf16 a[20:23], a[160:163], a[72:75], a[20:23]
  v_mfma_f32_16x16x32_bf16 a[20:23], a[164:167], a[76:79], a[20:23]
  v_mfma_f32_16x16x32_bf16 a[24:27], a[160:163], a[80:83], a[24:27]
  ds_read_b64_tr_b16 a[104:105], v9 offset:32768
  v_mfma_f32_16x16x32_bf16 a[24:27], a[164:167], a[84:87], a[24:27]
  v_mfma_f32_16x16x32_bf16 a[28:31], a[160:163], a[88:91], a[28:31]
  ds_read_b128 a[160:163], v6 offset:6144
  v_mfma_f32_16x16x32_bf16 a[28:31], a[164:167], a[92:95], a[28:31]
  s_nop 0
  ds_read_b128 a[164:167], v7 offset:6144
  ds_read_b64_tr_b16 a[106:107], v9 offset:33792
  v_mfma_f32_16x16x32_bf16 v[32:35], a[32:35], a[168:171], v[32:35]
  v_mfma_f32_16x16x32_bf16 v[32:35], a[36:39], a[172:175], v[32:35]
  v_mfma_f32_16x16x32_bf16 v[36:39], a[40:43], a[168:171], v[36:39]
  ds_read_b64_tr_b16 a[108:109], v9 offset:36864
  v_mfma_f32_16x16x32_bf16 v[36:39], a[44:47], a[172:175], v[36:39]
  v_mfma_f32_16x16x32_bf16 v[40:43], a[48:51], a[168:171], v[40:43]
  v_mfma_f32_16x16x32_bf16 v[40:43], a[52:55], a[172:175], v[40:43]
  ds_read_b64_tr_b16 a[110:111], v9 offset:37888
  v_mfma_f32_16x16x32_bf16 v[44:47], a[56:59], a[168:171], v[44:47]
  v_mfma_f32_16x16x32_bf16 v[44:47], a[60:63], a[172:175], v[44:47]
  v_mfma_f32_16x16x32_bf16 v[48:51], a[168:171], a[64:67], v[48:51]
  s_add_u32 m0, s86, 0x20000
  ds_read_b64_tr_b16 a[112:113], v10 offset:32768
  v_mfma_f32_16x16x32_bf16 v[48:51], a[172:175], a[68:71], v[48:51]
  s_add_u32 s57, s82, 0x0
  v_mfma_f32_16x16x32_bf16 v[52:55], a[168:171], a[72:75], v[52:55]
  buffer_load_dwordx4 v4, s[16:19], s57 offen lds
  v_mfma_f32_16x16x32_bf16 v[52:55], a[172:175], a[76:79], v[52:55]
  ds_read_b64_tr_b16 a[114:115], v10 offset:33792
  v_mfma_f32_16x16x32_bf16 v[56:59], a[168:171], a[80:83], v[56:59]
  v_mfma_f32_16x16x32_bf16 v[56:59], a[172:175], a[84:87], v[56:59]
  s_add_u32 m0, s86, 0x20400
  v_mfma_f32_16x16x32_bf16 v[60:63], a[168:171], a[88:91], v[60:63]
  s_add_u32 s58, s82, 0x8000
  ds_read_b128 a[168:171], v6 offset:8192
  ds_read_b64_tr_b16 a[116:117], v10 offset:36864
  v_mfma_f32_16x16x32_bf16 v[60:63], a[172:175], a[92:95], v[60:63]
  s_waitcnt lgkmcnt(3)
  buffer_load_dwordx4 v4, s[16:19], s58 offen lds
  v_mfma_f32_16x16x32_bf16 v[64:67], a[32:35], a[176:179], v[64:67]
  ds_read_b128 a[172:175], v7 offset:8192
  v_mfma_f32_16x16x32_bf16 v[64:67], a[36:39], a[180:183], v[64:67]
  ds_read_b64_tr_b16 a[118:119], v10 offset:37888
  v_mfma_f32_16x16x32_bf16 v[68:71], a[40:43], a[176:179], v[68:71]
  s_add_u32 m0, s86, 0x20800
  v_mfma_f32_16x16x32_bf16 v[68:71], a[44:47], a[180:183], v[68:71]
  s_add_u32 s59, s82, 0x20000
  v_mfma_f32_16x16x32_bf16 v[72:75], a[48:51], a[176:179], v[72:75]
  buffer_load_dwordx4 v4, s[16:19], s59 offen lds
  v_mfma_f32_16x16x32_bf16 v[72:75], a[52:55], a[180:183], v[72:75]
  ds_read_b64_tr_b16 a[120:121], v11 offset:32768
  v_mfma_f32_16x16x32_bf16 v[76:79], a[56:59], a[176:179], v[76:79]
  v_mfma_f32_16x16x32_bf16 v[76:79], a[60:63], a[180:183], v[76:79]
  s_add_u32 m0, s86, 0x20c00
  ds_read_b64_tr_b16 a[122:123], v11 offset:33792
  v_mfma_f32_16x16x32_bf16 v[80:83], a[176:179], a[64:67], v[80:83]
  s_add_u32 s56, s82, 0x28000
  v_mfma_f32_16x16x32_bf16 v[80:83], a[180:183], a[68:71], v[80:83]
  buffer_load_dwordx4 v4, s[16:19], s56 offen lds
  v_mfma_f32_16x16x32_bf16 v[84:87], a[176:179], a[72:75], v[84:87]
  ds_read_b64_tr_b16 a[124:125], v11 offset:36864
  v_mfma_f32_16x16x32_bf16 v[84:87], a[180:183], a[76:79], v[84:87]
  v_mfma_f32_16x16x32_bf16 v[88:91], a[176:179], a[80:83], v[88:91]
  s_add_u32 m0, s87, 0x24000
  v_mfma_f32_16x16x32_bf16 v[88:91], a[180:183], a[84:87], v[88:91]
  s_add_u32 s57, s83, 0x0
  ds_read_b64_tr_b16 a[126:127], v11 offset:37888
  v_mfma_f32_16x16x32_bf16 v[92:95], a[176:179], a[88:91], v[92:95]
  buffer_load_dwordx4 v5, s[20:23], s57 offen lds
  v_mfma_f32_16x16x32_bf16 v[92:95], a[180:183], a[92:95], v[92:95]
  s_nop 0
  ds_read_b128 a[176:179], v6 offset:10240
  ds_read_b128 a[180:183], v7 offset:10240
  v_mfma_f32_16x16x32_bf16 v[96:99], a[32:35], a[160:163], v[96:99]
  ds_read_b64_tr_b16 a[128:129], v8 offset:49152
  v_mfma_f32_16x16x32_bf16 v[96:99], a[36:39], a[164:167], v[96:99]
  s_add_u32 m0, s87, 0x24400
  v_mfma_f32_16x16x32_bf16 v[100:103], a[40:43], a[160:163], v[100:103]
  s_add_u32 s58, s83, 0x3600
  v_mfma_f32_16x16x32_bf16 v[100:103], a[44:47], a[164:167], v[100:103]
  buffer_load_dwordx4 v5, s[20:23], s58 offen lds
  v_mfma_f32_16x16x32_bf16 v[104:107], a[48:51], a[160:163], v[104:107]
  ds_read_b64_tr_b16 a[130:131], v8 offset:50176
  v_mfma_f32_16x16x32_bf16 v[104:107], a[52:55], a[164:167], v[104:107]
  v_mfma_f32_16x16x32_bf16 v[108:111], a[56:59], a[160:163], v[108:111]
  s_add_u32 m0, s86, 0x4000
  ds_read_b64_tr_b16 a[132:133], v8 offset:53248
  v_mfma_f32_16x16x32_bf16 v[108:111], a[60:63], a[164:167], v[108:111]
  s_add_u32 s59, s82, 0x80000
  v_mfma_f32_16x16x32_bf16 v[112:115], a[160:163], a[64:67], v[112:115]
  buffer_load_dwordx4 v4, s[16:19], s59 offen lds
  v_mfma_f32_16x16x32_bf16 v[112:115], a[164:167], a[68:71], v[112:115]
  ds_read_b64_tr_b16 a[134:135], v8 offset:54272
  v_mfma_f32_16x16x32_bf16 v[116:119], a[160:163], a[72:75], v[116:119]
  v_mfma_f32_16x16x32_bf16 v[116:119], a[164:167], a[76:79], v[116:119]
  s_add_u32 m0, s86, 0x4400
  v_mfma_f32_16x16x32_bf16 v[120:123], a[160:163], a[80:83], v[120:123]
  s_add_u32 s56, s82, 0x88000
  ds_read_b64_tr_b16 a[136:137], v9 offset:49152
  v_mfma_f32_16x16x32_bf16 v[120:123], a[164:167], a[84:87], v[120:123]
  buffer_load_dwordx4 v4, s[16:19], s56 offen lds
  v_mfma_f32_16x16x32_bf16 v[124:127], a[160:163], a[88:91], v[124:127]
  ds_read_b128 a[160:163], v6 offset:12288
  v_mfma_f32_16x16x32_bf16 v[124:127], a[164:167], a[92:95], v[124:127]
  s_waitcnt lgkmcnt(3)
  ds_read_b128 a[164:167], v7 offset:12288
  ds_read_b64_tr_b16 a[138:139], v9 offset:50176
  v_mfma_f32_16x16x32_bf16 v[128:131], a[32:35], a[168:171], v[128:131]
  s_add_u32 m0, s86, 0x4800
  v_mfma_f32_16x16x32_bf16 v[128:131], a[36:39], a[172:175], v[128:131]
  s_add_u32 s57, s82, 0xa0000
  v_mfma_f32_16x16x32_bf16 v[132:135], a[40:43], a[168:171], v[132:135]
  buffer_load_dwordx4 v4, s[16:19], s57 offen lds
  v_mfma_f32_16x16x32_bf16 v[132:135], a[44:47], a[172:175], v[132:135]
  ds_read_b64_tr_b16 a[140:141], v9 offset:53248
  v_mfma_f32_16x16x32_bf16 v[136:139], a[48:51], a[168:171], v[136:139]
  v_mfma_f32_16x16x32_bf16 v[136:139], a[52:55], a[172:175], v[136:139]
  s_add_u32 m0, s86, 0x4c00
  ds_read_b64_tr_b16 a[142:143], v9 offset:54272
  v_mfma_f32_16x16x32_bf16 v[140:143], a[56:59], a[168:171], v[140:143]
  s_add_u32 s58, s82, 0xa8000
  v_mfma_f32_16x16x32_bf16 v[140:143], a[60:63], a[172:175], v[140:143]
  buffer_load_dwordx4 v4, s[16:19], s58 offen lds
  v_mfma_f32_16x16x32_bf16 v[144:147], a[168:171], a[64:67], v[144:147]
  ds_read_b64_tr_b16 a[144:145], v10 offset:49152
  v_mfma_f32_16x16x32_bf16 v[144:147], a[172:175], a[68:71], v[144:147]
  v_mfma_f32_16x16x32_bf16 v[148:151], a[168:171], a[72:75], v[148:151]
  s_add_u32 m0, s87, 0x26000
  v_mfma_f32_16x16x32_bf16 v[148:151], a[172:175], a[76:79], v[148:151]
  s_add_u32 s59, s83, 0x36000
  ds_read_b64_tr_b16 a[146:147], v10 offset:50176
  v_mfma_f32_16x16x32_bf16 v[152:155], a[168:171], a[80:83], v[152:155]
  buffer_load_dwordx4 v5, s[20:23], s59 offen lds
  v_mfma_f32_16x16x32_bf16 v[152:155], a[172:175], a[84:87], v[152:155]
  v_mfma_f32_16x16x32_bf16 v[156:159], a[168:171], a[88:91], v[156:159]
  s_nop 0
  ds_read_b128 a[168:171], v6 offset:14336
  ds_read_b64_tr_b16 a[148:149], v10 offset:53248
  v_mfma_f32_16x16x32_bf16 v[156:159], a[172:175], a[92:95], v[156:159]
  s_add_u32 m0, s87, 0x26400
  ds_read_b128 a[172:175], v7 offset:14336
  v_mfma_f32_16x16x32_bf16 v[160:163], a[32:35], a[176:179], v[160:163]
  s_add_u32 s56, s83, 0x39600
  v_mfma_f32_16x16x32_bf16 v[160:163], a[36:39], a[180:183], v[160:163]
  buffer_load_dwordx4 v5, s[20:23], s56 offen lds
  v_mfma_f32_16x16x32_bf16 v[164:167], a[40:43], a[176:179], v[164:167]
  ds_read_b64_tr_b16 a[150:151], v10 offset:54272
  v_add_u32 v10, 0x20000, v2
  v_mfma_f32_16x16x32_bf16 v[164:167], a[44:47], a[180:183], v[164:167]
  v_mfma_f32_16x16x32_bf16 v[168:171], a[48:51], a[176:179], v[168:171]
  ds_read_b64_tr_b16 a[152:153], v11 offset:49152
  v_mfma_f32_16x16x32_bf16 v[168:171], a[52:55], a[180:183], v[168:171]
  v_mfma_f32_16x16x32_bf16 v[172:175], a[56:59], a[176:179], v[172:175]
  buffer_load_dword v30, v31, s[28:31], s64 offen sc1
  v_mfma_f32_16x16x32_bf16 v[172:175], a[60:63], a[180:183], v[172:175]
  ds_read_b64_tr_b16 a[154:155], v11 offset:50176
  v_mfma_f32_16x16x32_bf16 v[176:179], a[176:179], a[64:67], v[176:179]
  v_mfma_f32_16x16x32_bf16 v[176:179], a[180:183], a[68:71], v[176:179]
  v_mfma_f32_16x16x32_bf16 v[180:183], a[176:179], a[72:75], v[180:183]
  ds_read_b64_tr_b16 a[156:157], v11 offset:53248
  v_mfma_f32_16x16x32_bf16 v[180:183], a[180:183], a[76:79], v[180:183]
  v_mfma_f32_16x16x32_bf16 v[184:187], a[176:179], a[80:83], v[184:187]
  v_mfma_f32_16x16x32_bf16 v[184:187], a[180:183], a[84:87], v[184:187]
  ds_read_b64_tr_b16 a[158:159], v11 offset:54272
  v_add_u32 v11, 0x20000, v3
  v_mfma_f32_16x16x32_bf16 v[188:191], a[176:179], a[88:91], v[188:191]
  v_mfma_f32_16x16x32_bf16 v[188:191], a[180:183], a[92:95], v[188:191]
  s_waitcnt lgkmcnt(2)
  v_mfma_f32_16x16x32_bf16 v[192:195], a[32:35], a[160:163], v[192:195]
  v_mfma_f32_16x16x32_bf16 v[192:195], a[36:39], a[164:167], v[192:195]
  v_mfma_f32_16x16x32_bf16 v[196:199], a[40:43], a[160:163], v[196:199]
  v_mfma_f32_16x16x32_bf16 v[196:199], a[44:47], a[164:167], v[196:199]
  v_mfma_f32_16x16x32_bf16 v[200:203], a[48:51], a[160:163], v[200:203]
  v_mfma_f32_16x16x32_bf16 v[200:203], a[52:55], a[164:167], v[200:203]
  v_mfma_f32_16x16x32_bf16 v[204:207], a[56:59], a[160:163], v[204:207]
  v_mfma_f32_16x16x32_bf16 v[204:207], a[60:63], a[164:167], v[204:207]
  v_mfma_f32_16x16x32_bf16 v[208:211], a[160:163], a[64:67], v[208:211]
  v_mfma_f32_16x16x32_bf16 v[208:211], a[164:167], a[68:71], v[208:211]
  v_mfma_f32_16x16x32_bf16 v[212:215], a[160:163], a[72:75], v[212:215]
  v_mfma_f32_16x16x32_bf16 v[212:215], a[164:167], a[76:79], v[212:215]
  v_mfma_f32_16x16x32_bf16 v[216:219], a[160:163], a[80:83], v[216:219]
  v_mfma_f32_16x16x32_bf16 v[216:219], a[164:167], a[84:87], v[216:219]
  v_mfma_f32_16x16x32_bf16 v[220:223], a[160:163], a[88:91], v[220:223]
  v_mfma_f32_16x16x32_bf16 v[220:223], a[164:167], a[92:95], v[220:223]
  s_waitcnt vmcnt(0) lgkmcnt(0)
  s_barrier
  v_readfirstlane_b32 s43, v30
  s_nop 3
  s_cmp_ge_u32 s43, 32
  s_cbranch_scc1 L_pd_A
  v_mov_b32 v31, 0
  s_mov_b32 s45, 0x30d40
L_poll_A:
  buffer_load_dword v30, v31, s[28:31], s64 offen sc1
  s_waitcnt vmcnt(0)
  v_readfirstlane_b32 s43, v30
  s_nop 3
  s_cmp_ge_u32 s43, 32
  s_cbranch_scc1 L_pd_A
  s_sleep 6
  s_sub_u32 s45, s45, 1
  s_cmp_lg_u32 s45, 0
  s_cbranch_scc1 L_poll_A
L_pd_A:
  v_mfma_f32_16x16x32_bf16 v[224:227], a[32:35], a[168:171], v[224:227]
  s_and_b32 s43, s40, 1
  ds_read_b128 a[176:179], v6 offset:32768
  ds_read_b128 a[180:183], v7 offset:32768
  v_mfma_f32_16x16x32_bf16 v[224:227], a[36:39], a[172:175], v[224:227]
  s_lshl_b32 s43, s43, 13
  ds_read_b128 a[160:163], v6 offset:34816
  ds_read_b128 a[164:167], v7 offset:34816
  v_mfma_f32_16x16x32_bf16 v[228:231], a[40:43], a[168:171], v[228:231]
  s_add_u32 s47, s46, s43
  buffer_load_dwordx4 a[208:211], v1, s[28:31], s94 offen sc1
  v_mfma_f32_16x16x32_bf16 v[228:231], a[44:47], a[172:175], v[228:231]
  s_add_u32 s47, s47, 0xc000
  v_mov_b32 v31, 0
  v_mfma_f32_16x16x32_bf16 v[232:235], a[48:51], a[168:171], v[232:235]
  v_mfma_f32_16x16x32_bf16 v[232:235], a[52:55], a[172:175], v[232:235]
  buffer_load_dwordx4 a[212:215], v1, s[28:31], s94 offen offset:1024 sc1
  v_mfma_f32_16x16x32_bf16 v[236:239], a[56:59], a[168:171], v[236:239]
  v_mfma_f32_16x16x32_bf16 v[236:239], a[60:63], a[172:175], v[236:239]
  v_mfma_f32_16x16x32_bf16 v[240:243], a[168:171], a[64:67], v[240:243]
  buffer_load_dwordx4 a[216:219], v1, s[28:31], s94 offen offset:2048 sc1
  v_mfma_f32_16x16x32_bf16 v[240:243], a[172:175], a[68:71], v[240:243]
  v_mfma_f32_16x16x32_bf16 v[244:247], a[168:171], a[72:75], v[244:247]
  v_mfma_f32_16x16x32_bf16 v[244:247], a[172:175], a[76:79], v[244:247]
  buffer_load_dwordx4 a[220:223], v1, s[28:31], s94 offen offset:3072 sc1
  v_mfma_f32_16x16x32_bf16 v[248:251], a[168:171], a[80:83], v[248:251]
  s_add_u32 s94, s81, 0x2000
  v_mfma_f32_16x16x32_bf16 v[248:251], a[172:175], a[84:87], v[248:251]
  v_mfma_f32_16x16x32_bf16 v[252:255], a[168:171], a[88:91], v[252:255]
  buffer_load_dwordx4 a[224:227], v1, s[28:31], s93 offen sc1
  v_mfma_f32_16x16x32_bf16 v[252:255], a[172:175], a[92:95], v[252:255]
  s_waitcnt lgkmcnt(0)
  ds_read_b128 a[168:171], v6 offset:36864
  ds_read_b128 a[172:175], v7 offset:36864
  v_mfma_f32_16x16x32_bf16 a[0:3], a[96:99], a[176:179], a[0:3]
  v_mfma_f32_16x16x32_bf16 a[0:3], a[100:103], a[180:183], a[0:3]
  buffer_load_dwordx4 a[228:231], v1, s[28:31], s93 offen offset:1024 sc1
  v_mfma_f32_16x16x32_bf16 a[4:7], a[104:107], a[176:179], a[4:7]
  v_mfma_f32_16x16x32_bf16 a[4:7], a[108:111], a[180:183], a[4:7]
  v_mfma_f32_16x16x32_bf16 a[8:11], a[112:115], a[176:179], a[8:11]
  buffer_load_dwordx4 a[232:235], v1, s[28:31], s93 offen offset:2048 sc1
  v_mfma_f32_16x16x32_bf16 a[8:11], a[116:119], a[180:183], a[8:11]
  v_mfma_f32_16x16x32_bf16 a[12:15], a[120:123], a[176:179], a[12:15]
  v_mfma_f32_16x16x32_bf16 a[12:15], a[124:127], a[180:183], a[12:15]
  buffer_load_dwordx4 a[236:239], v1, s[28:31], s93 offen offset:3072 sc1
  v_mfma_f32_16x16x32_bf16 a[16:19], a[176:179], a[128:131], a[16:19]
  s_add_u32 s93, s81, 0x3000
  v_accvgpr_read_b32 v16, a0
  v_accvgpr_read_b32 v17, a1
  v_mfma_f32_16x16x32_bf16 a[16:19], a[180:183], a[132:135], a[16:19]
  v_accvgpr_read_b32 v18, a2
  v_accvgpr_read_b32 v19, a3
  v_mfma_f32_16x16x32_bf16 a[20:23], a[176:179], a[136:139], a[20:23]
  buffer_load_dwordx4 a[32:35], v1, s[28:31], s94 offen sc1
  v_mfma_f32_16x16x32_bf16 a[20:23], a[180:183], a[140:143], a[20:23]
  v_cvt_pk_bf16_f32 v16, v16, v17
  v_accvgpr_read_b32 v20, a4
  v_mfma_f32_16x16x32_bf16 a[24:27], a[176:179], a[144:147], a[24:27]
  v_accvgpr_read_b32 v21, a5
  v_accvgpr_read_b32 v22, a6
  v_mfma_f32_16x16x32_bf16 a[24:27], a[180:183], a[148:151], a[24:27]
  buffer_load_dwordx4 a[36:39], v1, s[28:31], s94 offen offset:1024 sc1
  v_mfma_f32_16x16x32_bf16 a[28:31], a[176:179], a[152:155], a[28:31]
  ds_read_b128 a[176:179], v6 offset:38912
  v_accvgpr_read_b32 v23, a7
  v_mfma_f32_16x16x32_bf16 a[28:31], a[180:183], a[156:159], a[28:31]
  ds_read_b128 a[180:183], v7 offset:38912
  v_cvt_pk_bf16_f32 v17, v18, v19
  v_mfma_f32_16x16x32_bf16 v[32:35], a[96:99], a[160:163], v[32:35]
  buffer_load_dwordx4 a[40:43], v1, s[28:31], s94 offen offset:2048 sc1
  v_mfma_f32_16x16x32_bf16 v[32:35], a[100:103], a[164:167], v[32:35]
  v_cvt_pk_bf16_f32 v18, v20, v21
  v_cvt_pk_bf16_f32 v19, v22, v23
  v_mfma_f32_16x16x32_bf16 v[36:39], a[104:107], a[160:163], v[36:39]
  v_accvgpr_read_b32 v20, a12
  v_accvgpr_read_b32 v21, a13
  v_mfma_f32_16x16x32_bf16 v[36:39], a[108:111], a[164:167], v[36:39]
  buffer_load_dwordx4 a[44:47], v1, s[28:31], s94 offen offset:3072 sc1
  v_mfma_f32_16x16x32_bf16 v[40:43], a[112:115], a[160:163], v[40:43]
  s_add_u32 s94, s81, 0x4000
  v_accvgpr_read_b32 v22, a14
  v_accvgpr_read_b32 v23, a15
  v_mfma_f32_16x16x32_bf16 v[40:43], a[116:119], a[164:167], v[40:43]
  v_cvt_pk_bf16_f32 v32, v32, v33
  v_cvt_pk_bf16_f32 v33, v34, v35
  v_mfma_f32_16x16x32_bf16 v[44:47], a[120:123], a[160:163], v[44:47]
  buffer_load_dwordx4 a[48:51], v1, s[28:31], s93 offen sc1
  v_mfma_f32_16x16x32_bf16 v[44:47], a[124:127], a[164:167], v[44:47]
  v_cvt_pk_bf16_f32 v34, v36, v37
  v_cvt_pk_bf16_f32 v35, v38, v39
  v_mfma_f32_16x16x32_bf16 v[48:51], a[160:163], a[128:131], v[48:51]
  v_cvt_pk_bf16_f32 v40, v40, v41
  v_cvt_pk_bf16_f32 v41, v42, v43
  v_mfma_f32_16x16x32_bf16 v[48:51], a[164:167], a[132:135], v[48:51]
  buffer_load_dwordx4 a[52:55], v1, s[28:31], s93 offen offset:1024 sc1
  v_mfma_f32_16x16x32_bf16 v[52:55], a[160:163], a[136:139], v[52:55]
  v_cvt_pk_bf16_f32 v42, v44, v45
  v_cvt_pk_bf16_f32 v43, v46, v47
  v_mfma_f32_16x16x32_bf16 v[52:55], a[164:167], a[140:143], v[52:55]
  v_mfma_f32_16x16x32_bf16 v[56:59], a[160:163], a[144:147], v[56:59]
  buffer_load_dwordx4 a[56:59], v1, s[28:31], s93 offen offset:2048 sc1
  v_mfma_f32_16x16x32_bf16 v[56:59], a[164:167], a[148:151], v[56:59]
  v_mfma_f32_16x16x32_bf16 v[60:63], a[160:163], a[152:155], v[60:63]
  ds_read_b128 a[160:163], v6 offset:40960
  v_mfma_f32_16x16x32_bf16 v[60:63], a[164:167], a[156:159], v[60:63]
  s_waitcnt lgkmcnt(1)
  buffer_load_dwordx4 a[60:63], v1, s[28:31], s93 offen offset:3072 sc1
  v_mfma_f32_16x16x32_bf16 v[64:67], a[96:99], a[168:171], v[64:67]
  s_add_u32 s93, s81, 0x5000
  ds_read_b128 a[164:167], v7 offset:40960
  v_mfma_f32_16x16x32_bf16 v[64:67], a[100:103], a[172:175], v[64:67]
  v_mfma_f32_16x16x32_bf16 v[68:71], a[104:107], a[168:171], v[68:71]
  v_mfma_f32_16x16x32_bf16 v[68:71], a[108:111], a[172:175], v[68:71]
  s_add_u32 s57, s51, 0x0
  v_mfma_f32_16x16x32_bf16 v[72:75], a[112:115], a[168:171], v[72:75]
  v_mfma_f32_16x16x32_bf16 v[72:75], a[116:119], a[172:175], v[72:75]
  v_mfma_f32_16x16x32_bf16 v[76:79], a[120:123], a[168:171], v[76:79]
  buffer_store_dwordx4 v[16:19], v1, s[28:31], s57 offen sc1
  v_mfma_f32_16x16x32_bf16 v[76:79], a[124:127], a[172:175], v[76:79]
  v_cvt_pk_bf16_f32 v64, v64, v65
  v_accvgpr_read_b32 v16, a8
  v_mfma_f32_16x16x32_bf16 v[80:83], a[168:171], a[128:131], v[80:83]
  v_accvgpr_read_b32 v17, a9
  v_accvgpr_read_b32 v18, a10
  v_mfma_f32_16x16x32_bf16 v[80:83], a[172:175], a[132:135], v[80:83]
  v_accvgpr_read_b32 v19, a11
  v_cvt_pk_bf16_f32 v16, v16, v17
  v_mfma_f32_16x16x32_bf16 v[84:87], a[168:171], a[136:139], v[84:87]
  v_cvt_pk_bf16_f32 v17, v18, v19
  v_cvt_pk_bf16_f32 v18, v20, v21
  v_mfma_f32_16x16x32_bf16 v[84:87], a[172:175], a[140:143], v[84:87]
  v_cvt_pk_bf16_f32 v19, v22, v23
  v_cvt_pk_bf16_f32 v65, v66, v67
  v_mfma_f32_16x16x32_bf16 v[88:91], a[168:171], a[144:147], v[88:91]
  v_cvt_pk_bf16_f32 v66, v68, v69
  v_cvt_pk_bf16_f32 v67, v70, v71
  v_mfma_f32_16x16x32_bf16 v[88:91], a[172:175], a[148:151], v[88:91]
  v_accvgpr_write_b32 a64, v64
  v_accvgpr_write_b32 a65, v65
  v_mfma_f32_16x16x32_bf16 v[92:95], a[168:171], a[152:155], v[92:95]
  s_add_u32 s58, s51, 0x400
  ds_read_b128 a[168:171], v6 offset:43008
  v_accvgpr_write_b32 a66, v66
  v_mfma_f32_16x16x32_bf16 v[92:95], a[172:175], a[156:159], v[92:95]
  ds_read_b128 a[172:175], v7 offset:43008
  v_accvgpr_write_b32 a67, v67
  v_mfma_f32_16x16x32_bf16 v[96:99], a[96:99], a[176:179], v[96:99]
  v_cvt_pk_bf16_f32 v72, v72, v73
  v_cvt_pk_bf16_f32 v73, v74, v75
  v_mfma_f32_16x16x32_bf16 v[96:99], a[100:103], a[180:183], v[96:99]
  buffer_store_dwordx4 v[16:19], v1, s[28:31], s58 offen sc1
  v_mfma_f32_16x16x32_bf16 v[100:103], a[104:107], a[176:179], v[100:103]
  v_cvt_pk_bf16_f32 v74, v76, v77
  v_accvgpr_read_b32 v16, a16
  v_mfma_f32_16x16x32_bf16 v[100:103], a[108:111], a[180:183], v[100:103]
  v_accvgpr_read_b32 v17, a17
  v_accvgpr_read_b32 v18, a18
  v_mfma_f32_16x16x32_bf16 v[104:107], a[112:115], a[176:179], v[104:107]
  v_accvgpr_read_b32 v19, a19
  v_cvt_pk_bf16_f32 v16, v16, v17
  v_mfma_f32_16x16x32_bf16 v[104:107], a[116:119], a[180:183], v[104:107]
  v_cvt_pk_bf16_f32 v17, v18, v19
  v_cvt_pk_bf16_f32 v18, v48, v49
  v_mfma_f32_16x16x32_bf16 v[108:111], a[120:123], a[176:179], v[108:111]
  v_cvt_pk_bf16_f32 v19, v50, v51
  v_cvt_pk_bf16_f32 v75, v78, v79
  v_mfma_f32_16x16x32_bf16 v[108:111], a[124:127], a[180:183], v[108:111]
  v_accvgpr_write_b32 a68, v72
  v_accvgpr_write_b32 a69, v73
  v_mfma_f32_16x16x32_bf16 v[112:115], a[176:179], a[128:131], v[112:115]
  v_accvgpr_write_b32 a70, v74
  v_accvgpr_write_b32 a71, v75
  v_mfma_f32_16x16x32_bf16 v[112:115], a[180:183], a[132:135], v[112:115]
  s_add_u32 s59, s51, 0x1000
  v_cvt_pk_bf16_f32 v80, v80, v81
  v_cvt_pk_bf16_f32 v81, v82, v83
  v_mfma_f32_16x16x32_bf16 v[116:119], a[176:179], a[136:139], v[116:119]
  v_accvgpr_write_b32 a80, v80
  v_accvgpr_write_b32 a81, v81
  v_mfma_f32_16x16x32_bf16 v[116:119], a[180:183], a[140:143], v[116:119]
  v_cvt_pk_bf16_f32 v84, v84, v85
  v_cvt_pk_bf16_f32 v82, v112, v113
  v_mfma_f32_16x16x32_bf16 v[120:123], a[176:179], a[144:147], v[120:123]
  buffer_store_dwordx4 v[32:35], v1, s[28:31], s59 offen sc1
  v_mfma_f32_16x16x32_bf16 v[120:123], a[180:183], a[148:151], v[120:123]
  v_cvt_pk_bf16_f32 v83, v114, v115
  v_accvgpr_write_b32 a82, v82
  v_mfma_f32_16x16x32_bf16 v[124:127], a[176:179], a[152:155], v[124:127]
  ds_read_b128 a[176:179], v6 offset:45056
  v_accvgpr_write_b32 a83, v83
  v_mfma_f32_16x16x32_bf16 v[124:127], a[180:183], a[156:159], v[124:127]
  s_waitcnt lgkmcnt(1)
  ds_read_b128 a[180:183], v7 offset:45056
  v_cvt_pk_bf16_f32 v85, v86, v87
  v_mfma_f32_16x16x32_bf16 v[128:131], a[96:99], a[160:163], v[128:131]
  v_cvt_pk_bf16_f32 v86, v116, v117
  v_cvt_pk_bf16_f32 v87, v118, v119
  v_mfma_f32_16x16x32_bf16 v[128:131], a[100:103], a[164:167], v[128:131]
  v_accvgpr_write_b32 a84, v84
  v_accvgpr_write_b32 a85, v85
  v_mfma_f32_16x16x32_bf16 v[132:135], a[104:107], a[160:163], v[132:135]
  v_accvgpr_write_b32 a86, v86
  v_accvgpr_write_b32 a87, v87
  v_mfma_f32_16x16x32_bf16 v[132:135], a[108:111], a[164:167], v[132:135]
  v_cvt_pk_bf16_f32 v88, v88, v89
  v_cvt_pk_bf16_f32 v89, v90, v91
  v_mfma_f32_16x16x32_bf16 v[136:139], a[112:115], a[160:163], v[136:139]
  s_add_u32 s56, s51, 0x1400
  v_cvt_pk_bf16_f32 v90, v120, v121
  v_cvt_pk_bf16_f32 v91, v122, v123
  v_mfma_f32_16x16x32_bf16 v[136:139], a[116:119], a[164:167], v[136:139]
  v_accvgpr_write_b32 a88, v88
  v_accvgpr_write_b32 a89, v89
  v_mfma_f32_16x16x32_bf16 v[140:143], a[120:123], a[160:163], v[140:143]
  v_accvgpr_write_b32 a90, v90
  v_accvgpr_write_b32 a91, v91
  v_mfma_f32_16x16x32_bf16 v[140:143], a[124:127], a[164:167], v[140:143]
  buffer_store_dwordx4 v[40:43], v1, s[28:31], s56 offen sc1
  v_mfma_f32_16x16x32_bf16 v[144:147], a[160:163], a[128:131], v[144:147]
  v_cvt_pk_bf16_f32 v92, v92, v93
  v_cvt_pk_bf16_f32 v93, v94, v95
  v_mfma_f32_16x16x32_bf16 v[144:147], a[164:167], a[132:135], v[144:147]
  v_cvt_pk_bf16_f32 v94, v124, v125
  v_cvt_pk_bf16_f32 v95, v126, v127
  v_mfma_f32_16x16x32_bf16 v[148:151], a[160:163], a[136:139], v[148:151]
  v_accvgpr_write_b32 a92, v92
  v_accvgpr_write_b32 a93, v93
  v_mfma_f32_16x16x32_bf16 v[148:151], a[164:167], a[140:143], v[148:151]
  v_accvgpr_write_b32 a94, v94
  v_accvgpr_write_b32 a95, v95
  v_mfma_f32_16x16x32_bf16 v[152:155], a[160:163], a[144:147], v[152:155]
  v_cvt_pk_bf16_f32 v96, v96, v97
  v_cvt_pk_bf16_f32 v97, v98, v99
  v_mfma_f32_16x16x32_bf16 v[152:155], a[164:167], a[148:151], v[152:155]
  v_cvt_pk_bf16_f32 v98, v100, v101
  v_cvt_pk_bf16_f32 v99, v102, v103
  v_mfma_f32_16x16x32_bf16 v[156:159], a[160:163], a[152:155], v[156:159]
  ds_read_b128 a[160:163], v6 offset:47104
  v_subrev_u32 v6, s44, v8
  v_mfma_f32_16x16x32_bf16 v[156:159], a[164:167], a[156:159], v[156:159]
  s_add_u32 s57, s52, 0x0
  ds_read_b128 a[164:167], v7 offset:47104
  v_add_u32 v8, 0x20000, v6
  v_mfma_f32_16x16x32_bf16 v[160:163], a[96:99], a[168:171], v[160:163]
  v_subrev_u32 v7, s44, v9
  v_add_u32 v9, 0x20000, v7
  v_mfma_f32_16x16x32_bf16 v[160:163], a[100:103], a[172:175], v[160:163]
  s_lshl_b32 s44, s41, 14
  v_accvgpr_write_b32 a72, v96
  v_accvgpr_write_b32 a73, v97
  v_mfma_f32_16x16x32_bf16 v[164:167], a[104:107], a[168:171], v[164:167]
  buffer_store_dwordx4 v[16:19], v1, s[28:31], s57 offen sc1
  v_mfma_f32_16x16x32_bf16 v[164:167], a[108:111], a[172:175], v[164:167]
  v_accvgpr_write_b32 a74, v98
  v_accvgpr_read_b32 v16, a20
  v_mfma_f32_16x16x32_bf16 v[168:171], a[112:115], a[168:171], v[168:171]
  v_accvgpr_read_b32 v17, a21
  v_accvgpr_read_b32 v18, a22
  v_mfma_f32_16x16x32_bf16 v[168:171], a[116:119], a[172:175], v[168:171]
  v_accvgpr_read_b32 v19, a23
  v_cvt_pk_bf16_f32 v16, v16, v17
  v_mfma_f32_16x16x32_bf16 v[172:175], a[120:123], a[168:171], v[172:175]
  v_cvt_pk_bf16_f32 v17, v18, v19
  v_cvt_pk_bf16_f32 v18, v52, v53
  v_mfma_f32_16x16x32_bf16 v[172:175], a[124:127], a[172:175], v[172:175]
  v_cvt_pk_bf16_f32 v19, v54, v55
  v_accvgpr_write_b32 a75, v99
  v_mfma_f32_16x16x32_bf16 v[176:179], a[168:171], a[128:131], v[176:179]
  v_cvt_pk_bf16_f32 v104, v104, v105
  v_cvt_pk_bf16_f32 v105, v106, v107
  v_mfma_f32_16x16x32_bf16 v[176:179], a[172:175], a[132:135], v[176:179]
  v_cvt_pk_bf16_f32 v106, v108, v109
  v_cvt_pk_bf16_f32 v107, v110, v111
  v_mfma_f32_16x16x32_bf16 v[180:183], a[168:171], a[136:139], v[180:183]
  s_add_u32 s58, s52, 0x800
  v_accvgpr_write_b32 a76, v104
  v_accvgpr_write_b32 a77, v105
  v_mfma_f32_16x16x32_bf16 v[180:183], a[172:175], a[140:143], v[180:183]
  v_accvgpr_write_b32 a78, v106
  v_accvgpr_write_b32 a79, v107
  v_mfma_f32_16x16x32_bf16 v[184:187], a[168:171], a[144:147], v[184:187]
  v_cvt_pk_bf16_f32 v128, v128, v129
  v_cvt_pk_bf16_f32 v129, v130, v131
  v_mfma_f32_16x16x32_bf16 v[184:187], a[172:175], a[148:151], v[184:187]
  buffer_store_dwordx4 v[16:19], v1, s[28:31], s58 offen sc1
  v_mfma_f32_16x16x32_bf16 v[188:191], a[168:171], a[152:155], v[188:191]
  v_cvt_pk_bf16_f32 v130, v132, v133
  v_accvgpr_read_b32 v16, a24
  v_mfma_f32_16x16x32_bf16 v[188:191], a[172:175], a[156:159], v[188:191]
  s_waitcnt lgkmcnt(0)
  v_accvgpr_read_b32 v17, a25
  v_accvgpr_read_b32 v18, a26
  v_mfma_f32_16x16x32_bf16 v[192:195], a[96:99], a[176:179], v[192:195]
  v_accvgpr_read_b32 v19, a27
  v_cvt_pk_bf16_f32 v16, v16, v17
  v_mfma_f32_16x16x32_bf16 v[192:195], a[100:103], a[180:183], v[192:195]
  v_cvt_pk_bf16_f32 v17, v18, v19
  v_cvt_pk_bf16_f32 v18, v56, v57
  v_mfma_f32_16x16x32_bf16 v[196:199], a[104:107], a[176:179], v[196:199]
  v_cvt_pk_bf16_f32 v19, v58, v59
  v_cvt_pk_bf16_f32 v131, v134, v135
  v_mfma_f32_16x16x32_bf16 v[196:199], a[108:111], a[180:183], v[196:199]
  v_accvgpr_write_b32 a0, v128
  v_accvgpr_write_b32 a1, v129
  v_mfma_f32_16x16x32_bf16 v[200:203], a[112:115], a[176:179], v[200:203]
  v_accvgpr_write_b32 a2, v130
  v_accvgpr_write_b32 a3, v131
  v_mfma_f32_16x16x32_bf16 v[200:203], a[116:119], a[180:183], v[200:203]
  s_add_u32 s59, s52, 0x1000
  v_cvt_pk_bf16_f32 v136, v136, v137
  v_cvt_pk_bf16_f32 v137, v138, v139
  v_mfma_f32_16x16x32_bf16 v[204:207], a[120:123], a[176:179], v[204:207]
  v_cvt_pk_bf16_f32 v138, v140, v141
  v_cvt_pk_bf16_f32 v139, v142, v143
  v_mfma_f32_16x16x32_bf16 v[204:207], a[124:127], a[180:183], v[204:207]
  v_accvgpr_write_b32 a4, v136
  v_accvgpr_write_b32 a5, v137
  v_mfma_f32_16x16x32_bf16 v[208:211], a[176:179], a[128:131], v[208:211]
  buffer_store_dwordx4 v[16:19], v1, s[28:31], s59 offen sc1
  v_mfma_f32_16x16x32_bf16 v[208:211], a[180:183], a[132:135], v[208:211]
  v_accvgpr_write_b32 a6, v138
  v_accvgpr_read_b32 v16, a28
  v_mfma_f32_16x16x32_bf16 v[212:215], a[176:179], a[136:139], v[212:215]
  v_accvgpr_read_b32 v17, a29
  v_accvgpr_read_b32 v18, a30
  v_mfma_f32_16x16x32_bf16 v[212:215], a[180:183], a[140:143], v[212:215]
  v_accvgpr_read_b32 v19, a31
  v_cvt_pk_bf16_f32 v16, v16, v17
  v_mfma_f32_16x16x32_bf16 v[216:219], a[176:179], a[144:147], v[216:219]
  v_cvt_pk_bf16_f32 v17, v18, v19
  v_cvt_pk_bf16_f32 v18, v60, v61
  v_mfma_f32_16x16x32_bf16 v[216:219], a[180:183], a[148:151], v[216:219]
  v_cvt_pk_bf16_f32 v19, v62, v63
  v_accvgpr_write_b32 a7, v139
  v_mfma_f32_16x16x32_bf16 v[220:223], a[176:179], a[152:155], v[220:223]
  v_cvt_pk_bf16_f32 v144, v144, v145
  v_cvt_pk_bf16_f32 v145, v146, v147
  v_mfma_f32_16x16x32_bf16 v[220:223], a[180:183], a[156:159], v[220:223]
  v_cvt_pk_bf16_f32 v146, v176, v177
  v_cvt_pk_bf16_f32 v147, v178, v179
  s_add_u32 s56, s52, 0x1800
  buffer_store_dwordx4 v[16:19], v1, s[28:31], s56 offen sc1
  s_waitcnt vmcnt(16) lgkmcnt(0)
  s_barrier
  v_mfma_f32_16x16x32_bf16 v[224:227], a[96:99], a[160:163], v[224:227]
  s_add_u32 m0, s86, 0x8000
  ds_read_b64_tr_b16 a[184:185], v8
  ds_read_b64_tr_b16 a[186:187], v8 offset:1024
  v_mfma_f32_16x16x32_bf16 v[224:227], a[100:103], a[164:167], v[224:227]
  s_add_u32 s57, s82, 0x100000
  ds_read_b64_tr_b16 a[188:189], v8 offset:4096
  ds_read_b64_tr_b16 a[190:191], v8 offset:5120
  v_mfma_f32_16x16x32_bf16 v[228:231], a[104:107], a[160:163], v[228:231]
  buffer_load_dwordx4 v4, s[16:19], s57 offen lds
  v_mfma_f32_16x16x32_bf16 v[228:231], a[108:111], a[164:167], v[228:231]
  s_nop 0
  ds_read_b64_tr_b16 a[192:193], v9
  ds_read_b64_tr_b16 a[194:195], v9 offset:1024
  v_mfma_f32_16x16x32_bf16 v[232:235], a[112:115], a[160:163], v[232:235]
  s_add_u32 s58, s51, 0x2000
  ds_read_b64_tr_b16 a[196:197], v9 offset:4096
  ds_read_b64_tr_b16 a[198:199], v9 offset:5120
  v_mfma_f32_16x16x32_bf16 v[232:235], a[116:119], a[164:167], v[232:235]
  s_nop 0
  ds_read_b64_tr_b16 a[200:201], v10
  ds_read_b64_tr_b16 a[202:203], v10 offset:1024
  v_mfma_f32_16x16x32_bf16 v[236:239], a[120:123], a[160:163], v[236:239]
  s_nop 0
  ds_read_b64_tr_b16 a[204:205], v10 offset:4096
  ds_read_b64_tr_b16 a[206:207], v10 offset:5120
  v_mfma_f32_16x16x32_bf16 v[236:239], a[124:127], a[164:167], v[236:239]
  buffer_store_dwordx4 a[64:67], v1, s[28:31], s58 offen sc1
  v_mfma_f32_16x16x32_bf16 v[240:243], a[160:163], a[128:131], v[240:243]
  s_nop 0
  ds_read_b64_tr_b16 a[240:241], v11
  ds_read_b64_tr_b16 a[242:243], v11 offset:1024
  v_mfma_f32_16x16x32_bf16 v[240:243], a[164:167], a[132:135], v[240:243]
  s_nop 0
  ds_read_b64_tr_b16 a[244:245], v11 offset:4096
  ds_read_b64_tr_b16 a[246:247], v11 offset:5120
  v_mfma_f32_16x16x32_bf16 v[244:247], a[160:163], a[136:139], v[244:247]
  s_add_u32 m0, s86, 0x8400
  v_accvgpr_write_b32 a16, v144
  v_accvgpr_write_b32 a17, v145
  v_mfma_f32_16x16x32_bf16 v[244:247], a[164:167], a[140:143], v[244:247]
  s_add_u32 s59, s82, 0x108000
  ds_read_b64_tr_b16 a[248:249], v8 offset:8192
  ds_read_b64_tr_b16 a[250:251], v8 offset:9216
  v_mfma_f32_16x16x32_bf16 v[248:251], a[160:163], a[144:147], v[248:251]
  buffer_load_dwordx4 v4, s[16:19], s59 offen lds
  v_mfma_f32_16x16x32_bf16 v[248:251], a[164:167], a[148:151], v[248:251]
  s_nop 0
  ds_read_b64_tr_b16 a[252:253], v8 offset:12288
  ds_read_b64_tr_b16 a[254:255], v8 offset:13312
  v_mfma_f32_16x16x32_bf16 v[252:255], a[160:163], a[152:155], v[252:255]
  v_accvgpr_write_b32 a18, v146
  v_accvgpr_write_b32 a19, v147
  v_mfma_f32_16x16x32_bf16 v[252:255], a[164:167], a[156:159], v[252:255]
  s_waitcnt lgkmcnt(6)
  v_cvt_pk_bf16_f32 v148, v148, v149
  v_cvt_pk_bf16_f32 v149, v150, v151
  v_mfma_f32_16x16x32_bf16 v[32:35], a[184:187], a[208:211], 0
  s_add_u32 m0, s86, 0x8800
  v_cvt_pk_bf16_f32 v150, v180, v181
  v_cvt_pk_bf16_f32 v151, v182, v183
  v_mfma_f32_16x16x32_bf16 v[32:35], a[188:191], a[224:227], v[32:35]
  s_add_u32 s56, s82, 0x120000
  buffer_load_dwordx4 v4, s[16:19], s56 offen lds
  v_mfma_f32_16x16x32_bf16 v[36:39], a[184:187], a[212:215], 0
  v_accvgpr_write_b32 a20, v148
  v_accvgpr_write_b32 a21, v149
  v_mfma_f32_16x16x32_bf16 v[36:39], a[188:191], a[228:231], v[36:39]
  v_accvgpr_write_b32 a22, v150
  v_accvgpr_write_b32 a23, v151
  v_mfma_f32_16x16x32_bf16 v[40:43], a[184:187], a[216:219], 0
  s_add_u32 m0, s86, 0x8c00
  v_cvt_pk_bf16_f32 v152, v152, v153
  v_cvt_pk_bf16_f32 v153, v154, v155
  v_mfma_f32_16x16x32_bf16 v[40:43], a[188:191], a[232:235], v[40:43]
  s_add_u32 s57, s82, 0x128000
  v_cvt_pk_bf16_f32 v154, v184, v185
  v_cvt_pk_bf16_f32 v155, v186, v187
  v_mfma_f32_16x16x32_bf16 v[44:47], a[184:187], a[220:223], 0
  buffer_load_dwordx4 v4, s[16:19], s57 offen lds
  v_mfma_f32_16x16x32_bf16 v[44:47], a[188:191], a[236:239], v[44:47]
  s_nop 0
  ds_read_b64_tr_b16 a[184:185], v9 offset:8192
  ds_read_b64_tr_b16 a[186:187], v9 offset:9216
  v_mfma_f32_16x16x32_bf16 v[48:51], a[192:195], a[208:211], 0
  s_add_u32 s58, s51, 0x2400
  ds_read_b64_tr_b16 a[188:189], v9 offset:12288
  ds_read_b64_tr_b16 a[190:191], v9 offset:13312
  v_mfma_f32_16x16x32_bf16 v[48:51], a[196:199], a[224:227], v[48:51]
  v_accvgpr_write_b32 a24, v152
  v_accvgpr_write_b32 a25, v153
  v_mfma_f32_16x16x32_bf16 v[52:55], a[192:195], a[212:215], 0
  v_accvgpr_write_b32 a26, v154
  v_accvgpr_write_b32 a27, v155
  v_mfma_f32_16x16x32_bf16 v[52:55], a[196:199], a[228:231], v[52:55]
  buffer_store_dwordx4 a[68:71], v1, s[28:31], s58 offen sc1
  v_mfma_f32_16x16x32_bf16 v[56:59], a[192:195], a[216:219], 0
  v_cvt_pk_bf16_f32 v156, v156, v157
  v_cvt_pk_bf16_f32 v157, v158, v159
  v_mfma_f32_16x16x32_bf16 v[56:59], a[196:199], a[232:235], v[56:59]
  v_cvt_pk_bf16_f32 v158, v188, v189
  v_cvt_pk_bf16_f32 v159, v190, v191
  v_mfma_f32_16x16x32_bf16 v[60:63], a[192:195], a[220:223], 0
  s_add_u32 m0, s87, 0xc000
  ds_read_b64_tr_b16 a[192:193], v10 offset:8192
  ds_read_b64_tr_b16 a[194:195], v10 offset:9216
  v_mfma_f32_16x16x32_bf16 v[60:63], a[196:199], a[236:239], v[60:63]
  s_add_u32 s59, s83, 0x6c000
  ds_read_b64_tr_b16 a[196:197], v10 offset:12288
  ds_read_b64_tr_b16 a[198:199], v10 offset:13312
  v_mfma_f32_16x16x32_bf16 v[64:67], a[200:203], a[208:211], 0
  buffer_load_dwordx4 v5, s[20:23], s59 offen lds
  v_mfma_f32_16x16x32_bf16 v[64:67], a[204:207], a[224:227], v[64:67]
  v_accvgpr_write_b32 a28, v156
  v_accvgpr_write_b32 a29, v157
  v_mfma_f32_16x16x32_bf16 v[68:71], a[200:203], a[212:215], 0
  v_accvgpr_write_b32 a30, v158
  v_accvgpr_write_b32 a31, v159
  v_mfma_f32_16x16x32_bf16 v[68:71], a[204:207], a[228:231], v[68:71]
  s_add_u32 m0, s87, 0xc400
  v_cvt_pk_bf16_f32 v160, v160, v161
  v_cvt_pk_bf16_f32 v161, v162, v163
  v_mfma_f32_16x16x32_bf16 v[72:75], a[200:203], a[216:219], 0
  s_add_u32 s56, s83, 0x6f600
  v_cvt_pk_bf16_f32 v162, v164, v165
  v_cvt_pk_bf16_f32 v163, v166, v167
  v_mfma_f32_16x16x32_bf16 v[72:75], a[204:207], a[232:235], v[72:75]
  buffer_load_dwordx4 v5, s[20:23], s56 offen lds
  v_mfma_f32_16x16x32_bf16 v[76:79], a[200:203], a[220:223], 0
  s_nop 0
  ds_read_b64_tr_b16 a[200:201], v11 offset:8192
  ds_read_b64_tr_b16 a[202:203], v11 offset:9216
  v_mfma_f32_16x16x32_bf16 v[76:79], a[204:207], a[236:239], v[76:79]
  s_nop 0
  ds_read_b64_tr_b16 a[204:205], v11 offset:12288
  ds_read_b64_tr_b16 a[206:207], v11 offset:13312
  v_mfma_f32_16x16x32_bf16 v[80:83], a[240:243], a[208:211], 0
  s_waitcnt lgkmcnt(4)
  v_accvgpr_write_b32 a8, v160
  v_accvgpr_write_b32 a9, v161
  v_mfma_f32_16x16x32_bf16 v[80:83], a[244:247], a[224:227], v[80:83]
  v_accvgpr_write_b32 a10, v162
  v_accvgpr_write_b32 a11, v163
  v_mfma_f32_16x16x32_bf16 v[84:87], a[240:243], a[212:215], 0
  buffer_load_dwordx4 a[96:99], v1, s[28:31], s94 offen sc1
  v_mfma_f32_16x16x32_bf16 v[84:87], a[244:247], a[228:231], v[84:87]
  v_cvt_pk_bf16_f32 v168, v168, v169
  v_cvt_pk_bf16_f32 v169, v170, v171
  v_mfma_f32_16x16x32_bf16 v[88:91], a[240:243], a[216:219], 0
  s_add_u32 s57, s51, 0x3000
  v_cvt_pk_bf16_f32 v170, v172, v173
  v_cvt_pk_bf16_f32 v171, v174, v175
  v_mfma_f32_16x16x32_bf16 v[88:91], a[244:247], a[232:235], v[88:91]
  v_accvgpr_write_b32 a12, v168
  v_accvgpr_write_b32 a13, v169
  v_mfma_f32_16x16x32_bf16 v[92:95], a[240:243], a[220:223], 0
  s_nop 0
  ds_read_b64_tr_b16 a[240:241], v8 offset:16384
  ds_read_b64_tr_b16 a[242:243], v8 offset:17408
  v_mfma_f32_16x16x32_bf16 v[92:95], a[244:247], a[236:239], v[92:95]
  buffer_store_dwordx4 a[72:75], v1, s[28:31], s57 offen sc1
  v_mfma_f32_16x16x32_bf16 v[96:99], a[248:251], a[208:211], 0
  s_nop 0
  ds_read_b64_tr_b16 a[244:245], v8 offset:20480
  ds_read_b64_tr_b16 a[246:247], v8 offset:21504
  v_mfma_f32_16x16x32_bf16 v[96:99], a[252:255], a[224:227], v[96:99]
  v_accvgpr_write_b32 a14, v170
  v_accvgpr_write_b32 a15, v171
  v_mfma_f32_16x16x32_bf16 v[100:103], a[248:251], a[212:215], 0
  v_cvt_pk_bf16_f32 v224, v224, v225
  v_cvt_pk_bf16_f32 v225, v226, v227
  v_mfma_f32_16x16x32_bf16 v[100:103], a[252:255], a[228:231], v[100:103]
  v_cvt_pk_bf16_f32 v226, v228, v229
  v_cvt_pk_bf16_f32 v228, v192, v193
  v_mfma_f32_16x16x32_bf16 v[104:107], a[248:251], a[216:219], 0
  buffer_load_dwordx4 a[100:103], v1, s[28:31], s94 offen offset:1024 sc1
  v_mfma_f32_16x16x32_bf16 v[104:107], a[252:255], a[232:235], v[104:107]
  v_cvt_pk_bf16_f32 v229, v194, v195
  v_cvt_pk_bf16_f32 v227, v230, v231
  v_mfma_f32_16x16x32_bf16 v[108:111], a[248:251], a[220:223], 0
  s_nop 0
  ds_read_b64_tr_b16 a[248:249], v9 offset:16384
  ds_read_b64_tr_b16 a[250:251], v9 offset:17408
  v_mfma_f32_16x16x32_bf16 v[108:111], a[252:255], a[236:239], v[108:111]
  s_nop 0
  ds_read_b64_tr_b16 a[252:253], v9 offset:20480
  ds_read_b64_tr_b16 a[254:255], v9 offset:21504
  v_mfma_f32_16x16x32_bf16 v[112:115], a[184:187], a[208:211], 0
  v_cvt_pk_bf16_f32 v231, v198, v199
  v_cvt_pk_bf16_f32 v230, v196, v197
  v_mfma_f32_16x16x32_bf16 v[112:115], a[188:191], a[224:227], v[112:115]
  buffer_load_dwordx4 a[104:107], v1, s[28:31], s94 offen offset:2048 sc1
  v_mfma_f32_16x16x32_bf16 v[116:119], a[184:187], a[212:215], 0
  v_cvt_pk_bf16_f32 v232, v232, v233
  v_cvt_pk_bf16_f32 v233, v234, v235
  v_mfma_f32_16x16x32_bf16 v[116:119], a[188:191], a[228:231], v[116:119]
  v_cvt_pk_bf16_f32 v234, v236, v237
  v_cvt_pk_bf16_f32 v236, v200, v201
  v_mfma_f32_16x16x32_bf16 v[120:123], a[184:187], a[216:219], 0
  v_cvt_pk_bf16_f32 v237, v202, v203
  v_cvt_pk_bf16_f32 v235, v238, v239
  v_mfma_f32_16x16x32_bf16 v[120:123], a[188:191], a[232:235], v[120:123]
  v_cvt_pk_bf16_f32 v239, v206, v207
  v_cvt_pk_bf16_f32 v238, v204, v205
  v_mfma_f32_16x16x32_bf16 v[124:127], a[184:187], a[220:223], 0
  buffer_load_dwordx4 a[108:111], v1, s[28:31], s94 offen offset:3072 sc1
  v_mfma_f32_16x16x32_bf16 v[124:127], a[188:191], a[236:239], v[124:127]
  s_add_u32 s94, s81, 0x6000
  ds_read_b64_tr_b16 a[184:185], v10 offset:16384
  ds_read_b64_tr_b16 a[186:187], v10 offset:17408
  v_mfma_f32_16x16x32_bf16 v[128:131], a[192:195], a[208:211], 0
  s_add_u32 s58, s51, 0x3400
  ds_read_b64_tr_b16 a[188:189], v10 offset:20480
  ds_read_b64_tr_b16 a[190:191], v10 offset:21504
  v_mfma_f32_16x16x32_bf16 v[128:131], a[196:199], a[224:227], v[128:131]
  v_cvt_pk_bf16_f32 v243, v242, v243
  v_cvt_pk_bf16_f32 v242, v240, v241
  v_mfma_f32_16x16x32_bf16 v[132:135], a[192:195], a[212:215], 0
  v_cvt_pk_bf16_f32 v240, v208, v209
  v_cvt_pk_bf16_f32 v241, v210, v211
  v_mfma_f32_16x16x32_bf16 v[132:135], a[196:199], a[228:231], v[132:135]
  buffer_store_dwordx4 a[76:79], v1, s[28:31], s58 offen sc1
  v_mfma_f32_16x16x32_bf16 v[136:139], a[192:195], a[216:219], 0
  v_cvt_pk_bf16_f32 v247, v246, v247
  v_cvt_pk_bf16_f32 v246, v244, v245
  v_mfma_f32_16x16x32_bf16 v[136:139], a[196:199], a[232:235], v[136:139]
  v_cvt_pk_bf16_f32 v244, v212, v213
  v_cvt_pk_bf16_f32 v245, v214, v215
  v_mfma_f32_16x16x32_bf16 v[140:143], a[192:195], a[220:223], 0
  s_nop 0
  ds_read_b64_tr_b16 a[192:193], v11 offset:16384
  ds_read_b64_tr_b16 a[194:195], v11 offset:17408
  v_mfma_f32_16x16x32_bf16 v[140:143], a[196:199], a[236:239], v[140:143]
  s_waitcnt lgkmcnt(2)
  ds_read_b64_tr_b16 a[196:197], v11 offset:20480
  ds_read_b64_tr_b16 a[198:199], v11 offset:21504
  v_mfma_f32_16x16x32_bf16 v[144:147], a[200:203], a[208:211], 0
  buffer_load_dwordx4 a[112:115], v1, s[28:31], s93 offen sc1
  v_mfma_f32_16x16x32_bf16 v[144:147], a[204:207], a[224:227], v[144:147]
  v_cvt_pk_bf16_f32 v251, v250, v251
  v_cvt_pk_bf16_f32 v250, v248, v249
  v_mfma_f32_16x16x32_bf16 v[148:151], a[200:203], a[212:215], 0
  v_cvt_pk_bf16_f32 v248, v216, v217
  v_cvt_pk_bf16_f32 v249, v218, v219
  v_mfma_f32_16x16x32_bf16 v[148:151], a[204:207], a[228:231], v[148:151]
  v_cvt_pk_bf16_f32 v255, v254, v255
  v_cvt_pk_bf16_f32 v254, v252, v253
  v_mfma_f32_16x16x32_bf16 v[152:155], a[200:203], a[216:219], 0
  v_cvt_pk_bf16_f32 v252, v220, v221
  v_cvt_pk_bf16_f32 v253, v222, v223
  v_mfma_f32_16x16x32_bf16 v[152:155], a[204:207], a[232:235], v[152:155]
  buffer_load_dwordx4 a[116:119], v1, s[28:31], s93 offen offset:1024 sc1
  v_mfma_f32_16x16x32_bf16 v[156:159], a[200:203], a[220:223], 0
  v_lshlrev_b32 v16, 15, v1
  v_bfe_u32 v17, v0, 4, 2
  v_mfma_f32_16x16x32_bf16 v[156:159], a[204:207], a[236:239], v[156:159]
  v_lshlrev_b32 v17, 2, v17
  v_bfe_u32 v19, v0, 4, 1
  v_mfma_f32_16x16x32_bf16 v[160:163], a[240:243], a[208:211], 0
  v_bfe_u32 v18, v0, 2, 4
  v_lshlrev_b32 v19, 1, v19
  v_mfma_f32_16x16x32_bf16 v[160:163], a[244:247], a[224:227], v[160:163]
  v_and_b32 v20, 3, v0
  v_mul_u32_u24 v18, 1280, v18
  v_mfma_f32_16x16x32_bf16 v[164:167], a[240:243], a[212:215], 0
  buffer_load_dwordx4 a[120:123], v1, s[28:31], s93 offen offset:2048 sc1
  v_mfma_f32_16x16x32_bf16 v[164:167], a[244:247], a[228:231], v[164:167]
  v_xor_b32 v19, v19, v20
  v_mfma_f32_16x16x32_bf16 v[168:171], a[240:243], a[216:219], 0
  v_mfma_f32_16x16x32_bf16 v[168:171], a[244:247], a[232:235], v[168:171]
  v_mfma_f32_16x16x32_bf16 v[172:175], a[240:243], a[220:223], 0
  v_mfma_f32_16x16x32_bf16 v[172:175], a[244:247], a[236:239], v[172:175]
  buffer_load_dwordx4 a[124:127], v1, s[28:31], s93 offen offset:3072 sc1
  v_mfma_f32_16x16x32_bf16 v[176:179], a[248:251], a[208:211], 0
  s_add_u32 s93, s81, 0x7000
  v_mfma_f32_16x16x32_bf16 v[176:179], a[252:255], a[224:227], v[176:179]
  v_mfma_f32_16x16x32_bf16 v[180:183], a[248:251], a[212:215], 0
  v_mfma_f32_16x16x32_bf16 v[180:183], a[252:255], a[228:231], v[180:183]
  v_mfma_f32_16x16x32_bf16 v[184:187], a[248:251], a[216:219], 0
  v_mfma_f32_16x16x32_bf16 v[184:187], a[252:255], a[232:235], v[184:187]
  v_mfma_f32_16x16x32_bf16 v[188:191], a[248:251], a[220:223], 0
  v_mfma_f32_16x16x32_bf16 v[188:191], a[252:255], a[236:239], v[188:191]
  v_mfma_f32_16x16x32_bf16 v[192:195], a[184:187], a[208:211], 0
  v_mfma_f32_16x16x32_bf16 v[192:195], a[188:191], a[224:227], v[192:195]
  v_mfma_f32_16x16x32_bf16 v[196:199], a[184:187], a[212:215], 0
  v_mfma_f32_16x16x32_bf16 v[196:199], a[188:191], a[228:231], v[196:199]
  v_mfma_f32_16x16x32_bf16 v[200:203], a[184:187], a[216:219], 0
  v_mfma_f32_16x16x32_bf16 v[200:203], a[188:191], a[232:235], v[200:203]
  v_mfma_f32_16x16x32_bf16 v[204:207], a[184:187], a[220:223], 0
  v_mfma_f32_16x16x32_bf16 v[204:207], a[188:191], a[236:239], v[204:207]
  s_waitcnt vmcnt(26) lgkmcnt(0)
  s_barrier
  v_mfma_f32_16x16x32_bf16 v[208:211], a[192:195], a[208:211], 0
  s_add_u32 m0, s86, 0x20000
  ds_read_b64_tr_b16 a[200:201], v6 offset:16384
  ds_read_b64_tr_b16 a[202:203], v6 offset:17408
  v_mfma_f32_16x16x32_bf16 v[208:211], a[196:199], a[224:227], v[208:211]
  s_add_u32 s59, s82, 0x180000
  ds_read_b64_tr_b16 a[204:205], v6 offset:20480
  ds_read_b64_tr_b16 a[206:207], v6 offset:21504
  v_mfma_f32_16x16x32_bf16 v[212:215], a[192:195], a[212:215], 0
  s_nop 0
  ds_read_b64_tr_b16 a[240:241], v7 offset:16384
  ds_read_b64_tr_b16 a[242:243], v7 offset:17408
  v_mfma_f32_16x16x32_bf16 v[212:215], a[196:199], a[228:231], v[212:215]
  buffer_load_dwordx4 v4, s[16:19], s59 offen lds
  v_mfma_f32_16x16x32_bf16 v[216:219], a[192:195], a[216:219], 0
  s_add_u32 s56, s52, 0x400
  ds_read_b64_tr_b16 a[244:245], v7 offset:20480
  ds_read_b64_tr_b16 a[246:247], v7 offset:21504
  v_mfma_f32_16x16x32_bf16 v[216:219], a[196:199], a[232:235], v[216:219]
  s_nop 0
  ds_read_b64_tr_b16 a[248:249], v2 offset:16384
  ds_read_b64_tr_b16 a[250:251], v2 offset:17408
  v_mfma_f32_16x16x32_bf16 v[220:223], a[192:195], a[220:223], 0
  s_nop 0
  ds_read_b64_tr_b16 a[252:253], v2 offset:20480
  ds_read_b64_tr_b16 a[254:255], v2 offset:21504
  v_mfma_f32_16x16x32_bf16 v[220:223], a[196:199], a[236:239], v[220:223]
  s_waitcnt lgkmcnt(10)
  buffer_store_dwordx4 a[80:83], v1, s[28:31], s56 offen sc1
  v_mfma_f32_16x16x32_bf16 v[32:35], a[200:203], a[32:35], v[32:35]
  s_waitcnt lgkmcnt(8)
  ds_read_b64_tr_b16 a[184:185], v3 offset:16384
  ds_read_b64_tr_b16 a[186:187], v3 offset:17408
  v_mfma_f32_16x16x32_bf16 v[32:35], a[204:207], a[48:51], v[32:35]
  s_nop 0
  ds_read_b64_tr_b16 a[188:189], v3 offset:20480
  ds_read_b64_tr_b16 a[190:191], v3 offset:21504
  v_mfma_f32_16x16x32_bf16 v[36:39], a[200:203], a[36:39], v[36:39]
  s_add_u32 m0, s86, 0x20400
  ds_read_b64_tr_b16 a[192:193], v6 offset:24576
  ds_read_b64_tr_b16 a[194:195], v6 offset:25600
  v_mfma_f32_16x16x32_bf16 v[36:39], a[204:207], a[52:55], v[36:39]
  s_add_u32 s57, s82, 0x188000
  v_mfma_f32_16x16x32_bf16 v[40:43], a[200:203], a[40:43], v[40:43]
  buffer_load_dwordx4 v4, s[16:19], s57 offen lds
  v_mfma_f32_16x16x32_bf16 v[40:43], a[204:207], a[56:59], v[40:43]
  s_nop 0
  ds_read_b64_tr_b16 a[196:197], v6 offset:28672
  ds_read_b64_tr_b16 a[198:199], v6 offset:29696
  v_mfma_f32_16x16x32_bf16 v[44:47], a[200:203], a[44:47], v[44:47]
  s_nop 0
  ds_read_b64_tr_b16 a[200:201], v7 offset:24576
  ds_read_b64_tr_b16 a[202:203], v7 offset:25600
  v_mfma_f32_16x16x32_bf16 v[44:47], a[204:207], a[60:63], v[44:47]
  s_waitcnt lgkmcnt(8)
  ds_read_b64_tr_b16 a[204:205], v7 offset:28672
  ds_read_b64_tr_b16 a[206:207], v7 offset:29696
  v_mfma_f32_16x16x32_bf16 v[48:51], a[240:243], a[32:35], v[48:51]
  s_add_u32 m0, s86, 0x20800
  v_mfma_f32_16x16x32_bf16 v[48:51], a[244:247], a[48:51], v[48:51]
  s_add_u32 s58, s82, 0x1a0000
  buffer_load_dwordx4 v4, s[16:19], s58 offen lds
  v_mfma_f32_16x16x32_bf16 v[52:55], a[240:243], a[36:39], v[52:55]
  v_mfma_f32_16x16x32_bf16 v[52:55], a[244:247], a[52:55], v[52:55]
  v_mfma_f32_16x16x32_bf16 v[56:59], a[240:243], a[40:43], v[56:59]
  s_add_u32 m0, s86, 0x20c00
  v_mfma_f32_16x16x32_bf16 v[56:59], a[244:247], a[56:59], v[56:59]
  s_add_u32 s59, s82, 0x1a8000
  v_mfma_f32_16x16x32_bf16 v[60:63], a[240:243], a[44:47], v[60:63]
  buffer_load_dwordx4 v4, s[16:19], s59 offen lds
  v_mfma_f32_16x16x32_bf16 v[60:63], a[244:247], a[60:63], v[60:63]
  s_nop 0
  ds_read_b64_tr_b16 a[240:241], v2 offset:24576
  ds_read_b64_tr_b16 a[242:243], v2 offset:25600
  v_mfma_f32_16x16x32_bf16 v[64:67], a[248:251], a[32:35], v[64:67]
  s_add_u32 s56, s52, 0xc00
  ds_read_b64_tr_b16 a[244:245], v2 offset:28672
  ds_read_b64_tr_b16 a[246:247], v2 offset:29696
  v_mfma_f32_16x16x32_bf16 v[64:67], a[252:255], a[48:51], v[64:67]
  v_mfma_f32_16x16x32_bf16 v[68:71], a[248:251], a[36:39], v[68:71]
  v_mfma_f32_16x16x32_bf16 v[68:71], a[252:255], a[52:55], v[68:71]
  buffer_store_dwordx4 a[84:87], v1, s[28:31], s56 offen sc1
  v_mfma_f32_16x16x32_bf16 v[72:75], a[248:251], a[40:43], v[72:75]
  v_mfma_f32_16x16x32_bf16 v[72:75], a[252:255], a[56:59], v[72:75]
  v_mfma_f32_16x16x32_bf16 v[76:79], a[248:251], a[44:47], v[76:79]
  s_add_u32 m0, s87, 0x24000
  ds_read_b64_tr_b16 a[248:249], v3 offset:24576
  ds_read_b64_tr_b16 a[250:251], v3 offset:25600
  v_mfma_f32_16x16x32_bf16 v[76:79], a[252:255], a[60:63], v[76:79]
  s_add_u32 s57, s83, 0xa2000
  ds_read_b64_tr_b16 a[252:253], v3 offset:28672
  ds_read_b64_tr_b16 a[254:255], v3 offset:29696
  v_mfma_f32_16x16x32_bf16 v[80:83], a[184:187], a[32:35], v[80:83]
  s_waitcnt lgkmcnt(4)
  buffer_load_dwordx4 v5, s[20:23], s57 offen lds
  v_mfma_f32_16x16x32_bf16 v[80:83], a[188:191], a[48:51], v[80:83]
  v_mfma_f32_16x16x32_bf16 v[84:87], a[184:187], a[36:39], v[84:87]
  v_mfma_f32_16x16x32_bf16 v[84:87], a[188:191], a[52:55], v[84:87]
  s_add_u32 m0, s87, 0x24400
  v_mfma_f32_16x16x32_bf16 v[88:91], a[184:187], a[40:43], v[88:91]
  s_add_u32 s58, s83, 0xa5600
  v_mfma_f32_16x16x32_bf16 v[88:91], a[188:191], a[56:59], v[88:91]
  buffer_load_dwordx4 v5, s[20:23], s58 offen lds
  v_mfma_f32_16x16x32_bf16 v[92:95], a[184:187], a[44:47], v[92:95]
  s_nop 0
  ds_read_b64_tr_b16 a[184:185], v8 offset:24576
  ds_read_b64_tr_b16 a[186:187], v8 offset:25600
  v_mfma_f32_16x16x32_bf16 v[92:95], a[188:191], a[60:63], v[92:95]
  s_nop 0
  ds_read_b64_tr_b16 a[188:189], v8 offset:28672
  ds_read_b64_tr_b16 a[190:191], v8 offset:29696
  v_mfma_f32_16x16x32_bf16 v[96:99], a[192:195], a[32:35], v[96:99]
  v_mfma_f32_16x16x32_bf16 v[96:99], a[196:199], a[48:51], v[96:99]
  v_mfma_f32_16x16x32_bf16 v[100:103], a[192:195], a[36:39], v[100:103]
  buffer_load_dwordx4 a[208:211], v1, s[28:31], s94 offen sc1
  v_mfma_f32_16x16x32_bf16 v[100:103], a[196:199], a[52:55], v[100:103]
  v_mfma_f32_16x16x32_bf16 v[104:107], a[192:195], a[40:43], v[104:107]
  s_add_u32 s59, s52, 0x1400
  v_mfma_f32_16x16x32_bf16 v[104:107], a[196:199], a[56:59], v[104:107]
  v_mfma_f32_16x16x32_bf16 v[108:111], a[192:195], a[44:47], v[108:111]
  s_nop 0
  ds_read_b64_tr_b16 a[192:193], v9 offset:24576
  ds_read_b64_tr_b16 a[194:195], v9 offset:25600
  v_mfma_f32_16x16x32_bf16 v[108:111], a[196:199], a[60:63], v[108:111]
  buffer_store_dwordx4 a[88:91], v1, s[28:31], s59 offen sc1
  v_mfma_f32_16x16x32_bf16 v[112:115], a[200:203], a[32:35], v[112:115]
  s_nop 0
  ds_read_b64_tr_b16 a[196:197], v9 offset:28672
  ds_read_b64_tr_b16 a[198:199], v9 offset:29696
  v_mfma_f32_16x16x32_bf16 v[112:115], a[204:207], a[48:51], v[112:115]
  v_mfma_f32_16x16x32_bf16 v[116:119], a[200:203], a[36:39], v[116:119]
  v_mfma_f32_16x16x32_bf16 v[116:119], a[204:207], a[52:55], v[116:119]
  v_mfma_f32_16x16x32_bf16 v[120:123], a[200:203], a[40:43], v[120:123]
  buffer_load_dwordx4 a[212:215], v1, s[28:31], s94 offen offset:1024 sc1
  v_mfma_f32_16x16x32_bf16 v[120:123], a[204:207], a[56:59], v[120:123]
  v_mfma_f32_16x16x32_bf16 v[124:127], a[200:203], a[44:47], v[124:127]
  s_nop 0
  ds_read_b64_tr_b16 a[200:201], v10 offset:24576
  ds_read_b64_tr_b16 a[202:203], v10 offset:25600
  v_mfma_f32_16x16x32_bf16 v[124:127], a[204:207], a[60:63], v[124:127]
  s_nop 0
  ds_read_b64_tr_b16 a[204:205], v10 offset:28672
  ds_read_b64_tr_b16 a[206:207], v10 offset:29696
  v_mfma_f32_16x16x32_bf16 v[128:131], a[240:243], a[32:35], v[128:131]
  v_mfma_f32_16x16x32_bf16 v[128:131], a[244:247], a[48:51], v[128:131]
  buffer_load_dwordx4 a[216:219], v1, s[28:31], s94 offen offset:2048 sc1
  v_mfma_f32_16x16x32_bf16 v[132:135], a[240:243], a[36:39], v[132:135]
  v_mfma_f32_16x16x32_bf16 v[132:135], a[244:247], a[52:55], v[132:135]
  v_mfma_f32_16x16x32_bf16 v[136:139], a[240:243], a[40:43], v[136:139]
  v_mfma_f32_16x16x32_bf16 v[136:139], a[244:247], a[56:59], v[136:139]
  v_mfma_f32_16x16x32_bf16 v[140:143], a[240:243], a[44:47], v[140:143]
  buffer_load_dwordx4 a[220:223], v1, s[28:31], s94 offen offset:3072 sc1
  v_mfma_f32_16x16x32_bf16 v[140:143], a[244:247], a[60:63], v[140:143]
  s_waitcnt lgkmcnt(0)
  ds_read_b64_tr_b16 a[240:241], v11 offset:24576
  ds_read_b64_tr_b16 a[242:243], v11 offset:25600
  v_mfma_f32_16x16x32_bf16 v[144:147], a[248:251], a[32:35], v[144:147]
  s_add_u32 s56, s52, 0x1c00
  ds_read_b64_tr_b16 a[244:245], v11 offset:28672
  ds_read_b64_tr_b16 a[246:247], v11 offset:29696
  v_mfma_f32_16x16x32_bf16 v[144:147], a[252:255], a[48:51], v[144:147]
  s_add_u32 s94, s81, 0x8000
  v_mfma_f32_16x16x32_bf16 v[148:151], a[248:251], a[36:39], v[148:151]
  v_mfma_f32_16x16x32_bf16 v[148:151], a[252:255], a[52:55], v[148:151]
  buffer_store_dwordx4 a[92:95], v1, s[28:31], s56 offen sc1
  v_mfma_f32_16x16x32_bf16 v[152:155], a[248:251], a[40:43], v[152:155]
  v_mfma_f32_16x16x32_bf16 v[152:155], a[252:255], a[56:59], v[152:155]
  v_mfma_f32_16x16x32_bf16 v[156:159], a[248:251], a[44:47], v[156:159]
  v_mfma_f32_16x16x32_bf16 v[156:159], a[252:255], a[60:63], v[156:159]
  v_mfma_f32_16x16x32_bf16 v[160:163], a[184:187], a[32:35], v[160:163]
  buffer_load_dwordx4 a[224:227], v1, s[28:31], s93 offen sc1
  v_mfma_f32_16x16x32_bf16 v[160:163], a[188:191], a[48:51], v[160:163]
  v_mfma_f32_16x16x32_bf16 v[164:167], a[184:187], a[36:39], v[164:167]
  v_mfma_f32_16x16x32_bf16 v[164:167], a[188:191], a[52:55], v[164:167]
  v_mfma_f32_16x16x32_bf16 v[168:171], a[184:187], a[40:43], v[168:171]
  v_mfma_f32_16x16x32_bf16 v[168:171], a[188:191], a[56:59], v[168:171]
  buffer_load_dwordx4 a[228:231], v1, s[28:31], s93 offen offset:1024 sc1
  v_mfma_f32_16x16x32_bf16 v[172:175], a[184:187], a[44:47], v[172:175]
  v_mfma_f32_16x16x32_bf16 v[172:175], a[188:191], a[60:63], v[172:175]
  v_mfma_f32_16x16x32_bf16 v[176:179], a[192:195], a[32:35], v[176:179]
  v_mfma_f32_16x16x32_bf16 v[176:179], a[196:199], a[48:51], v[176:179]
  v_mfma_f32_16x16x32_bf16 v[180:183], a[192:195], a[36:39], v[180:183]
  buffer_load_dwordx4 a[232:235], v1, s[28:31], s93 offen offset:2048 sc1
  v_mfma_f32_16x16x32_bf16 v[180:183], a[196:199], a[52:55], v[180:183]
  v_mfma_f32_16x16x32_bf16 v[184:187], a[192:195], a[40:43], v[184:187]
  v_mfma_f32_16x16x32_bf16 v[184:187], a[196:199], a[56:59], v[184:187]
  v_mfma_f32_16x16x32_bf16 v[188:191], a[192:195], a[44:47], v[188:191]
  v_mfma_f32_16x16x32_bf16 v[188:191], a[196:199], a[60:63], v[188:191]
  buffer_load_dwordx4 a[236:239], v1, s[28:31], s93 offen offset:3072 sc1
  v_mfma_f32_16x16x32_bf16 v[192:195], a[200:203], a[32:35], v[192:195]
  s_add_u32 s93, s81, 0x9000
  v_mfma_f32_16x16x32_bf16 v[192:195], a[204:207], a[48:51], v[192:195]
  v_mfma_f32_16x16x32_bf16 v[196:199], a[200:203], a[36:39], v[196:199]
  v_mfma_f32_16x16x32_bf16 v[196:199], a[204:207], a[52:55], v[196:199]
  v_mfma_f32_16x16x32_bf16 v[200:203], a[200:203], a[40:43], v[200:203]
  buffer_load_dword a169, v28, s[24:27], s3 offen
  v_mfma_f32_16x16x32_bf16 v[200:203], a[204:207], a[56:59], v[200:203]
  v_mfma_f32_16x16x32_bf16 v[204:207], a[200:203], a[44:47], v[204:207]
  v_mfma_f32_16x16x32_bf16 v[204:207], a[204:207], a[60:63], v[204:207]
  s_waitcnt vmcnt(19) lgkmcnt(0)
  s_barrier
  v_mfma_f32_16x16x32_bf16 v[208:211], a[240:243], a[32:35], v[208:211]
  s_add_u32 m0, s86, 0x4000
  ds_read_b64_tr_b16 a[248:249], v6 offset:32768
  ds_read_b64_tr_b16 a[250:251], v6 offset:33792
  v_mfma_f32_16x16x32_bf16 v[208:211], a[244:247], a[48:51], v[208:211]
  s_add_u32 s57, s82, 0x200000
  ds_read_b64_tr_b16 a[252:253], v6 offset:36864
  ds_read_b64_tr_b16 a[254:255], v6 offset:37888
  v_mfma_f32_16x16x32_bf16 v[212:215], a[240:243], a[36:39], v[212:215]
  s_nop 0
  ds_read_b64_tr_b16 a[184:185], v7 offset:32768
  ds_read_b64_tr_b16 a[186:187], v7 offset:33792
  v_mfma_f32_16x16x32_bf16 v[212:215], a[244:247], a[52:55], v[212:215]
  buffer_load_dwordx4 v4, s[16:19], s57 offen lds
  v_mfma_f32_16x16x32_bf16 v[216:219], a[240:243], a[40:43], v[216:219]
  s_add_u32 s58, s51, 0x8000
  ds_read_b64_tr_b16 a[188:189], v7 offset:36864
  ds_read_b64_tr_b16 a[190:191], v7 offset:37888
  v_mfma_f32_16x16x32_bf16 v[216:219], a[244:247], a[56:59], v[216:219]
  s_nop 0
  ds_read_b64_tr_b16 a[192:193], v2 offset:32768
  ds_read_b64_tr_b16 a[194:195], v2 offset:33792
  v_mfma_f32_16x16x32_bf16 v[220:223], a[240:243], a[44:47], v[220:223]
  s_nop 0
  ds_read_b64_tr_b16 a[196:197], v2 offset:36864
  ds_read_b64_tr_b16 a[198:199], v2 offset:37888
  v_mfma_f32_16x16x32_bf16 v[220:223], a[244:247], a[60:63], v[220:223]
  s_waitcnt lgkmcnt(10)
  buffer_store_dwordx4 a[0:3], v1, s[28:31], s58 offen sc1
  v_mfma_f32_16x16x32_bf16 v[32:35], a[248:251], a[96:99], v[32:35]
  s_waitcnt lgkmcnt(8)
  ds_read_b64_tr_b16 a[200:201], v3 offset:32768
  ds_read_b64_tr_b16 a[202:203], v3 offset:33792
  v_mfma_f32_16x16x32_bf16 v[32:35], a[252:255], a[112:115], v[32:35]
  s_nop 0
  ds_read_b64_tr_b16 a[204:205], v3 offset:36864
  ds_read_b64_tr_b16 a[206:207], v3 offset:37888
  v_mfma_f32_16x16x32_bf16 v[36:39], a[248:251], a[100:103], v[36:39]
  s_add_u32 m0, s86, 0x4400
  ds_read_b64_tr_b16 a[240:241], v6 offset:40960
  ds_read_b64_tr_b16 a[242:243], v6 offset:41984
  v_mfma_f32_16x16x32_bf16 v[36:39], a[252:255], a[116:119], v[36:39]
  s_add_u32 s59, s82, 0x208000
  v_mfma_f32_16x16x32_bf16 v[40:43], a[248:251], a[104:107], v[40:43]
  buffer_load_dwordx4 v4, s[16:19], s59 offen lds
  v_mfma_f32_16x16x32_bf16 v[40:43], a[252:255], a[120:123], v[40:43]
  s_nop 0
  ds_read_b64_tr_b16 a[244:245], v6 offset:45056
  ds_read_b64_tr_b16 a[246:247], v6 offset:46080
  v_mfma_f32_16x16x32_bf16 v[44:47], a[248:251], a[108:111], v[44:47]
  s_nop 0
  ds_read_b64_tr_b16 a[248:249], v7 offset:40960
  ds_read_b64_tr_b16 a[250:251], v7 offset:41984
  v_mfma_f32_16x16x32_bf16 v[44:47], a[252:255], a[124:127], v[44:47]
  s_waitcnt lgkmcnt(8)
  ds_read_b64_tr_b16 a[252:253], v7 offset:45056
  ds_read_b64_tr_b16 a[254:255], v7 offset:46080
  v_mfma_f32_16x16x32_bf16 v[48:51], a[184:187], a[96:99], v[48:51]
  s_add_u32 m0, s86, 0x4800
  v_mfma_f32_16x16x32_bf16 v[48:51], a[188:191], a[112:115], v[48:51]
  s_add_u32 s56, s82, 0x220000
  buffer_load_dwordx4 v4, s[16:19], s56 offen lds
  v_mfma_f32_16x16x32_bf16 v[52:55], a[184:187], a[100:103], v[52:55]
  v_mfma_f32_16x16x32_bf16 v[52:55], a[188:191], a[116:119], v[52:55]
  v_mfma_f32_16x16x32_bf16 v[56:59], a[184:187], a[104:107], v[56:59]
  s_add_u32 m0, s86, 0x4c00
  v_mfma_f32_16x16x32_bf16 v[56:59], a[188:191], a[120:123], v[56:59]
  s_add_u32 s57, s82, 0x228000
  v_mfma_f32_16x16x32_bf16 v[60:63], a[184:187], a[108:111], v[60:63]
  buffer_load_dwordx4 v4, s[16:19], s57 offen lds
  v_mfma_f32_16x16x32_bf16 v[60:63], a[188:191], a[124:127], v[60:63]
  s_nop 0
  ds_read_b64_tr_b16 a[184:185], v2 offset:40960
  ds_read_b64_tr_b16 a[186:187], v2 offset:41984
  v_mfma_f32_16x16x32_bf16 v[64:67], a[192:195], a[96:99], v[64:67]
  s_add_u32 s58, s51, 0x8400
  ds_read_b64_tr_b16 a[188:189], v2 offset:45056
  ds_read_b64_tr_b16 a[190:191], v2 offset:46080
  v_mfma_f32_16x16x32_bf16 v[64:67], a[196:199], a[112:115], v[64:67]
  v_mfma_f32_16x16x32_bf16 v[68:71], a[192:195], a[100:103], v[68:71]
  v_mfma_f32_16x16x32_bf16 v[68:71], a[196:199], a[116:119], v[68:71]
  buffer_store_dwordx4 a[4:7], v1, s[28:31], s58 offen sc1
  v_mfma_f32_16x16x32_bf16 v[72:75], a[192:195], a[104:107], v[72:75]
  v_mfma_f32_16x16x32_bf16 v[72:75], a[196:199], a[120:123], v[72:75]
  v_mfma_f32_16x16x32_bf16 v[76:79], a[192:195], a[108:111], v[76:79]
  s_add_u32 m0, s87, 0x26000
  ds_read_b64_tr_b16 a[192:193], v3 offset:40960
  ds_read_b64_tr_b16 a[194:195], v3 offset:41984
  v_mfma_f32_16x16x32_bf16 v[76:79], a[196:199], a[124:127], v[76:79]
  s_add_u32 s59, s83, 0xd8000
  ds_read_b64_tr_b16 a[196:197], v3 offset:45056
  ds_read_b64_tr_b16 a[198:199], v3 offset:46080
  v_mfma_f32_16x16x32_bf16 v[80:83], a[200:203], a[96:99], v[80:83]
  s_waitcnt lgkmcnt(4)
  buffer_load_dwordx4 v5, s[20:23], s59 offen lds
  v_mfma_f32_16x16x32_bf16 v[80:83], a[204:207], a[112:115], v[80:83]
  v_mfma_f32_16x16x32_bf16 v[84:87], a[200:203], a[100:103], v[84:87]
  v_mfma_f32_16x16x32_bf16 v[84:87], a[204:207], a[116:119], v[84:87]
  s_add_u32 m0, s87, 0x26400
  v_mfma_f32_16x16x32_bf16 v[88:91], a[200:203], a[104:107], v[88:91]
  s_add_u32 s56, s83, 0xdb600
  v_mfma_f32_16x16x32_bf16 v[88:91], a[204:207], a[120:123], v[88:91]
  buffer_load_dwordx4 v5, s[20:23], s56 offen lds
  v_mfma_f32_16x16x32_bf16 v[92:95], a[200:203], a[108:111], v[92:95]
  s_nop 0
  ds_read_b64_tr_b16 a[200:201], v6 offset:49152
  ds_read_b64_tr_b16 a[202:203], v6 offset:50176
  v_mfma_f32_16x16x32_bf16 v[92:95], a[204:207], a[124:127], v[92:95]
  s_nop 0
  ds_read_b64_tr_b16 a[204:205], v6 offset:53248
  ds_read_b64_tr_b16 a[206:207], v6 offset:54272
  v_mfma_f32_16x16x32_bf16 v[96:99], a[240:243], a[96:99], v[96:99]
  v_mfma_f32_16x16x32_bf16 v[96:99], a[244:247], a[112:115], v[96:99]
  v_mfma_f32_16x16x32_bf16 v[100:103], a[240:243], a[100:103], v[100:103]
  buffer_load_dwordx4 a[32:35], v1, s[28:31], s94 offen sc1
  v_mfma_f32_16x16x32_bf16 v[100:103], a[244:247], a[116:119], v[100:103]
  v_mfma_f32_16x16x32_bf16 v[104:107], a[240:243], a[104:107], v[104:107]
  s_add_u32 s57, s51, 0x9000
  v_mfma_f32_16x16x32_bf16 v[104:107], a[244:247], a[120:123], v[104:107]
  v_mfma_f32_16x16x32_bf16 v[108:111], a[240:243], a[108:111], v[108:111]
  s_nop 0
  ds_read_b64_tr_b16 a[240:241], v7 offset:49152
  ds_read_b64_tr_b16 a[242:243], v7 offset:50176
  v_mfma_f32_16x16x32_bf16 v[108:111], a[244:247], a[124:127], v[108:111]
  buffer_store_dwordx4 a[8:11], v1, s[28:31], s57 offen sc1
  v_mfma_f32_16x16x32_bf16 v[112:115], a[248:251], a[96:99], v[112:115]
  s_nop 0
  ds_read_b64_tr_b16 a[244:245], v7 offset:53248
  ds_read_b64_tr_b16 a[246:247], v7 offset:54272
  v_mfma_f32_16x16x32_bf16 v[112:115], a[252:255], a[112:115], v[112:115]
  v_mfma_f32_16x16x32_bf16 v[116:119], a[248:251], a[100:103], v[116:119]
  v_mfma_f32_16x16x32_bf16 v[116:119], a[252:255], a[116:119], v[116:119]
  v_mfma_f32_16x16x32_bf16 v[120:123], a[248:251], a[104:107], v[120:123]
  buffer_load_dwordx4 a[36:39], v1, s[28:31], s94 offen offset:1024 sc1
  v_mfma_f32_16x16x32_bf16 v[120:123], a[252:255], a[120:123], v[120:123]
  v_mfma_f32_16x16x32_bf16 v[124:127], a[248:251], a[108:111], v[124:127]
  s_nop 0
  ds_read_b64_tr_b16 a[248:249], v2 offset:49152
  ds_read_b64_tr_b16 a[250:251], v2 offset:50176
  v_mfma_f32_16x16x32_bf16 v[124:127], a[252:255], a[124:127], v[124:127]
  s_nop 0
  ds_read_b64_tr_b16 a[252:253], v2 offset:53248
  ds_read_b64_tr_b16 a[254:255], v2 offset:54272
  v_mfma_f32_16x16x32_bf16 v[128:131], a[184:187], a[96:99], v[128:131]
  v_mfma_f32_16x16x32_bf16 v[128:131], a[188:191], a[112:115], v[128:131]
  buffer_load_dwordx4 a[40:43], v1, s[28:31], s94 offen offset:2048 sc1
  v_mfma_f32_16x16x32_bf16 v[132:135], a[184:187], a[100:103], v[132:135]
  v_mfma_f32_16x16x32_bf16 v[132:135], a[188:191], a[116:119], v[132:135]
  v_mfma_f32_16x16x32_bf16 v[136:139], a[184:187], a[104:107], v[136:139]
  v_mfma_f32_16x16x32_bf16 v[136:139], a[188:191], a[120:123], v[136:139]
  v_mfma_f32_16x16x32_bf16 v[140:143], a[184:187], a[108:111], v[140:143]
  buffer_load_dwordx4 a[44:47], v1, s[28:31], s94 offen offset:3072 sc1
  v_mfma_f32_16x16x32_bf16 v[140:143], a[188:191], a[124:127], v[140:143]
  s_waitcnt lgkmcnt(0)
  ds_read_b64_tr_b16 a[184:185], v3 offset:49152
  ds_read_b64_tr_b16 a[186:187], v3 offset:50176
  v_mfma_f32_16x16x32_bf16 v[144:147], a[192:195], a[96:99], v[144:147]
  s_add_u32 s58, s51, 0x9400
  ds_read_b64_tr_b16 a[188:189], v3 offset:53248
  ds_read_b64_tr_b16 a[190:191], v3 offset:54272
  v_mfma_f32_16x16x32_bf16 v[144:147], a[196:199], a[112:115], v[144:147]
  s_add_u32 s94, s81, 0xa000
  v_mfma_f32_16x16x32_bf16 v[148:151], a[192:195], a[100:103], v[148:151]
  v_mfma_f32_16x16x32_bf16 v[148:151], a[196:199], a[116:119], v[148:151]
  buffer_store_dwordx4 a[12:15], v1, s[28:31], s58 offen sc1
  v_mfma_f32_16x16x32_bf16 v[152:155], a[192:195], a[104:107], v[152:155]
  v_mfma_f32_16x16x32_bf16 v[152:155], a[196:199], a[120:123], v[152:155]
  v_mfma_f32_16x16x32_bf16 v[156:159], a[192:195], a[108:111], v[156:159]
  v_mfma_f32_16x16x32_bf16 v[156:159], a[196:199], a[124:127], v[156:159]
  v_mfma_f32_16x16x32_bf16 v[160:163], a[200:203], a[96:99], v[160:163]
  buffer_load_dwordx4 a[48:51], v1, s[28:31], s93 offen sc1
  v_mfma_f32_16x16x32_bf16 v[160:163], a[204:207], a[112:115], v[160:163]
  v_mfma_f32_16x16x32_bf16 v[164:167], a[200:203], a[100:103], v[164:167]
  v_mfma_f32_16x16x32_bf16 v[164:167], a[204:207], a[116:119], v[164:167]
  v_mfma_f32_16x16x32_bf16 v[168:171], a[200:203], a[104:107], v[168:171]
  v_mfma_f32_16x16x32_bf16 v[168:171], a[204:207], a[120:123], v[168:171]
  buffer_load_dwordx4 a[52:55], v1, s[28:31], s93 offen offset:1024 sc1
  v_mfma_f32_16x16x32_bf16 v[172:175], a[200:203], a[108:111], v[172:175]
  v_mfma_f32_16x16x32_bf16 v[172:175], a[204:207], a[124:127], v[172:175]
  v_mfma_f32_16x16x32_bf16 v[176:179], a[240:243], a[96:99], v[176:179]
  v_mfma_f32_16x16x32_bf16 v[176:179], a[244:247], a[112:115], v[176:179]
  v_mfma_f32_16x16x32_bf16 v[180:183], a[240:243], a[100:103], v[180:183]
  buffer_load_dwordx4 a[56:59], v1, s[28:31], s93 offen offset:2048 sc1
  v_mfma_f32_16x16x32_bf16 v[180:183], a[244:247], a[116:119], v[180:183]
  v_mfma_f32_16x16x32_bf16 v[184:187], a[240:243], a[104:107], v[184:187]
  v_mfma_f32_16x16x32_bf16 v[184:187], a[244:247], a[120:123], v[184:187]
  v_mfma_f32_16x16x32_bf16 v[188:191], a[240:243], a[108:111], v[188:191]
  v_mfma_f32_16x16x32_bf16 v[188:191], a[244:247], a[124:127], v[188:191]
  buffer_load_dwordx4 a[60:63], v1, s[28:31], s93 offen offset:3072 sc1
  v_mfma_f32_16x16x32_bf16 v[192:195], a[248:251], a[96:99], v[192:195]
  s_add_u32 s93, s81, 0xb000
  v_mfma_f32_16x16x32_bf16 v[192:195], a[252:255], a[112:115], v[192:195]
  v_mfma_f32_16x16x32_bf16 v[196:199], a[248:251], a[100:103], v[196:199]
  v_mfma_f32_16x16x32_bf16 v[196:199], a[252:255], a[116:119], v[196:199]
  v_mfma_f32_16x16x32_bf16 v[200:203], a[248:251], a[104:107], v[200:203]
  v_mfma_f32_16x16x32_bf16 v[200:203], a[252:255], a[120:123], v[200:203]
  v_mfma_f32_16x16x32_bf16 v[204:207], a[248:251], a[108:111], v[204:207]
  v_mfma_f32_16x16x32_bf16 v[204:207], a[252:255], a[124:127], v[204:207]
  s_waitcnt vmcnt(19) lgkmcnt(0)
  s_barrier
  v_mfma_f32_16x16x32_bf16 v[208:211], a[184:187], a[96:99], v[208:211]
  s_add_u32 m0, s86, 0x8000
  ds_read_b64_tr_b16 a[192:193], v8
  ds_read_b64_tr_b16 a[194:195], v8 offset:1024
  v_mfma_f32_16x16x32_bf16 v[208:211], a[188:191], a[112:115], v[208:211]
  s_add_u32 s59, s82, 0x280000
  ds_read_b64_tr_b16 a[196:197], v8 offset:4096
  ds_read_b64_tr_b16 a[198:199], v8 offset:5120
  v_mfma_f32_16x16x32_bf16 v[212:215], a[184:187], a[100:103], v[212:215]
  s_nop 0
  ds_read_b64_tr_b16 a[200:201], v9
  ds_read_b64_tr_b16 a[202:203], v9 offset:1024
  v_mfma_f32_16x16x32_bf16 v[212:215], a[188:191], a[116:119], v[212:215]
  buffer_load_dwordx4 v4, s[16:19], s59 offen lds
  v_mfma_f32_16x16x32_bf16 v[216:219], a[184:187], a[104:107], v[216:219]
  s_add_u32 s56, s52, 0x8000
  ds_read_b64_tr_b16 a[204:205], v9 offset:4096
  ds_read_b64_tr_b16 a[206:207], v9 offset:5120
  v_mfma_f32_16x16x32_bf16 v[216:219], a[188:191], a[120:123], v[216:219]
  s_nop 0
  ds_read_b64_tr_b16 a[240:241], v10
  ds_read_b64_tr_b16 a[242:243], v10 offset:1024
  v_mfma_f32_16x16x32_bf16 v[220:223], a[184:187], a[108:111], v[220:223]
  s_nop 0
  ds_read_b64_tr_b16 a[244:245], v10 offset:4096
  ds_read_b64_tr_b16 a[246:247], v10 offset:5120
  v_mfma_f32_16x16x32_bf16 v[220:223], a[188:191], a[124:127], v[220:223]
  s_waitcnt lgkmcnt(10)
  buffer_store_dwordx4 a[16:19], v1, s[28:31], s56 offen sc1
  v_mfma_f32_16x16x32_bf16 v[32:35], a[192:195], a[208:211], v[32:35]
  s_waitcnt lgkmcnt(8)
  ds_read_b64_tr_b16 a[248:249], v11
  ds_read_b64_tr_b16 a[250:251], v11 offset:1024
  v_mfma_f32_16x16x32_bf16 v[32:35], a[196:199], a[224:227], v[32:35]
  s_nop 0
  ds_read_b64_tr_b16 a[252:253], v11 offset:4096
  ds_read_b64_tr_b16 a[254:255], v11 offset:5120
  v_mfma_f32_16x16x32_bf16 v[36:39], a[192:195], a[212:215], v[36:39]
  s_add_u32 m0, s86, 0x8400
  ds_read_b64_tr_b16 a[184:185], v8 offset:8192
  ds_read_b64_tr_b16 a[186:187], v8 offset:9216
  v_mfma_f32_16x16x32_bf16 v[36:39], a[196:199], a[228:231], v[36:39]
  s_add_u32 s57, s82, 0x288000
  v_mfma_f32_16x16x32_bf16 v[40:43], a[192:195], a[216:219], v[40:43]
  buffer_load_dwordx4 v4, s[16:19], s57 offen lds
  v_mfma_f32_16x16x32_bf16 v[40:43], a[196:199], a[232:235], v[40:43]
  s_nop 0
  ds_read_b64_tr_b16 a[188:189], v8 offset:12288
  ds_read_b64_tr_b16 a[190:191], v8 offset:13312
  v_mfma_f32_16x16x32_bf16 v[44:47], a[192:195], a[220:223], v[44:47]
  s_nop 0
  ds_read_b64_tr_b16 a[192:193], v9 offset:8192
  ds_read_b64_tr_b16 a[194:195], v9 offset:9216
  v_mfma_f32_16x16x32_bf16 v[44:47], a[196:199], a[236:239], v[44:47]
  s_waitcnt lgkmcnt(8)
  ds_read_b64_tr_b16 a[196:197], v9 offset:12288
  ds_read_b64_tr_b16 a[198:199], v9 offset:13312
  v_mfma_f32_16x16x32_bf16 v[48:51], a[200:203], a[208:211], v[48:51]
  s_add_u32 m0, s86, 0x8800
  v_mfma_f32_16x16x32_bf16 v[48:51], a[204:207], a[224:227], v[48:51]
  s_add_u32 s58, s82, 0x2a0000
  buffer_load_dwordx4 v4, s[16:19], s58 offen lds
  v_mfma_f32_16x16x32_bf16 v[52:55], a[200:203], a[212:215], v[52:55]
  v_mfma_f32_16x16x32_bf16 v[52:55], a[204:207], a[228:231], v[52:55]
  v_mfma_f32_16x16x32_bf16 v[56:59], a[200:203], a[216:219], v[56:59]
  s_add_u32 m0, s86, 0x8c00
  v_mfma_f32_16x16x32_bf16 v[56:59], a[204:207], a[232:235], v[56:59]
  s_add_u32 s59, s82, 0x2a8000
  v_mfma_f32_16x16x32_bf16 v[60:63], a[200:203], a[220:223], v[60:63]
  buffer_load_dwordx4 v4, s[16:19], s59 offen lds
  v_mfma_f32_16x16x32_bf16 v[60:63], a[204:207], a[236:239], v[60:63]
  s_nop 0
  ds_read_b64_tr_b16 a[200:201], v10 offset:8192
  ds_read_b64_tr_b16 a[202:203], v10 offset:9216
  v_mfma_f32_16x16x32_bf16 v[64:67], a[240:243], a[208:211], v[64:67]
  s_add_u32 s56, s52, 0x8800
  ds_read_b64_tr_b16 a[204:205], v10 offset:12288
  ds_read_b64_tr_b16 a[206:207], v10 offset:13312
  v_mfma_f32_16x16x32_bf16 v[64:67], a[244:247], a[224:227], v[64:67]
  v_mfma_f32_16x16x32_bf16 v[68:71], a[240:243], a[212:215], v[68:71]
  v_mfma_f32_16x16x32_bf16 v[68:71], a[244:247], a[228:231], v[68:71]
  buffer_store_dwordx4 a[20:23], v1, s[28:31], s56 offen sc1
  v_mfma_f32_16x16x32_bf16 v[72:75], a[240:243], a[216:219], v[72:75]
  v_mfma_f32_16x16x32_bf16 v[72:75], a[244:247], a[232:235], v[72:75]
  v_mfma_f32_16x16x32_bf16 v[76:79], a[240:243], a[220:223], v[76:79]
  s_add_u32 m0, s87, 0xc000
  ds_read_b64_tr_b16 a[240:241], v11 offset:8192
  ds_read_b64_tr_b16 a[242:243], v11 offset:9216
  v_mfma_f32_16x16x32_bf16 v[76:79], a[244:247], a[236:239], v[76:79]
  s_add_u32 s57, s83, 0x10e000
  ds_read_b64_tr_b16 a[244:245], v11 offset:12288
  ds_read_b64_tr_b16 a[246:247], v11 offset:13312
  v_mfma_f32_16x16x32_bf16 v[80:83], a[248:251], a[208:211], v[80:83]
  s_waitcnt lgkmcnt(4)
  buffer_load_dwordx4 v5, s[20:23], s57 offen lds
  v_mfma_f32_16x16x32_bf16 v[80:83], a[252:255], a[224:227], v[80:83]
  v_mfma_f32_16x16x32_bf16 v[84:87], a[248:251], a[212:215], v[84:87]
  v_mfma_f32_16x16x32_bf16 v[84:87], a[252:255], a[228:231], v[84:87]
  s_add_u32 m0, s87, 0xc400
  v_mfma_f32_16x16x32_bf16 v[88:91], a[248:251], a[216:219], v[88:91]
  s_add_u32 s58, s83, 0x111600
  v_mfma_f32_16x16x32_bf16 v[88:91], a[252:255], a[232:235], v[88:91]
  buffer_load_dwordx4 v5, s[20:23], s58 offen lds
  v_mfma_f32_16x16x32_bf16 v[92:95], a[248:251], a[220:223], v[92:95]
  s_nop 0
  ds_read_b64_tr_b16 a[248:249], v8 offset:16384
  ds_read_b64_tr_b16 a[250:251], v8 offset:17408
  v_mfma_f32_16x16x32_bf16 v[92:95], a[252:255], a[236:239], v[92:95]
  s_nop 0
  ds_read_b64_tr_b16 a[252:253], v8 offset:20480
  ds_read_b64_tr_b16 a[254:255], v8 offset:21504
  v_mfma_f32_16x16x32_bf16 v[96:99], a[184:187], a[208:211], v[96:99]
  v_mfma_f32_16x16x32_bf16 v[96:99], a[188:191], a[224:227], v[96:99]
  v_mfma_f32_16x16x32_bf16 v[100:103], a[184:187], a[212:215], v[100:103]
  buffer_load_dwordx4 a[96:99], v1, s[28:31], s94 offen sc1
  v_mfma_f32_16x16x32_bf16 v[100:103], a[188:191], a[228:231], v[100:103]
  v_mfma_f32_16x16x32_bf16 v[104:107], a[184:187], a[216:219], v[104:107]
  s_add_u32 s59, s52, 0x9000
  v_mfma_f32_16x16x32_bf16 v[104:107], a[188:191], a[232:235], v[104:107]
  v_mfma_f32_16x16x32_bf16 v[108:111], a[184:187], a[220:223], v[108:111]
  s_nop 0
  ds_read_b64_tr_b16 a[184:185], v9 offset:16384
  ds_read_b64_tr_b16 a[186:187], v9 offset:17408
  v_mfma_f32_16x16x32_bf16 v[108:111], a[188:191], a[236:239], v[108:111]
  buffer_store_dwordx4 a[24:27], v1, s[28:31], s59 offen sc1
  v_mfma_f32_16x16x32_bf16 v[112:115], a[192:195], a[208:211], v[112:115]
  s_nop 0
  ds_read_b64_tr_b16 a[188:189], v9 offset:20480
  ds_read_b64_tr_b16 a[190:191], v9 offset:21504
  v_mfma_f32_16x16x32_bf16 v[112:115], a[196:199], a[224:227], v[112:115]
  v_mfma_f32_16x16x32_bf16 v[116:119], a[192:195], a[212:215], v[116:119]
  v_mfma_f32_16x16x32_bf16 v[116:119], a[196:199], a[228:231], v[116:119]
  v_mfma_f32_16x16x32_bf16 v[120:123], a[192:195], a[216:219], v[120:123]
  buffer_load_dwordx4 a[100:103], v1, s[28:31], s94 offen offset:1024 sc1
  v_mfma_f32_16x16x32_bf16 v[120:123], a[196:199], a[232:235], v[120:123]
  v_mfma_f32_16x16x32_bf16 v[124:127], a[192:195], a[220:223], v[124:127]
  s_nop 0
  ds_read_b64_tr_b16 a[192:193], v10 offset:16384
  ds_read_b64_tr_b16 a[194:195], v10 offset:17408
  v_mfma_f32_16x16x32_bf16 v[124:127], a[196:199], a[236:239], v[124:127]
  s_nop 0
  ds_read_b64_tr_b16 a[196:197], v10 offset:20480
  ds_read_b64_tr_b16 a[198:199], v10 offset:21504
  v_mfma_f32_16x16x32_bf16 v[128:131], a[200:203], a[208:211], v[128:131]
  v_mfma_f32_16x16x32_bf16 v[128:131], a[204:207], a[224:227], v[128:131]
  buffer_load_dwordx4 a[104:107], v1, s[28:31], s94 offen offset:2048 sc1
  v_mfma_f32_16x16x32_bf16 v[132:135], a[200:203], a[212:215], v[132:135]
  v_mfma_f32_16x16x32_bf16 v[132:135], a[204:207], a[228:231], v[132:135]
  v_mfma_f32_16x16x32_bf16 v[136:139], a[200:203], a[216:219], v[136:139]
  v_mfma_f32_16x16x32_bf16 v[136:139], a[204:207], a[232:235], v[136:139]
  v_mfma_f32_16x16x32_bf16 v[140:143], a[200:203], a[220:223], v[140:143]
  buffer_load_dwordx4 a[108:111], v1, s[28:31], s94 offen offset:3072 sc1
  v_mfma_f32_16x16x32_bf16 v[140:143], a[204:207], a[236:239], v[140:143]
  s_waitcnt lgkmcnt(0)
  ds_read_b64_tr_b16 a[200:201], v11 offset:16384
  ds_read_b64_tr_b16 a[202:203], v11 offset:17408
  v_mfma_f32_16x16x32_bf16 v[144:147], a[240:243], a[208:211], v[144:147]
  s_add_u32 s94, s81, 0xc000
  ds_read_b64_tr_b16 a[204:205], v11 offset:20480
  ds_read_b64_tr_b16 a[206:207], v11 offset:21504
  v_mfma_f32_16x16x32_bf16 v[144:147], a[244:247], a[224:227], v[144:147]
  v_mfma_f32_16x16x32_bf16 v[148:151], a[240:243], a[212:215], v[148:151]
  v_mfma_f32_16x16x32_bf16 v[148:151], a[244:247], a[228:231], v[148:151]
  buffer_load_dwordx4 a[112:115], v1, s[28:31], s93 offen sc1
  v_mfma_f32_16x16x32_bf16 v[152:155], a[240:243], a[216:219], v[152:155]
  v_mfma_f32_16x16x32_bf16 v[152:155], a[244:247], a[232:235], v[152:155]
  v_mfma_f32_16x16x32_bf16 v[156:159], a[240:243], a[220:223], v[156:159]
  v_mfma_f32_16x16x32_bf16 v[156:159], a[244:247], a[236:239], v[156:159]
  v_mfma_f32_16x16x32_bf16 v[160:163], a[248:251], a[208:211], v[160:163]
  buffer_load_dwordx4 a[116:119], v1, s[28:31], s93 offen offset:1024 sc1
  v_mfma_f32_16x16x32_bf16 v[160:163], a[252:255], a[224:227], v[160:163]
  v_mfma_f32_16x16x32_bf16 v[164:167], a[248:251], a[212:215], v[164:167]
  v_mfma_f32_16x16x32_bf16 v[164:167], a[252:255], a[228:231], v[164:167]
  v_mfma_f32_16x16x32_bf16 v[168:171], a[248:251], a[216:219], v[168:171]
  v_mfma_f32_16x16x32_bf16 v[168:171], a[252:255], a[232:235], v[168:171]
  buffer_load_dwordx4 a[120:123], v1, s[28:31], s93 offen offset:2048 sc1
  v_mfma_f32_16x16x32_bf16 v[172:175], a[248:251], a[220:223], v[172:175]
  v_mfma_f32_16x16x32_bf16 v[172:175], a[252:255], a[236:239], v[172:175]
  v_mfma_f32_16x16x32_bf16 v[176:179], a[184:187], a[208:211], v[176:179]
  v_mfma_f32_16x16x32_bf16 v[176:179], a[188:191], a[224:227], v[176:179]
  v_mfma_f32_16x16x32_bf16 v[180:183], a[184:187], a[212:215], v[180:183]
  buffer_load_dwordx4 a[124:127], v1, s[28:31], s93 offen offset:3072 sc1
  v_mfma_f32_16x16x32_bf16 v[180:183], a[188:191], a[228:231], v[180:183]
  s_add_u32 s93, s81, 0xd000
  v_mfma_f32_16x16x32_bf16 v[184:187], a[184:187], a[216:219], v[184:187]
  v_mfma_f32_16x16x32_bf16 v[184:187], a[188:191], a[232:235], v[184:187]
  v_mfma_f32_16x16x32_bf16 v[188:191], a[184:187], a[220:223], v[188:191]
  v_mfma_f32_16x16x32_bf16 v[188:191], a[188:191], a[236:239], v[188:191]
  v_mfma_f32_16x16x32_bf16 v[192:195], a[192:195], a[208:211], v[192:195]
  v_mfma_f32_16x16x32_bf16 v[192:195], a[196:199], a[224:227], v[192:195]
  v_mfma_f32_16x16x32_bf16 v[196:199], a[192:195], a[212:215], v[196:199]
  v_mfma_f32_16x16x32_bf16 v[196:199], a[196:199], a[228:231], v[196:199]
  v_mfma_f32_16x16x32_bf16 v[200:203], a[192:195], a[216:219], v[200:203]
  v_mfma_f32_16x16x32_bf16 v[200:203], a[196:199], a[232:235], v[200:203]
  v_mfma_f32_16x16x32_bf16 v[204:207], a[192:195], a[220:223], v[204:207]
  v_mfma_f32_16x16x32_bf16 v[204:207], a[196:199], a[236:239], v[204:207]
  s_waitcnt vmcnt(17) lgkmcnt(0)
  s_barrier
  v_mfma_f32_16x16x32_bf16 v[208:211], a[200:203], a[208:211], v[208:211]
  s_add_u32 m0, s86, 0x20000
  ds_read_b64_tr_b16 a[240:241], v6 offset:16384
  ds_read_b64_tr_b16 a[242:243], v6 offset:17408
  v_mfma_f32_16x16x32_bf16 v[208:211], a[204:207], a[224:227], v[208:211]
  s_add_u32 s56, s82, 0x300000
  ds_read_b64_tr_b16 a[244:245], v6 offset:20480
  ds_read_b64_tr_b16 a[246:247], v6 offset:21504
  v_mfma_f32_16x16x32_bf16 v[212:215], a[200:203], a[212:215], v[212:215]
  s_nop 0
  ds_read_b64_tr_b16 a[248:249], v7 offset:16384
  ds_read_b64_tr_b16 a[250:251], v7 offset:17408
  v_mfma_f32_16x16x32_bf16 v[212:215], a[204:207], a[228:231], v[212:215]
  buffer_load_dwordx4 v4, s[16:19], s56 offen lds
  v_mfma_f32_16x16x32_bf16 v[216:219], a[200:203], a[216:219], v[216:219]
  s_add_u32 s57, s52, 0x9800
  ds_read_b64_tr_b16 a[252:253], v7 offset:20480
  ds_read_b64_tr_b16 a[254:255], v7 offset:21504
  v_mfma_f32_16x16x32_bf16 v[216:219], a[204:207], a[232:235], v[216:219]
  s_nop 0
  ds_read_b64_tr_b16 a[184:185], v2 offset:16384
  ds_read_b64_tr_b16 a[186:187], v2 offset:17408
  v_mfma_f32_16x16x32_bf16 v[220:223], a[200:203], a[220:223], v[220:223]
  s_nop 0
  ds_read_b64_tr_b16 a[188:189], v2 offset:20480
  ds_read_b64_tr_b16 a[190:191], v2 offset:21504
  v_mfma_f32_16x16x32_bf16 v[220:223], a[204:207], a[236:239], v[220:223]
  s_waitcnt lgkmcnt(10)
  buffer_store_dwordx4 a[28:31], v1, s[28:31], s57 offen sc1
  v_mfma_f32_16x16x32_bf16 v[32:35], a[240:243], a[32:35], v[32:35]
  s_waitcnt lgkmcnt(8)
  ds_read_b64_tr_b16 a[192:193], v3 offset:16384
  ds_read_b64_tr_b16 a[194:195], v3 offset:17408
  v_mfma_f32_16x16x32_bf16 v[32:35], a[244:247], a[48:51], v[32:35]
  s_nop 0
  ds_read_b64_tr_b16 a[196:197], v3 offset:20480
  ds_read_b64_tr_b16 a[198:199], v3 offset:21504
  v_mfma_f32_16x16x32_bf16 v[36:39], a[240:243], a[36:39], v[36:39]
  s_add_u32 m0, s86, 0x20400
  ds_read_b64_tr_b16 a[200:201], v6 offset:24576
  ds_read_b64_tr_b16 a[202:203], v6 offset:25600
  v_mfma_f32_16x16x32_bf16 v[36:39], a[244:247], a[52:55], v[36:39]
  s_add_u32 s58, s82, 0x308000
  v_mfma_f32_16x16x32_bf16 v[40:43], a[240:243], a[40:43], v[40:43]
  buffer_load_dwordx4 v4, s[16:19], s58 offen lds
  v_mfma_f32_16x16x32_bf16 v[40:43], a[244:247], a[56:59], v[40:43]
  s_nop 0
  ds_read_b64_tr_b16 a[204:205], v6 offset:28672
  ds_read_b64_tr_b16 a[206:207], v6 offset:29696
  v_mfma_f32_16x16x32_bf16 v[44:47], a[240:243], a[44:47], v[44:47]
  s_nop 0
  ds_read_b64_tr_b16 a[240:241], v7 offset:24576
  ds_read_b64_tr_b16 a[242:243], v7 offset:25600
  v_mfma_f32_16x16x32_bf16 v[44:47], a[244:247], a[60:63], v[44:47]
  s_waitcnt lgkmcnt(8)
  ds_read_b64_tr_b16 a[244:245], v7 offset:28672
  ds_read_b64_tr_b16 a[246:247], v7 offset:29696
  v_mfma_f32_16x16x32_bf16 v[48:51], a[248:251], a[32:35], v[48:51]
  s_add_u32 m0, s86, 0x20800
  v_mfma_f32_16x16x32_bf16 v[48:51], a[252:255], a[48:51], v[48:51]
  s_add_u32 s59, s82, 0x320000
  buffer_load_dwordx4 v4, s[16:19], s59 offen lds
  v_mfma_f32_16x16x32_bf16 v[52:55], a[248:251], a[36:39], v[52:55]
  v_mfma_f32_16x16x32_bf16 v[52:55], a[252:255], a[52:55], v[52:55]
  v_mfma_f32_16x16x32_bf16 v[56:59], a[248:251], a[40:43], v[56:59]
  s_add_u32 m0, s86, 0x20c00
  v_mfma_f32_16x16x32_bf16 v[56:59], a[252:255], a[56:59], v[56:59]
  s_add_u32 s56, s82, 0x328000
  v_mfma_f32_16x16x32_bf16 v[60:63], a[248:251], a[44:47], v[60:63]
  buffer_load_dwordx4 v4, s[16:19], s56 offen lds
  v_mfma_f32_16x16x32_bf16 v[60:63], a[252:255], a[60:63], v[60:63]
  s_nop 0
  ds_read_b64_tr_b16 a[248:249], v2 offset:24576
  ds_read_b64_tr_b16 a[250:251], v2 offset:25600
  v_mfma_f32_16x16x32_bf16 v[64:67], a[184:187], a[32:35], v[64:67]
  s_add_u32 s57, s51, 0xb000
  ds_read_b64_tr_b16 a[252:253], v2 offset:28672
  ds_read_b64_tr_b16 a[254:255], v2 offset:29696
  v_mfma_f32_16x16x32_bf16 v[64:67], a[188:191], a[48:51], v[64:67]
  v_mfma_f32_16x16x32_bf16 v[68:71], a[184:187], a[36:39], v[68:71]
  v_mfma_f32_16x16x32_bf16 v[68:71], a[188:191], a[52:55], v[68:71]
  buffer_store_dwordx4 v[224:227], v1, s[28:31], s57 offen sc1
  v_mfma_f32_16x16x32_bf16 v[72:75], a[184:187], a[40:43], v[72:75]
  v_mfma_f32_16x16x32_bf16 v[72:75], a[188:191], a[56:59], v[72:75]
  v_mfma_f32_16x16x32_bf16 v[76:79], a[184:187], a[44:47], v[76:79]
  s_add_u32 m0, s87, 0x24000
  ds_read_b64_tr_b16 a[184:185], v3 offset:24576
  ds_read_b64_tr_b16 a[186:187], v3 offset:25600
  v_mfma_f32_16x16x32_bf16 v[76:79], a[188:191], a[60:63], v[76:79]
  s_add_u32 s58, s83, 0x144000
  ds_read_b64_tr_b16 a[188:189], v3 offset:28672
  ds_read_b64_tr_b16 a[190:191], v3 offset:29696
  v_mfma_f32_16x16x32_bf16 v[80:83], a[192:195], a[32:35], v[80:83]
  s_waitcnt lgkmcnt(4)
  buffer_load_dwordx4 v5, s[20:23], s58 offen lds
  v_mfma_f32_16x16x32_bf16 v[80:83], a[196:199], a[48:51], v[80:83]
  v_mfma_f32_16x16x32_bf16 v[84:87], a[192:195], a[36:39], v[84:87]
  v_mfma_f32_16x16x32_bf16 v[84:87], a[196:199], a[52:55], v[84:87]
  s_add_u32 m0, s87, 0x24400
  v_mfma_f32_16x16x32_bf16 v[88:91], a[192:195], a[40:43], v[88:91]
  s_add_u32 s59, s83, 0x147600
  v_mfma_f32_16x16x32_bf16 v[88:91], a[196:199], a[56:59], v[88:91]
  buffer_load_dwordx4 v5, s[20:23], s59 offen lds
  v_mfma_f32_16x16x32_bf16 v[92:95], a[192:195], a[44:47], v[92:95]
  s_nop 0
  ds_read_b64_tr_b16 a[192:193], v8 offset:24576
  ds_read_b64_tr_b16 a[194:195], v8 offset:25600
  v_mfma_f32_16x16x32_bf16 v[92:95], a[196:199], a[60:63], v[92:95]
  s_nop 0
  ds_read_b64_tr_b16 a[196:197], v8 offset:28672
  ds_read_b64_tr_b16 a[198:199], v8 offset:29696
  v_mfma_f32_16x16x32_bf16 v[96:99], a[200:203], a[32:35], v[96:99]
  v_mfma_f32_16x16x32_bf16 v[96:99], a[204:207], a[48:51], v[96:99]
  v_mfma_f32_16x16x32_bf16 v[100:103], a[200:203], a[36:39], v[100:103]
  buffer_load_dwordx4 a[208:211], v1, s[28:31], s94 offen sc1
  v_mfma_f32_16x16x32_bf16 v[100:103], a[204:207], a[52:55], v[100:103]
  v_mfma_f32_16x16x32_bf16 v[104:107], a[200:203], a[40:43], v[104:107]
  s_add_u32 s56, s51, 0xb400
  v_mfma_f32_16x16x32_bf16 v[104:107], a[204:207], a[56:59], v[104:107]
  v_mfma_f32_16x16x32_bf16 v[108:111], a[200:203], a[44:47], v[108:111]
  s_nop 0
  ds_read_b64_tr_b16 a[200:201], v9 offset:24576
  ds_read_b64_tr_b16 a[202:203], v9 offset:25600
  v_mfma_f32_16x16x32_bf16 v[108:111], a[204:207], a[60:63], v[108:111]
  buffer_store_dwordx4 v[232:235], v1, s[28:31], s56 offen sc1
  v_mfma_f32_16x16x32_bf16 v[112:115], a[240:243], a[32:35], v[112:115]
  s_nop 0
  ds_read_b64_tr_b16 a[204:205], v9 offset:28672
  ds_read_b64_tr_b16 a[206:207], v9 offset:29696
  v_mfma_f32_16x16x32_bf16 v[112:115], a[244:247], a[48:51], v[112:115]
  v_mfma_f32_16x16x32_bf16 v[116:119], a[240:243], a[36:39], v[116:119]
  v_mfma_f32_16x16x32_bf16 v[116:119], a[244:247], a[52:55], v[116:119]
  v_mfma_f32_16x16x32_bf16 v[120:123], a[240:243], a[40:43], v[120:123]
  buffer_load_dwordx4 a[212:215], v1, s[28:31], s94 offen offset:1024 sc1
  v_mfma_f32_16x16x32_bf16 v[120:123], a[244:247], a[56:59], v[120:123]
  v_mfma_f32_16x16x32_bf16 v[124:127], a[240:243], a[44:47], v[124:127]
  s_nop 0
  ds_read_b64_tr_b16 a[240:241], v10 offset:24576
  ds_read_b64_tr_b16 a[242:243], v10 offset:25600
  v_mfma_f32_16x16x32_bf16 v[124:127], a[244:247], a[60:63], v[124:127]
  s_nop 0
  ds_read_b64_tr_b16 a[244:245], v10 offset:28672
  ds_read_b64_tr_b16 a[246:247], v10 offset:29696
  v_mfma_f32_16x16x32_bf16 v[128:131], a[248:251], a[32:35], v[128:131]
  v_mfma_f32_16x16x32_bf16 v[128:131], a[252:255], a[48:51], v[128:131]
  buffer_load_dwordx4 a[216:219], v1, s[28:31], s94 offen offset:2048 sc1
  v_mfma_f32_16x16x32_bf16 v[132:135], a[248:251], a[36:39], v[132:135]
  v_mfma_f32_16x16x32_bf16 v[132:135], a[252:255], a[52:55], v[132:135]
  v_mfma_f32_16x16x32_bf16 v[136:139], a[248:251], a[40:43], v[136:139]
  v_mfma_f32_16x16x32_bf16 v[136:139], a[252:255], a[56:59], v[136:139]
  v_mfma_f32_16x16x32_bf16 v[140:143], a[248:251], a[44:47], v[140:143]
  buffer_load_dwordx4 a[220:223], v1, s[28:31], s94 offen offset:3072 sc1
  v_mfma_f32_16x16x32_bf16 v[140:143], a[252:255], a[60:63], v[140:143]
  s_waitcnt lgkmcnt(0)
  ds_read_b64_tr_b16 a[248:249], v11 offset:24576
  ds_read_b64_tr_b16 a[250:251], v11 offset:25600
  v_mfma_f32_16x16x32_bf16 v[144:147], a[184:187], a[32:35], v[144:147]
  s_add_u32 s94, s81, 0xe000
  ds_read_b64_tr_b16 a[252:253], v11 offset:28672
  ds_read_b64_tr_b16 a[254:255], v11 offset:29696
  v_mfma_f32_16x16x32_bf16 v[144:147], a[188:191], a[48:51], v[144:147]
  v_mfma_f32_16x16x32_bf16 v[148:151], a[184:187], a[36:39], v[148:151]
  v_mfma_f32_16x16x32_bf16 v[148:151], a[188:191], a[52:55], v[148:151]
  buffer_load_dwordx4 a[224:227], v1, s[28:31], s93 offen sc1
  v_mfma_f32_16x16x32_bf16 v[152:155], a[184:187], a[40:43], v[152:155]
  v_mfma_f32_16x16x32_bf16 v[152:155], a[188:191], a[56:59], v[152:155]
  v_mfma_f32_16x16x32_bf16 v[156:159], a[184:187], a[44:47], v[156:159]
  v_mfma_f32_16x16x32_bf16 v[156:159], a[188:191], a[60:63], v[156:159]
  v_mfma_f32_16x16x32_bf16 v[160:163], a[192:195], a[32:35], v[160:163]
  buffer_load_dwordx4 a[228:231], v1, s[28:31], s93 offen offset:1024 sc1
  v_mfma_f32_16x16x32_bf16 v[160:163], a[196:199], a[48:51], v[160:163]
  v_mfma_f32_16x16x32_bf16 v[164:167], a[192:195], a[36:39], v[164:167]
  v_mfma_f32_16x16x32_bf16 v[164:167], a[196:199], a[52:55], v[164:167]
  v_mfma_f32_16x16x32_bf16 v[168:171], a[192:195], a[40:43], v[168:171]
  v_mfma_f32_16x16x32_bf16 v[168:171], a[196:199], a[56:59], v[168:171]
  buffer_load_dwordx4 a[232:235], v1, s[28:31], s93 offen offset:2048 sc1
  v_mfma_f32_16x16x32_bf16 v[172:175], a[192:195], a[44:47], v[172:175]
  v_mfma_f32_16x16x32_bf16 v[172:175], a[196:199], a[60:63], v[172:175]
  v_mfma_f32_16x16x32_bf16 v[176:179], a[200:203], a[32:35], v[176:179]
  v_mfma_f32_16x16x32_bf16 v[176:179], a[204:207], a[48:51], v[176:179]
  v_mfma_f32_16x16x32_bf16 v[180:183], a[200:203], a[36:39], v[180:183]
  buffer_load_dwordx4 a[236:239], v1, s[28:31], s93 offen offset:3072 sc1
  v_mfma_f32_16x16x32_bf16 v[180:183], a[204:207], a[52:55], v[180:183]
  s_add_u32 s93, s81, 0xf000
  v_mfma_f32_16x16x32_bf16 v[184:187], a[200:203], a[40:43], v[184:187]
  v_mfma_f32_16x16x32_bf16 v[184:187], a[204:207], a[56:59], v[184:187]
  v_mfma_f32_16x16x32_bf16 v[188:191], a[200:203], a[44:47], v[188:191]
  v_mfma_f32_16x16x32_bf16 v[188:191], a[204:207], a[60:63], v[188:191]
  v_mfma_f32_16x16x32_bf16 v[192:195], a[240:243], a[32:35], v[192:195]
  v_mfma_f32_16x16x32_bf16 v[192:195], a[244:247], a[48:51], v[192:195]
  v_mfma_f32_16x16x32_bf16 v[196:199], a[240:243], a[36:39], v[196:199]
  buffer_load_dword a170, v16, s[8:11], 0 offen
  v_mfma_f32_16x16x32_bf16 v[196:199], a[244:247], a[52:55], v[196:199]
  v_mfma_f32_16x16x32_bf16 v[200:203], a[240:243], a[40:43], v[200:203]
  buffer_load_dword a171, v16, s[12:15], 0 offen
  v_mfma_f32_16x16x32_bf16 v[200:203], a[244:247], a[56:59], v[200:203]
  v_and_b32 v16, 15, v0
  v_cmp_le_u32 s[60:61], v17, v16
  v_mfma_f32_16x16x32_bf16 v[204:207], a[240:243], a[44:47], v[204:207]
  v_add_u32 v17, 1, v17
  v_cmp_le_u32 s[62:63], v17, v16
  v_mfma_f32_16x16x32_bf16 v[204:207], a[244:247], a[60:63], v[204:207]
  v_add_u32 v17, 1, v17
  v_cmp_le_u32 s[64:65], v17, v16
  s_waitcnt vmcnt(19) lgkmcnt(0)
  s_barrier
  v_mfma_f32_16x16x32_bf16 v[208:211], a[248:251], a[32:35], v[208:211]
  s_add_u32 m0, s86, 0x4000
  ds_read_b64_tr_b16 a[184:185], v6 offset:32768
  ds_read_b64_tr_b16 a[186:187], v6 offset:33792
  v_mfma_f32_16x16x32_bf16 v[208:211], a[252:255], a[48:51], v[208:211]
  s_add_u32 s57, s82, 0x380000
  ds_read_b64_tr_b16 a[188:189], v6 offset:36864
  ds_read_b64_tr_b16 a[190:191], v6 offset:37888
  v_mfma_f32_16x16x32_bf16 v[212:215], a[248:251], a[36:39], v[212:215]
  s_nop 0
  ds_read_b64_tr_b16 a[192:193], v7 offset:32768
  ds_read_b64_tr_b16 a[194:195], v7 offset:33792
  v_mfma_f32_16x16x32_bf16 v[212:215], a[252:255], a[52:55], v[212:215]
  buffer_load_dwordx4 v4, s[16:19], s57 offen lds
  v_mfma_f32_16x16x32_bf16 v[216:219], a[248:251], a[40:43], v[216:219]
  s_add_u32 s58, s51, 0xa000
  ds_read_b64_tr_b16 a[196:197], v7 offset:36864
  ds_read_b64_tr_b16 a[198:199], v7 offset:37888
  v_mfma_f32_16x16x32_bf16 v[216:219], a[252:255], a[56:59], v[216:219]
  s_nop 0
  ds_read_b64_tr_b16 a[200:201], v2 offset:32768
  ds_read_b64_tr_b16 a[202:203], v2 offset:33792
  v_mfma_f32_16x16x32_bf16 v[220:223], a[248:251], a[44:47], v[220:223]
  s_nop 0
  ds_read_b64_tr_b16 a[204:205], v2 offset:36864
  ds_read_b64_tr_b16 a[206:207], v2 offset:37888
  v_mfma_f32_16x16x32_bf16 v[220:223], a[252:255], a[60:63], v[220:223]
  s_waitcnt lgkmcnt(10)
  buffer_store_dwordx4 v[228:231], v1, s[28:31], s58 offen sc1
  v_mfma_f32_16x16x32_bf16 v[32:35], a[184:187], a[96:99], v[32:35]
  s_waitcnt lgkmcnt(8)
  ds_read_b64_tr_b16 a[240:241], v3 offset:32768
  ds_read_b64_tr_b16 a[242:243], v3 offset:33792
  v_mfma_f32_16x16x32_bf16 v[32:35], a[188:191], a[112:115], v[32:35]
  s_nop 0
  ds_read_b64_tr_b16 a[244:245], v3 offset:36864
  ds_read_b64_tr_b16 a[246:247], v3 offset:37888
  v_mfma_f32_16x16x32_bf16 v[36:39], a[184:187], a[100:103], v[36:39]
  s_add_u32 m0, s86, 0x4400
  ds_read_b64_tr_b16 a[248:249], v6 offset:40960
  ds_read_b64_tr_b16 a[250:251], v6 offset:41984
  v_mfma_f32_16x16x32_bf16 v[36:39], a[188:191], a[116:119], v[36:39]
  s_add_u32 s59, s82, 0x388000
  v_add_u32 v17, 1, v17
  v_cmp_le_u32 s[66:67], v17, v16
  v_mfma_f32_16x16x32_bf16 v[40:43], a[184:187], a[104:107], v[40:43]
  buffer_load_dwordx4 v4, s[16:19], s59 offen lds
  v_mfma_f32_16x16x32_bf16 v[40:43], a[188:191], a[120:123], v[40:43]
  s_nop 0
  ds_read_b64_tr_b16 a[252:253], v6 offset:45056
  ds_read_b64_tr_b16 a[254:255], v6 offset:46080
  v_mfma_f32_16x16x32_bf16 v[44:47], a[184:187], a[108:111], v[44:47]
  s_nop 0
  ds_read_b64_tr_b16 a[184:185], v7 offset:40960
  ds_read_b64_tr_b16 a[186:187], v7 offset:41984
  v_mfma_f32_16x16x32_bf16 v[44:47], a[188:191], a[124:127], v[44:47]
  s_waitcnt lgkmcnt(8)
  ds_read_b64_tr_b16 a[188:189], v7 offset:45056
  ds_read_b64_tr_b16 a[190:191], v7 offset:46080
  v_mfma_f32_16x16x32_bf16 v[48:51], a[192:195], a[96:99], v[48:51]
  s_add_u32 m0, s86, 0x4800
  v_add_u32 v17, 1, v17
  v_and_b32 v16, 63, v0
  v_mfma_f32_16x16x32_bf16 v[48:51], a[196:199], a[112:115], v[48:51]
  s_add_u32 s56, s82, 0x3a0000
  buffer_load_dwordx4 v4, s[16:19], s56 offen lds
  v_mfma_f32_16x16x32_bf16 v[52:55], a[192:195], a[100:103], v[52:55]
  v_mov_b32 v17, 0x40000000
  v_cmp_eq_u32 vcc, 0, v16
  v_mfma_f32_16x16x32_bf16 v[52:55], a[196:199], a[116:119], v[52:55]
  v_mfma_f32_16x16x32_bf16 v[56:59], a[192:195], a[104:107], v[56:59]
  s_add_u32 m0, s86, 0x4c00
  v_mfma_f32_16x16x32_bf16 v[56:59], a[196:199], a[120:123], v[56:59]
  s_add_u32 s57, s82, 0x3a8000
  v_mfma_f32_16x16x32_bf16 v[60:63], a[192:195], a[108:111], v[60:63]
  buffer_load_dwordx4 v4, s[16:19], s57 offen lds
  v_mfma_f32_16x16x32_bf16 v[60:63], a[196:199], a[124:127], v[60:63]
  s_nop 0
  ds_read_b64_tr_b16 a[192:193], v2 offset:40960
  ds_read_b64_tr_b16 a[194:195], v2 offset:41984
  v_mfma_f32_16x16x32_bf16 v[64:67], a[200:203], a[96:99], v[64:67]
  s_add_u32 s58, s51, 0xa400
  ds_read_b64_tr_b16 a[196:197], v2 offset:45056
  ds_read_b64_tr_b16 a[198:199], v2 offset:46080
  v_mfma_f32_16x16x32_bf16 v[64:67], a[204:207], a[112:115], v[64:67]
  s_add_u32 s51, s50, s44
  v_mfma_f32_16x16x32_bf16 v[68:71], a[200:203], a[100:103], v[68:71]
  s_lshl_b32 s44, s41, 13
  v_mfma_f32_16x16x32_bf16 v[68:71], a[204:207], a[116:119], v[68:71]
  s_add_u32 s50, s50, s44
  buffer_store_dwordx4 v[236:239], v1, s[28:31], s58 offen sc1
  v_mfma_f32_16x16x32_bf16 v[72:75], a[200:203], a[104:107], v[72:75]
  s_lshl_b32 s44, s40, 14
  v_mfma_f32_16x16x32_bf16 v[72:75], a[204:207], a[120:123], v[72:75]
  s_add_u32 s44, s44, 0x20000
  v_mfma_f32_16x16x32_bf16 v[76:79], a[200:203], a[108:111], v[76:79]
  s_add_u32 m0, s87, 0x26000
  ds_read_b64_tr_b16 a[200:201], v3 offset:40960
  ds_read_b64_tr_b16 a[202:203], v3 offset:41984
  v_mfma_f32_16x16x32_bf16 v[76:79], a[204:207], a[124:127], v[76:79]
  s_add_u32 s59, s83, 0x17a000
  ds_read_b64_tr_b16 a[204:205], v3 offset:45056
  ds_read_b64_tr_b16 a[206:207], v3 offset:46080
  v_mfma_f32_16x16x32_bf16 v[80:83], a[240:243], a[96:99], v[80:83]
  s_waitcnt lgkmcnt(4)
  buffer_load_dwordx4 v5, s[20:23], s59 offen lds
  v_mfma_f32_16x16x32_bf16 v[80:83], a[244:247], a[112:115], v[80:83]
  s_add_u32 s50, s50, 0x2480000
  v_mfma_f32_16x16x32_bf16 v[84:87], a[240:243], a[100:103], v[84:87]
  s_cmp_lt_u32 s41, 27
  s_cselect_b32 s50, s50, 0x40000000
  v_mfma_f32_16x16x32_bf16 v[84:87], a[244:247], a[116:119], v[84:87]
  s_add_u32 m0, s87, 0x26400
  v_mfma_f32_16x16x32_bf16 v[88:91], a[240:243], a[104:107], v[88:91]
  s_add_u32 s56, s83, 0x17d600
  v_mfma_f32_16x16x32_bf16 v[88:91], a[244:247], a[120:123], v[88:91]
  s_add_u32 s51, s51, 0x2400000
  buffer_load_dwordx4 v5, s[20:23], s56 offen lds
  v_mfma_f32_16x16x32_bf16 v[92:95], a[240:243], a[108:111], v[92:95]
  s_nop 0
  ds_read_b64_tr_b16 a[240:241], v6 offset:49152
  ds_read_b64_tr_b16 a[242:243], v6 offset:50176
  v_mfma_f32_16x16x32_bf16 v[92:95], a[244:247], a[124:127], v[92:95]
  s_nop 0
  ds_read_b64_tr_b16 a[244:245], v6 offset:53248
  ds_read_b64_tr_b16 a[246:247], v6 offset:54272
  v_mfma_f32_16x16x32_bf16 v[96:99], a[248:251], a[96:99], v[96:99]
  v_mfma_f32_16x16x32_bf16 v[96:99], a[252:255], a[112:115], v[96:99]
  v_mfma_f32_16x16x32_bf16 v[100:103], a[248:251], a[100:103], v[100:103]
  buffer_load_dwordx4 a[32:35], v1, s[28:31], s94 offen sc1
  v_mfma_f32_16x16x32_bf16 v[100:103], a[252:255], a[116:119], v[100:103]
  v_mfma_f32_16x16x32_bf16 v[104:107], a[248:251], a[104:107], v[104:107]
  s_add_u32 s57, s52, 0x8400
  v_mfma_f32_16x16x32_bf16 v[104:107], a[252:255], a[120:123], v[104:107]
  v_mfma_f32_16x16x32_bf16 v[108:111], a[248:251], a[108:111], v[108:111]
  s_nop 0
  ds_read_b64_tr_b16 a[248:249], v7 offset:49152
  ds_read_b64_tr_b16 a[250:251], v7 offset:50176
  v_mfma_f32_16x16x32_bf16 v[108:111], a[252:255], a[124:127], v[108:111]
  buffer_store_dwordx4 v[240:243], v1, s[28:31], s57 offen sc1
  v_mfma_f32_16x16x32_bf16 v[112:115], a[184:187], a[96:99], v[112:115]
  s_nop 0
  ds_read_b64_tr_b16 a[252:253], v7 offset:53248
  ds_read_b64_tr_b16 a[254:255], v7 offset:54272
  v_mfma_f32_16x16x32_bf16 v[112:115], a[188:191], a[112:115], v[112:115]
  v_mfma_f32_16x16x32_bf16 v[116:119], a[184:187], a[100:103], v[116:119]
  v_mfma_f32_16x16x32_bf16 v[116:119], a[188:191], a[116:119], v[116:119]
  v_mfma_f32_16x16x32_bf16 v[120:123], a[184:187], a[104:107], v[120:123]
  buffer_load_dwordx4 a[36:39], v1, s[28:31], s94 offen offset:1024 sc1
  v_mfma_f32_16x16x32_bf16 v[120:123], a[188:191], a[120:123], v[120:123]
  v_mfma_f32_16x16x32_bf16 v[124:127], a[184:187], a[108:111], v[124:127]
  s_nop 0
  ds_read_b64_tr_b16 a[184:185], v2 offset:49152
  ds_read_b64_tr_b16 a[186:187], v2 offset:50176
  v_mfma_f32_16x16x32_bf16 v[124:127], a[188:191], a[124:127], v[124:127]
  s_nop 0
  ds_read_b64_tr_b16 a[188:189], v2 offset:53248
  ds_read_b64_tr_b16 a[190:191], v2 offset:54272
  v_mfma_f32_16x16x32_bf16 v[128:131], a[192:195], a[96:99], v[128:131]
  v_mfma_f32_16x16x32_bf16 v[128:131], a[196:199], a[112:115], v[128:131]
  buffer_load_dwordx4 a[40:43], v1, s[28:31], s94 offen offset:2048 sc1
  v_mfma_f32_16x16x32_bf16 v[132:135], a[192:195], a[100:103], v[132:135]
  v_mfma_f32_16x16x32_bf16 v[132:135], a[196:199], a[116:119], v[132:135]
  v_mfma_f32_16x16x32_bf16 v[136:139], a[192:195], a[104:107], v[136:139]
  v_mfma_f32_16x16x32_bf16 v[136:139], a[196:199], a[120:123], v[136:139]
  v_mfma_f32_16x16x32_bf16 v[140:143], a[192:195], a[108:111], v[140:143]
  buffer_load_dwordx4 a[44:47], v1, s[28:31], s94 offen offset:3072 sc1
  v_mfma_f32_16x16x32_bf16 v[140:143], a[196:199], a[124:127], v[140:143]
  s_waitcnt lgkmcnt(0)
  ds_read_b64_tr_b16 a[192:193], v3 offset:49152
  ds_read_b64_tr_b16 a[194:195], v3 offset:50176
  v_mfma_f32_16x16x32_bf16 v[144:147], a[200:203], a[96:99], v[144:147]
  s_add_u32 s94, s81, 0x10000
  ds_read_b64_tr_b16 a[196:197], v3 offset:53248
  ds_read_b64_tr_b16 a[198:199], v3 offset:54272
  v_mfma_f32_16x16x32_bf16 v[144:147], a[204:207], a[112:115], v[144:147]
  v_mfma_f32_16x16x32_bf16 v[148:151], a[200:203], a[100:103], v[148:151]
  v_mfma_f32_16x16x32_bf16 v[148:151], a[204:207], a[116:119], v[148:151]
  buffer_load_dwordx4 a[48:51], v1, s[28:31], s93 offen sc1
  v_mfma_f32_16x16x32_bf16 v[152:155], a[200:203], a[104:107], v[152:155]
  v_mfma_f32_16x16x32_bf16 v[152:155], a[204:207], a[120:123], v[152:155]
  v_mfma_f32_16x16x32_bf16 v[156:159], a[200:203], a[108:111], v[156:159]
  v_mfma_f32_16x16x32_bf16 v[156:159], a[204:207], a[124:127], v[156:159]
  v_mfma_f32_16x16x32_bf16 v[160:163], a[240:243], a[96:99], v[160:163]
  buffer_load_dwordx4 a[52:55], v1, s[28:31], s93 offen offset:1024 sc1
  v_mfma_f32_16x16x32_bf16 v[160:163], a[244:247], a[112:115], v[160:163]
  v_mfma_f32_16x16x32_bf16 v[164:167], a[240:243], a[100:103], v[164:167]
  v_mfma_f32_16x16x32_bf16 v[164:167], a[244:247], a[116:119], v[164:167]
  v_mfma_f32_16x16x32_bf16 v[168:171], a[240:243], a[104:107], v[168:171]
  v_mfma_f32_16x16x32_bf16 v[168:171], a[244:247], a[120:123], v[168:171]
  buffer_load_dwordx4 a[56:59], v1, s[28:31], s93 offen offset:2048 sc1
  v_mfma_f32_16x16x32_bf16 v[172:175], a[240:243], a[108:111], v[172:175]
  v_mfma_f32_16x16x32_bf16 v[172:175], a[244:247], a[124:127], v[172:175]
  v_mfma_f32_16x16x32_bf16 v[176:179], a[248:251], a[96:99], v[176:179]
  v_mfma_f32_16x16x32_bf16 v[176:179], a[252:255], a[112:115], v[176:179]
  v_mfma_f32_16x16x32_bf16 v[180:183], a[248:251], a[100:103], v[180:183]
  buffer_load_dwordx4 a[60:63], v1, s[28:31], s93 offen offset:3072 sc1
  v_mfma_f32_16x16x32_bf16 v[180:183], a[252:255], a[116:119], v[180:183]
  s_add_u32 s93, s81, 0x11000
  v_mfma_f32_16x16x32_bf16 v[184:187], a[248:251], a[104:107], v[184:187]
  v_mfma_f32_16x16x32_bf16 v[184:187], a[252:255], a[120:123], v[184:187]
  v_mfma_f32_16x16x32_bf16 v[188:191], a[248:251], a[108:111], v[188:191]
  v_mfma_f32_16x16x32_bf16 v[188:191], a[252:255], a[124:127], v[188:191]
  v_mfma_f32_16x16x32_bf16 v[192:195], a[184:187], a[96:99], v[192:195]
  v_mfma_f32_16x16x32_bf16 v[192:195], a[188:191], a[112:115], v[192:195]
  v_mfma_f32_16x16x32_bf16 v[196:199], a[184:187], a[100:103], v[196:199]
  v_mfma_f32_16x16x32_bf16 v[196:199], a[188:191], a[116:119], v[196:199]
  v_mfma_f32_16x16x32_bf16 v[200:203], a[184:187], a[104:107], v[200:203]
  v_mfma_f32_16x16x32_bf16 v[200:203], a[188:191], a[120:123], v[200:203]
  v_mfma_f32_16x16x32_bf16 v[204:207], a[184:187], a[108:111], v[204:207]
  v_mfma_f32_16x16x32_bf16 v[204:207], a[188:191], a[124:127], v[204:207]
  s_waitcnt vmcnt(19) lgkmcnt(0)
  s_barrier
  v_mfma_f32_16x16x32_bf16 v[208:211], a[192:195], a[96:99], v[208:211]
  s_add_u32 m0, s86, 0x8000
  ds_read_b64_tr_b16 a[200:201], v8
  ds_read_b64_tr_b16 a[202:203], v8 offset:1024
  v_mfma_f32_16x16x32_bf16 v[208:211], a[196:199], a[112:115], v[208:211]
  s_add_u32 s58, s82, 0x400000
  ds_read_b64_tr_b16 a[204:205], v8 offset:4096
  ds_read_b64_tr_b16 a[206:207], v8 offset:5120
  v_mfma_f32_16x16x32_bf16 v[212:215], a[192:195], a[100:103], v[212:215]
  s_nop 0
  ds_read_b64_tr_b16 a[240:241], v9
  ds_read_b64_tr_b16 a[242:243], v9 offset:1024
  v_mfma_f32_16x16x32_bf16 v[212:215], a[196:199], a[116:119], v[212:215]
  buffer_load_dwordx4 v4, s[16:19], s58 offen lds
  v_mfma_f32_16x16x32_bf16 v[216:219], a[192:195], a[104:107], v[216:219]
  s_add_u32 s59, s52, 0x8c00
  ds_read_b64_tr_b16 a[244:245], v9 offset:4096
  ds_read_b64_tr_b16 a[246:247], v9 offset:5120
  v_mfma_f32_16x16x32_bf16 v[216:219], a[196:199], a[120:123], v[216:219]
  s_nop 0
  ds_read_b64_tr_b16 a[248:249], v10
  ds_read_b64_tr_b16 a[250:251], v10 offset:1024
  v_mfma_f32_16x16x32_bf16 v[220:223], a[192:195], a[108:111], v[220:223]
  s_nop 0
  ds_read_b64_tr_b16 a[252:253], v10 offset:4096
  ds_read_b64_tr_b16 a[254:255], v10 offset:5120
  v_mfma_f32_16x16x32_bf16 v[220:223], a[196:199], a[124:127], v[220:223]
  s_waitcnt lgkmcnt(10)
  buffer_store_dwordx4 v[244:247], v1, s[28:31], s59 offen sc1
  v_mfma_f32_16x16x32_bf16 v[32:35], a[200:203], a[208:211], v[32:35]
  s_waitcnt lgkmcnt(8)
  ds_read_b64_tr_b16 a[184:185], v11
  ds_read_b64_tr_b16 a[186:187], v11 offset:1024
  v_mfma_f32_16x16x32_bf16 v[32:35], a[204:207], a[224:227], v[32:35]
  s_nop 0
  ds_read_b64_tr_b16 a[188:189], v11 offset:4096
  ds_read_b64_tr_b16 a[190:191], v11 offset:5120
  v_mfma_f32_16x16x32_bf16 v[36:39], a[200:203], a[212:215], v[36:39]
  s_add_u32 m0, s86, 0x8400
  ds_read_b64_tr_b16 a[192:193], v8 offset:8192
  ds_read_b64_tr_b16 a[194:195], v8 offset:9216
  v_mfma_f32_16x16x32_bf16 v[36:39], a[204:207], a[228:231], v[36:39]
  s_add_u32 s56, s82, 0x408000
  v_mfma_f32_16x16x32_bf16 v[40:43], a[200:203], a[216:219], v[40:43]
  buffer_load_dwordx4 v4, s[16:19], s56 offen lds
  v_mfma_f32_16x16x32_bf16 v[40:43], a[204:207], a[232:235], v[40:43]
  s_nop 0
  ds_read_b64_tr_b16 a[196:197], v8 offset:12288
  ds_read_b64_tr_b16 a[198:199], v8 offset:13312
  v_mfma_f32_16x16x32_bf16 v[44:47], a[200:203], a[220:223], v[44:47]
  s_nop 0
  ds_read_b64_tr_b16 a[200:201], v9 offset:8192
  ds_read_b64_tr_b16 a[202:203], v9 offset:9216
  v_mfma_f32_16x16x32_bf16 v[44:47], a[204:207], a[236:239], v[44:47]
  s_waitcnt lgkmcnt(8)
  ds_read_b64_tr_b16 a[204:205], v9 offset:12288
  ds_read_b64_tr_b16 a[206:207], v9 offset:13312
  v_mfma_f32_16x16x32_bf16 v[48:51], a[240:243], a[208:211], v[48:51]
  s_add_u32 m0, s86, 0x8800
  v_mfma_f32_16x16x32_bf16 v[48:51], a[244:247], a[224:227], v[48:51]
  s_add_u32 s57, s82, 0x420000
  buffer_load_dwordx4 v4, s[16:19], s57 offen lds
  v_mfma_f32_16x16x32_bf16 v[52:55], a[240:243], a[212:215], v[52:55]
  v_mfma_f32_16x16x32_bf16 v[52:55], a[244:247], a[228:231], v[52:55]
  v_mfma_f32_16x16x32_bf16 v[56:59], a[240:243], a[216:219], v[56:59]
  s_add_u32 m0, s86, 0x8c00
  v_mfma_f32_16x16x32_bf16 v[56:59], a[244:247], a[232:235], v[56:59]
  s_add_u32 s58, s82, 0x428000
  v_mfma_f32_16x16x32_bf16 v[60:63], a[240:243], a[220:223], v[60:63]
  buffer_load_dwordx4 v4, s[16:19], s58 offen lds
  v_mfma_f32_16x16x32_bf16 v[60:63], a[244:247], a[236:239], v[60:63]
  s_nop 0
  ds_read_b64_tr_b16 a[240:241], v10 offset:8192
  ds_read_b64_tr_b16 a[242:243], v10 offset:9216
  v_mfma_f32_16x16x32_bf16 v[64:67], a[248:251], a[208:211], v[64:67]
  s_add_u32 s59, s52, 0x9400
  ds_read_b64_tr_b16 a[244:245], v10 offset:12288
  ds_read_b64_tr_b16 a[246:247], v10 offset:13312
  v_mfma_f32_16x16x32_bf16 v[64:67], a[252:255], a[224:227], v[64:67]
  v_mfma_f32_16x16x32_bf16 v[68:71], a[248:251], a[212:215], v[68:71]
  v_mfma_f32_16x16x32_bf16 v[68:71], a[252:255], a[228:231], v[68:71]
  buffer_store_dwordx4 v[248:251], v1, s[28:31], s59 offen sc1
  v_mfma_f32_16x16x32_bf16 v[72:75], a[248:251], a[216:219], v[72:75]
  v_mfma_f32_16x16x32_bf16 v[72:75], a[252:255], a[232:235], v[72:75]
  v_mfma_f32_16x16x32_bf16 v[76:79], a[248:251], a[220:223], v[76:79]
  s_add_u32 m0, s87, 0xc000
  ds_read_b64_tr_b16 a[248:249], v11 offset:8192
  ds_read_b64_tr_b16 a[250:251], v11 offset:9216
  v_mfma_f32_16x16x32_bf16 v[76:79], a[252:255], a[236:239], v[76:79]
  s_add_u32 s56, s83, 0x1b0000
  ds_read_b64_tr_b16 a[252:253], v11 offset:12288
  ds_read_b64_tr_b16 a[254:255], v11 offset:13312
  v_mfma_f32_16x16x32_bf16 v[80:83], a[184:187], a[208:211], v[80:83]
  s_waitcnt lgkmcnt(4)
  buffer_load_dwordx4 v5, s[20:23], s56 offen lds
  v_mfma_f32_16x16x32_bf16 v[80:83], a[188:191], a[224:227], v[80:83]
  v_mfma_f32_16x16x32_bf16 v[84:87], a[184:187], a[212:215], v[84:87]
  v_mfma_f32_16x16x32_bf16 v[84:87], a[188:191], a[228:231], v[84:87]
  s_add_u32 m0, s87, 0xc400
  v_mfma_f32_16x16x32_bf16 v[88:91], a[184:187], a[216:219], v[88:91]
  s_add_u32 s57, s83, 0x1b3600
  v_mfma_f32_16x16x32_bf16 v[88:91], a[188:191], a[232:235], v[88:91]
  buffer_load_dwordx4 v5, s[20:23], s57 offen lds
  v_mfma_f32_16x16x32_bf16 v[92:95], a[184:187], a[220:223], v[92:95]
  s_nop 0
  ds_read_b64_tr_b16 a[184:185], v8 offset:16384
  ds_read_b64_tr_b16 a[186:187], v8 offset:17408
  v_mfma_f32_16x16x32_bf16 v[92:95], a[188:191], a[236:239], v[92:95]
  s_nop 0
  ds_read_b64_tr_b16 a[188:189], v8 offset:20480
  ds_read_b64_tr_b16 a[190:191], v8 offset:21504
  v_mfma_f32_16x16x32_bf16 v[96:99], a[192:195], a[208:211], v[96:99]
  v_mfma_f32_16x16x32_bf16 v[96:99], a[196:199], a[224:227], v[96:99]
  v_mfma_f32_16x16x32_bf16 v[100:103], a[192:195], a[212:215], v[100:103]
  buffer_load_dwordx4 a[96:99], v1, s[28:31], s94 offen sc1
  v_mfma_f32_16x16x32_bf16 v[100:103], a[196:199], a[228:231], v[100:103]
  v_mfma_f32_16x16x32_bf16 v[104:107], a[192:195], a[216:219], v[104:107]
  s_add_u32 s58, s52, 0x9c00
  v_mfma_f32_16x16x32_bf16 v[104:107], a[196:199], a[232:235], v[104:107]
  v_mfma_f32_16x16x32_bf16 v[108:111], a[192:195], a[220:223], v[108:111]
  s_nop 0
  ds_read_b64_tr_b16 a[192:193], v9 offset:16384
  ds_read_b64_tr_b16 a[194:195], v9 offset:17408
  v_mfma_f32_16x16x32_bf16 v[108:111], a[196:199], a[236:239], v[108:111]
  buffer_store_dwordx4 v[252:255], v1, s[28:31], s58 offen sc1
  v_mfma_f32_16x16x32_bf16 v[112:115], a[200:203], a[208:211], v[112:115]
  s_nop 0
  ds_read_b64_tr_b16 a[196:197], v9 offset:20480
  ds_read_b64_tr_b16 a[198:199], v9 offset:21504
  v_mfma_f32_16x16x32_bf16 v[112:115], a[204:207], a[224:227], v[112:115]
  v_add_u32 v254, s44, v1
  v_mov_b32 v252, v1
  v_mfma_f32_16x16x32_bf16 v[116:119], a[200:203], a[212:215], v[116:119]
  s_lshl_b32 s44, s40, 10
  v_cndmask_b32_e64 v253, v17, 0, vcc
  v_mfma_f32_16x16x32_bf16 v[116:119], a[204:207], a[228:231], v[116:119]
  s_add_u32 s44, s44, 0x1c000
  v_mfma_f32_16x16x32_bf16 v[120:123], a[200:203], a[216:219], v[120:123]
  s_cmp_lt_u32 s40, 2
  s_cselect_b32 s44, s44, 0x30000
  buffer_load_dwordx4 a[100:103], v1, s[28:31], s94 offen offset:1024 sc1
  v_mfma_f32_16x16x32_bf16 v[120:123], a[204:207], a[232:235], v[120:123]
  v_add_u32 v255, s44, v1
  v_mfma_f32_16x16x32_bf16 v[124:127], a[200:203], a[220:223], v[124:127]
  s_lshl_b32 s44, s40, 12
  ds_read_b64_tr_b16 a[200:201], v10 offset:16384
  ds_read_b64_tr_b16 a[202:203], v10 offset:17408
  v_mfma_f32_16x16x32_bf16 v[124:127], a[204:207], a[236:239], v[124:127]
  s_add_u32 s48, s46, s44
  ds_read_b64_tr_b16 a[204:205], v10 offset:20480
  ds_read_b64_tr_b16 a[206:207], v10 offset:21504
  v_mfma_f32_16x16x32_bf16 v[128:131], a[240:243], a[208:211], v[128:131]
  s_lshr_b32 s44, s40, 1
  v_mfma_f32_16x16x32_bf16 v[128:131], a[244:247], a[224:227], v[128:131]
  s_lshl_b32 s44, s44, 16
  buffer_load_dwordx4 a[104:107], v1, s[28:31], s94 offen offset:2048 sc1
  v_mfma_f32_16x16x32_bf16 v[132:135], a[240:243], a[212:215], v[132:135]
  s_add_u32 s49, s43, s44
  v_mfma_f32_16x16x32_bf16 v[132:135], a[244:247], a[228:231], v[132:135]
  s_lshl_b32 s43, s72, 17
  v_mfma_f32_16x16x32_bf16 v[136:139], a[240:243], a[216:219], v[136:139]
  s_add_u32 s70, s68, s43
  v_mfma_f32_16x16x32_bf16 v[136:139], a[244:247], a[232:235], v[136:139]
  s_mul_i32 s43, s72, 57344
  v_mfma_f32_16x16x32_bf16 v[140:143], a[240:243], a[220:223], v[140:143]
  s_lshl_b32 s44, s40, 10
  buffer_load_dwordx4 a[108:111], v1, s[28:31], s94 offen offset:3072 sc1
  v_mfma_f32_16x16x32_bf16 v[140:143], a[244:247], a[236:239], v[140:143]
  s_waitcnt lgkmcnt(0)
  ds_read_b64_tr_b16 a[240:241], v11 offset:16384
  ds_read_b64_tr_b16 a[242:243], v11 offset:17408
  v_mfma_f32_16x16x32_bf16 v[144:147], a[248:251], a[208:211], v[144:147]
  s_add_u32 s94, s81, 0x12000
  ds_read_b64_tr_b16 a[244:245], v11 offset:20480
  ds_read_b64_tr_b16 a[246:247], v11 offset:21504
  v_mfma_f32_16x16x32_bf16 v[144:147], a[252:255], a[224:227], v[144:147]
  s_add_u32 s74, s74, s44
  v_mfma_f32_16x16x32_bf16 v[148:151], a[248:251], a[212:215], v[148:151]
  s_and_b32 s44, s40, 1
  v_mfma_f32_16x16x32_bf16 v[148:151], a[252:255], a[228:231], v[148:151]
  s_cmp_lt_u32 s40, 2
  s_cselect_b32 s74, s74, 0x40000000
  buffer_load_dwordx4 a[112:115], v1, s[28:31], s93 offen sc1
  v_mfma_f32_16x16x32_bf16 v[152:155], a[248:251], a[216:219], v[152:155]
  v_mfma_f32_16x16x32_bf16 v[152:155], a[252:255], a[232:235], v[152:155]
  v_mfma_f32_16x16x32_bf16 v[156:159], a[248:251], a[220:223], v[156:159]
  v_mfma_f32_16x16x32_bf16 v[156:159], a[252:255], a[236:239], v[156:159]
  v_mfma_f32_16x16x32_bf16 v[160:163], a[184:187], a[208:211], v[160:163]
  buffer_load_dwordx4 a[116:119], v1, s[28:31], s93 offen offset:1024 sc1
  v_mfma_f32_16x16x32_bf16 v[160:163], a[188:191], a[224:227], v[160:163]
  v_mfma_f32_16x16x32_bf16 v[164:167], a[184:187], a[212:215], v[164:167]
  v_mfma_f32_16x16x32_bf16 v[164:167], a[188:191], a[228:231], v[164:167]
  v_mfma_f32_16x16x32_bf16 v[168:171], a[184:187], a[216:219], v[168:171]
  v_mfma_f32_16x16x32_bf16 v[168:171], a[188:191], a[232:235], v[168:171]
  buffer_load_dwordx4 a[120:123], v1, s[28:31], s93 offen offset:2048 sc1
  v_mfma_f32_16x16x32_bf16 v[172:175], a[184:187], a[220:223], v[172:175]
  v_mfma_f32_16x16x32_bf16 v[172:175], a[188:191], a[236:239], v[172:175]
  v_mfma_f32_16x16x32_bf16 v[176:179], a[192:195], a[208:211], v[176:179]
  v_mfma_f32_16x16x32_bf16 v[176:179], a[196:199], a[224:227], v[176:179]
  v_mfma_f32_16x16x32_bf16 v[180:183], a[192:195], a[212:215], v[180:183]
  buffer_load_dwordx4 a[124:127], v1, s[28:31], s93 offen offset:3072 sc1
  v_mfma_f32_16x16x32_bf16 v[180:183], a[196:199], a[228:231], v[180:183]
  s_add_u32 s93, s81, 0x13000
  v_mfma_f32_16x16x32_bf16 v[184:187], a[192:195], a[216:219], v[184:187]
  v_mfma_f32_16x16x32_bf16 v[184:187], a[196:199], a[232:235], v[184:187]
  v_mfma_f32_16x16x32_bf16 v[188:191], a[192:195], a[220:223], v[188:191]
  v_mfma_f32_16x16x32_bf16 v[188:191], a[196:199], a[236:239], v[188:191]
  v_mfma_f32_16x16x32_bf16 v[192:195], a[200:203], a[208:211], v[192:195]
  v_mfma_f32_16x16x32_bf16 v[192:195], a[204:207], a[224:227], v[192:195]
  v_mfma_f32_16x16x32_bf16 v[196:199], a[200:203], a[212:215], v[196:199]
  v_mfma_f32_16x16x32_bf16 v[196:199], a[204:207], a[228:231], v[196:199]
  v_mfma_f32_16x16x32_bf16 v[200:203], a[200:203], a[216:219], v[200:203]
  buffer_load_dword a174, v28, s[24:27], s3 offen
  v_mfma_f32_16x16x32_bf16 v[200:203], a[204:207], a[232:235], v[200:203]
  s_lshr_b32 s3, s2, 3
  v_mfma_f32_16x16x32_bf16 v[204:207], a[200:203], a[220:223], v[204:207]
  s_lshl_b32 s3, s3, 1
  v_mfma_f32_16x16x32_bf16 v[204:207], a[204:207], a[236:239], v[204:207]
  s_waitcnt vmcnt(18) lgkmcnt(0)
  s_barrier
  v_mfma_f32_16x16x32_bf16 v[208:211], a[240:243], a[208:211], v[208:211]
  s_add_u32 m0, s86, 0x20000
  ds_read_b64_tr_b16 a[248:249], v6 offset:16384
  ds_read_b64_tr_b16 a[250:251], v6 offset:17408
  v_mfma_f32_16x16x32_bf16 v[208:211], a[244:247], a[224:227], v[208:211]
  s_add_u32 s59, s82, 0x480000
  ds_read_b64_tr_b16 a[252:253], v6 offset:20480
  ds_read_b64_tr_b16 a[254:255], v6 offset:21504
  v_mfma_f32_16x16x32_bf16 v[212:215], a[240:243], a[212:215], v[212:215]
  s_add_u32 s3, s3, s44
  ds_read_b64_tr_b16 a[184:185], v7 offset:16384
  ds_read_b64_tr_b16 a[186:187], v7 offset:17408
  v_mfma_f32_16x16x32_bf16 v[212:215], a[244:247], a[228:231], v[212:215]
  s_lshl_b32 s3, s3, 11
  buffer_load_dwordx4 v4, s[16:19], s59 offen lds
  v_mfma_f32_16x16x32_bf16 v[216:219], a[240:243], a[216:219], v[216:219]
  s_add_u32 m0, s86, 0x20400
  ds_read_b64_tr_b16 a[188:189], v7 offset:20480
  ds_read_b64_tr_b16 a[190:191], v7 offset:21504
  v_mfma_f32_16x16x32_bf16 v[216:219], a[244:247], a[232:235], v[216:219]
  s_add_u32 s56, s82, 0x488000
  ds_read_b64_tr_b16 a[192:193], v2 offset:16384
  ds_read_b64_tr_b16 a[194:195], v2 offset:17408
  v_mfma_f32_16x16x32_bf16 v[220:223], a[240:243], a[220:223], v[220:223]
  buffer_load_dwordx4 v4, s[16:19], s56 offen lds
  v_mfma_f32_16x16x32_bf16 v[220:223], a[244:247], a[236:239], v[220:223]
  s_waitcnt lgkmcnt(8)
  ds_read_b64_tr_b16 a[196:197], v2 offset:20480
  ds_read_b64_tr_b16 a[198:199], v2 offset:21504
  v_mfma_f32_16x16x32_bf16 v[32:35], a[248:251], a[32:35], v[32:35]
  s_waitcnt lgkmcnt(8)
  ds_read_b64_tr_b16 a[200:201], v3 offset:16384
  ds_read_b64_tr_b16 a[202:203], v3 offset:17408
  v_mfma_f32_16x16x32_bf16 v[32:35], a[252:255], a[48:51], v[32:35]
  s_add_u32 m0, s86, 0x20800
  ds_read_b64_tr_b16 a[204:205], v3 offset:20480
  ds_read_b64_tr_b16 a[206:207], v3 offset:21504
  v_mfma_f32_16x16x32_bf16 v[36:39], a[248:251], a[36:39], v[36:39]
  s_add_u32 s57, s82, 0x4a0000
  buffer_load_dwordx4 v4, s[16:19], s57 offen lds
  v_mfma_f32_16x16x32_bf16 v[36:39], a[252:255], a[52:55], v[36:39]
  s_lshl_b32 s57, s40, 12
  ds_read_b64_tr_b16 a[240:241], v6 offset:24576
  ds_read_b64_tr_b16 a[242:243], v6 offset:25600
  v_mfma_f32_16x16x32_bf16 v[40:43], a[248:251], a[40:43], v[40:43]
  s_add_u32 m0, s86, 0x20c00
  ds_read_b64_tr_b16 a[244:245], v6 offset:28672
  ds_read_b64_tr_b16 a[246:247], v6 offset:29696
  v_mfma_f32_16x16x32_bf16 v[40:43], a[252:255], a[56:59], v[40:43]
  s_add_u32 s58, s82, 0x4a8000
  v_mfma_f32_16x16x32_bf16 v[44:47], a[248:251], a[44:47], v[44:47]
  s_add_u32 s82, s68, 0xb4000
  buffer_load_dwordx4 v4, s[16:19], s58 offen lds
  v_mfma_f32_16x16x32_bf16 v[44:47], a[252:255], a[60:63], v[44:47]
  s_waitcnt lgkmcnt(6)
  ds_read_b64_tr_b16 a[248:249], v7 offset:24576
  ds_read_b64_tr_b16 a[250:251], v7 offset:25600
  v_mfma_f32_16x16x32_bf16 v[48:51], a[184:187], a[32:35], v[48:51]
  s_add_u32 m0, s87, 0x24000
  ds_read_b64_tr_b16 a[252:253], v7 offset:28672
  ds_read_b64_tr_b16 a[254:255], v7 offset:29696
  v_mfma_f32_16x16x32_bf16 v[48:51], a[188:191], a[48:51], v[48:51]
  s_add_u32 s59, s83, 0x1e6000
  v_lshl_add_u32 v4, v19, 4, v18
  v_mfma_f32_16x16x32_bf16 v[52:55], a[184:187], a[36:39], v[52:55]
  s_add_u32 s68, s68, s43
  buffer_load_dwordx4 v5, s[20:23], s59 offen lds
  v_mfma_f32_16x16x32_bf16 v[52:55], a[188:191], a[52:55], v[52:55]
  s_mul_i32 s43, s72, 1310720
  v_mfma_f32_16x16x32_bf16 v[56:59], a[184:187], a[40:43], v[56:59]
  s_add_u32 m0, s87, 0x24400
  v_mfma_f32_16x16x32_bf16 v[56:59], a[188:191], a[56:59], v[56:59]
  s_add_u32 s56, s83, 0x1e9600
  v_mfma_f32_16x16x32_bf16 v[60:63], a[184:187], a[44:47], v[60:63]
  s_add_u32 s81, s69, s43
  buffer_load_dwordx4 v5, s[20:23], s56 offen lds
  v_mfma_f32_16x16x32_bf16 v[60:63], a[188:191], a[60:63], v[60:63]
  s_mul_i32 s43, s72, 573440
  ds_read_b64_tr_b16 a[184:185], v2 offset:24576
  ds_read_b64_tr_b16 a[186:187], v2 offset:25600
  v_mfma_f32_16x16x32_bf16 v[64:67], a[192:195], a[32:35], v[64:67]
  s_add_u32 s69, s69, s43
  ds_read_b64_tr_b16 a[188:189], v2 offset:28672
  ds_read_b64_tr_b16 a[190:191], v2 offset:29696
  v_mfma_f32_16x16x32_bf16 v[64:67], a[196:199], a[48:51], v[64:67]
  s_lshl_b32 m0, s40, 12
  v_mov_b32 v5, 0xf149f2ca
  v_mfma_f32_16x16x32_bf16 v[68:71], a[192:195], a[36:39], v[68:71]
  s_lshl_b32 s58, s40, 12
  buffer_load_dwordx4 a[0:3], v1, s[28:31], s94 offen sc1
  v_mfma_f32_16x16x32_bf16 v[68:71], a[196:199], a[52:55], v[68:71]
  s_add_u32 s59, s50, 0x0
  v_mfma_f32_16x16x32_bf16 v[72:75], a[192:195], a[40:43], v[72:75]
  s_add_u32 s56, s50, 0x1000
  v_mfma_f32_16x16x32_bf16 v[72:75], a[196:199], a[56:59], v[72:75]
  s_add_u32 s68, s68, 0x80000
  v_mfma_f32_16x16x32_bf16 v[76:79], a[192:195], a[44:47], v[76:79]
  buffer_load_dwordx4 a[4:7], v1, s[28:31], s94 offen offset:1024 sc1
  v_mfma_f32_16x16x32_bf16 v[76:79], a[196:199], a[60:63], v[76:79]
  s_nop 0
  ds_read_b64_tr_b16 a[192:193], v3 offset:24576
  ds_read_b64_tr_b16 a[194:195], v3 offset:25600
  v_mfma_f32_16x16x32_bf16 v[80:83], a[200:203], a[32:35], v[80:83]
  s_waitcnt lgkmcnt(2)
  ds_read_b64_tr_b16 a[196:197], v3 offset:28672
  ds_read_b64_tr_b16 a[198:199], v3 offset:29696
  v_mfma_f32_16x16x32_bf16 v[80:83], a[204:207], a[48:51], v[80:83]
  v_mfma_f32_16x16x32_bf16 v[84:87], a[200:203], a[36:39], v[84:87]
  buffer_load_dwordx4 a[8:11], v1, s[28:31], s94 offen offset:2048 sc1
  v_mfma_f32_16x16x32_bf16 v[84:87], a[204:207], a[52:55], v[84:87]
  v_mfma_f32_16x16x32_bf16 v[88:91], a[200:203], a[40:43], v[88:91]
  v_mfma_f32_16x16x32_bf16 v[88:91], a[204:207], a[56:59], v[88:91]
  v_mfma_f32_16x16x32_bf16 v[92:95], a[200:203], a[44:47], v[92:95]
  buffer_load_dwordx4 a[12:15], v1, s[28:31], s94 offen offset:3072 sc1
  v_mfma_f32_16x16x32_bf16 v[92:95], a[204:207], a[60:63], v[92:95]
  v_mfma_f32_16x16x32_bf16 v[96:99], a[240:243], a[32:35], v[96:99]
  v_mfma_f32_16x16x32_bf16 v[96:99], a[244:247], a[48:51], v[96:99]
  v_mfma_f32_16x16x32_bf16 v[100:103], a[240:243], a[36:39], v[100:103]
  buffer_load_dwordx4 a[16:19], v1, s[28:31], s93 offen sc1
  v_mfma_f32_16x16x32_bf16 v[100:103], a[244:247], a[52:55], v[100:103]
  v_mfma_f32_16x16x32_bf16 v[104:107], a[240:243], a[40:43], v[104:107]
  v_mfma_f32_16x16x32_bf16 v[104:107], a[244:247], a[56:59], v[104:107]
  v_mfma_f32_16x16x32_bf16 v[108:111], a[240:243], a[44:47], v[108:111]
  buffer_load_dwordx4 a[20:23], v1, s[28:31], s93 offen offset:1024 sc1
  v_mfma_f32_16x16x32_bf16 v[108:111], a[244:247], a[60:63], v[108:111]
  v_mfma_f32_16x16x32_bf16 v[112:115], a[248:251], a[32:35], v[112:115]
  v_mfma_f32_16x16x32_bf16 v[112:115], a[252:255], a[48:51], v[112:115]
  v_mfma_f32_16x16x32_bf16 v[116:119], a[248:251], a[36:39], v[116:119]
  buffer_load_dwordx4 a[24:27], v1, s[28:31], s93 offen offset:2048 sc1
  v_mfma_f32_16x16x32_bf16 v[116:119], a[252:255], a[52:55], v[116:119]
  v_mfma_f32_16x16x32_bf16 v[120:123], a[248:251], a[40:43], v[120:123]
  v_mfma_f32_16x16x32_bf16 v[120:123], a[252:255], a[56:59], v[120:123]
  v_mfma_f32_16x16x32_bf16 v[124:127], a[248:251], a[44:47], v[124:127]
  buffer_load_dwordx4 a[28:31], v1, s[28:31], s93 offen offset:3072 sc1
  v_mfma_f32_16x16x32_bf16 v[124:127], a[252:255], a[60:63], v[124:127]
  v_mfma_f32_16x16x32_bf16 v[128:131], a[184:187], a[32:35], v[128:131]
  v_mfma_f32_16x16x32_bf16 v[128:131], a[188:191], a[48:51], v[128:131]
  v_mfma_f32_16x16x32_bf16 v[132:135], a[184:187], a[36:39], v[132:135]
  v_mfma_f32_16x16x32_bf16 v[132:135], a[188:191], a[52:55], v[132:135]
  v_mfma_f32_16x16x32_bf16 v[136:139], a[184:187], a[40:43], v[136:139]
  v_mfma_f32_16x16x32_bf16 v[136:139], a[188:191], a[56:59], v[136:139]
  v_mfma_f32_16x16x32_bf16 v[140:143], a[184:187], a[44:47], v[140:143]
  v_mfma_f32_16x16x32_bf16 v[140:143], a[188:191], a[60:63], v[140:143]
  s_waitcnt vmcnt(15) lgkmcnt(0)
  s_barrier
  v_mfma_f32_16x16x32_bf16 v[144:147], a[192:195], a[32:35], v[144:147]
  s_nop 0
  ds_read_b64_tr_b16 a[200:201], v6 offset:32768
  ds_read_b64_tr_b16 a[202:203], v6 offset:33792
  v_mfma_f32_16x16x32_bf16 v[144:147], a[196:199], a[48:51], v[144:147]
  s_nop 0
  ds_read_b64_tr_b16 a[204:205], v6 offset:36864
  ds_read_b64_tr_b16 a[206:207], v6 offset:37888
  v_mfma_f32_16x16x32_bf16 v[148:151], a[192:195], a[36:39], v[148:151]
  s_nop 0
  ds_read_b64_tr_b16 a[240:241], v7 offset:32768
  ds_read_b64_tr_b16 a[242:243], v7 offset:33792
  v_mfma_f32_16x16x32_bf16 v[148:151], a[196:199], a[52:55], v[148:151]
  s_nop 0
  ds_read_b64_tr_b16 a[244:245], v7 offset:36864
  ds_read_b64_tr_b16 a[246:247], v7 offset:37888
  v_mfma_f32_16x16x32_bf16 v[152:155], a[192:195], a[40:43], v[152:155]
  s_nop 0
  ds_read_b64_tr_b16 a[248:249], v2 offset:32768
  ds_read_b64_tr_b16 a[250:251], v2 offset:33792
  v_mfma_f32_16x16x32_bf16 v[152:155], a[196:199], a[56:59], v[152:155]
  s_nop 0
  ds_read_b64_tr_b16 a[252:253], v2 offset:36864
  ds_read_b64_tr_b16 a[254:255], v2 offset:37888
  v_mfma_f32_16x16x32_bf16 v[156:159], a[192:195], a[44:47], v[156:159]
  buffer_atomic_add v15, v14, s[28:31], s53 offen sc1
  v_mfma_f32_16x16x32_bf16 v[156:159], a[196:199], a[60:63], v[156:159]
  s_waitcnt lgkmcnt(10)
  ds_read_b64_tr_b16 a[184:185], v3 offset:32768
  ds_read_b64_tr_b16 a[186:187], v3 offset:33792
  v_mfma_f32_16x16x32_bf16 v[32:35], a[200:203], a[96:99], v[32:35]
  s_waitcnt lgkmcnt(10)
  ds_read_b64_tr_b16 a[188:189], v3 offset:36864
  ds_read_b64_tr_b16 a[190:191], v3 offset:37888
  v_mfma_f32_16x16x32_bf16 v[32:35], a[204:207], a[112:115], v[32:35]
  v_mfma_f32_16x16x32_bf16 v[36:39], a[200:203], a[100:103], v[36:39]
  s_nop 0
  ds_read_b64_tr_b16 a[192:193], v6 offset:40960
  ds_read_b64_tr_b16 a[194:195], v6 offset:41984
  v_mfma_f32_16x16x32_bf16 v[36:39], a[204:207], a[116:119], v[36:39]
  s_nop 0
  ds_read_b64_tr_b16 a[196:197], v6 offset:45056
  ds_read_b64_tr_b16 a[198:199], v6 offset:46080
  v_mfma_f32_16x16x32_bf16 v[40:43], a[200:203], a[104:107], v[40:43]
  v_mfma_f32_16x16x32_bf16 v[40:43], a[204:207], a[120:123], v[40:43]
  v_mfma_f32_16x16x32_bf16 v[44:47], a[200:203], a[108:111], v[44:47]
  s_nop 0
  ds_read_b64_tr_b16 a[200:201], v7 offset:40960
  ds_read_b64_tr_b16 a[202:203], v7 offset:41984
  v_mfma_f32_16x16x32_bf16 v[44:47], a[204:207], a[124:127], v[44:47]
  s_waitcnt lgkmcnt(6)
  ds_read_b64_tr_b16 a[204:205], v7 offset:45056
  ds_read_b64_tr_b16 a[206:207], v7 offset:46080
  v_mfma_f32_16x16x32_bf16 v[48:51], a[240:243], a[96:99], v[48:51]
  v_mfma_f32_16x16x32_bf16 v[48:51], a[244:247], a[112:115], v[48:51]
  v_mfma_f32_16x16x32_bf16 v[52:55], a[240:243], a[100:103], v[52:55]
  v_mfma_f32_16x16x32_bf16 v[52:55], a[244:247], a[116:119], v[52:55]
  v_mfma_f32_16x16x32_bf16 v[56:59], a[240:243], a[104:107], v[56:59]
  v_mfma_f32_16x16x32_bf16 v[56:59], a[244:247], a[120:123], v[56:59]
  v_mfma_f32_16x16x32_bf16 v[60:63], a[240:243], a[108:111], v[60:63]
  s_nop 0
  ds_read_b64_tr_b16 a[240:241], v2 offset:40960
  ds_read_b64_tr_b16 a[242:243], v2 offset:41984
  v_mfma_f32_16x16x32_bf16 v[60:63], a[244:247], a[124:127], v[60:63]
  s_nop 0
  ds_read_b64_tr_b16 a[244:245], v2 offset:45056
  ds_read_b64_tr_b16 a[246:247], v2 offset:46080
  v_mfma_f32_16x16x32_bf16 v[64:67], a[248:251], a[96:99], v[64:67]
  v_mfma_f32_16x16x32_bf16 v[64:67], a[252:255], a[112:115], v[64:67]
  v_mfma_f32_16x16x32_bf16 v[68:71], a[248:251], a[100:103], v[68:71]
  v_mfma_f32_16x16x32_bf16 v[68:71], a[252:255], a[116:119], v[68:71]
  v_mfma_f32_16x16x32_bf16 v[72:75], a[248:251], a[104:107], v[72:75]
  v_mfma_f32_16x16x32_bf16 v[72:75], a[252:255], a[120:123], v[72:75]
  v_mfma_f32_16x16x32_bf16 v[76:79], a[248:251], a[108:111], v[76:79]
  s_nop 0
  ds_read_b64_tr_b16 a[248:249], v3 offset:40960
  ds_read_b64_tr_b16 a[250:251], v3 offset:41984
  v_mfma_f32_16x16x32_bf16 v[76:79], a[252:255], a[124:127], v[76:79]
  s_nop 0
  ds_read_b64_tr_b16 a[252:253], v3 offset:45056
  ds_read_b64_tr_b16 a[254:255], v3 offset:46080
  v_mfma_f32_16x16x32_bf16 v[80:83], a[184:187], a[96:99], v[80:83]
  v_mfma_f32_16x16x32_bf16 v[80:83], a[188:191], a[112:115], v[80:83]
  v_mfma_f32_16x16x32_bf16 v[84:87], a[184:187], a[100:103], v[84:87]
  v_mfma_f32_16x16x32_bf16 v[84:87], a[188:191], a[116:119], v[84:87]
  v_mfma_f32_16x16x32_bf16 v[88:91], a[184:187], a[104:107], v[88:91]
  v_mfma_f32_16x16x32_bf16 v[88:91], a[188:191], a[120:123], v[88:91]
  v_mfma_f32_16x16x32_bf16 v[92:95], a[184:187], a[108:111], v[92:95]
  v_mfma_f32_16x16x32_bf16 v[92:95], a[188:191], a[124:127], v[92:95]
  s_waitcnt lgkmcnt(0)
  v_mfma_f32_16x16x32_bf16 v[96:99], a[192:195], a[96:99], v[96:99]
  v_mfma_f32_16x16x32_bf16 v[96:99], a[196:199], a[112:115], v[96:99]
  v_mfma_f32_16x16x32_bf16 v[100:103], a[192:195], a[100:103], v[100:103]
  v_mfma_f32_16x16x32_bf16 v[100:103], a[196:199], a[116:119], v[100:103]
  v_mfma_f32_16x16x32_bf16 v[104:107], a[192:195], a[104:107], v[104:107]
  v_mfma_f32_16x16x32_bf16 v[104:107], a[196:199], a[120:123], v[104:107]
  v_mfma_f32_16x16x32_bf16 v[108:111], a[192:195], a[108:111], v[108:111]
  v_mfma_f32_16x16x32_bf16 v[108:111], a[196:199], a[124:127], v[108:111]
  v_mfma_f32_16x16x32_bf16 v[112:115], a[200:203], a[96:99], v[112:115]
  v_mfma_f32_16x16x32_bf16 v[112:115], a[204:207], a[112:115], v[112:115]
  v_mfma_f32_16x16x32_bf16 v[116:119], a[200:203], a[100:103], v[116:119]
  v_mfma_f32_16x16x32_bf16 v[116:119], a[204:207], a[116:119], v[116:119]
  v_mfma_f32_16x16x32_bf16 v[120:123], a[200:203], a[104:107], v[120:123]
  v_mfma_f32_16x16x32_bf16 v[120:123], a[204:207], a[120:123], v[120:123]
  v_mfma_f32_16x16x32_bf16 v[124:127], a[200:203], a[108:111], v[124:127]
  v_mfma_f32_16x16x32_bf16 v[124:127], a[204:207], a[124:127], v[124:127]
  v_mfma_f32_16x16x32_bf16 v[128:131], a[240:243], a[96:99], v[128:131]
  v_mfma_f32_16x16x32_bf16 v[128:131], a[244:247], a[112:115], v[128:131]
  v_mfma_f32_16x16x32_bf16 v[132:135], a[240:243], a[100:103], v[132:135]
  v_mfma_f32_16x16x32_bf16 v[132:135], a[244:247], a[116:119], v[132:135]
  v_mfma_f32_16x16x32_bf16 v[136:139], a[240:243], a[104:107], v[136:139]
  v_mfma_f32_16x16x32_bf16 v[136:139], a[244:247], a[120:123], v[136:139]
  v_mfma_f32_16x16x32_bf16 v[140:143], a[240:243], a[108:111], v[140:143]
  v_mfma_f32_16x16x32_bf16 v[140:143], a[244:247], a[124:127], v[140:143]
  s_waitcnt vmcnt(1) lgkmcnt(0)
  s_barrier
  v_mfma_f32_16x16x32_bf16 v[144:147], a[248:251], a[96:99], v[144:147]
  s_nop 0
  ds_read_b64_tr_b16 v[232:233], v8
  ds_read_b64_tr_b16 v[234:235], v8 offset:1024
  v_mfma_f32_16x16x32_bf16 v[144:147], a[252:255], a[112:115], v[144:147]
  s_nop 0
  ds_read_b64_tr_b16 v[236:237], v8 offset:4096
  ds_read_b64_tr_b16 v[238:239], v8 offset:5120
  v_mfma_f32_16x16x32_bf16 v[148:151], a[248:251], a[100:103], v[148:151]
  s_nop 0
  ds_read_b64_tr_b16 v[240:241], v9
  ds_read_b64_tr_b16 v[242:243], v9 offset:1024
  v_mfma_f32_16x16x32_bf16 v[148:151], a[252:255], a[116:119], v[148:151]
  s_nop 0
  ds_read_b64_tr_b16 v[244:245], v9 offset:4096
  ds_read_b64_tr_b16 v[246:247], v9 offset:5120
  v_mfma_f32_16x16x32_bf16 v[152:155], a[248:251], a[104:107], v[152:155]
  s_nop 0
  ds_read_b64_tr_b16 v[224:225], v10
  ds_read_b64_tr_b16 v[226:227], v10 offset:1024
  v_mfma_f32_16x16x32_bf16 v[152:155], a[252:255], a[120:123], v[152:155]
  s_nop 0
  ds_read_b64_tr_b16 v[228:229], v10 offset:4096
  ds_read_b64_tr_b16 v[230:231], v10 offset:5120
  v_mfma_f32_16x16x32_bf16 v[156:159], a[248:251], a[108:111], v[156:159]
  v_mfma_f32_16x16x32_bf16 v[156:159], a[252:255], a[124:127], v[156:159]
  s_waitcnt lgkmcnt(10)
  v_mfma_f32_16x16x32_bf16 v[32:35], v[232:235], a[0:3], v[32:35]
  s_waitcnt lgkmcnt(8)
  v_mfma_f32_16x16x32_bf16 v[32:35], v[236:239], a[16:19], v[32:35]
  v_mfma_f32_16x16x32_bf16 v[36:39], v[232:235], a[4:7], v[36:39]
  v_mfma_f32_16x16x32_bf16 v[36:39], v[236:239], a[20:23], v[36:39]
  v_mfma_f32_16x16x32_bf16 v[40:43], v[232:235], a[8:11], v[40:43]
  v_mfma_f32_16x16x32_bf16 v[40:43], v[236:239], a[24:27], v[40:43]
  v_mfma_f32_16x16x32_bf16 v[44:47], v[232:235], a[12:15], v[44:47]
  s_nop 0
  ds_read_b64_tr_b16 v[232:233], v11
  ds_read_b64_tr_b16 v[234:235], v11 offset:1024
  v_mfma_f32_16x16x32_bf16 v[44:47], v[236:239], a[28:31], v[44:47]
  s_waitcnt lgkmcnt(2)
  ds_read_b64_tr_b16 v[236:237], v11 offset:4096
  ds_read_b64_tr_b16 v[238:239], v11 offset:5120
  v_mfma_f32_16x16x32_bf16 v[48:51], v[240:243], a[0:3], v[48:51]
  v_mul_f32 v32, 0x3e0293ee, v32
  v_mul_f32 v33, 0x3e0293ee, v33
  v_mfma_f32_16x16x32_bf16 v[48:51], v[244:247], a[16:19], v[48:51]
  v_mul_f32 v34, 0x3e0293ee, v34
  v_mul_f32 v35, 0x3e0293ee, v35
  v_mfma_f32_16x16x32_bf16 v[52:55], v[240:243], a[4:7], v[52:55]
  v_cvt_pk_bf16_f32 v32, v32, v33
  v_cvt_pk_bf16_f32 v33, v34, v35
  v_mfma_f32_16x16x32_bf16 v[52:55], v[244:247], a[20:23], v[52:55]
  v_accvgpr_write_b32 a144, v32
  v_accvgpr_write_b32 a145, v33
  v_mfma_f32_16x16x32_bf16 v[56:59], v[240:243], a[8:11], v[56:59]
  v_mul_f32 v48, 0x3e0293ee, v48
  v_mul_f32 v49, 0x3e0293ee, v49
  v_mfma_f32_16x16x32_bf16 v[56:59], v[244:247], a[24:27], v[56:59]
  v_mul_f32 v50, 0x3e0293ee, v50
  v_mul_f32 v51, 0x3e0293ee, v51
  v_mfma_f32_16x16x32_bf16 v[60:63], v[240:243], a[12:15], v[60:63]
  s_nop 0
  ds_read_b64_tr_b16 v[240:241], v8 offset:8192
  ds_read_b64_tr_b16 v[242:243], v8 offset:9216
  v_mfma_f32_16x16x32_bf16 v[60:63], v[244:247], a[28:31], v[60:63]
  s_nop 0
  ds_read_b64_tr_b16 v[244:245], v8 offset:12288
  ds_read_b64_tr_b16 v[246:247], v8 offset:13312
  v_mfma_f32_16x16x32_bf16 v[64:67], v[224:227], a[0:3], v[64:67]
  v_cvt_pk_bf16_f32 v34, v48, v49
  v_cvt_pk_bf16_f32 v35, v50, v51
  v_mfma_f32_16x16x32_bf16 v[64:67], v[228:231], a[16:19], v[64:67]
  v_accvgpr_write_b32 a146, v34
  v_accvgpr_write_b32 a147, v35
  v_mfma_f32_16x16x32_bf16 v[68:71], v[224:227], a[4:7], v[68:71]
  v_mul_f32 v36, 0x3e0293ee, v36
  v_mul_f32 v37, 0x3e0293ee, v37
  v_mfma_f32_16x16x32_bf16 v[68:71], v[228:231], a[20:23], v[68:71]
  v_mul_f32 v38, 0x3e0293ee, v38
  v_mul_f32 v39, 0x3e0293ee, v39
  v_mfma_f32_16x16x32_bf16 v[72:75], v[224:227], a[8:11], v[72:75]
  v_mul_f32 v64, 0x3e0293ee, v64
  v_mul_f32 v65, 0x3e0293ee, v65
  v_mfma_f32_16x16x32_bf16 v[72:75], v[228:231], a[24:27], v[72:75]
  v_mul_f32 v66, 0x3e0293ee, v66
  v_mul_f32 v67, 0x3e0293ee, v67
  v_mfma_f32_16x16x32_bf16 v[76:79], v[224:227], a[12:15], v[76:79]
  s_nop 0
  ds_read_b64_tr_b16 v[224:225], v9 offset:8192
  ds_read_b64_tr_b16 v[226:227], v9 offset:9216
  v_mfma_f32_16x16x32_bf16 v[76:79], v[228:231], a[28:31], v[76:79]
  s_waitcnt lgkmcnt(2)
  ds_read_b64_tr_b16 v[228:229], v9 offset:12288
  ds_read_b64_tr_b16 v[230:231], v9 offset:13312
  v_mfma_f32_16x16x32_bf16 v[80:83], v[232:235], a[0:3], v[80:83]
  v_cvt_pk_bf16_f32 v64, v64, v65
  v_cvt_pk_bf16_f32 v65, v66, v67
  v_mfma_f32_16x16x32_bf16 v[80:83], v[236:239], a[16:19], v[80:83]
  v_accvgpr_write_b32 a148, v64
  v_accvgpr_write_b32 a149, v65
  v_mfma_f32_16x16x32_bf16 v[84:87], v[232:235], a[4:7], v[84:87]
  v_cvt_pk_bf16_f32 v36, v36, v37
  v_mul_f32 v52, 0x3e0293ee, v52
  v_mfma_f32_16x16x32_bf16 v[84:87], v[236:239], a[20:23], v[84:87]
  v_mul_f32 v53, 0x3e0293ee, v53
  v_mul_f32 v54, 0x3e0293ee, v54
  v_mfma_f32_16x16x32_bf16 v[88:91], v[232:235], a[8:11], v[88:91]
  v_mul_f32 v80, 0x3e0293ee, v80
  v_mul_f32 v81, 0x3e0293ee, v81
  v_mfma_f32_16x16x32_bf16 v[88:91], v[236:239], a[24:27], v[88:91]
  v_mul_f32 v82, 0x3e0293ee, v82
  v_mul_f32 v83, 0x3e0293ee, v83
  v_mfma_f32_16x16x32_bf16 v[92:95], v[232:235], a[12:15], v[92:95]
  s_nop 0
  ds_read_b64_tr_b16 v[232:233], v10 offset:8192
  ds_read_b64_tr_b16 v[234:235], v10 offset:9216
  v_mfma_f32_16x16x32_bf16 v[92:95], v[236:239], a[28:31], v[92:95]
  s_nop 0
  ds_read_b64_tr_b16 v[236:237], v10 offset:12288
  ds_read_b64_tr_b16 v[238:239], v10 offset:13312
  v_mfma_f32_16x16x32_bf16 v[96:99], v[240:243], a[0:3], v[96:99]
  buffer_load_dword v30, v31, s[28:31], s53 offen sc1
  v_mfma_f32_16x16x32_bf16 v[96:99], v[244:247], a[16:19], v[96:99]
  v_cvt_pk_bf16_f32 v66, v80, v81
  v_cvt_pk_bf16_f32 v67, v82, v83
  v_mfma_f32_16x16x32_bf16 v[100:103], v[240:243], a[4:7], v[100:103]
  v_accvgpr_write_b32 a150, v66
  v_accvgpr_write_b32 a151, v67
  v_mfma_f32_16x16x32_bf16 v[100:103], v[244:247], a[20:23], v[100:103]
  v_mul_f32 v55, 0x3e0293ee, v55
  v_cvt_pk_bf16_f32 v37, v38, v39
  v_mfma_f32_16x16x32_bf16 v[104:107], v[240:243], a[8:11], v[104:107]
  v_mul_f32 v96, 0x3e0293ee, v96
  v_mul_f32 v97, 0x3e0293ee, v97
  v_mfma_f32_16x16x32_bf16 v[104:107], v[244:247], a[24:27], v[104:107]
  v_mul_f32 v98, 0x3e0293ee, v98
  v_mul_f32 v99, 0x3e0293ee, v99
  v_mfma_f32_16x16x32_bf16 v[108:111], v[240:243], a[12:15], v[108:111]
  s_nop 0
  ds_read_b64_tr_b16 v[240:241], v11 offset:8192
  ds_read_b64_tr_b16 v[242:243], v11 offset:9216
  v_mfma_f32_16x16x32_bf16 v[108:111], v[244:247], a[28:31], v[108:111]
  s_waitcnt lgkmcnt(2)
  ds_read_b64_tr_b16 v[244:245], v11 offset:12288
  ds_read_b64_tr_b16 v[246:247], v11 offset:13312
  v_mfma_f32_16x16x32_bf16 v[112:115], v[224:227], a[0:3], v[112:115]
  v_cvt_pk_bf16_f32 v96, v96, v97
  v_cvt_pk_bf16_f32 v97, v98, v99
  v_mfma_f32_16x16x32_bf16 v[112:115], v[228:231], a[16:19], v[112:115]
  v_accvgpr_write_b32 a152, v96
  v_accvgpr_write_b32 a153, v97
  v_mfma_f32_16x16x32_bf16 v[116:119], v[224:227], a[4:7], v[116:119]
  v_cvt_pk_bf16_f32 v38, v52, v53
  v_cvt_pk_bf16_f32 v39, v54, v55
  v_mfma_f32_16x16x32_bf16 v[116:119], v[228:231], a[20:23], v[116:119]
  v_accvgpr_write_b32 a160, v36
  v_accvgpr_write_b32 a161, v37
  v_mfma_f32_16x16x32_bf16 v[120:123], v[224:227], a[8:11], v[120:123]
  v_mul_f32 v112, 0x3e0293ee, v112
  v_mul_f32 v113, 0x3e0293ee, v113
  v_mfma_f32_16x16x32_bf16 v[120:123], v[228:231], a[24:27], v[120:123]
  v_mul_f32 v114, 0x3e0293ee, v114
  v_mul_f32 v115, 0x3e0293ee, v115
  v_mfma_f32_16x16x32_bf16 v[124:127], v[224:227], a[12:15], v[124:127]
  s_nop 0
  ds_read_b64_tr_b16 v[224:225], v8 offset:24576
  ds_read_b64_tr_b16 v[226:227], v8 offset:25600
  v_mfma_f32_16x16x32_bf16 v[124:127], v[228:231], a[28:31], v[124:127]
  s_nop 0
  ds_read_b64_tr_b16 v[228:229], v8 offset:28672
  ds_read_b64_tr_b16 v[230:231], v8 offset:29696
  v_mfma_f32_16x16x32_bf16 v[128:131], v[232:235], a[0:3], v[128:131]
  v_cvt_pk_bf16_f32 v98, v112, v113
  v_cvt_pk_bf16_f32 v99, v114, v115
  v_mfma_f32_16x16x32_bf16 v[128:131], v[236:239], a[16:19], v[128:131]
  v_accvgpr_write_b32 a154, v98
  v_accvgpr_write_b32 a155, v99
  v_mfma_f32_16x16x32_bf16 v[132:135], v[232:235], a[4:7], v[132:135]
  v_accvgpr_write_b32 a162, v38
  v_accvgpr_write_b32 a163, v39
  v_mfma_f32_16x16x32_bf16 v[132:135], v[236:239], a[20:23], v[132:135]
  v_mul_f32 v68, 0x3e0293ee, v68
  v_mul_f32 v69, 0x3e0293ee, v69
  v_mfma_f32_16x16x32_bf16 v[136:139], v[232:235], a[8:11], v[136:139]
  v_mul_f32 v128, 0x3e0293ee, v128
  v_mul_f32 v129, 0x3e0293ee, v129
  v_mfma_f32_16x16x32_bf16 v[136:139], v[236:239], a[24:27], v[136:139]
  v_mul_f32 v130, 0x3e0293ee, v130
  v_mul_f32 v131, 0x3e0293ee, v131
  v_mfma_f32_16x16x32_bf16 v[140:143], v[232:235], a[12:15], v[140:143]
  s_nop 0
  ds_read_b64_tr_b16 v[232:233], v9 offset:24576
  ds_read_b64_tr_b16 v[234:235], v9 offset:25600
  v_mfma_f32_16x16x32_bf16 v[140:143], v[236:239], a[28:31], v[140:143]
  s_waitcnt lgkmcnt(2)
  ds_read_b64_tr_b16 v[236:237], v9 offset:28672
  ds_read_b64_tr_b16 v[238:239], v9 offset:29696
  v_mfma_f32_16x16x32_bf16 v[144:147], v[240:243], a[0:3], v[144:147]
  v_cvt_pk_bf16_f32 v128, v128, v129
  v_cvt_pk_bf16_f32 v129, v130, v131
  v_mfma_f32_16x16x32_bf16 v[144:147], v[244:247], a[16:19], v[144:147]
  v_accvgpr_write_b32 a156, v128
  v_accvgpr_write_b32 a157, v129
  v_mfma_f32_16x16x32_bf16 v[148:151], v[240:243], a[4:7], v[148:151]
  v_mul_f32 v70, 0x3e0293ee, v70
  v_mul_f32 v71, 0x3e0293ee, v71
  v_mfma_f32_16x16x32_bf16 v[148:151], v[244:247], a[20:23], v[148:151]
  v_cvt_pk_bf16_f32 v68, v68, v69
  v_mul_f32 v84, 0x3e0293ee, v84
  v_mfma_f32_16x16x32_bf16 v[152:155], v[240:243], a[8:11], v[152:155]
  v_mul_f32 v144, 0x3e0293ee, v144
  v_mul_f32 v145, 0x3e0293ee, v145
  v_mfma_f32_16x16x32_bf16 v[152:155], v[244:247], a[24:27], v[152:155]
  v_mul_f32 v146, 0x3e0293ee, v146
  v_mul_f32 v147, 0x3e0293ee, v147
  v_mfma_f32_16x16x32_bf16 v[156:159], v[240:243], a[12:15], v[156:159]
  s_nop 0
  ds_read_b64_tr_b16 v[240:241], v10 offset:24576
  ds_read_b64_tr_b16 v[242:243], v10 offset:25600
  v_mfma_f32_16x16x32_bf16 v[156:159], v[244:247], a[28:31], v[156:159]
  s_nop 0
  ds_read_b64_tr_b16 v[244:245], v10 offset:28672
  ds_read_b64_tr_b16 v[246:247], v10 offset:29696
  v_mfma_f32_16x16x32_bf16 v[160:163], v[224:227], a[32:35], v[160:163]
  v_cvt_pk_bf16_f32 v130, v144, v145
  v_cvt_pk_bf16_f32 v131, v146, v147
  v_mfma_f32_16x16x32_bf16 v[160:163], v[228:231], a[48:51], v[160:163]
  v_accvgpr_write_b32 a158, v130
  v_accvgpr_write_b32 a159, v131
  v_mfma_f32_16x16x32_bf16 v[164:167], v[224:227], a[36:39], v[164:167]
  v_mul_f32 v85, 0x3e0293ee, v85
  v_mul_f32 v86, 0x3e0293ee, v86
  v_mfma_f32_16x16x32_bf16 v[164:167], v[228:231], a[52:55], v[164:167]
  v_mul_f32 v87, 0x3e0293ee, v87
  v_cvt_pk_bf16_f32 v69, v70, v71
  v_mfma_f32_16x16x32_bf16 v[168:171], v[224:227], a[40:43], v[168:171]
  v_cvt_pk_bf16_f32 v70, v84, v85
  v_cvt_pk_bf16_f32 v71, v86, v87
  v_mfma_f32_16x16x32_bf16 v[168:171], v[228:231], a[56:59], v[168:171]
  v_accvgpr_write_b32 a164, v68
  v_accvgpr_write_b32 a165, v69
  v_mfma_f32_16x16x32_bf16 v[172:175], v[224:227], a[44:47], v[172:175]
  s_nop 0
  ds_read_b64_tr_b16 v[224:225], v11 offset:24576
  ds_read_b64_tr_b16 v[226:227], v11 offset:25600
  v_mfma_f32_16x16x32_bf16 v[172:175], v[228:231], a[60:63], v[172:175]
  s_waitcnt lgkmcnt(2)
  ds_read_b64_tr_b16 v[228:229], v11 offset:28672
  ds_read_b64_tr_b16 v[230:231], v11 offset:29696
  v_mfma_f32_16x16x32_bf16 v[176:179], v[232:235], a[32:35], v[176:179]
  v_accvgpr_write_b32 a166, v70
  v_accvgpr_write_b32 a167, v71
  v_mfma_f32_16x16x32_bf16 v[176:179], v[236:239], a[48:51], v[176:179]
  v_mul_f32 v100, 0x3e0293ee, v100
  v_mul_f32 v101, 0x3e0293ee, v101
  v_mfma_f32_16x16x32_bf16 v[180:183], v[232:235], a[36:39], v[180:183]
  v_mul_f32 v102, 0x3e0293ee, v102
  v_mul_f32 v103, 0x3e0293ee, v103
  v_mfma_f32_16x16x32_bf16 v[180:183], v[236:239], a[52:55], v[180:183]
  v_cvt_pk_bf16_f32 v100, v100, v101
  v_mul_f32 v116, 0x3e0293ee, v116
  v_mfma_f32_16x16x32_bf16 v[184:187], v[232:235], a[40:43], v[184:187]
  v_mul_f32 v117, 0x3e0293ee, v117
  v_mul_f32 v118, 0x3e0293ee, v118
  v_mfma_f32_16x16x32_bf16 v[184:187], v[236:239], a[56:59], v[184:187]
  v_mul_f32 v119, 0x3e0293ee, v119
  v_cvt_pk_bf16_f32 v101, v102, v103
  v_mfma_f32_16x16x32_bf16 v[188:191], v[232:235], a[44:47], v[188:191]
  s_nop 0
  ds_read_b64_tr_b16 v[232:233], v6 offset:49152
  ds_read_b64_tr_b16 v[234:235], v6 offset:50176
  v_mfma_f32_16x16x32_bf16 v[188:191], v[236:239], a[60:63], v[188:191]
  s_nop 0
  ds_read_b64_tr_b16 v[236:237], v6 offset:53248
  ds_read_b64_tr_b16 v[238:239], v6 offset:54272
  v_mfma_f32_16x16x32_bf16 v[192:195], v[240:243], a[32:35], v[192:195]
  v_cvt_pk_bf16_f32 v102, v116, v117
  v_cvt_pk_bf16_f32 v103, v118, v119
  v_mfma_f32_16x16x32_bf16 v[192:195], v[244:247], a[48:51], v[192:195]
  v_accvgpr_write_b32 a168, v100
  v_accvgpr_write_b32 a169, v101
  v_mfma_f32_16x16x32_bf16 v[196:199], v[240:243], a[36:39], v[196:199]
  v_accvgpr_write_b32 a170, v102
  v_accvgpr_write_b32 a171, v103
  v_mfma_f32_16x16x32_bf16 v[196:199], v[244:247], a[52:55], v[196:199]
  v_mul_f32 v132, 0x3e0293ee, v132
  v_mul_f32 v133, 0x3e0293ee, v133
  v_mfma_f32_16x16x32_bf16 v[200:203], v[240:243], a[40:43], v[200:203]
  v_mul_f32 v134, 0x3e0293ee, v134
  v_mul_f32 v135, 0x3e0293ee, v135
  v_mfma_f32_16x16x32_bf16 v[200:203], v[244:247], a[56:59], v[200:203]
  v_cvt_pk_bf16_f32 v132, v132, v133
  v_mul_f32 v148, 0x3e0293ee, v148
  v_mfma_f32_16x16x32_bf16 v[204:207], v[240:243], a[44:47], v[204:207]
  s_nop 0
  ds_read_b64_tr_b16 v[240:241], v7 offset:49152
  ds_read_b64_tr_b16 v[242:243], v7 offset:50176
  v_mfma_f32_16x16x32_bf16 v[204:207], v[244:247], a[60:63], v[204:207]
  s_waitcnt lgkmcnt(2)
  ds_read_b64_tr_b16 v[244:245], v7 offset:53248
  ds_read_b64_tr_b16 v[246:247], v7 offset:54272
  v_mfma_f32_16x16x32_bf16 v[208:211], v[224:227], a[32:35], v[208:211]
  v_mul_f32 v149, 0x3e0293ee, v149
  v_mul_f32 v150, 0x3e0293ee, v150
  v_mfma_f32_16x16x32_bf16 v[208:211], v[228:231], a[48:51], v[208:211]
  v_mul_f32 v151, 0x3e0293ee, v151
  v_cvt_pk_bf16_f32 v133, v134, v135
  v_mfma_f32_16x16x32_bf16 v[212:215], v[224:227], a[36:39], v[212:215]
  v_cvt_pk_bf16_f32 v134, v148, v149
  v_cvt_pk_bf16_f32 v135, v150, v151
  v_mfma_f32_16x16x32_bf16 v[212:215], v[228:231], a[52:55], v[212:215]
  v_mul_f32 v40, 0x3e0293ee, v40
  v_mul_f32 v41, 0x3e0293ee, v41
  v_mfma_f32_16x16x32_bf16 v[216:219], v[224:227], a[40:43], v[216:219]
  v_accvgpr_write_b32 a172, v132
  v_accvgpr_write_b32 a173, v133
  v_mfma_f32_16x16x32_bf16 v[216:219], v[228:231], a[56:59], v[216:219]
  v_accvgpr_write_b32 a174, v134
  v_accvgpr_write_b32 a175, v135
  v_mfma_f32_16x16x32_bf16 v[220:223], v[224:227], a[44:47], v[220:223]
  s_nop 0
  ds_read_b64_tr_b16 v[224:225], v2 offset:49152
  ds_read_b64_tr_b16 v[226:227], v2 offset:50176
  v_mfma_f32_16x16x32_bf16 v[220:223], v[228:231], a[60:63], v[220:223]
  s_nop 0
  ds_read_b64_tr_b16 v[228:229], v2 offset:53248
  ds_read_b64_tr_b16 v[230:231], v2 offset:54272
  v_mfma_f32_16x16x32_bf16 v[160:163], v[232:235], a[96:99], v[160:163]
  v_mul_f32 v42, 0x3e0293ee, v42
  v_mul_f32 v43, 0x3e0293ee, v43
  v_mfma_f32_16x16x32_bf16 v[160:163], v[236:239], a[112:115], v[160:163]
  v_cvt_pk_bf16_f32 v40, v40, v41
  v_mul_f32 v56, 0x3e0293ee, v56
  v_mfma_f32_16x16x32_bf16 v[164:167], v[232:235], a[100:103], v[164:167]
  v_mul_f32 v57, 0x3e0293ee, v57
  v_mul_f32 v58, 0x3e0293ee, v58
  v_mfma_f32_16x16x32_bf16 v[164:167], v[236:239], a[116:119], v[164:167]
  v_mul_f32 v59, 0x3e0293ee, v59
  v_cvt_pk_bf16_f32 v41, v42, v43
  v_mfma_f32_16x16x32_bf16 v[168:171], v[232:235], a[104:107], v[168:171]
  v_cvt_pk_bf16_f32 v42, v56, v57
  v_cvt_pk_bf16_f32 v43, v58, v59
  v_mfma_f32_16x16x32_bf16 v[168:171], v[236:239], a[120:123], v[168:171]
  v_accvgpr_write_b32 a176, v40
  v_accvgpr_write_b32 a177, v41
  v_mfma_f32_16x16x32_bf16 v[172:175], v[232:235], a[108:111], v[172:175]
  s_nop 0
  ds_read_b64_tr_b16 v[232:233], v3 offset:49152
  ds_read_b64_tr_b16 v[234:235], v3 offset:50176
  v_mfma_f32_16x16x32_bf16 v[172:175], v[236:239], a[124:127], v[172:175]
  s_nop 0
  ds_read_b64_tr_b16 v[236:237], v3 offset:53248
  ds_read_b64_tr_b16 v[238:239], v3 offset:54272
  s_waitcnt vmcnt(0)
  v_readfirstlane_b32 s43, v30
  s_nop 3
  s_cmp_ge_u32 s43, 8
  s_cbranch_scc1 L_pd_B
  v_mov_b32 v31, 0
  s_mov_b32 s45, 0x30d40
L_poll_B:
  buffer_load_dword v30, v31, s[28:31], s53 offen sc1
  s_waitcnt vmcnt(0)
  v_readfirstlane_b32 s43, v30
  s_nop 3
  s_cmp_ge_u32 s43, 8
  s_cbranch_scc1 L_pd_B
  s_sleep 6
  s_sub_u32 s45, s45, 1
  s_cmp_lg_u32 s45, 0
  s_cbranch_scc1 L_poll_B
L_pd_B:
  s_waitcnt lgkmcnt(10)
  v_mfma_f32_16x16x32_bf16 v[176:179], v[240:243], a[96:99], v[176:179]
  s_waitcnt lgkmcnt(4)
  buffer_load_dwordx4 v1, s[28:31], s48 offen sc1 lds
  v_mfma_f32_16x16x32_bf16 v[176:179], v[244:247], a[112:115], v[176:179]
  v_accvgpr_write_b32 a178, v42
  v_accvgpr_write_b32 a179, v43
  v_mfma_f32_16x16x32_bf16 v[180:183], v[240:243], a[100:103], v[180:183]
  v_mul_f32 v72, 0x3e0293ee, v72
  v_mul_f32 v73, 0x3e0293ee, v73
  v_mfma_f32_16x16x32_bf16 v[180:183], v[244:247], a[116:119], v[180:183]
  buffer_load_dwordx4 v1, s[28:31], s48 offen offset:1024 sc1 lds
  v_mfma_f32_16x16x32_bf16 v[184:187], v[240:243], a[104:107], v[184:187]
  v_mul_f32 v74, 0x3e0293ee, v74
  v_mul_f32 v75, 0x3e0293ee, v75
  v_mfma_f32_16x16x32_bf16 v[184:187], v[244:247], a[120:123], v[184:187]
  v_cvt_pk_bf16_f32 v72, v72, v73
  v_mul_f32 v88, 0x3e0293ee, v88
  v_mfma_f32_16x16x32_bf16 v[188:191], v[240:243], a[108:111], v[188:191]
  buffer_load_dwordx4 v1, s[28:31], s48 offen offset:2048 sc1 lds
  v_mfma_f32_16x16x32_bf16 v[188:191], v[244:247], a[124:127], v[188:191]
  s_nop 0
  ds_read_b64_tr_b16 v[240:241], v8 offset:16384
  ds_read_b64_tr_b16 v[242:243], v8 offset:17408
  v_mfma_f32_16x16x32_bf16 v[192:195], v[224:227], a[96:99], v[192:195]
  s_nop 0
  ds_read_b64_tr_b16 v[244:245], v8 offset:20480
  ds_read_b64_tr_b16 v[246:247], v8 offset:21504
  v_mfma_f32_16x16x32_bf16 v[192:195], v[228:231], a[112:115], v[192:195]
  buffer_load_dwordx4 v1, s[28:31], s48 offen offset:3072 sc1 lds
  v_mfma_f32_16x16x32_bf16 v[196:199], v[224:227], a[100:103], v[196:199]
  s_add_u32 m0, s57, 0x8000
  v_mul_f32 v89, 0x3e0293ee, v89
  v_mul_f32 v90, 0x3e0293ee, v90
  v_mfma_f32_16x16x32_bf16 v[196:199], v[228:231], a[116:119], v[196:199]
  s_add_u32 s57, s48, 0x4000
  v_mul_f32 v91, 0x3e0293ee, v91
  v_cvt_pk_bf16_f32 v73, v74, v75
  v_mfma_f32_16x16x32_bf16 v[200:203], v[224:227], a[104:107], v[200:203]
  v_cvt_pk_bf16_f32 v74, v88, v89
  v_cvt_pk_bf16_f32 v75, v90, v91
  v_mfma_f32_16x16x32_bf16 v[200:203], v[228:231], a[120:123], v[200:203]
  v_accvgpr_write_b32 a180, v72
  v_accvgpr_write_b32 a181, v73
  v_mfma_f32_16x16x32_bf16 v[204:207], v[224:227], a[108:111], v[204:207]
  s_nop 0
  ds_read_b64_tr_b16 v[224:225], v9 offset:16384
  ds_read_b64_tr_b16 v[226:227], v9 offset:17408
  v_mfma_f32_16x16x32_bf16 v[204:207], v[228:231], a[124:127], v[204:207]
  s_waitcnt lgkmcnt(2)
  ds_read_b64_tr_b16 v[228:229], v9 offset:20480
  ds_read_b64_tr_b16 v[230:231], v9 offset:21504
  v_mfma_f32_16x16x32_bf16 v[208:211], v[232:235], a[96:99], v[208:211]
  v_accvgpr_write_b32 a182, v74
  v_accvgpr_write_b32 a183, v75
  v_mfma_f32_16x16x32_bf16 v[208:211], v[236:239], a[112:115], v[208:211]
  v_mul_f32 v104, 0x3e0293ee, v104
  v_mul_f32 v105, 0x3e0293ee, v105
  v_mfma_f32_16x16x32_bf16 v[212:215], v[232:235], a[100:103], v[212:215]
  v_mul_f32 v106, 0x3e0293ee, v106
  v_mul_f32 v107, 0x3e0293ee, v107
  v_mfma_f32_16x16x32_bf16 v[212:215], v[236:239], a[116:119], v[212:215]
  v_cvt_pk_bf16_f32 v104, v104, v105
  v_mul_f32 v120, 0x3e0293ee, v120
  v_mfma_f32_16x16x32_bf16 v[216:219], v[232:235], a[104:107], v[216:219]
  v_mul_f32 v121, 0x3e0293ee, v121
  v_mul_f32 v122, 0x3e0293ee, v122
  v_mfma_f32_16x16x32_bf16 v[216:219], v[236:239], a[120:123], v[216:219]
  v_mul_f32 v123, 0x3e0293ee, v123
  v_cvt_pk_bf16_f32 v105, v106, v107
  v_mfma_f32_16x16x32_bf16 v[220:223], v[232:235], a[108:111], v[220:223]
  s_nop 0
  ds_read_b64_tr_b16 v[232:233], v10 offset:16384
  ds_read_b64_tr_b16 v[234:235], v10 offset:17408
  v_mfma_f32_16x16x32_bf16 v[220:223], v[236:239], a[124:127], v[220:223]
  s_nop 0
  ds_read_b64_tr_b16 v[236:237], v10 offset:20480
  ds_read_b64_tr_b16 v[238:239], v10 offset:21504
  v_mfma_f32_16x16x32_bf16 v[160:163], v[240:243], a[0:3], v[160:163]
  v_cvt_pk_bf16_f32 v106, v120, v121
  v_cvt_pk_bf16_f32 v107, v122, v123
  v_mfma_f32_16x16x32_bf16 v[160:163], v[244:247], a[16:19], v[160:163]
  v_accvgpr_write_b32 a184, v104
  v_accvgpr_write_b32 a185, v105
  v_mfma_f32_16x16x32_bf16 v[164:167], v[240:243], a[4:7], v[164:167]
  v_accvgpr_write_b32 a186, v106
  v_accvgpr_write_b32 a187, v107
  v_mfma_f32_16x16x32_bf16 v[164:167], v[244:247], a[20:23], v[164:167]
  v_mul_f32 v136, 0x3e0293ee, v136
  v_mul_f32 v137, 0x3e0293ee, v137
  v_mfma_f32_16x16x32_bf16 v[168:171], v[240:243], a[8:11], v[168:171]
  v_mul_f32 v138, 0x3e0293ee, v138
  v_mul_f32 v139, 0x3e0293ee, v139
  v_mfma_f32_16x16x32_bf16 v[168:171], v[244:247], a[24:27], v[168:171]
  v_cvt_pk_bf16_f32 v136, v136, v137
  v_mul_f32 v152, 0x3e0293ee, v152
  v_mfma_f32_16x16x32_bf16 v[172:175], v[240:243], a[12:15], v[172:175]
  s_nop 0
  ds_read_b64_tr_b16 v[240:241], v11 offset:16384
  ds_read_b64_tr_b16 v[242:243], v11 offset:17408
  v_mfma_f32_16x16x32_bf16 v[172:175], v[244:247], a[28:31], v[172:175]
  s_waitcnt lgkmcnt(2)
  ds_read_b64_tr_b16 v[244:245], v11 offset:20480
  ds_read_b64_tr_b16 v[246:247], v11 offset:21504
  v_mfma_f32_16x16x32_bf16 v[176:179], v[224:227], a[0:3], v[176:179]
  v_mul_f32 v153, 0x3e0293ee, v153
  v_mul_f32 v154, 0x3e0293ee, v154
  v_mfma_f32_16x16x32_bf16 v[176:179], v[228:231], a[16:19], v[176:179]
  v_mul_f32 v155, 0x3e0293ee, v155
  v_cvt_pk_bf16_f32 v137, v138, v139
  v_mfma_f32_16x16x32_bf16 v[180:183], v[224:227], a[4:7], v[180:183]
  v_cvt_pk_bf16_f32 v138, v152, v153
  v_cvt_pk_bf16_f32 v139, v154, v155
  v_mfma_f32_16x16x32_bf16 v[180:183], v[228:231], a[20:23], v[180:183]
  v_mul_f32 v44, 0x3e0293ee, v44
  v_mul_f32 v45, 0x3e0293ee, v45
  v_mfma_f32_16x16x32_bf16 v[184:187], v[224:227], a[8:11], v[184:187]
  v_accvgpr_write_b32 a188, v136
  v_accvgpr_write_b32 a189, v137
  v_mfma_f32_16x16x32_bf16 v[184:187], v[228:231], a[24:27], v[184:187]
  v_accvgpr_write_b32 a190, v138
  v_accvgpr_write_b32 a191, v139
  v_mfma_f32_16x16x32_bf16 v[188:191], v[224:227], a[12:15], v[188:191]
  v_mul_f32 v46, 0x3e0293ee, v46
  v_mul_f32 v47, 0x3e0293ee, v47
  v_mfma_f32_16x16x32_bf16 v[188:191], v[228:231], a[28:31], v[188:191]
  v_cvt_pk_bf16_f32 v44, v44, v45
  v_mul_f32 v60, 0x3e0293ee, v60
  v_mfma_f32_16x16x32_bf16 v[192:195], v[232:235], a[0:3], v[192:195]
  v_mul_f32 v61, 0x3e0293ee, v61
  v_mul_f32 v62, 0x3e0293ee, v62
  v_mfma_f32_16x16x32_bf16 v[192:195], v[236:239], a[16:19], v[192:195]
  v_mul_f32 v63, 0x3e0293ee, v63
  v_cvt_pk_bf16_f32 v45, v46, v47
  v_mfma_f32_16x16x32_bf16 v[196:199], v[232:235], a[4:7], v[196:199]
  v_cvt_pk_bf16_f32 v46, v60, v61
  v_cvt_pk_bf16_f32 v47, v62, v63
  v_mfma_f32_16x16x32_bf16 v[196:199], v[236:239], a[20:23], v[196:199]
  v_accvgpr_write_b32 a192, v44
  v_accvgpr_write_b32 a193, v45
  v_mfma_f32_16x16x32_bf16 v[200:203], v[232:235], a[8:11], v[200:203]
  v_accvgpr_write_b32 a194, v46
  v_accvgpr_write_b32 a195, v47
  v_mfma_f32_16x16x32_bf16 v[200:203], v[236:239], a[24:27], v[200:203]
  v_mul_f32 v76, 0x3e0293ee, v76
  v_mul_f32 v77, 0x3e0293ee, v77
  v_mfma_f32_16x16x32_bf16 v[204:207], v[232:235], a[12:15], v[204:207]
  v_mul_f32 v78, 0x3e0293ee, v78
  v_mul_f32 v79, 0x3e0293ee, v79
  v_mfma_f32_16x16x32_bf16 v[204:207], v[236:239], a[28:31], v[204:207]
  v_cvt_pk_bf16_f32 v76, v76, v77
  v_mul_f32 v92, 0x3e0293ee, v92
  s_waitcnt vmcnt(0) lgkmcnt(0)
  s_barrier
  v_mfma_f32_16x16x32_bf16 v[208:211], v[240:243], a[0:3], v[208:211]
  s_nop 0
  ds_read_b128 a[208:211], v252
  ds_read_b128 a[212:215], v252 offset:1024
  v_mfma_f32_16x16x32_bf16 v[208:211], v[244:247], a[16:19], v[208:211]
  s_nop 0
  ds_read_b128 a[216:219], v252 offset:2048
  ds_read_b128 a[220:223], v252 offset:3072
  v_mfma_f32_16x16x32_bf16 v[212:215], v[240:243], a[4:7], v[212:215]
  ds_read_b128 a[224:227], v252 offset:4096
  v_mul_f32 v93, 0x3e0293ee, v93
  v_mfma_f32_16x16x32_bf16 v[212:215], v[244:247], a[20:23], v[212:215]
  ds_read_b128 a[228:231], v252 offset:5120
  v_mul_f32 v94, 0x3e0293ee, v94
  v_mfma_f32_16x16x32_bf16 v[216:219], v[240:243], a[8:11], v[216:219]
  buffer_load_dwordx4 v1, s[28:31], s57 offen sc1 lds
  v_mfma_f32_16x16x32_bf16 v[216:219], v[244:247], a[24:27], v[216:219]
  v_mul_f32 v95, 0x3e0293ee, v95
  v_cvt_pk_bf16_f32 v77, v78, v79
  v_mfma_f32_16x16x32_bf16 v[220:223], v[240:243], a[12:15], v[220:223]
  v_cvt_pk_bf16_f32 v78, v92, v93
  v_cvt_pk_bf16_f32 v79, v94, v95
  v_mfma_f32_16x16x32_bf16 v[220:223], v[244:247], a[28:31], v[220:223]
  s_waitcnt lgkmcnt(4)
  ds_read_b128 a[232:235], v252 offset:6144
  v_accvgpr_write_b32 a196, v76
  v_mfma_f32_16x16x32_bf16 v[16:19], a[208:211], a[144:147], 0
  v_accvgpr_write_b32 a197, v77
  v_accvgpr_write_b32 a198, v78
  v_mfma_f32_16x16x32_bf16 v[16:19], a[212:215], a[148:151], v[16:19]
  s_waitcnt lgkmcnt(2)
  v_accvgpr_write_b32 a199, v79
  v_mul_f32 v108, 0x3e0293ee, v108
  v_mfma_f32_16x16x32_bf16 v[16:19], a[216:219], a[152:155], v[16:19]
  buffer_load_dwordx4 v1, s[28:31], s57 offen offset:1024 sc1 lds
  v_mfma_f32_16x16x32_bf16 v[16:19], a[220:223], a[156:159], v[16:19]
  v_mul_f32 v109, 0x3e0293ee, v109
  v_mul_f32 v110, 0x3e0293ee, v110
  v_mfma_f32_16x16x32_bf16 v[20:23], a[208:211], a[160:163], 0
  v_mul_f32 v111, 0x3e0293ee, v111
  v_cvt_pk_bf16_f32 v108, v108, v109
  v_mfma_f32_16x16x32_bf16 v[20:23], a[212:215], a[164:167], v[20:23]
  v_mul_f32 v124, 0x3e0293ee, v124
  v_mul_f32 v125, 0x3e0293ee, v125
  v_mfma_f32_16x16x32_bf16 v[20:23], a[216:219], a[168:171], v[20:23]
  v_mul_f32 v126, 0x3e0293ee, v126
  v_mul_f32 v127, 0x3e0293ee, v127
  v_mfma_f32_16x16x32_bf16 v[20:23], a[220:223], a[172:175], v[20:23]
  v_cvt_pk_bf16_f32 v109, v110, v111
  v_cvt_pk_bf16_f32 v110, v124, v125
  v_mfma_f32_16x16x32_bf16 v[24:27], a[208:211], a[176:179], 0
  buffer_load_dwordx4 v1, s[28:31], s57 offen offset:2048 sc1 lds
  v_mfma_f32_16x16x32_bf16 v[24:27], a[212:215], a[180:183], v[24:27]
  v_cvt_pk_bf16_f32 v111, v126, v127
  v_accvgpr_write_b32 a200, v108
  v_mfma_f32_16x16x32_bf16 v[24:27], a[216:219], a[184:187], v[24:27]
  ds_read_b128 a[236:239], v252 offset:7168
  v_accvgpr_write_b32 a201, v109
  v_mfma_f32_16x16x32_bf16 v[24:27], a[220:223], a[188:191], v[24:27]
  v_accvgpr_write_b32 a202, v110
  v_accvgpr_write_b32 a203, v111
  v_mfma_f32_16x16x32_bf16 v[28:31], a[208:211], a[192:195], 0
  v_mul_f32 v140, 0x3e0293ee, v140
  v_mul_f32 v141, 0x3e0293ee, v141
  v_mfma_f32_16x16x32_bf16 v[28:31], a[212:215], a[196:199], v[28:31]
  v_mul_f32 v142, 0x3e0293ee, v142
  v_mul_f32 v143, 0x3e0293ee, v143
  v_mfma_f32_16x16x32_bf16 v[28:31], a[216:219], a[200:203], v[28:31]
  v_cvt_pk_bf16_f32 v140, v140, v141
  v_mul_f32 v156, 0x3e0293ee, v156
  v_accvgpr_write_b32 a204, v140
  v_cvt_pk_bf16_f32 v141, v142, v143
  v_accvgpr_write_b32 a205, v141
  v_mul_f32 v157, 0x3e0293ee, v157
  v_cvt_pk_bf16_f32 v142, v156, v157
  v_accvgpr_write_b32 a206, v142
  v_mul_f32 v158, 0x3e0293ee, v158
  v_mul_f32 v159, 0x3e0293ee, v159
  v_cvt_pk_bf16_f32 v143, v158, v159
  v_accvgpr_write_b32 a207, v143
  s_nop 1
  v_mfma_f32_16x16x32_bf16 v[28:31], a[220:223], a[204:207], v[28:31]
  v_mov_b32 v240, 0
  v_mov_b32 v241, 0
  v_mov_b32 v242, 0
  v_mov_b32 v243, 0
  s_nop 1
  v_mfma_f32_32x32x16_bf16 a[0:15], v[240:243], v[240:243], 0
  buffer_load_dwordx4 v1, s[28:31], s57 offen offset:3072 sc1 lds
  v_max3_f32 v232, v16, v17, v18
  v_max_f32 v232, v232, v19
  v_mov_b32 v236, v232
  v_cvt_pk_bf16_f32 v192, v192, v193
  v_mfma_f32_32x32x16_bf16 a[16:31], v[240:243], v[240:243], 0
  s_add_u32 m0, s58, 0x4000
  v_permlane16_swap_b32 v232, v236
  v_max_f32 v232, v232, v236
  v_mov_b32 v236, v232
  v_cvt_pk_bf16_f32 v193, v194, v195
  v_cvt_pk_bf16_f32 v194, v208, v209
  v_permlane32_swap_b32 v232, v236
  v_mfma_f32_32x32x16_bf16 a[32:47], v[240:243], v[240:243], 0
  s_add_u32 s58, s48, 0x8000
  v_cvt_pk_bf16_f32 v195, v210, v211
  v_max_f32 v232, v232, v236
  v_sub_f32 v208, 0, v232
  v_sub_f32 v209, 0, v232
  v_sub_f32 v210, 0, v232
  v_sub_f32 v211, 0, v232
  v_mfma_f32_32x32x16_bf16 a[48:63], v[240:243], v[240:243], 0
  s_add_u32 s48, s47, 0x4000
  v_max3_f32 v233, v20, v21, v22
  v_max_f32 v233, v233, v23
  v_mov_b32 v237, v233
  v_cvt_pk_bf16_f32 v196, v196, v197
  v_cvt_pk_bf16_f32 v197, v198, v199
  v_permlane16_swap_b32 v233, v237
  v_mfma_f32_32x32x16_bf16 a[64:79], v[240:243], v[240:243], 0
  buffer_load_dwordx4 v1, s[28:31], s58 offen sc1 lds
  v_max_f32 v233, v233, v237
  v_mov_b32 v237, v233
  v_cvt_pk_bf16_f32 v198, v212, v213
  v_cvt_pk_bf16_f32 v199, v214, v215
  v_mfma_f32_32x32x16_bf16 a[80:95], v[240:243], v[240:243], 0
  v_permlane32_swap_b32 v233, v237
  v_max_f32 v233, v233, v237
  v_sub_f32 v212, 0, v233
  v_sub_f32 v213, 0, v233
  v_sub_f32 v214, 0, v233
  v_sub_f32 v215, 0, v233
  v_mfma_f32_32x32x16_bf16 a[96:111], v[240:243], v[240:243], 0
  v_max3_f32 v234, v24, v25, v26
  v_max_f32 v234, v234, v27
  v_mov_b32 v238, v234
  v_cvt_pk_bf16_f32 v200, v200, v201
  v_cvt_pk_bf16_f32 v201, v202, v203
  v_permlane16_swap_b32 v234, v238
  v_mfma_f32_32x32x16_bf16 a[112:127], v[240:243], v[240:243], 0
  v_max_f32 v234, v234, v238
  v_mov_b32 v238, v234
  v_cvt_pk_bf16_f32 v202, v216, v217
  v_cvt_pk_bf16_f32 v203, v218, v219
  v_permlane32_swap_b32 v234, v238
  v_max_f32 v234, v234, v238
  v_mfma_f32_32x32x16_bf16 a[128:143], v[240:243], v[240:243], 0
  v_sub_f32 v216, 0, v234
  v_sub_f32 v217, 0, v234
  v_sub_f32 v218, 0, v234
  v_sub_f32 v219, 0, v234
  v_max3_f32 v235, v28, v29, v30
  v_max_f32 v235, v235, v31
  v_mfma_f32_16x16x32_bf16 v[32:35], a[224:227], a[144:147], v[208:211]
  s_waitcnt lgkmcnt(0)
  ds_read_b128 a[240:243], v252 offset:8192
  ds_read_b128 a[244:247], v252 offset:9216
  v_mfma_f32_16x16x32_bf16 v[32:35], a[228:231], a[148:151], v[32:35]
  buffer_load_dwordx4 v1, s[28:31], s58 offen offset:1024 sc1 lds
  v_mfma_f32_16x16x32_bf16 v[32:35], a[232:235], a[152:155], v[32:35]
  ds_read_b128 a[248:251], v252 offset:10240
  v_mov_b32 v239, v235
  v_mfma_f32_16x16x32_bf16 v[32:35], a[236:239], a[156:159], v[32:35]
  ds_read_b128 a[252:255], v252 offset:11264
  v_permlane16_swap_b32 v235, v239
  v_mfma_f32_16x16x32_bf16 v[36:39], a[224:227], a[160:163], v[212:215]
  v_max_f32 v235, v235, v239
  v_cvt_pk_bf16_f32 v204, v204, v205
  v_mfma_f32_16x16x32_bf16 v[36:39], a[228:231], a[164:167], v[36:39]
  v_mov_b32 v239, v235
  v_cvt_pk_bf16_f32 v205, v206, v207
  v_mfma_f32_16x16x32_bf16 v[36:39], a[232:235], a[168:171], v[36:39]
  v_permlane32_swap_b32 v235, v239
  v_cvt_pk_bf16_f32 v206, v220, v221
  v_mfma_f32_16x16x32_bf16 v[36:39], a[236:239], a[172:175], v[36:39]
  v_cvt_pk_bf16_f32 v207, v222, v223
  v_max_f32 v235, v235, v239
  v_mfma_f32_16x16x32_bf16 v[40:43], a[224:227], a[176:179], v[216:219]
  buffer_load_dwordx4 v1, s[28:31], s58 offen offset:2048 sc1 lds
  v_mfma_f32_16x16x32_bf16 v[40:43], a[228:231], a[180:183], v[40:43]
  v_sub_f32 v220, 0, v235
  v_sub_f32 v221, 0, v235
  v_mfma_f32_16x16x32_bf16 v[40:43], a[232:235], a[184:187], v[40:43]
  v_sub_f32 v222, 0, v235
  v_sub_f32 v223, 0, v235
  v_mfma_f32_16x16x32_bf16 v[40:43], a[236:239], a[188:191], v[40:43]
  s_nop 0
  ds_read_b128 a[208:211], v252 offset:12288
  ds_read_b128 a[212:215], v252 offset:13312
  v_mfma_f32_16x16x32_bf16 v[44:47], a[224:227], a[192:195], v[220:223]
  s_nop 0
  ds_read_b128 a[216:219], v252 offset:14336
  ds_read_b128 a[220:223], v252 offset:15360
  v_mfma_f32_16x16x32_bf16 v[44:47], a[228:231], a[196:199], v[44:47]
  buffer_load_dwordx4 v1, s[28:31], s58 offen offset:3072 sc1 lds
  v_mfma_f32_16x16x32_bf16 v[44:47], a[232:235], a[200:203], v[44:47]
  v_cvt_pk_bf16_f32 v160, v160, v161
  v_cvt_pk_bf16_f32 v161, v162, v163
  v_mfma_f32_16x16x32_bf16 v[44:47], a[236:239], a[204:207], v[44:47]
  s_waitcnt lgkmcnt(4)
  v_cvt_pk_bf16_f32 v164, v164, v165
  v_cvt_pk_bf16_f32 v162, v176, v177
  v_mfma_f32_16x16x32_bf16 v[48:51], a[240:243], a[144:147], v[208:211]
  v_cvt_pk_bf16_f32 v163, v178, v179
  v_cvt_pk_bf16_f32 v165, v166, v167
  v_mfma_f32_16x16x32_bf16 v[48:51], a[244:247], a[148:151], v[48:51]
  v_cvt_pk_bf16_f32 v168, v168, v169
  v_pk_max_i16 v160, v160, 0
  v_mfma_f32_16x16x32_bf16 v[48:51], a[248:251], a[152:155], v[48:51]
  v_pk_max_i16 v161, v161, 0
  v_pk_max_i16 v162, v162, 0
  v_mfma_f32_16x16x32_bf16 v[48:51], a[252:255], a[156:159], v[48:51]
  v_pk_max_i16 v163, v163, 0
  v_cvt_pk_bf16_f32 v166, v180, v181
  v_mfma_f32_16x16x32_bf16 v[52:55], a[240:243], a[160:163], v[212:215]
  v_cvt_pk_bf16_f32 v167, v182, v183
  v_cvt_pk_bf16_f32 v169, v170, v171
  v_mfma_f32_16x16x32_bf16 v[52:55], a[244:247], a[164:167], v[52:55]
  v_cvt_pk_bf16_f32 v172, v172, v173
  v_pk_max_i16 v164, v164, 0
  v_mfma_f32_16x16x32_bf16 v[52:55], a[248:251], a[168:171], v[52:55]
  buffer_store_dwordx4 v[160:163], v1, s[28:31], s59 offen sc1
  v_mfma_f32_16x16x32_bf16 v[52:55], a[252:255], a[172:175], v[52:55]
  v_pk_max_i16 v165, v165, 0
  v_pk_max_i16 v166, v166, 0
  v_mfma_f32_16x16x32_bf16 v[56:59], a[240:243], a[176:179], v[216:219]
  v_pk_max_i16 v167, v167, 0
  v_cvt_pk_bf16_f32 v170, v184, v185
  v_mfma_f32_16x16x32_bf16 v[56:59], a[244:247], a[180:183], v[56:59]
  v_cvt_pk_bf16_f32 v171, v186, v187
  v_cvt_pk_bf16_f32 v173, v174, v175
  v_mfma_f32_16x16x32_bf16 v[56:59], a[248:251], a[184:187], v[56:59]
  buffer_store_dwordx4 v[164:167], v1, s[28:31], s59 offen offset:1024 sc1
  v_mfma_f32_16x16x32_bf16 v[56:59], a[252:255], a[188:191], v[56:59]
  v_pk_max_i16 v168, v168, 0
  v_pk_max_i16 v169, v169, 0
  v_mfma_f32_16x16x32_bf16 v[60:63], a[240:243], a[192:195], v[220:223]
  v_pk_max_i16 v170, v170, 0
  v_pk_max_i16 v171, v171, 0
  v_mfma_f32_16x16x32_bf16 v[60:63], a[244:247], a[196:199], v[60:63]
  v_cvt_pk_bf16_f32 v174, v188, v189
  v_cvt_pk_bf16_f32 v175, v190, v191
  v_mfma_f32_16x16x32_bf16 v[60:63], a[248:251], a[200:203], v[60:63]
  buffer_store_dwordx4 v[168:171], v1, s[28:31], s59 offen offset:2048 sc1
  v_mfma_f32_16x16x32_bf16 v[60:63], a[252:255], a[204:207], v[60:63]
  s_waitcnt lgkmcnt(0)
  v_pk_max_i16 v172, v172, 0
  v_pk_max_i16 v173, v173, 0
  v_mfma_f32_16x16x32_bf16 v[64:67], a[208:211], a[144:147], v[208:211]
  v_pk_max_i16 v174, v174, 0
  v_pk_max_i16 v175, v175, 0
  v_mfma_f32_16x16x32_bf16 v[64:67], a[212:215], a[148:151], v[64:67]
  buffer_store_dwordx4 v[172:175], v1, s[28:31], s59 offen offset:3072 sc1
  v_mfma_f32_16x16x32_bf16 v[64:67], a[216:219], a[152:155], v[64:67]
  v_pk_max_i16 v192, v192, 0
  v_pk_max_i16 v193, v193, 0
  v_mfma_f32_16x16x32_bf16 v[64:67], a[220:223], a[156:159], v[64:67]
  v_pk_max_i16 v194, v194, 0
  v_pk_max_i16 v195, v195, 0
  v_mfma_f32_16x16x32_bf16 v[68:71], a[208:211], a[160:163], v[212:215]
  buffer_store_dwordx4 v[192:195], v1, s[28:31], s56 offen sc1
  v_mfma_f32_16x16x32_bf16 v[68:71], a[212:215], a[164:167], v[68:71]
  v_pk_max_i16 v196, v196, 0
  v_pk_max_i16 v197, v197, 0
  v_mfma_f32_16x16x32_bf16 v[68:71], a[216:219], a[168:171], v[68:71]
  v_pk_max_i16 v198, v198, 0
  v_pk_max_i16 v199, v199, 0
  v_mfma_f32_16x16x32_bf16 v[68:71], a[220:223], a[172:175], v[68:71]
  buffer_store_dwordx4 v[196:199], v1, s[28:31], s56 offen offset:1024 sc1
  v_mfma_f32_16x16x32_bf16 v[72:75], a[208:211], a[176:179], v[216:219]
  v_pk_max_i16 v200, v200, 0
  v_pk_max_i16 v201, v201, 0
  v_mfma_f32_16x16x32_bf16 v[72:75], a[212:215], a[180:183], v[72:75]
  v_pk_max_i16 v202, v202, 0
  v_pk_max_i16 v203, v203, 0
  v_mfma_f32_16x16x32_bf16 v[72:75], a[216:219], a[184:187], v[72:75]
  buffer_store_dwordx4 v[200:203], v1, s[28:31], s56 offen offset:2048 sc1
  v_mfma_f32_16x16x32_bf16 v[72:75], a[220:223], a[188:191], v[72:75]
  v_pk_max_i16 v204, v204, 0
  v_pk_max_i16 v205, v205, 0
  v_mfma_f32_16x16x32_bf16 v[76:79], a[208:211], a[192:195], v[220:223]
  v_pk_max_i16 v206, v206, 0
  v_pk_max_i16 v207, v207, 0
  v_mfma_f32_16x16x32_bf16 v[76:79], a[212:215], a[196:199], v[76:79]
  buffer_store_dwordx4 v[204:207], v1, s[28:31], s56 offen offset:3072 sc1
  v_mfma_f32_16x16x32_bf16 v[76:79], a[216:219], a[200:203], v[76:79]
  v_lshlrev_b32 v10, 3, v1
  v_sub_f32 v16, v16, v232
  v_mfma_f32_16x16x32_bf16 v[76:79], a[220:223], a[204:207], v[76:79]
  v_sub_f32 v17, v17, v232
  v_sub_f32 v18, v18, v232
  v_mfma_f32_32x32x16_bf16 v[176:191], v[240:243], v[240:243], 0
  v_sub_f32 v19, v19, v232
  v_sub_f32 v20, v20, v233
  v_sub_f32 v21, v21, v233
  v_sub_f32 v22, v22, v233
  v_sub_f32 v23, v23, v233
  v_sub_f32 v24, v24, v234
  v_mfma_f32_32x32x16_bf16 v[192:207], v[240:243], v[240:243], 0
  v_sub_f32 v25, v25, v234
  v_sub_f32 v26, v26, v234
  v_sub_f32 v27, v27, v234
  v_sub_f32 v28, v28, v235
  v_sub_f32 v29, v29, v235
  v_sub_f32 v30, v30, v235
  v_mfma_f32_16x16x32_bf16 a[232:235], v[240:243], v[240:243], 0
  v_sub_f32 v31, v31, v235
  v_mov_b32 v11, 0x40000000
  v_mfma_f32_16x16x32_bf16 a[236:239], v[240:243], v[240:243], 0
  v_cmp_gt_u32 vcc, 2048, v10
  v_mov_b32 v224, 0x3f803f80
  v_mov_b32 v225, 0x3f803f80
  v_cndmask_b32 v11, v11, v10, vcc
  v_mov_b32 v226, 0x3f803f80
  v_mov_b32 v227, 0x3f803f80
  ds_write_b128 v255, v[232:235]
  v_mov_b32 v240, -1
  v_mov_b32 v241, -1
  v_mov_b32 v242, -1
  v_mov_b32 v243, -1
  v_exp_f32 v16, v16
  v_exp_f32 v17, v17
  v_exp_f32 v18, v18
  v_cvt_pk_bf16_f32 v144, v16, v17
  v_exp_f32 v19, v19
  v_exp_f32 v20, v20
  v_cvt_pk_bf16_f32 v145, v18, v19
  v_exp_f32 v21, v21
  v_exp_f32 v22, v22
  v_cvt_pk_bf16_f32 v152, v20, v21
  v_exp_f32 v23, v23
  v_exp_f32 v24, v24
  v_cvt_pk_bf16_f32 v153, v22, v23
  v_exp_f32 v25, v25
  v_exp_f32 v26, v26
  v_cvt_pk_bf16_f32 v160, v24, v25
  v_exp_f32 v27, v27
  v_exp_f32 v28, v28
  v_cvt_pk_bf16_f32 v161, v26, v27
  v_exp_f32 v29, v29
  v_exp_f32 v30, v30
  v_cvt_pk_bf16_f32 v168, v28, v29
  v_exp_f32 v31, v31
  v_exp_f32 v32, v32
  v_cvt_pk_bf16_f32 v169, v30, v31
  v_exp_f32 v33, v33
  v_exp_f32 v34, v34
  v_cvt_pk_bf16_f32 v146, v32, v33
  v_exp_f32 v35, v35
  v_exp_f32 v36, v36
  v_cvt_pk_bf16_f32 v147, v34, v35
  v_exp_f32 v37, v37
  v_exp_f32 v38, v38
  v_cvt_pk_bf16_f32 v154, v36, v37
  v_exp_f32 v39, v39
  v_exp_f32 v40, v40
  v_cvt_pk_bf16_f32 v155, v38, v39
  v_exp_f32 v41, v41
  v_exp_f32 v42, v42
  v_cvt_pk_bf16_f32 v162, v40, v41
  v_exp_f32 v43, v43
  v_exp_f32 v44, v44
  v_cvt_pk_bf16_f32 v163, v42, v43
  v_exp_f32 v45, v45
  v_exp_f32 v46, v46
  v_cvt_pk_bf16_f32 v170, v44, v45
  v_exp_f32 v47, v47
  s_nop 0
  v_cvt_pk_bf16_f32 v171, v46, v47
  s_cmp_lt_u32 s40, 2
  s_cbranch_scc1 L_od1
  s_waitcnt vmcnt(8)
  s_lshl_b32 s43, s42, 1
  s_sub_u32 s43, s43, 3
  s_add_u32 s44, s43, s40
  s_add_u32 s44, s44, s40
  s_sub_u32 s44, s44, 4
  s_sub_u32 s43, s42, 1
  s_mul_i32 s43, s43, s44
  s_sub_u32 s43, s43, 1
  s_lshl_b32 s43, s43, 5
  s_add_u32 s43, s43, s41
  s_mul_i32 s88, s43, 1920
  s_mul_i32 s89, s43, 768
  s_add_u32 s88, s88, 0x40000000
  s_add_u32 s89, s89, 0x40000000
  v_lshlrev_b32 v228, 3, v1
  v_mov_b32 v229, 0x40000000
  s_waitcnt lgkmcnt(0)
  v_cmp_gt_u32 vcc, 1920, v228
  s_nop 1
  v_cndmask_b32 v254, v229, v228, vcc
  v_cmp_gt_u32 vcc, 768, v228
  s_nop 1
  v_cndmask_b32 v255, v229, v228, vcc
  s_cmp_lg_u32 s42, 0
  s_cbranch_scc1 L_on
  s_cmp_eq_u32 s40, 2
  s_cbranch_scc0 L_odn
  v_mov_b32 v48, 0xf149f2ca
  v_mov_b32 v49, 0xf149f2ca
  v_mov_b32 v50, 0xf149f2ca
  v_mov_b32 v51, 0xf149f2ca
  v_mov_b32 v52, 0xf149f2ca
  v_mov_b32 v53, 0xf149f2ca
  v_mov_b32 v54, 0xf149f2ca
  v_mov_b32 v55, 0xf149f2ca
  v_cndmask_b32 v56, v5, v56, s[60:61]
  v_cndmask_b32 v57, v5, v57, s[62:63]
  v_cndmask_b32 v58, v5, v58, s[64:65]
  v_cndmask_b32 v59, v5, v59, s[66:67]
  v_mov_b32 v64, 0xf149f2ca
  v_mov_b32 v65, 0xf149f2ca
  v_mov_b32 v66, 0xf149f2ca
  v_mov_b32 v67, 0xf149f2ca
  v_mov_b32 v68, 0xf149f2ca
  v_mov_b32 v69, 0xf149f2ca
  v_mov_b32 v70, 0xf149f2ca
  v_mov_b32 v71, 0xf149f2ca
  v_mov_b32 v72, 0xf149f2ca
  v_mov_b32 v73, 0xf149f2ca
  v_mov_b32 v74, 0xf149f2ca
  v_mov_b32 v75, 0xf149f2ca
  v_cndmask_b32 v76, v5, v76, s[60:61]
  v_cndmask_b32 v77, v5, v77, s[62:63]
  v_cndmask_b32 v78, v5, v78, s[64:65]
  v_cndmask_b32 v79, v5, v79, s[66:67]
  v_mov_b32 v228, 0xffff
  v_mov_b32 v229, 0xffff0000
  v_cndmask_b32 v236, 0, v228, s[60:61]
  v_cndmask_b32 v238, 0, v229, s[62:63]
  v_or_b32 v236, v236, v238
  v_cndmask_b32 v237, 0, v228, s[64:65]
  v_cndmask_b32 v238, 0, v229, s[66:67]
  v_or_b32 v237, v237, v238
  v_and_b32 v144, v144, v236
  v_mov_b32 v146, 0
  v_and_b32 v154, v154, v236
  v_and_b32 v145, v145, v237
  v_mov_b32 v147, 0
  v_and_b32 v155, v155, v237
  s_branch L_t1_A
L_on:
  s_waitcnt lgkmcnt(0)
  s_barrier
  v_mfma_f32_16x16x32_bf16 a[128:131], v[224:227], v[176:179], a[128:131]
  s_add_u32 s92, s92, 1
  ds_read_b128 a[208:211], v252 offset:16384
  ds_read_b128 a[212:215], v252 offset:17408
  v_mfma_f32_16x16x32_bf16 a[128:131], v[224:227], v[180:183], a[128:131]
  s_nop 0
  ds_read_b128 a[216:219], v252 offset:18432
  ds_read_b128 a[220:223], v252 offset:19456
  v_mfma_f32_16x16x32_bf16 a[132:135], v[224:227], v[184:187], a[132:135]
  s_nop 0
  ds_read_b128 a[224:227], v252 offset:20480
  ds_read_b128 a[228:231], v252 offset:21504
  v_mfma_f32_16x16x32_bf16 a[132:135], v[224:227], v[188:191], a[132:135]
  s_nop 0
  ds_read_b128 a[240:243], v252 offset:24576
  ds_read_b128 a[244:247], v252 offset:25600
  v_mfma_f32_16x16x32_bf16 a[136:139], v[224:227], v[192:195], a[136:139]
  s_nop 0
  ds_read_b128 a[248:251], v252 offset:26624
  ds_read_b128 a[252:255], v252 offset:27648
  v_mfma_f32_16x16x32_bf16 a[136:139], v[224:227], v[196:199], a[136:139]
  v_exp_f32 v48, v48
  v_mfma_f32_16x16x32_bf16 a[140:143], v[224:227], v[200:203], a[140:143]
  v_exp_f32 v49, v49
  v_mfma_f32_16x16x32_bf16 a[140:143], v[224:227], v[204:207], a[140:143]
  v_exp_f32 v50, v50
  v_mfma_f32_16x16x32_bf16 a[112:115], a[232:235], v[176:179], a[112:115]
  v_exp_f32 v51, v51
  v_mfma_f32_16x16x32_bf16 a[112:115], a[236:239], v[180:183], a[112:115]
  v_exp_f32 v64, v64
  v_mfma_f32_16x16x32_bf16 a[116:119], a[232:235], v[184:187], a[116:119]
  v_exp_f32 v65, v65
  v_mfma_f32_16x16x32_bf16 a[116:119], a[236:239], v[188:191], a[116:119]
  v_exp_f32 v66, v66
  v_mfma_f32_16x16x32_bf16 a[120:123], a[232:235], v[192:195], a[120:123]
  v_exp_f32 v67, v67
  v_mfma_f32_16x16x32_bf16 a[120:123], a[236:239], v[196:199], a[120:123]
  v_cvt_pk_bf16_f32 v148, v48, v49
  v_cvt_pk_bf16_f32 v149, v50, v51
  v_mfma_f32_16x16x32_bf16 a[124:127], a[232:235], v[200:203], a[124:127]
  ds_read_b128 a[232:235], v252 offset:22528
  v_cvt_pk_bf16_f32 v150, v64, v65
  v_mfma_f32_16x16x32_bf16 a[124:127], a[236:239], v[204:207], a[124:127]
  s_waitcnt lgkmcnt(1)
  ds_read_b128 a[236:239], v252 offset:23552
  v_cvt_pk_bf16_f32 v151, v66, v67
  v_mfma_f32_16x16x32_bf16 v[80:83], a[208:211], a[144:147], v[208:211]
  v_exp_f32 v52, v52
  v_mfma_f32_16x16x32_bf16 v[80:83], a[212:215], a[148:151], v[80:83]
  v_exp_f32 v53, v53
  v_mfma_f32_16x16x32_bf16 v[80:83], a[216:219], a[152:155], v[80:83]
  v_exp_f32 v54, v54
  v_mfma_f32_16x16x32_bf16 v[80:83], a[220:223], a[156:159], v[80:83]
  v_exp_f32 v55, v55
  v_mfma_f32_16x16x32_bf16 v[84:87], a[208:211], a[160:163], v[212:215]
  v_exp_f32 v68, v68
  v_mfma_f32_16x16x32_bf16 v[84:87], a[212:215], a[164:167], v[84:87]
  v_exp_f32 v69, v69
  v_mfma_f32_16x16x32_bf16 v[84:87], a[216:219], a[168:171], v[84:87]
  v_exp_f32 v70, v70
  v_mfma_f32_16x16x32_bf16 v[84:87], a[220:223], a[172:175], v[84:87]
  v_exp_f32 v71, v71
  v_mfma_f32_16x16x32_bf16 v[88:91], a[208:211], a[176:179], v[216:219]
  v_cvt_pk_bf16_f32 v156, v52, v53
  v_cvt_pk_bf16_f32 v157, v54, v55
  v_mfma_f32_16x16x32_bf16 v[88:91], a[212:215], a[180:183], v[88:91]
  v_cvt_pk_bf16_f32 v158, v68, v69
  v_cvt_pk_bf16_f32 v159, v70, v71
  v_mfma_f32_16x16x32_bf16 v[88:91], a[216:219], a[184:187], v[88:91]
  v_exp_f32 v56, v56
  v_mfma_f32_16x16x32_bf16 v[88:91], a[220:223], a[188:191], v[88:91]
  v_exp_f32 v57, v57
  v_mfma_f32_16x16x32_bf16 v[92:95], a[208:211], a[192:195], v[220:223]
  ds_read_b128 a[208:211], v252 offset:28672
  v_cvt_pk_bf16_f32 v164, v56, v57
  v_mfma_f32_16x16x32_bf16 v[92:95], a[212:215], a[196:199], v[92:95]
  ds_read_b128 a[212:215], v252 offset:29696
  v_mfma_f32_16x16x32_bf16 v[92:95], a[216:219], a[200:203], v[92:95]
  ds_read_b128 a[216:219], v252 offset:30720
  v_mfma_f32_16x16x32_bf16 v[92:95], a[220:223], a[204:207], v[92:95]
  ds_read_b128 a[220:223], v252 offset:31744
  v_mfma_f32_16x16x32_bf16 v[96:99], a[224:227], a[144:147], v[208:211]
  v_exp_f32 v58, v58
  v_mfma_f32_16x16x32_bf16 v[96:99], a[228:231], a[148:151], v[96:99]
  s_waitcnt lgkmcnt(4)
  v_exp_f32 v59, v59
  v_mfma_f32_16x16x32_bf16 v[96:99], a[232:235], a[152:155], v[96:99]
  v_exp_f32 v72, v72
  v_mfma_f32_16x16x32_bf16 v[96:99], a[236:239], a[156:159], v[96:99]
  v_exp_f32 v73, v73
  v_mfma_f32_16x16x32_bf16 v[100:103], a[224:227], a[160:163], v[212:215]
  v_exp_f32 v74, v74
  v_mfma_f32_16x16x32_bf16 v[100:103], a[228:231], a[164:167], v[100:103]
  v_exp_f32 v75, v75
  v_mfma_f32_16x16x32_bf16 v[100:103], a[232:235], a[168:171], v[100:103]
  v_cvt_pk_bf16_f32 v165, v58, v59
  v_cvt_pk_bf16_f32 v166, v72, v73
  v_mfma_f32_16x16x32_bf16 v[100:103], a[236:239], a[172:175], v[100:103]
  v_cvt_pk_bf16_f32 v167, v74, v75
  v_mfma_f32_16x16x32_bf16 v[104:107], a[224:227], a[176:179], v[216:219]
  v_exp_f32 v60, v60
  v_mfma_f32_16x16x32_bf16 v[104:107], a[228:231], a[180:183], v[104:107]
  v_exp_f32 v61, v61
  v_mfma_f32_16x16x32_bf16 v[104:107], a[232:235], a[184:187], v[104:107]
  v_exp_f32 v62, v62
  v_mfma_f32_16x16x32_bf16 v[104:107], a[236:239], a[188:191], v[104:107]
  v_exp_f32 v63, v63
  v_mfma_f32_16x16x32_bf16 v[108:111], a[224:227], a[192:195], v[220:223]
  ds_read_b128 a[224:227], v252 offset:32768
  v_cvt_pk_bf16_f32 v172, v60, v61
  v_mfma_f32_16x16x32_bf16 v[108:111], a[228:231], a[196:199], v[108:111]
  ds_read_b128 a[228:231], v252 offset:33792
  v_cvt_pk_bf16_f32 v173, v62, v63
  v_mfma_f32_16x16x32_bf16 v[108:111], a[232:235], a[200:203], v[108:111]
  ds_read_b128 a[232:235], v252 offset:34816
  v_mfma_f32_16x16x32_bf16 v[108:111], a[236:239], a[204:207], v[108:111]
  ds_read_b128 a[236:239], v252 offset:35840
  v_mfma_f32_16x16x32_bf16 v[112:115], a[240:243], a[144:147], v[208:211]
  v_exp_f32 v76, v76
  v_mfma_f32_16x16x32_bf16 v[112:115], a[244:247], a[148:151], v[112:115]
  v_exp_f32 v77, v77
  v_mfma_f32_16x16x32_bf16 v[112:115], a[248:251], a[152:155], v[112:115]
  v_exp_f32 v78, v78
  v_mfma_f32_16x16x32_bf16 v[112:115], a[252:255], a[156:159], v[112:115]
  v_exp_f32 v79, v79
  v_mfma_f32_16x16x32_bf16 v[116:119], a[240:243], a[160:163], v[212:215]
  v_cvt_pk_bf16_f32 v174, v76, v77
  v_cvt_pk_bf16_f32 v175, v78, v79
  v_mfma_f32_16x16x32_bf16 v[116:119], a[244:247], a[164:167], v[116:119]
  v_exp_f32 v80, v80
  v_mfma_f32_16x16x32_bf16 v[116:119], a[248:251], a[168:171], v[116:119]
  v_exp_f32 v81, v81
  v_mfma_f32_16x16x32_bf16 v[116:119], a[252:255], a[172:175], v[116:119]
  v_exp_f32 v82, v82
  v_mfma_f32_16x16x32_bf16 v[120:123], a[240:243], a[176:179], v[216:219]
  v_exp_f32 v83, v83
  v_mfma_f32_16x16x32_bf16 v[120:123], a[244:247], a[180:183], v[120:123]
  v_exp_f32 v84, v84
  v_mfma_f32_16x16x32_bf16 v[120:123], a[248:251], a[184:187], v[120:123]
  v_exp_f32 v85, v85
  v_mfma_f32_16x16x32_bf16 v[120:123], a[252:255], a[188:191], v[120:123]
  v_exp_f32 v86, v86
  v_mfma_f32_16x16x32_bf16 v[124:127], a[240:243], a[192:195], v[220:223]
  ds_read_b128 a[240:243], v252 offset:36864
  v_cvt_pk_bf16_f32 v176, v80, v81
  v_mfma_f32_16x16x32_bf16 v[124:127], a[244:247], a[196:199], v[124:127]
  ds_read_b128 a[244:247], v252 offset:37888
  v_cvt_pk_bf16_f32 v177, v82, v83
  v_mfma_f32_16x16x32_bf16 v[124:127], a[248:251], a[200:203], v[124:127]
  ds_read_b128 a[248:251], v252 offset:38912
  v_cvt_pk_bf16_f32 v184, v84, v85
  v_mfma_f32_16x16x32_bf16 v[124:127], a[252:255], a[204:207], v[124:127]
  s_waitcnt lgkmcnt(3)
  ds_read_b128 a[252:255], v252 offset:39936
  v_mfma_f32_16x16x32_bf16 v[128:131], a[208:211], a[144:147], v[208:211]
  v_exp_f32 v87, v87
  v_mfma_f32_16x16x32_bf16 v[128:131], a[212:215], a[148:151], v[128:131]
  v_exp_f32 v88, v88
  v_mfma_f32_16x16x32_bf16 v[128:131], a[216:219], a[152:155], v[128:131]
  v_exp_f32 v89, v89
  v_mfma_f32_16x16x32_bf16 v[128:131], a[220:223], a[156:159], v[128:131]
  v_exp_f32 v90, v90
  v_mfma_f32_16x16x32_bf16 v[132:135], a[208:211], a[160:163], v[212:215]
  v_exp_f32 v91, v91
  v_mfma_f32_16x16x32_bf16 v[132:135], a[212:215], a[164:167], v[132:135]
  v_exp_f32 v92, v92
  v_mfma_f32_16x16x32_bf16 v[132:135], a[216:219], a[168:171], v[132:135]
  v_exp_f32 v93, v93
  v_mfma_f32_16x16x32_bf16 v[132:135], a[220:223], a[172:175], v[132:135]
  v_exp_f32 v94, v94
  v_mfma_f32_16x16x32_bf16 v[136:139], a[208:211], a[176:179], v[216:219]
  v_exp_f32 v95, v95
  v_mfma_f32_16x16x32_bf16 v[136:139], a[212:215], a[180:183], v[136:139]
  v_exp_f32 v96, v96
  v_mfma_f32_16x16x32_bf16 v[136:139], a[216:219], a[184:187], v[136:139]
  v_exp_f32 v97, v97
  v_mfma_f32_16x16x32_bf16 v[136:139], a[220:223], a[188:191], v[136:139]
  v_exp_f32 v98, v98
  v_mfma_f32_16x16x32_bf16 v[140:143], a[208:211], a[192:195], v[220:223]
  ds_read_b128 a[208:211], v252 offset:40960
  v_cvt_pk_bf16_f32 v185, v86, v87
  v_mfma_f32_16x16x32_bf16 v[140:143], a[212:215], a[196:199], v[140:143]
  ds_read_b128 a[212:215], v252 offset:41984
  v_cvt_pk_bf16_f32 v192, v88, v89
  v_mfma_f32_16x16x32_bf16 v[140:143], a[216:219], a[200:203], v[140:143]
  ds_read_b128 a[216:219], v252 offset:43008
  v_cvt_pk_bf16_f32 v193, v90, v91
  v_mfma_f32_16x16x32_bf16 v[140:143], a[220:223], a[204:207], v[140:143]
  ds_read_b128 a[220:223], v252 offset:44032
  v_cvt_pk_bf16_f32 v200, v92, v93
  v_mfma_f32_16x16x32_bf16 a[0:3], a[224:227], v[144:147], a[0:3]
  v_exp_f32 v99, v99
  v_mfma_f32_16x16x32_bf16 a[0:3], a[228:231], v[148:151], a[0:3]
  v_exp_f32 v100, v100
  v_mfma_f32_16x16x32_bf16 a[4:7], a[224:227], v[152:155], a[4:7]
  v_exp_f32 v101, v101
  v_mfma_f32_16x16x32_bf16 a[4:7], a[228:231], v[156:159], a[4:7]
  v_exp_f32 v102, v102
  v_mfma_f32_16x16x32_bf16 a[8:11], a[224:227], v[160:163], a[8:11]
  buffer_load_dword v246, v254, s[8:11], s88 offen
  v_mfma_f32_16x16x32_bf16 a[8:11], a[228:231], v[164:167], a[8:11]
  s_add_u32 s88, s88, 61440
  v_exp_f32 v103, v103
  v_mfma_f32_16x16x32_bf16 a[12:15], a[224:227], v[168:171], a[12:15]
  s_and_b32 s88, s88, 0x3fffffff
  ds_read_b128 a[224:227], v252 offset:45056
  v_cvt_pk_bf16_f32 v201, v94, v95
  v_mfma_f32_16x16x32_bf16 a[12:15], a[228:231], v[172:175], a[12:15]
  ds_read_b128 a[228:231], v252 offset:46080
  v_cvt_pk_bf16_f32 v178, v96, v97
  v_mfma_f32_16x16x32_bf16 a[16:19], a[232:235], v[144:147], a[16:19]
  buffer_load_dword v247, v255, s[12:15], s89 offen
  v_mfma_f32_16x16x32_bf16 a[16:19], a[236:239], v[148:151], a[16:19]
  s_add_u32 s89, s89, 24576
  v_exp_f32 v104, v104
  v_mfma_f32_16x16x32_bf16 a[20:23], a[232:235], v[152:155], a[20:23]
  s_and_b32 s89, s89, 0x3fffffff
  v_exp_f32 v105, v105
  v_mfma_f32_16x16x32_bf16 a[20:23], a[236:239], v[156:159], a[20:23]
  v_exp_f32 v106, v106
  v_mfma_f32_16x16x32_bf16 a[24:27], a[232:235], v[160:163], a[24:27]
  v_exp_f32 v107, v107
  v_mfma_f32_16x16x32_bf16 a[24:27], a[236:239], v[164:167], a[24:27]
  v_exp_f32 v108, v108
  v_mfma_f32_16x16x32_bf16 a[28:31], a[232:235], v[168:171], a[28:31]
  v_exp_f32 v109, v109
  v_mfma_f32_16x16x32_bf16 a[28:31], a[236:239], v[172:175], a[28:31]
  s_waitcnt lgkmcnt(0)
  v_exp_f32 v110, v110
  v_mfma_f32_16x16x32_bf16 a[32:35], a[240:243], v[144:147], a[32:35]
  v_exp_f32 v111, v111
  v_mfma_f32_16x16x32_bf16 a[32:35], a[244:247], v[148:151], a[32:35]
  ds_read_b128 a[232:235], v252 offset:47104
  v_cvt_pk_bf16_f32 v179, v98, v99
  v_mfma_f32_16x16x32_bf16 a[36:39], a[240:243], v[152:155], a[36:39]
  ds_read_b128 a[236:239], v252 offset:48128
  v_cvt_pk_bf16_f32 v186, v100, v101
  v_mfma_f32_16x16x32_bf16 a[36:39], a[244:247], v[156:159], a[36:39]
  v_cvt_pk_bf16_f32 v187, v102, v103
  v_cvt_pk_bf16_f32 v194, v104, v105
  v_mfma_f32_16x16x32_bf16 a[40:43], a[240:243], v[160:163], a[40:43]
  v_cvt_pk_bf16_f32 v195, v106, v107
  v_cvt_pk_bf16_f32 v202, v108, v109
  v_mfma_f32_16x16x32_bf16 a[40:43], a[244:247], v[164:167], a[40:43]
  v_cvt_pk_bf16_f32 v203, v110, v111
  v_mfma_f32_16x16x32_bf16 a[44:47], a[240:243], v[168:171], a[44:47]
  v_mfma_f32_16x16x32_bf16 a[44:47], a[244:247], v[172:175], a[44:47]
  v_mfma_f32_16x16x32_bf16 a[48:51], a[248:251], v[144:147], a[48:51]
  v_mfma_f32_16x16x32_bf16 a[48:51], a[252:255], v[148:151], a[48:51]
  v_mfma_f32_16x16x32_bf16 a[52:55], a[248:251], v[152:155], a[52:55]
  v_mfma_f32_16x16x32_bf16 a[52:55], a[252:255], v[156:159], a[52:55]
  v_mfma_f32_16x16x32_bf16 a[56:59], a[248:251], v[160:163], a[56:59]
  v_mfma_f32_16x16x32_bf16 a[56:59], a[252:255], v[164:167], a[56:59]
  v_mfma_f32_16x16x32_bf16 a[60:63], a[248:251], v[168:171], a[60:63]
  v_mfma_f32_16x16x32_bf16 a[60:63], a[252:255], v[172:175], a[60:63]
  v_mfma_f32_16x16x32_bf16 a[64:67], a[208:211], v[144:147], a[64:67]
  v_mfma_f32_16x16x32_bf16 a[64:67], a[212:215], v[148:151], a[64:67]
  v_mfma_f32_16x16x32_bf16 a[68:71], a[208:211], v[152:155], a[68:71]
  v_mfma_f32_16x16x32_bf16 a[68:71], a[212:215], v[156:159], a[68:71]
  v_mfma_f32_16x16x32_bf16 a[72:75], a[208:211], v[160:163], a[72:75]
  v_mfma_f32_16x16x32_bf16 a[72:75], a[212:215], v[164:167], a[72:75]
  v_mfma_f32_16x16x32_bf16 a[76:79], a[208:211], v[168:171], a[76:79]
  v_mfma_f32_16x16x32_bf16 a[76:79], a[212:215], v[172:175], a[76:79]
  v_mfma_f32_16x16x32_bf16 a[80:83], a[216:219], v[144:147], a[80:83]
  v_mfma_f32_16x16x32_bf16 a[80:83], a[220:223], v[148:151], a[80:83]
  v_mfma_f32_16x16x32_bf16 a[84:87], a[216:219], v[152:155], a[84:87]
  v_mfma_f32_16x16x32_bf16 a[84:87], a[220:223], v[156:159], a[84:87]
  v_mfma_f32_16x16x32_bf16 a[88:91], a[216:219], v[160:163], a[88:91]
  v_mfma_f32_16x16x32_bf16 a[88:91], a[220:223], v[164:167], a[88:91]
  v_mfma_f32_16x16x32_bf16 a[92:95], a[216:219], v[168:171], a[92:95]
  v_mfma_f32_16x16x32_bf16 a[92:95], a[220:223], v[172:175], a[92:95]
  v_mfma_f32_16x16x32_bf16 a[96:99], a[224:227], v[144:147], a[96:99]
  v_mfma_f32_16x16x32_bf16 a[96:99], a[228:231], v[148:151], a[96:99]
  v_mfma_f32_16x16x32_bf16 a[100:103], a[224:227], v[152:155], a[100:103]
  v_mfma_f32_16x16x32_bf16 a[100:103], a[228:231], v[156:159], a[100:103]
  v_mfma_f32_16x16x32_bf16 a[104:107], a[224:227], v[160:163], a[104:107]
  v_mfma_f32_16x16x32_bf16 a[104:107], a[228:231], v[164:167], a[104:107]
  v_mfma_f32_16x16x32_bf16 a[108:111], a[224:227], v[168:171], a[108:111]
  v_mfma_f32_16x16x32_bf16 a[108:111], a[228:231], v[172:175], a[108:111]
  s_waitcnt vmcnt(2)
  s_lshl_b32 s43, s42, 1
  s_cmp_lg_u32 s92, s43
  s_cbranch_scc1 L_en
  s_cmp_eq_u32 s40, 2
  s_cbranch_scc1 L_edn
L_en:
  s_waitcnt lgkmcnt(0)
  s_barrier
  v_mfma_f32_16x16x32_bf16 a[128:131], v[224:227], v[144:147], a[128:131]
  s_add_u32 s92, s92, 1
  ds_read_b128 a[208:211], v252
  ds_read_b128 a[212:215], v252 offset:1024
  v_mfma_f32_16x16x32_bf16 a[128:131], v[224:227], v[148:151], a[128:131]
  s_nop 0
  ds_read_b128 a[216:219], v252 offset:2048
  ds_read_b128 a[220:223], v252 offset:3072
  v_mfma_f32_16x16x32_bf16 a[132:135], v[224:227], v[152:155], a[132:135]
  s_nop 0
  ds_read_b128 a[224:227], v252 offset:4096
  ds_read_b128 a[228:231], v252 offset:5120
  v_mfma_f32_16x16x32_bf16 a[132:135], v[224:227], v[156:159], a[132:135]
  s_nop 0
  ds_read_b128 a[240:243], v252 offset:8192
  ds_read_b128 a[244:247], v252 offset:9216
  v_mfma_f32_16x16x32_bf16 a[136:139], v[224:227], v[160:163], a[136:139]
  s_nop 0
  ds_read_b128 a[248:251], v252 offset:10240
  ds_read_b128 a[252:255], v252 offset:11264
  v_mfma_f32_16x16x32_bf16 a[136:139], v[224:227], v[164:167], a[136:139]
  v_exp_f32 v112, v112
  v_mfma_f32_16x16x32_bf16 a[140:143], v[224:227], v[168:171], a[140:143]
  v_exp_f32 v113, v113
  v_mfma_f32_16x16x32_bf16 a[140:143], v[224:227], v[172:175], a[140:143]
  v_exp_f32 v114, v114
  v_mfma_f32_16x16x32_bf16 a[112:115], a[232:235], v[144:147], a[112:115]
  v_exp_f32 v115, v115
  v_mfma_f32_16x16x32_bf16 a[112:115], a[236:239], v[148:151], a[112:115]
  v_exp_f32 v128, v128
  v_mfma_f32_16x16x32_bf16 a[116:119], a[232:235], v[152:155], a[116:119]
  v_exp_f32 v129, v129
  v_mfma_f32_16x16x32_bf16 a[116:119], a[236:239], v[156:159], a[116:119]
  v_exp_f32 v130, v130
  v_mfma_f32_16x16x32_bf16 a[120:123], a[232:235], v[160:163], a[120:123]
  v_exp_f32 v131, v131
  v_mfma_f32_16x16x32_bf16 a[120:123], a[236:239], v[164:167], a[120:123]
  v_cvt_pk_bf16_f32 v180, v112, v113
  v_cvt_pk_bf16_f32 v181, v114, v115
  v_mfma_f32_16x16x32_bf16 a[124:127], a[232:235], v[168:171], a[124:127]
  ds_read_b128 a[232:235], v252 offset:6144
  v_cvt_pk_bf16_f32 v182, v128, v129
  v_mfma_f32_16x16x32_bf16 a[124:127], a[236:239], v[172:175], a[124:127]
  s_waitcnt lgkmcnt(1)
  ds_read_b128 a[236:239], v252 offset:7168
  v_cvt_pk_bf16_f32 v183, v130, v131
  v_mfma_f32_16x16x32_bf16 v[16:19], a[208:211], a[144:147], v[208:211]
  v_exp_f32 v116, v116
  v_mfma_f32_16x16x32_bf16 v[16:19], a[212:215], a[148:151], v[16:19]
  v_exp_f32 v117, v117
  v_mfma_f32_16x16x32_bf16 v[16:19], a[216:219], a[152:155], v[16:19]
  v_exp_f32 v118, v118
  v_mfma_f32_16x16x32_bf16 v[16:19], a[220:223], a[156:159], v[16:19]
  v_exp_f32 v119, v119
  v_mfma_f32_16x16x32_bf16 v[20:23], a[208:211], a[160:163], v[212:215]
  v_exp_f32 v132, v132
  v_mfma_f32_16x16x32_bf16 v[20:23], a[212:215], a[164:167], v[20:23]
  v_exp_f32 v133, v133
  v_mfma_f32_16x16x32_bf16 v[20:23], a[216:219], a[168:171], v[20:23]
  v_exp_f32 v134, v134
  v_mfma_f32_16x16x32_bf16 v[20:23], a[220:223], a[172:175], v[20:23]
  v_exp_f32 v135, v135
  v_mfma_f32_16x16x32_bf16 v[24:27], a[208:211], a[176:179], v[216:219]
  v_cvt_pk_bf16_f32 v188, v116, v117
  v_cvt_pk_bf16_f32 v189, v118, v119
  v_mfma_f32_16x16x32_bf16 v[24:27], a[212:215], a[180:183], v[24:27]
  v_cvt_pk_bf16_f32 v190, v132, v133
  v_cvt_pk_bf16_f32 v191, v134, v135
  v_mfma_f32_16x16x32_bf16 v[24:27], a[216:219], a[184:187], v[24:27]
  v_exp_f32 v120, v120
  v_mfma_f32_16x16x32_bf16 v[24:27], a[220:223], a[188:191], v[24:27]
  v_exp_f32 v121, v121
  v_mfma_f32_16x16x32_bf16 v[28:31], a[208:211], a[192:195], v[220:223]
  ds_read_b128 a[208:211], v252 offset:12288
  v_cvt_pk_bf16_f32 v196, v120, v121
  v_mfma_f32_16x16x32_bf16 v[28:31], a[212:215], a[196:199], v[28:31]
  ds_read_b128 a[212:215], v252 offset:13312
  v_mfma_f32_16x16x32_bf16 v[28:31], a[216:219], a[200:203], v[28:31]
  ds_read_b128 a[216:219], v252 offset:14336
  v_mfma_f32_16x16x32_bf16 v[28:31], a[220:223], a[204:207], v[28:31]
  ds_read_b128 a[220:223], v252 offset:15360
  v_mfma_f32_16x16x32_bf16 v[32:35], a[224:227], a[144:147], v[208:211]
  v_exp_f32 v122, v122
  v_mfma_f32_16x16x32_bf16 v[32:35], a[228:231], a[148:151], v[32:35]
  s_waitcnt lgkmcnt(4)
  v_exp_f32 v123, v123
  v_mfma_f32_16x16x32_bf16 v[32:35], a[232:235], a[152:155], v[32:35]
  v_exp_f32 v136, v136
  v_mfma_f32_16x16x32_bf16 v[32:35], a[236:239], a[156:159], v[32:35]
  v_exp_f32 v137, v137
  v_mfma_f32_16x16x32_bf16 v[36:39], a[224:227], a[160:163], v[212:215]
  v_exp_f32 v138, v138
  v_mfma_f32_16x16x32_bf16 v[36:39], a[228:231], a[164:167], v[36:39]
  v_exp_f32 v139, v139
  v_mfma_f32_16x16x32_bf16 v[36:39], a[232:235], a[168:171], v[36:39]
  v_cvt_pk_bf16_f32 v197, v122, v123
  v_cvt_pk_bf16_f32 v198, v136, v137
  v_mfma_f32_16x16x32_bf16 v[36:39], a[236:239], a[172:175], v[36:39]
  v_cvt_pk_bf16_f32 v199, v138, v139
  v_mfma_f32_16x16x32_bf16 v[40:43], a[224:227], a[176:179], v[216:219]
  v_exp_f32 v124, v124
  v_mfma_f32_16x16x32_bf16 v[40:43], a[228:231], a[180:183], v[40:43]
  v_exp_f32 v125, v125
  v_mfma_f32_16x16x32_bf16 v[40:43], a[232:235], a[184:187], v[40:43]
  v_exp_f32 v126, v126
  v_mfma_f32_16x16x32_bf16 v[40:43], a[236:239], a[188:191], v[40:43]
  v_exp_f32 v127, v127
  v_mfma_f32_16x16x32_bf16 v[44:47], a[224:227], a[192:195], v[220:223]
  ds_read_b128 a[224:227], v252 offset:49152
  v_cvt_pk_bf16_f32 v204, v124, v125
  v_mfma_f32_16x16x32_bf16 v[44:47], a[228:231], a[196:199], v[44:47]
  ds_read_b128 a[228:231], v252 offset:50176
  v_cvt_pk_bf16_f32 v205, v126, v127
  v_mfma_f32_16x16x32_bf16 v[44:47], a[232:235], a[200:203], v[44:47]
  ds_read_b128 a[232:235], v252 offset:51200
  v_mfma_f32_16x16x32_bf16 v[44:47], a[236:239], a[204:207], v[44:47]
  ds_read_b128 a[236:239], v252 offset:52224
  v_mfma_f32_16x16x32_bf16 v[48:51], a[240:243], a[144:147], v[208:211]
  v_exp_f32 v140, v140
  v_mfma_f32_16x16x32_bf16 v[48:51], a[244:247], a[148:151], v[48:51]
  v_exp_f32 v141, v141
  v_mfma_f32_16x16x32_bf16 v[48:51], a[248:251], a[152:155], v[48:51]
  v_exp_f32 v142, v142
  v_mfma_f32_16x16x32_bf16 v[48:51], a[252:255], a[156:159], v[48:51]
  v_exp_f32 v143, v143
  v_mfma_f32_16x16x32_bf16 v[52:55], a[240:243], a[160:163], v[212:215]
  v_cvt_pk_bf16_f32 v206, v140, v141
  v_cvt_pk_bf16_f32 v207, v142, v143
  v_mfma_f32_16x16x32_bf16 v[52:55], a[244:247], a[164:167], v[52:55]
  v_exp_f32 v16, v16
  v_mfma_f32_16x16x32_bf16 v[52:55], a[248:251], a[168:171], v[52:55]
  v_exp_f32 v17, v17
  v_mfma_f32_16x16x32_bf16 v[52:55], a[252:255], a[172:175], v[52:55]
  v_exp_f32 v18, v18
  v_mfma_f32_16x16x32_bf16 v[56:59], a[240:243], a[176:179], v[216:219]
  v_exp_f32 v19, v19
  v_mfma_f32_16x16x32_bf16 v[56:59], a[244:247], a[180:183], v[56:59]
  v_exp_f32 v20, v20
  v_mfma_f32_16x16x32_bf16 v[56:59], a[248:251], a[184:187], v[56:59]
  v_exp_f32 v21, v21
  v_mfma_f32_16x16x32_bf16 v[56:59], a[252:255], a[188:191], v[56:59]
  v_exp_f32 v22, v22
  v_mfma_f32_16x16x32_bf16 v[60:63], a[240:243], a[192:195], v[220:223]
  ds_read_b128 a[240:243], v252 offset:53248
  v_cvt_pk_bf16_f32 v144, v16, v17
  v_mfma_f32_16x16x32_bf16 v[60:63], a[244:247], a[196:199], v[60:63]
  ds_read_b128 a[244:247], v252 offset:54272
  v_cvt_pk_bf16_f32 v145, v18, v19
  v_mfma_f32_16x16x32_bf16 v[60:63], a[248:251], a[200:203], v[60:63]
  ds_read_b128 a[248:251], v252 offset:55296
  v_cvt_pk_bf16_f32 v152, v20, v21
  v_mfma_f32_16x16x32_bf16 v[60:63], a[252:255], a[204:207], v[60:63]
  s_waitcnt lgkmcnt(3)
  ds_read_b128 a[252:255], v252 offset:56320
  v_mfma_f32_16x16x32_bf16 v[64:67], a[208:211], a[144:147], v[208:211]
  v_exp_f32 v23, v23
  v_mfma_f32_16x16x32_bf16 v[64:67], a[212:215], a[148:151], v[64:67]
  v_exp_f32 v24, v24
  v_mfma_f32_16x16x32_bf16 v[64:67], a[216:219], a[152:155], v[64:67]
  v_exp_f32 v25, v25
  v_mfma_f32_16x16x32_bf16 v[64:67], a[220:223], a[156:159], v[64:67]
  v_exp_f32 v26, v26
  v_mfma_f32_16x16x32_bf16 v[68:71], a[208:211], a[160:163], v[212:215]
  v_exp_f32 v27, v27
  v_mfma_f32_16x16x32_bf16 v[68:71], a[212:215], a[164:167], v[68:71]
  v_exp_f32 v28, v28
  v_mfma_f32_16x16x32_bf16 v[68:71], a[216:219], a[168:171], v[68:71]
  v_exp_f32 v29, v29
  v_mfma_f32_16x16x32_bf16 v[68:71], a[220:223], a[172:175], v[68:71]
  v_exp_f32 v30, v30
  v_mfma_f32_16x16x32_bf16 v[72:75], a[208:211], a[176:179], v[216:219]
  v_exp_f32 v31, v31
  v_mfma_f32_16x16x32_bf16 v[72:75], a[212:215], a[180:183], v[72:75]
  v_exp_f32 v32, v32
  v_mfma_f32_16x16x32_bf16 v[72:75], a[216:219], a[184:187], v[72:75]
  v_exp_f32 v33, v33
  v_mfma_f32_16x16x32_bf16 v[72:75], a[220:223], a[188:191], v[72:75]
  v_exp_f32 v34, v34
  v_mfma_f32_16x16x32_bf16 v[76:79], a[208:211], a[192:195], v[220:223]
  ds_read_b128 a[208:211], v252 offset:57344
  v_cvt_pk_bf16_f32 v153, v22, v23
  v_mfma_f32_16x16x32_bf16 v[76:79], a[212:215], a[196:199], v[76:79]
  ds_read_b128 a[212:215], v252 offset:58368
  v_cvt_pk_bf16_f32 v160, v24, v25
  v_mfma_f32_16x16x32_bf16 v[76:79], a[216:219], a[200:203], v[76:79]
  ds_read_b128 a[216:219], v252 offset:59392
  v_cvt_pk_bf16_f32 v161, v26, v27
  v_mfma_f32_16x16x32_bf16 v[76:79], a[220:223], a[204:207], v[76:79]
  ds_read_b128 a[220:223], v252 offset:60416
  v_cvt_pk_bf16_f32 v168, v28, v29
  v_mfma_f32_16x16x32_bf16 a[0:3], a[224:227], v[176:179], a[0:3]
  v_exp_f32 v35, v35
  v_mfma_f32_16x16x32_bf16 a[0:3], a[228:231], v[180:183], a[0:3]
  v_exp_f32 v36, v36
  v_mfma_f32_16x16x32_bf16 a[4:7], a[224:227], v[184:187], a[4:7]
  v_exp_f32 v37, v37
  v_mfma_f32_16x16x32_bf16 a[4:7], a[228:231], v[188:191], a[4:7]
  v_exp_f32 v38, v38
  v_mfma_f32_16x16x32_bf16 a[8:11], a[224:227], v[192:195], a[8:11]
  buffer_load_dword v246, v254, s[8:11], s88 offen
  v_mfma_f32_16x16x32_bf16 a[8:11], a[228:231], v[196:199], a[8:11]
  s_add_u32 s88, s88, 61440
  v_exp_f32 v39, v39
  v_mfma_f32_16x16x32_bf16 a[12:15], a[224:227], v[200:203], a[12:15]
  s_and_b32 s88, s88, 0x3fffffff
  ds_read_b128 a[224:227], v252 offset:61440
  v_cvt_pk_bf16_f32 v169, v30, v31
  v_mfma_f32_16x16x32_bf16 a[12:15], a[228:231], v[204:207], a[12:15]
  ds_read_b128 a[228:231], v252 offset:62464
  v_cvt_pk_bf16_f32 v146, v32, v33
  v_mfma_f32_16x16x32_bf16 a[16:19], a[232:235], v[176:179], a[16:19]
  buffer_load_dword v247, v255, s[12:15], s89 offen
  v_mfma_f32_16x16x32_bf16 a[16:19], a[236:239], v[180:183], a[16:19]
  s_add_u32 s89, s89, 24576
  v_exp_f32 v40, v40
  v_mfma_f32_16x16x32_bf16 a[20:23], a[232:235], v[184:187], a[20:23]
  s_and_b32 s89, s89, 0x3fffffff
  v_exp_f32 v41, v41
  v_mfma_f32_16x16x32_bf16 a[20:23], a[236:239], v[188:191], a[20:23]
  v_exp_f32 v42, v42
  v_mfma_f32_16x16x32_bf16 a[24:27], a[232:235], v[192:195], a[24:27]
  v_exp_f32 v43, v43
  v_mfma_f32_16x16x32_bf16 a[24:27], a[236:239], v[196:199], a[24:27]
  v_exp_f32 v44, v44
  v_mfma_f32_16x16x32_bf16 a[28:31], a[232:235], v[200:203], a[28:31]
  v_exp_f32 v45, v45
  v_mfma_f32_16x16x32_bf16 a[28:31], a[236:239], v[204:207], a[28:31]
  s_waitcnt lgkmcnt(0)
  v_exp_f32 v46, v46
  v_mfma_f32_16x16x32_bf16 a[32:35], a[240:243], v[176:179], a[32:35]
  v_exp_f32 v47, v47
  v_mfma_f32_16x16x32_bf16 a[32:35], a[244:247], v[180:183], a[32:35]
  ds_read_b128 a[232:235], v252 offset:63488
  v_cvt_pk_bf16_f32 v147, v34, v35
  v_mfma_f32_16x16x32_bf16 a[36:39], a[240:243], v[184:187], a[36:39]
  ds_read_b128 a[236:239], v252 offset:64512
  v_cvt_pk_bf16_f32 v154, v36, v37
  v_mfma_f32_16x16x32_bf16 a[36:39], a[244:247], v[188:191], a[36:39]
  v_cvt_pk_bf16_f32 v155, v38, v39
  v_cvt_pk_bf16_f32 v162, v40, v41
  v_mfma_f32_16x16x32_bf16 a[40:43], a[240:243], v[192:195], a[40:43]
  v_cvt_pk_bf16_f32 v163, v42, v43
  v_cvt_pk_bf16_f32 v170, v44, v45
  v_mfma_f32_16x16x32_bf16 a[40:43], a[244:247], v[196:199], a[40:43]
  v_cvt_pk_bf16_f32 v171, v46, v47
  v_mfma_f32_16x16x32_bf16 a[44:47], a[240:243], v[200:203], a[44:47]
  v_mfma_f32_16x16x32_bf16 a[44:47], a[244:247], v[204:207], a[44:47]
  v_mfma_f32_16x16x32_bf16 a[48:51], a[248:251], v[176:179], a[48:51]
  v_mfma_f32_16x16x32_bf16 a[48:51], a[252:255], v[180:183], a[48:51]
  v_mfma_f32_16x16x32_bf16 a[52:55], a[248:251], v[184:187], a[52:55]
  v_mfma_f32_16x16x32_bf16 a[52:55], a[252:255], v[188:191], a[52:55]
  v_mfma_f32_16x16x32_bf16 a[56:59], a[248:251], v[192:195], a[56:59]
  v_mfma_f32_16x16x32_bf16 a[56:59], a[252:255], v[196:199], a[56:59]
  v_mfma_f32_16x16x32_bf16 a[60:63], a[248:251], v[200:203], a[60:63]
  v_mfma_f32_16x16x32_bf16 a[60:63], a[252:255], v[204:207], a[60:63]
  v_mfma_f32_16x16x32_bf16 a[64:67], a[208:211], v[176:179], a[64:67]
  v_mfma_f32_16x16x32_bf16 a[64:67], a[212:215], v[180:183], a[64:67]
  v_mfma_f32_16x16x32_bf16 a[68:71], a[208:211], v[184:187], a[68:71]
  v_mfma_f32_16x16x32_bf16 a[68:71], a[212:215], v[188:191], a[68:71]
  v_mfma_f32_16x16x32_bf16 a[72:75], a[208:211], v[192:195], a[72:75]
  v_mfma_f32_16x16x32_bf16 a[72:75], a[212:215], v[196:199], a[72:75]
  v_mfma_f32_16x16x32_bf16 a[76:79], a[208:211], v[200:203], a[76:79]
  v_mfma_f32_16x16x32_bf16 a[76:79], a[212:215], v[204:207], a[76:79]
  v_mfma_f32_16x16x32_bf16 a[80:83], a[216:219], v[176:179], a[80:83]
  v_mfma_f32_16x16x32_bf16 a[80:83], a[220:223], v[180:183], a[80:83]
  v_mfma_f32_16x16x32_bf16 a[84:87], a[216:219], v[184:187], a[84:87]
  v_mfma_f32_16x16x32_bf16 a[84:87], a[220:223], v[188:191], a[84:87]
  v_mfma_f32_16x16x32_bf16 a[88:91], a[216:219], v[192:195], a[88:91]
  v_mfma_f32_16x16x32_bf16 a[88:91], a[220:223], v[196:199], a[88:91]
  v_mfma_f32_16x16x32_bf16 a[92:95], a[216:219], v[200:203], a[92:95]
  v_mfma_f32_16x16x32_bf16 a[92:95], a[220:223], v[204:207], a[92:95]
  v_mfma_f32_16x16x32_bf16 a[96:99], a[224:227], v[176:179], a[96:99]
  v_mfma_f32_16x16x32_bf16 a[96:99], a[228:231], v[180:183], a[96:99]
  v_mfma_f32_16x16x32_bf16 a[100:103], a[224:227], v[184:187], a[100:103]
  v_mfma_f32_16x16x32_bf16 a[100:103], a[228:231], v[188:191], a[100:103]
  v_mfma_f32_16x16x32_bf16 a[104:107], a[224:227], v[192:195], a[104:107]
  v_mfma_f32_16x16x32_bf16 a[104:107], a[228:231], v[196:199], a[104:107]
  v_mfma_f32_16x16x32_bf16 a[108:111], a[224:227], v[200:203], a[108:111]
  v_mfma_f32_16x16x32_bf16 a[108:111], a[228:231], v[204:207], a[108:111]
  s_lshl_b32 s43, s92, 2
  s_add_u32 s43, s43, s40
  s_cmp_lg_u32 s43, 15
  s_cbranch_scc1 L_en_nosig
  s_lshl_b32 s44, s42, 8
  s_add_u32 s44, s44, 0x5402000
  buffer_atomic_add v15, v253, s[28:31], s44 offen sc1
L_en_nosig:
  s_lshl_b32 s43, s42, 1
  s_add_u32 s43, s43, 1
  s_cmp_lg_u32 s92, s43
  s_cbranch_scc1 L_on
L_odn:
  s_waitcnt lgkmcnt(0)
  s_barrier
  v_mfma_f32_16x16x32_bf16 a[128:131], v[224:227], v[176:179], a[128:131]
  s_add_u32 s92, s92, 1
  ds_read_b128 a[208:211], v252 offset:16384
  ds_read_b128 a[212:215], v252 offset:17408
  v_mfma_f32_16x16x32_bf16 a[128:131], v[224:227], v[180:183], a[128:131]
  s_nop 0
  ds_read_b128 a[216:219], v252 offset:18432
  ds_read_b128 a[220:223], v252 offset:19456
  v_mfma_f32_16x16x32_bf16 a[132:135], v[224:227], v[184:187], a[132:135]
  v_cndmask_b32 v80, v5, v208, s[60:61]
  v_cndmask_b32 v81, v5, v209, s[62:63]
  v_mfma_f32_16x16x32_bf16 a[132:135], v[224:227], v[188:191], a[132:135]
  v_cndmask_b32 v82, v5, v210, s[64:65]
  v_cndmask_b32 v83, v5, v211, s[66:67]
  v_mfma_f32_16x16x32_bf16 a[136:139], v[224:227], v[192:195], a[136:139]
  s_nop 0
  ds_read_b128 a[224:227], v252 offset:20480
  ds_read_b128 a[228:231], v252 offset:21504
  v_mfma_f32_16x16x32_bf16 a[136:139], v[224:227], v[196:199], a[136:139]
  ds_read_b128 a[240:243], v252 offset:24576
  v_cndmask_b32 v100, v5, v212, s[60:61]
  v_mfma_f32_16x16x32_bf16 a[140:143], v[224:227], v[200:203], a[140:143]
  ds_read_b128 a[244:247], v252 offset:25600
  v_cndmask_b32 v101, v5, v213, s[62:63]
  v_mfma_f32_16x16x32_bf16 a[140:143], v[224:227], v[204:207], a[140:143]
  ds_read_b128 a[248:251], v252 offset:26624
  v_cndmask_b32 v102, v5, v214, s[64:65]
  v_mfma_f32_16x16x32_bf16 a[112:115], a[232:235], v[176:179], a[112:115]
  v_cndmask_b32 v103, v5, v215, s[66:67]
  v_cndmask_b32 v120, v5, v216, s[60:61]
  v_mfma_f32_16x16x32_bf16 a[112:115], a[236:239], v[180:183], a[112:115]
  ds_read_b128 a[252:255], v252 offset:27648
  v_cndmask_b32 v121, v5, v217, s[62:63]
  v_mfma_f32_16x16x32_bf16 a[116:119], a[232:235], v[184:187], a[116:119]
  v_cndmask_b32 v122, v5, v218, s[64:65]
  v_cndmask_b32 v123, v5, v219, s[66:67]
  v_mfma_f32_16x16x32_bf16 a[116:119], a[236:239], v[188:191], a[116:119]
  v_cndmask_b32 v140, v5, v220, s[60:61]
  v_cndmask_b32 v141, v5, v221, s[62:63]
  v_mfma_f32_16x16x32_bf16 a[120:123], a[232:235], v[192:195], a[120:123]
  v_cndmask_b32 v142, v5, v222, s[64:65]
  v_cndmask_b32 v143, v5, v223, s[66:67]
  v_mfma_f32_16x16x32_bf16 a[120:123], a[236:239], v[196:199], a[120:123]
  v_exp_f32 v48, v48
  v_mfma_f32_16x16x32_bf16 a[124:127], a[232:235], v[200:203], a[124:127]
  ds_read_b128 a[232:235], v252 offset:22528
  v_mov_b32 v96, 0xf149f2ca
  v_mfma_f32_16x16x32_bf16 a[124:127], a[236:239], v[204:207], a[124:127]
  s_waitcnt lgkmcnt(2)
  ds_read_b128 a[236:239], v252 offset:23552
  v_mov_b32 v97, 0xf149f2ca
  v_mfma_f32_16x16x32_bf16 v[80:83], a[208:211], a[144:147], v[80:83]
  v_exp_f32 v49, v49
  v_mfma_f32_16x16x32_bf16 v[80:83], a[212:215], a[148:151], v[80:83]
  v_exp_f32 v50, v50
  v_mfma_f32_16x16x32_bf16 v[80:83], a[216:219], a[152:155], v[80:83]
  v_exp_f32 v51, v51
  v_mfma_f32_16x16x32_bf16 v[80:83], a[220:223], a[156:159], v[80:83]
  v_exp_f32 v64, v64
  v_mfma_f32_16x16x32_bf16 v[84:87], a[208:211], a[160:163], v[212:215]
  v_exp_f32 v65, v65
  v_mfma_f32_16x16x32_bf16 v[84:87], a[212:215], a[164:167], v[84:87]
  v_exp_f32 v66, v66
  v_mfma_f32_16x16x32_bf16 v[84:87], a[216:219], a[168:171], v[84:87]
  v_exp_f32 v67, v67
  v_mfma_f32_16x16x32_bf16 v[84:87], a[220:223], a[172:175], v[84:87]
  v_cvt_pk_bf16_f32 v148, v48, v49
  v_cvt_pk_bf16_f32 v149, v50, v51
  v_mfma_f32_16x16x32_bf16 v[88:91], a[208:211], a[176:179], v[216:219]
  v_cvt_pk_bf16_f32 v150, v64, v65
  v_cvt_pk_bf16_f32 v151, v66, v67
  v_mfma_f32_16x16x32_bf16 v[88:91], a[212:215], a[180:183], v[88:91]
  v_exp_f32 v52, v52
  v_mfma_f32_16x16x32_bf16 v[88:91], a[216:219], a[184:187], v[88:91]
  v_exp_f32 v53, v53
  v_mfma_f32_16x16x32_bf16 v[88:91], a[220:223], a[188:191], v[88:91]
  v_exp_f32 v54, v54
  v_mfma_f32_16x16x32_bf16 v[92:95], a[208:211], a[192:195], v[220:223]
  ds_read_b128 a[208:211], v252 offset:28672
  v_cvt_pk_bf16_f32 v156, v52, v53
  v_mfma_f32_16x16x32_bf16 v[92:95], a[212:215], a[196:199], v[92:95]
  ds_read_b128 a[212:215], v252 offset:29696
  v_mov_b32 v98, 0xf149f2ca
  v_mfma_f32_16x16x32_bf16 v[92:95], a[216:219], a[200:203], v[92:95]
  ds_read_b128 a[216:219], v252 offset:30720
  v_mov_b32 v99, 0xf149f2ca
  v_mfma_f32_16x16x32_bf16 v[92:95], a[220:223], a[204:207], v[92:95]
  ds_read_b128 a[220:223], v252 offset:31744
  v_mov_b32 v112, 0xf149f2ca
  v_mfma_f32_16x16x32_bf16 v[100:103], a[224:227], a[160:163], v[100:103]
  v_exp_f32 v55, v55
  v_mfma_f32_16x16x32_bf16 v[100:103], a[228:231], a[164:167], v[100:103]
  s_waitcnt lgkmcnt(4)
  v_exp_f32 v68, v68
  v_mfma_f32_16x16x32_bf16 v[100:103], a[232:235], a[168:171], v[100:103]
  v_exp_f32 v69, v69
  v_mfma_f32_16x16x32_bf16 v[100:103], a[236:239], a[172:175], v[100:103]
  v_exp_f32 v70, v70
  v_mfma_f32_16x16x32_bf16 v[104:107], a[224:227], a[176:179], v[216:219]
  v_exp_f32 v71, v71
  v_mfma_f32_16x16x32_bf16 v[104:107], a[228:231], a[180:183], v[104:107]
  v_cvt_pk_bf16_f32 v157, v54, v55
  v_cvt_pk_bf16_f32 v158, v68, v69
  v_mfma_f32_16x16x32_bf16 v[104:107], a[232:235], a[184:187], v[104:107]
  v_cvt_pk_bf16_f32 v159, v70, v71
  v_mov_b32 v113, 0xf149f2ca
  v_mfma_f32_16x16x32_bf16 v[104:107], a[236:239], a[188:191], v[104:107]
  v_exp_f32 v56, v56
  v_mfma_f32_16x16x32_bf16 v[108:111], a[224:227], a[192:195], v[220:223]
  ds_read_b128 a[224:227], v252 offset:32768
  v_mov_b32 v114, 0xf149f2ca
  v_mfma_f32_16x16x32_bf16 v[108:111], a[228:231], a[196:199], v[108:111]
  ds_read_b128 a[228:231], v252 offset:33792
  v_mov_b32 v115, 0xf149f2ca
  v_mfma_f32_16x16x32_bf16 v[108:111], a[232:235], a[200:203], v[108:111]
  ds_read_b128 a[232:235], v252 offset:34816
  v_mov_b32 v116, 0xf149f2ca
  v_mfma_f32_16x16x32_bf16 v[108:111], a[236:239], a[204:207], v[108:111]
  ds_read_b128 a[236:239], v252 offset:35840
  v_mov_b32 v117, 0xf149f2ca
  v_mfma_f32_16x16x32_bf16 v[120:123], a[240:243], a[176:179], v[120:123]
  v_exp_f32 v57, v57
  v_mfma_f32_16x16x32_bf16 v[120:123], a[244:247], a[180:183], v[120:123]
  v_exp_f32 v58, v58
  v_mfma_f32_16x16x32_bf16 v[120:123], a[248:251], a[184:187], v[120:123]
  v_exp_f32 v59, v59
  v_mfma_f32_16x16x32_bf16 v[120:123], a[252:255], a[188:191], v[120:123]
  v_exp_f32 v72, v72
  v_mfma_f32_16x16x32_bf16 v[124:127], a[240:243], a[192:195], v[220:223]
  v_exp_f32 v73, v73
  v_mfma_f32_16x16x32_bf16 v[124:127], a[244:247], a[196:199], v[124:127]
  v_exp_f32 v74, v74
  v_mfma_f32_16x16x32_bf16 v[124:127], a[248:251], a[200:203], v[124:127]
  v_exp_f32 v75, v75
  v_mfma_f32_16x16x32_bf16 v[124:127], a[252:255], a[204:207], v[124:127]
  s_waitcnt lgkmcnt(0)
  ds_read_b128 a[240:243], v252 offset:36864
  v_cvt_pk_bf16_f32 v164, v56, v57
  v_mfma_f32_16x16x32_bf16 v[140:143], a[208:211], a[192:195], v[140:143]
  ds_read_b128 a[244:247], v252 offset:37888
  v_cvt_pk_bf16_f32 v165, v58, v59
  v_mfma_f32_16x16x32_bf16 v[140:143], a[212:215], a[196:199], v[140:143]
  v_cvt_pk_bf16_f32 v166, v72, v73
  v_cvt_pk_bf16_f32 v167, v74, v75
  v_mfma_f32_16x16x32_bf16 v[140:143], a[216:219], a[200:203], v[140:143]
  v_exp_f32 v60, v60
  v_mfma_f32_16x16x32_bf16 v[140:143], a[220:223], a[204:207], v[140:143]
  v_exp_f32 v61, v61
  v_mfma_f32_16x16x32_bf16 a[0:3], a[224:227], v[144:147], a[0:3]
  v_exp_f32 v62, v62
  v_mfma_f32_16x16x32_bf16 a[0:3], a[228:231], v[148:151], a[0:3]
  v_exp_f32 v63, v63
  v_mfma_f32_16x16x32_bf16 a[4:7], a[224:227], v[152:155], a[4:7]
  v_exp_f32 v76, v76
  v_mfma_f32_16x16x32_bf16 a[4:7], a[228:231], v[156:159], a[4:7]
  v_exp_f32 v77, v77
  v_mfma_f32_16x16x32_bf16 a[8:11], a[224:227], v[160:163], a[8:11]
  v_exp_f32 v78, v78
  v_mfma_f32_16x16x32_bf16 a[8:11], a[228:231], v[164:167], a[8:11]
  v_exp_f32 v79, v79
  v_mfma_f32_16x16x32_bf16 a[12:15], a[224:227], v[168:171], a[12:15]
  v_cvt_pk_bf16_f32 v172, v60, v61
  v_cvt_pk_bf16_f32 v173, v62, v63
  v_cvt_pk_bf16_f32 v174, v76, v77
  v_cvt_pk_bf16_f32 v175, v78, v79
  s_nop 1
  v_mfma_f32_16x16x32_bf16 a[12:15], a[228:231], v[172:175], a[12:15]
  s_nop 0
  ds_read_b128 a[248:251], v252 offset:38912
  ds_read_b128 a[252:255], v252 offset:39936
  v_mfma_f32_16x16x32_bf16 a[16:19], a[232:235], v[144:147], a[16:19]
  s_nop 0
  ds_read_b128 a[208:211], v252 offset:40960
  ds_read_b128 a[212:215], v252 offset:41984
  v_mfma_f32_16x16x32_bf16 a[16:19], a[236:239], v[148:151], a[16:19]
  s_nop 0
  ds_read_b128 a[216:219], v252 offset:43008
  ds_read_b128 a[220:223], v252 offset:44032
  v_mfma_f32_16x16x32_bf16 a[20:23], a[232:235], v[152:155], a[20:23]
  s_nop 0
  ds_read_b128 a[224:227], v252 offset:45056
  ds_read_b128 a[228:231], v252 offset:46080
  v_mfma_f32_16x16x32_bf16 a[20:23], a[236:239], v[156:159], a[20:23]
  v_exp_f32 v80, v80
  v_mfma_f32_16x16x32_bf16 a[24:27], a[232:235], v[160:163], a[24:27]
  v_exp_f32 v81, v81
  v_mfma_f32_16x16x32_bf16 a[24:27], a[236:239], v[164:167], a[24:27]
  v_exp_f32 v82, v82
  v_mfma_f32_16x16x32_bf16 a[28:31], a[232:235], v[168:171], a[28:31]
  v_exp_f32 v83, v83
  v_mfma_f32_16x16x32_bf16 a[28:31], a[236:239], v[172:175], a[28:31]
  s_waitcnt lgkmcnt(4)
  v_exp_f32 v84, v84
  v_mfma_f32_16x16x32_bf16 a[32:35], a[240:243], v[144:147], a[32:35]
  v_exp_f32 v85, v85
  v_mfma_f32_16x16x32_bf16 a[32:35], a[244:247], v[148:151], a[32:35]
  v_exp_f32 v86, v86
  v_mfma_f32_16x16x32_bf16 a[36:39], a[240:243], v[152:155], a[36:39]
  v_exp_f32 v87, v87
  v_mfma_f32_16x16x32_bf16 a[36:39], a[244:247], v[156:159], a[36:39]
  v_exp_f32 v88, v88
  v_mfma_f32_16x16x32_bf16 a[40:43], a[240:243], v[160:163], a[40:43]
  v_exp_f32 v89, v89
  v_mfma_f32_16x16x32_bf16 a[40:43], a[244:247], v[164:167], a[40:43]
  v_exp_f32 v90, v90
  v_mfma_f32_16x16x32_bf16 a[44:47], a[240:243], v[168:171], a[44:47]
  v_exp_f32 v91, v91
  v_mfma_f32_16x16x32_bf16 a[44:47], a[244:247], v[172:175], a[44:47]
  v_exp_f32 v92, v92
  v_mfma_f32_16x16x32_bf16 a[48:51], a[248:251], v[144:147], a[48:51]
  v_exp_f32 v93, v93
  v_mfma_f32_16x16x32_bf16 a[48:51], a[252:255], v[148:151], a[48:51]
  v_exp_f32 v94, v94
  v_mfma_f32_16x16x32_bf16 a[52:55], a[248:251], v[152:155], a[52:55]
  v_exp_f32 v95, v95
  v_mfma_f32_16x16x32_bf16 a[52:55], a[252:255], v[156:159], a[52:55]
  v_exp_f32 v96, v96
  v_mfma_f32_16x16x32_bf16 a[56:59], a[248:251], v[160:163], a[56:59]
  v_exp_f32 v97, v97
  v_mfma_f32_16x16x32_bf16 a[56:59], a[252:255], v[164:167], a[56:59]
  v_exp_f32 v98, v98
  v_mfma_f32_16x16x32_bf16 a[60:63], a[248:251], v[168:171], a[60:63]
  v_exp_f32 v99, v99
  v_mfma_f32_16x16x32_bf16 a[60:63], a[252:255], v[172:175], a[60:63]
  v_exp_f32 v100, v100
  v_mfma_f32_16x16x32_bf16 a[64:67], a[208:211], v[144:147], a[64:67]
  v_exp_f32 v101, v101
  v_mfma_f32_16x16x32_bf16 a[64:67], a[212:215], v[148:151], a[64:67]
  v_exp_f32 v102, v102
  v_mfma_f32_16x16x32_bf16 a[68:71], a[208:211], v[152:155], a[68:71]
  v_exp_f32 v103, v103
  v_mfma_f32_16x16x32_bf16 a[68:71], a[212:215], v[156:159], a[68:71]
  v_exp_f32 v104, v104
  v_mfma_f32_16x16x32_bf16 a[72:75], a[208:211], v[160:163], a[72:75]
  v_exp_f32 v105, v105
  v_mfma_f32_16x16x32_bf16 a[72:75], a[212:215], v[164:167], a[72:75]
  v_exp_f32 v106, v106
  v_mfma_f32_16x16x32_bf16 a[76:79], a[208:211], v[168:171], a[76:79]
  v_exp_f32 v107, v107
  v_mfma_f32_16x16x32_bf16 a[76:79], a[212:215], v[172:175], a[76:79]
  s_waitcnt lgkmcnt(0)
  v_exp_f32 v108, v108
  v_mfma_f32_16x16x32_bf16 a[80:83], a[216:219], v[144:147], a[80:83]
  v_exp_f32 v109, v109
  v_mfma_f32_16x16x32_bf16 a[80:83], a[220:223], v[148:151], a[80:83]
  v_exp_f32 v110, v110
  v_mfma_f32_16x16x32_bf16 a[84:87], a[216:219], v[152:155], a[84:87]
  v_exp_f32 v111, v111
  v_mfma_f32_16x16x32_bf16 a[84:87], a[220:223], v[156:159], a[84:87]
  ds_read_b128 a[232:235], v252 offset:47104
  v_mov_b32 v118, 0xf149f2ca
  v_mfma_f32_16x16x32_bf16 a[88:91], a[216:219], v[160:163], a[88:91]
  ds_read_b128 a[236:239], v252 offset:48128
  v_mov_b32 v119, 0xf149f2ca
  v_mfma_f32_16x16x32_bf16 a[88:91], a[220:223], v[164:167], a[88:91]
  v_mov_b32 v128, 0xf149f2ca
  v_mov_b32 v129, 0xf149f2ca
  v_mfma_f32_16x16x32_bf16 a[92:95], a[216:219], v[168:171], a[92:95]
  v_mov_b32 v130, 0xf149f2ca
  v_mov_b32 v131, 0xf149f2ca
  v_mfma_f32_16x16x32_bf16 a[92:95], a[220:223], v[172:175], a[92:95]
  v_mov_b32 v132, 0xf149f2ca
  v_mov_b32 v133, 0xf149f2ca
  v_mfma_f32_16x16x32_bf16 a[96:99], a[224:227], v[144:147], a[96:99]
  v_mov_b32 v134, 0xf149f2ca
  v_mov_b32 v135, 0xf149f2ca
  v_mfma_f32_16x16x32_bf16 a[96:99], a[228:231], v[148:151], a[96:99]
  v_mov_b32 v136, 0xf149f2ca
  v_mov_b32 v137, 0xf149f2ca
  v_mfma_f32_16x16x32_bf16 a[100:103], a[224:227], v[152:155], a[100:103]
  v_mov_b32 v138, 0xf149f2ca
  v_mov_b32 v139, 0xf149f2ca
  v_mfma_f32_16x16x32_bf16 a[100:103], a[228:231], v[156:159], a[100:103]
  v_cvt_pk_bf16_f32 v176, v80, v81
  v_cvt_pk_bf16_f32 v177, v82, v83
  v_mfma_f32_16x16x32_bf16 a[104:107], a[224:227], v[160:163], a[104:107]
  v_cvt_pk_bf16_f32 v184, v84, v85
  v_cvt_pk_bf16_f32 v185, v86, v87
  v_mfma_f32_16x16x32_bf16 a[104:107], a[228:231], v[164:167], a[104:107]
  v_cvt_pk_bf16_f32 v192, v88, v89
  v_cvt_pk_bf16_f32 v193, v90, v91
  v_mfma_f32_16x16x32_bf16 a[108:111], a[224:227], v[168:171], a[108:111]
  v_cvt_pk_bf16_f32 v200, v92, v93
  v_cvt_pk_bf16_f32 v201, v94, v95
  v_mfma_f32_16x16x32_bf16 a[108:111], a[228:231], v[172:175], a[108:111]
  v_cvt_pk_bf16_f32 v178, v96, v97
  v_cvt_pk_bf16_f32 v179, v98, v99
  v_cvt_pk_bf16_f32 v186, v100, v101
  v_cvt_pk_bf16_f32 v187, v102, v103
  v_cvt_pk_bf16_f32 v194, v104, v105
  v_cvt_pk_bf16_f32 v195, v106, v107
  v_cvt_pk_bf16_f32 v202, v108, v109
  v_cvt_pk_bf16_f32 v203, v110, v111
L_t1_B:
  s_waitcnt vmcnt(0) lgkmcnt(0)
  s_barrier
  v_mfma_f32_16x16x32_bf16 a[128:131], v[224:227], v[144:147], a[128:131]
  s_and_b32 s44, s40, 1
  ds_read_b128 a[208:211], v252 offset:49152
  ds_read_b128 a[212:215], v252 offset:51200
  v_mfma_f32_16x16x32_bf16 a[128:131], v[224:227], v[148:151], a[128:131]
  s_lshl_b32 s44, s44, 13
  ds_read_b128 a[216:219], v252 offset:53248
  ds_read_b128 a[220:223], v252 offset:55296
  v_mfma_f32_16x16x32_bf16 a[132:135], v[224:227], v[152:155], a[132:135]
  s_add_u32 s44, s44, s46
  ds_read_b128 a[224:227], v252 offset:57344
  ds_read_b128 a[228:231], v252 offset:59392
  v_mfma_f32_16x16x32_bf16 a[132:135], v[224:227], v[156:159], a[132:135]
  s_lshl_b32 s43, s42, 16
  ds_read_b128 a[240:243], v252 offset:61440
  ds_read_b128 a[244:247], v252 offset:63488
  v_mfma_f32_16x16x32_bf16 a[136:139], v[224:227], v[160:163], a[136:139]
  s_sub_u32 s47, s44, s43
  ds_read_b128 a[248:251], v252 offset:50176
  ds_read_b128 a[252:255], v252 offset:52224
  s_add_u32 s47, s47, 0xfc000
  s_add_u32 m0, s49, 0x8000
  s_add_u32 s57, s47, 0x0
  v_mfma_f32_16x16x32_bf16 a[136:139], v[224:227], v[164:167], a[136:139]
  s_add_u32 s58, s47, 0x1000
  buffer_load_dwordx4 v1, s[28:31], s57 offen sc1 lds
  v_mfma_f32_16x16x32_bf16 a[140:143], v[224:227], v[168:171], a[140:143]
  s_add_u32 s48, s44, 0x88000
  buffer_load_dwordx4 v1, s[28:31], s57 offen offset:1024 sc1 lds
  v_mfma_f32_16x16x32_bf16 a[140:143], v[224:227], v[172:175], a[140:143]
  s_add_u32 s59, s48, 0x0
  v_exp_f32 v120, v120
  v_mfma_f32_16x16x32_bf16 a[112:115], a[232:235], v[144:147], a[112:115]
  s_add_u32 s56, s48, 0x1000
  v_exp_f32 v121, v121
  v_mfma_f32_16x16x32_bf16 a[112:115], a[236:239], v[148:151], a[112:115]
  s_add_u32 s47, s47, 0x8000
  v_exp_f32 v122, v122
  v_mfma_f32_16x16x32_bf16 a[116:119], a[232:235], v[152:155], a[116:119]
  s_add_u32 s48, s48, 0x8000
  v_exp_f32 v123, v123
  v_mfma_f32_16x16x32_bf16 a[116:119], a[236:239], v[156:159], a[116:119]
  s_lshl_b32 s94, s42, 1
  buffer_load_dwordx4 v1, s[28:31], s57 offen offset:2048 sc1 lds
  v_mfma_f32_16x16x32_bf16 a[120:123], a[232:235], v[160:163], a[120:123]
  s_sub_u32 s47, s48, 0x4000
  v_exp_f32 v136, v136
  v_mfma_f32_16x16x32_bf16 a[120:123], a[236:239], v[164:167], a[120:123]
  s_add_u32 s94, s94, 2
  v_exp_f32 v137, v137
  v_mfma_f32_16x16x32_bf16 a[124:127], a[232:235], v[168:171], a[124:127]
  s_add_u32 s92, s92, 1
  ds_read_b128 a[232:235], v252 offset:54272
  v_cvt_pk_bf16_f32 v196, v120, v121
  v_mfma_f32_16x16x32_bf16 a[124:127], a[236:239], v[172:175], a[124:127]
  v_exp_f32 v138, v138
  v_mfma_f32_16x16x32_bf16 a[128:131], v[224:227], v[176:179], a[128:131]
  buffer_load_dwordx4 v1, s[28:31], s57 offen offset:3072 sc1 lds
  v_mfma_f32_16x16x32_bf16 a[132:135], v[224:227], v[184:187], a[132:135]
  s_add_u32 m0, s49, 0x9000
  v_exp_f32 v139, v139
  v_mfma_f32_16x16x32_bf16 a[136:139], v[224:227], v[192:195], a[136:139]
  s_add_u32 s57, s51, 0x0
  ds_read_b128 a[236:239], v252 offset:56320
  v_cvt_pk_bf16_f32 v197, v122, v123
  v_mfma_f32_16x16x32_bf16 a[140:143], v[224:227], v[200:203], a[140:143]
  s_waitcnt lgkmcnt(2)
  v_cvt_pk_bf16_f32 v198, v136, v137
  v_cvt_pk_bf16_f32 v199, v138, v139
  v_mfma_f32_16x16x32_bf16 a[0:3], a[208:211], v[176:179], a[0:3]
  v_exp_f32 v124, v124
  v_mfma_f32_16x16x32_bf16 a[4:7], a[208:211], v[184:187], a[4:7]
  buffer_load_dwordx4 v1, s[28:31], s58 offen sc1 lds
  v_mfma_f32_16x16x32_bf16 a[8:11], a[208:211], v[192:195], a[8:11]
  v_exp_f32 v125, v125
  v_mfma_f32_16x16x32_bf16 a[12:15], a[208:211], v[200:203], a[12:15]
  v_exp_f32 v126, v126
  v_mfma_f32_16x16x32_bf16 a[16:19], a[212:215], v[176:179], a[16:19]
  v_exp_f32 v127, v127
  v_mfma_f32_16x16x32_bf16 a[20:23], a[212:215], v[184:187], a[20:23]
  v_exp_f32 v140, v140
  v_mfma_f32_16x16x32_bf16 a[24:27], a[212:215], v[192:195], a[24:27]
  buffer_load_dwordx4 v1, s[28:31], s58 offen offset:1024 sc1 lds
  v_mfma_f32_16x16x32_bf16 a[28:31], a[212:215], v[200:203], a[28:31]
  v_exp_f32 v141, v141
  v_mfma_f32_16x16x32_bf16 a[32:35], a[216:219], v[176:179], a[32:35]
  v_exp_f32 v142, v142
  v_mfma_f32_16x16x32_bf16 a[36:39], a[216:219], v[184:187], a[36:39]
  v_exp_f32 v143, v143
  v_mfma_f32_16x16x32_bf16 a[40:43], a[216:219], v[192:195], a[40:43]
  ds_read_b128 a[208:211], v252 offset:58368
  v_cvt_pk_bf16_f32 v204, v124, v125
  v_mfma_f32_16x16x32_bf16 a[44:47], a[216:219], v[200:203], a[44:47]
  buffer_load_dwordx4 v1, s[28:31], s58 offen offset:2048 sc1 lds
  v_mfma_f32_16x16x32_bf16 a[48:51], a[220:223], v[176:179], a[48:51]
  ds_read_b128 a[212:215], v252 offset:60416
  v_cvt_pk_bf16_f32 v205, v126, v127
  v_mfma_f32_16x16x32_bf16 a[52:55], a[220:223], v[184:187], a[52:55]
  ds_read_b128 a[216:219], v252 offset:62464
  v_cvt_pk_bf16_f32 v206, v140, v141
  v_mfma_f32_16x16x32_bf16 a[56:59], a[220:223], v[192:195], a[56:59]
  v_cvt_pk_bf16_f32 v207, v142, v143
  v_add_u32 v249, 0x1c000, v1
  v_mfma_f32_16x16x32_bf16 a[60:63], a[220:223], v[200:203], a[60:63]
  s_nop 0
  ds_read_b128 a[220:223], v252 offset:64512
  ds_read_b128 v[240:243], v249
  v_mfma_f32_16x16x32_bf16 a[64:67], a[224:227], v[176:179], a[64:67]
  buffer_load_dwordx4 v1, s[28:31], s58 offen offset:3072 sc1 lds
  v_mfma_f32_16x16x32_bf16 a[68:71], a[224:227], v[184:187], a[68:71]
  s_add_u32 m0, s49, 0x4000
  v_accvgpr_read_b32 v32, a128
  v_accvgpr_read_b32 v16, a0
  v_mfma_f32_16x16x32_bf16 a[72:75], a[224:227], v[192:195], a[72:75]
  s_add_u32 s58, s51, 0x1000
  v_rcp_f32 v32, v32
  v_mfma_f32_16x16x32_bf16 a[76:79], a[224:227], v[200:203], a[76:79]
  v_accvgpr_read_b32 v17, a1
  v_accvgpr_read_b32 v18, a2
  v_mfma_f32_16x16x32_bf16 a[80:83], a[228:231], v[176:179], a[80:83]
  v_accvgpr_read_b32 v19, a3
  v_mul_f32 v16, v16, v32
  v_mfma_f32_16x16x32_bf16 a[84:87], a[228:231], v[184:187], a[84:87]
  buffer_load_dwordx4 v1, s[28:31], s59 offen sc1 lds
  v_mfma_f32_16x16x32_bf16 a[88:91], a[228:231], v[192:195], a[88:91]
  v_mul_f32 v17, v17, v32
  v_accvgpr_read_b32 v24, a32
  v_mfma_f32_16x16x32_bf16 a[92:95], a[228:231], v[200:203], a[92:95]
  v_accvgpr_read_b32 v25, a33
  v_accvgpr_read_b32 v20, a16
  v_mfma_f32_16x16x32_bf16 a[96:99], a[240:243], v[176:179], a[96:99]
  v_accvgpr_read_b32 v21, a17
  v_accvgpr_read_b32 v22, a18
  v_mfma_f32_16x16x32_bf16 a[100:103], a[240:243], v[184:187], a[100:103]
  v_accvgpr_read_b32 v23, a19
  v_mul_f32 v18, v18, v32
  v_mfma_f32_16x16x32_bf16 a[104:107], a[240:243], v[192:195], a[104:107]
  buffer_load_dwordx4 v1, s[28:31], s59 offen offset:1024 sc1 lds
  v_mfma_f32_16x16x32_bf16 a[108:111], a[240:243], v[200:203], a[108:111]
  v_mul_f32 v19, v19, v32
  v_cvt_pk_bf16_f32 v16, v16, v17
  v_mfma_f32_16x16x32_bf16 a[112:115], a[244:247], v[176:179], a[112:115]
  v_accvgpr_read_b32 v26, a34
  v_accvgpr_read_b32 v27, a35
  v_mfma_f32_16x16x32_bf16 a[116:119], a[244:247], v[184:187], a[116:119]
  v_mul_f32 v24, v24, v32
  v_mul_f32 v25, v25, v32
  v_mfma_f32_16x16x32_bf16 a[120:123], a[244:247], v[192:195], a[120:123]
  v_mul_f32 v20, v20, v32
  v_mul_f32 v21, v21, v32
  v_mfma_f32_16x16x32_bf16 a[124:127], a[244:247], v[200:203], a[124:127]
  buffer_load_dwordx4 v1, s[28:31], s59 offen offset:2048 sc1 lds
  v_mfma_f32_16x16x32_bf16 a[136:139], v[224:227], v[196:199], a[136:139]
  v_mul_f32 v22, v22, v32
  v_mul_f32 v23, v23, v32
  v_mfma_f32_16x16x32_bf16 a[140:143], v[224:227], v[204:207], a[140:143]
  v_cvt_pk_bf16_f32 v17, v18, v19
  v_accvgpr_read_b32 v28, a48
  v_mfma_f32_16x16x32_bf16 a[8:11], a[248:251], v[196:199], a[8:11]
  v_accvgpr_read_b32 v29, a49
  v_accvgpr_read_b32 v30, a50
  v_mfma_f32_16x16x32_bf16 a[12:15], a[248:251], v[204:207], a[12:15]
  v_accvgpr_read_b32 v31, a51
  v_mul_f32 v26, v26, v32
  v_mfma_f32_16x16x32_bf16 a[24:27], a[252:255], v[196:199], a[24:27]
  buffer_load_dwordx4 v1, s[28:31], s59 offen offset:3072 sc1 lds
  v_mfma_f32_16x16x32_bf16 a[28:31], a[252:255], v[204:207], a[28:31]
  s_waitcnt lgkmcnt(0)
  v_mul_f32 v27, v27, v32
  v_cvt_pk_bf16_f32 v24, v24, v25
  v_mfma_f32_16x16x32_bf16 a[40:43], a[232:235], v[196:199], a[40:43]
  s_add_u32 m0, s49, 0x5000
  v_cvt_pk_bf16_f32 v18, v20, v21
  v_cvt_pk_bf16_f32 v19, v22, v23
  v_mfma_f32_16x16x32_bf16 a[44:47], a[232:235], v[204:207], a[44:47]
  s_add_u32 s59, s51, 0x2000
  v_mul_f32 v28, v28, v32
  v_mul_f32 v29, v29, v32
  v_mfma_f32_16x16x32_bf16 a[56:59], a[236:239], v[196:199], a[56:59]
  v_mul_f32 v30, v30, v32
  v_mul_f32 v31, v31, v32
  v_mfma_f32_16x16x32_bf16 a[60:63], a[236:239], v[204:207], a[60:63]
  buffer_load_dwordx4 v1, s[28:31], s56 offen sc1 lds
  v_mfma_f32_16x16x32_bf16 a[72:75], a[208:211], v[196:199], a[72:75]
  v_cvt_pk_bf16_f32 v25, v26, v27
  v_cvt_pk_bf16_f32 v26, v28, v29
  v_mfma_f32_16x16x32_bf16 a[76:79], a[208:211], v[204:207], a[76:79]
  v_cvt_pk_bf16_f32 v27, v30, v31
  v_accvgpr_read_b32 v20, a80
  v_mfma_f32_16x16x32_bf16 a[88:91], a[212:215], v[196:199], a[88:91]
  v_accvgpr_read_b32 v21, a81
  v_accvgpr_read_b32 v22, a82
  v_mfma_f32_16x16x32_bf16 a[92:95], a[212:215], v[204:207], a[92:95]
  v_accvgpr_read_b32 v23, a83
  v_mul_f32 v20, v20, v32
  v_mfma_f32_16x16x32_bf16 a[104:107], a[216:219], v[196:199], a[104:107]
  buffer_load_dwordx4 v1, s[28:31], s56 offen offset:1024 sc1 lds
  v_mfma_f32_16x16x32_bf16 a[108:111], a[216:219], v[204:207], a[108:111]
  v_mul_f32 v21, v21, v32
  v_mul_f32 v22, v22, v32
  v_mfma_f32_16x16x32_bf16 a[120:123], a[220:223], v[196:199], a[120:123]
  v_mul_f32 v23, v23, v32
  v_accvgpr_read_b32 v28, a112
  v_mfma_f32_16x16x32_bf16 a[124:127], a[220:223], v[204:207], a[124:127]
  v_accvgpr_read_b32 v29, a113
  v_accvgpr_read_b32 v30, a114
  buffer_load_dwordx4 v1, s[28:31], s56 offen offset:2048 sc1 lds
  buffer_load_dwordx4 v1, s[28:31], s56 offen offset:3072 sc1 lds
  buffer_store_dwordx4 v[16:19], v1, s[28:31], s57 offen sc1
  buffer_store_dwordx4 v[24:27], v1, s[28:31], s58 offen sc1
  s_nop 0
  v_accvgpr_read_b32 v16, a64
  v_accvgpr_read_b32 v17, a65
  v_accvgpr_read_b32 v18, a66
  v_accvgpr_read_b32 v19, a67
  v_mul_f32 v16, v16, v32
  v_mul_f32 v17, v17, v32
  v_mul_f32 v18, v18, v32
  v_mul_f32 v19, v19, v32
  v_cvt_pk_bf16_f32 v16, v16, v17
  v_cvt_pk_bf16_f32 v17, v18, v19
  v_cvt_pk_bf16_f32 v18, v20, v21
  v_cvt_pk_bf16_f32 v19, v22, v23
  buffer_store_dwordx4 v[16:19], v1, s[28:31], s59 offen sc1
  v_accvgpr_read_b32 v24, a96
  v_accvgpr_read_b32 v25, a97
  v_accvgpr_read_b32 v26, a98
  v_accvgpr_read_b32 v27, a99
  v_accvgpr_read_b32 v31, a115
  v_mul_f32 v24, v24, v32
  v_mul_f32 v25, v25, v32
  v_mul_f32 v26, v26, v32
  v_mul_f32 v27, v27, v32
  v_mul_f32 v28, v28, v32
  v_mul_f32 v29, v29, v32
  v_mul_f32 v30, v30, v32
  v_mul_f32 v31, v31, v32
  v_cvt_pk_bf16_f32 v24, v24, v25
  v_cvt_pk_bf16_f32 v25, v26, v27
  v_cvt_pk_bf16_f32 v26, v28, v29
  v_cvt_pk_bf16_f32 v27, v30, v31
  s_add_u32 s56, s51, 0x3000
  buffer_store_dwordx4 v[24:27], v1, s[28:31], s56 offen sc1
  v_accvgpr_read_b32 v33, a132
  v_rcp_f32 v33, v33
  v_accvgpr_read_b32 v16, a4
  v_accvgpr_read_b32 v17, a5
  v_accvgpr_read_b32 v18, a6
  v_accvgpr_read_b32 v19, a7
  v_accvgpr_read_b32 v20, a20
  v_accvgpr_read_b32 v21, a21
  v_accvgpr_read_b32 v22, a22
  v_accvgpr_read_b32 v23, a23
  v_mul_f32 v16, v16, v33
  v_mul_f32 v17, v17, v33
  v_mul_f32 v18, v18, v33
  v_mul_f32 v19, v19, v33
  v_mul_f32 v20, v20, v33
  v_mul_f32 v21, v21, v33
  v_mul_f32 v22, v22, v33
  v_mul_f32 v23, v23, v33
  v_cvt_pk_bf16_f32 v16, v16, v17
  v_cvt_pk_bf16_f32 v17, v18, v19
  v_cvt_pk_bf16_f32 v18, v20, v21
  v_cvt_pk_bf16_f32 v19, v22, v23
  s_add_u32 s57, s51, 0x0
  buffer_store_dwordx4 v[16:19], v1, s[28:31], s57 offen offset:1024 sc1
  v_accvgpr_read_b32 v24, a36
  v_accvgpr_read_b32 v25, a37
  v_accvgpr_read_b32 v26, a38
  v_accvgpr_read_b32 v27, a39
  v_accvgpr_read_b32 v28, a52
  v_accvgpr_read_b32 v29, a53
  v_accvgpr_read_b32 v30, a54
  v_accvgpr_read_b32 v31, a55
  v_mul_f32 v24, v24, v33
  v_mul_f32 v25, v25, v33
  v_mul_f32 v26, v26, v33
  v_mul_f32 v27, v27, v33
  v_mul_f32 v28, v28, v33
  v_mul_f32 v29, v29, v33
  v_mul_f32 v30, v30, v33
  v_mul_f32 v31, v31, v33
  v_cvt_pk_bf16_f32 v24, v24, v25
  v_cvt_pk_bf16_f32 v25, v26, v27
  v_cvt_pk_bf16_f32 v26, v28, v29
  v_cvt_pk_bf16_f32 v27, v30, v31
  s_add_u32 s58, s51, 0x1000
  buffer_store_dwordx4 v[24:27], v1, s[28:31], s58 offen offset:1024 sc1
  v_accvgpr_read_b32 v16, a68
  v_accvgpr_read_b32 v17, a69
  v_accvgpr_read_b32 v18, a70
  v_accvgpr_read_b32 v19, a71
  v_accvgpr_read_b32 v20, a84
  v_accvgpr_read_b32 v21, a85
  v_accvgpr_read_b32 v22, a86
  v_accvgpr_read_b32 v23, a87
  v_mul_f32 v16, v16, v33
  v_mul_f32 v17, v17, v33
  v_mul_f32 v18, v18, v33
  v_mul_f32 v19, v19, v33
  v_mul_f32 v20, v20, v33
  v_mul_f32 v21, v21, v33
  v_mul_f32 v22, v22, v33
  v_mul_f32 v23, v23, v33
  v_cvt_pk_bf16_f32 v16, v16, v17
  v_cvt_pk_bf16_f32 v17, v18, v19
  v_cvt_pk_bf16_f32 v18, v20, v21
  v_cvt_pk_bf16_f32 v19, v22, v23
  s_add_u32 s59, s51, 0x2000
  buffer_store_dwordx4 v[16:19], v1, s[28:31], s59 offen offset:1024 sc1
  v_accvgpr_read_b32 v24, a100
  v_accvgpr_read_b32 v25, a101
  v_accvgpr_read_b32 v26, a102
  v_accvgpr_read_b32 v27, a103
  v_accvgpr_read_b32 v28, a116
  v_accvgpr_read_b32 v29, a117
  v_accvgpr_read_b32 v30, a118
  v_accvgpr_read_b32 v31, a119
  v_mul_f32 v24, v24, v33
  v_mul_f32 v25, v25, v33
  v_mul_f32 v26, v26, v33
  v_mul_f32 v27, v27, v33
  v_mul_f32 v28, v28, v33
  v_mul_f32 v29, v29, v33
  v_mul_f32 v30, v30, v33
  v_mul_f32 v31, v31, v33
  v_cvt_pk_bf16_f32 v24, v24, v25
  v_cvt_pk_bf16_f32 v25, v26, v27
  v_cvt_pk_bf16_f32 v26, v28, v29
  v_cvt_pk_bf16_f32 v27, v30, v31
  s_add_u32 s56, s51, 0x3000
  buffer_store_dwordx4 v[24:27], v1, s[28:31], s56 offen offset:1024 sc1
  v_accvgpr_read_b32 v232, a128
  v_accvgpr_read_b32 v233, a132
  v_accvgpr_read_b32 v234, a136
  v_accvgpr_read_b32 v235, a140
  v_add_u32 v248, 0x20000, v1
  v_add_u32 v252, 0x10000, v1
  v_sub_f32 v208, 0, v240
  v_sub_f32 v209, 0, v240
  v_sub_f32 v210, 0, v240
  v_sub_f32 v211, 0, v240
  v_sub_f32 v212, 0, v241
  v_sub_f32 v213, 0, v241
  v_sub_f32 v214, 0, v241
  v_sub_f32 v215, 0, v241
  v_sub_f32 v216, 0, v242
  v_sub_f32 v217, 0, v242
  v_sub_f32 v218, 0, v242
  v_sub_f32 v219, 0, v242
  v_sub_f32 v220, 0, v243
  v_sub_f32 v221, 0, v243
  v_sub_f32 v222, 0, v243
  v_sub_f32 v223, 0, v243
  v_add_f32 v228, v232, v233
  v_min_f32 v229, v232, v233
  v_add_f32 v228, v228, v234
  v_add_f32 v228, v228, v235
  v_min3_f32 v229, v229, v234, v235
  v_mov_b32 v230, 0x4e800000
  v_mov_b32 v231, 0x30800000
  v_cmp_nlt_f32 vcc, v228, v230
  v_cmp_nge_f32 s[98:99], v229, v231
  s_nop 3
  s_or_b64 vcc, vcc, s[98:99]
  s_cbranch_vccz L_ok_t1B
  s_mov_b32 s93, 1
  s_branch L_fallback
L_ret_1:
  v_accvgpr_read_b32 v32, a128
  v_rcp_f32 v32, v32
  v_accvgpr_read_b32 v16, a0
  v_accvgpr_read_b32 v17, a1
  v_accvgpr_read_b32 v18, a2
  v_accvgpr_read_b32 v19, a3
  v_accvgpr_read_b32 v20, a16
  v_accvgpr_read_b32 v21, a17
  v_accvgpr_read_b32 v22, a18
  v_accvgpr_read_b32 v23, a19
  v_mul_f32 v16, v16, v32
  v_mul_f32 v17, v17, v32
  v_mul_f32 v18, v18, v32
  v_mul_f32 v19, v19, v32
  v_mul_f32 v20, v20, v32
  v_mul_f32 v21, v21, v32
  v_mul_f32 v22, v22, v32
  v_mul_f32 v23, v23, v32
  v_cvt_pk_bf16_f32 v16, v16, v17
  v_cvt_pk_bf16_f32 v17, v18, v19
  v_cvt_pk_bf16_f32 v18, v20, v21
  v_cvt_pk_bf16_f32 v19, v22, v23
  s_add_u32 s57, s51, 0x0
  buffer_store_dwordx4 v[16:19], v1, s[28:31], s57 offen sc1
  v_accvgpr_read_b32 v24, a32
  v_accvgpr_read_b32 v25, a33
  v_accvgpr_read_b32 v26, a34
  v_accvgpr_read_b32 v27, a35
  v_accvgpr_read_b32 v28, a48
  v_accvgpr_read_b32 v29, a49
  v_accvgpr_read_b32 v30, a50
  v_accvgpr_read_b32 v31, a51
  v_mul_f32 v24, v24, v32
  v_mul_f32 v25, v25, v32
  v_mul_f32 v26, v26, v32
  v_mul_f32 v27, v27, v32
  v_mul_f32 v28, v28, v32
  v_mul_f32 v29, v29, v32
  v_mul_f32 v30, v30, v32
  v_mul_f32 v31, v31, v32
  v_cvt_pk_bf16_f32 v24, v24, v25
  v_cvt_pk_bf16_f32 v25, v26, v27
  v_cvt_pk_bf16_f32 v26, v28, v29
  v_cvt_pk_bf16_f32 v27, v30, v31
  s_add_u32 s58, s51, 0x1000
  buffer_store_dwordx4 v[24:27], v1, s[28:31], s58 offen sc1
  v_accvgpr_read_b32 v16, a64
  v_accvgpr_read_b32 v17, a65
  v_accvgpr_read_b32 v18, a66
  v_accvgpr_read_b32 v19, a67
  v_accvgpr_read_b32 v20, a80
  v_accvgpr_read_b32 v21, a81
  v_accvgpr_read_b32 v22, a82
  v_accvgpr_read_b32 v23, a83
  v_mul_f32 v16, v16, v32
  v_mul_f32 v17, v17, v32
  v_mul_f32 v18, v18, v32
  v_mul_f32 v19, v19, v32
  v_mul_f32 v20, v20, v32
  v_mul_f32 v21, v21, v32
  v_mul_f32 v22, v22, v32
  v_mul_f32 v23, v23, v32
  v_cvt_pk_bf16_f32 v16, v16, v17
  v_cvt_pk_bf16_f32 v17, v18, v19
  v_cvt_pk_bf16_f32 v18, v20, v21
  v_cvt_pk_bf16_f32 v19, v22, v23
  s_add_u32 s59, s51, 0x2000
  buffer_store_dwordx4 v[16:19], v1, s[28:31], s59 offen sc1
  v_accvgpr_read_b32 v24, a96
  v_accvgpr_read_b32 v25, a97
  v_accvgpr_read_b32 v26, a98
  v_accvgpr_read_b32 v27, a99
  v_accvgpr_read_b32 v28, a112
  v_accvgpr_read_b32 v29, a113
  v_accvgpr_read_b32 v30, a114
  v_accvgpr_read_b32 v31, a115
  v_mul_f32 v24, v24, v32
  v_mul_f32 v25, v25, v32
  v_mul_f32 v26, v26, v32
  v_mul_f32 v27, v27, v32
  v_mul_f32 v28, v28, v32
  v_mul_f32 v29, v29, v32
  v_mul_f32 v30, v30, v32
  v_mul_f32 v31, v31, v32
  v_cvt_pk_bf16_f32 v24, v24, v25
  v_cvt_pk_bf16_f32 v25, v26, v27
  v_cvt_pk_bf16_f32 v26, v28, v29
  v_cvt_pk_bf16_f32 v27, v30, v31
  s_add_u32 s56, s51, 0x3000
  buffer_store_dwordx4 v[24:27], v1, s[28:31], s56 offen sc1
  v_accvgpr_read_b32 v33, a132
  v_rcp_f32 v33, v33
  v_accvgpr_read_b32 v16, a4
  v_accvgpr_read_b32 v17, a5
  v_accvgpr_read_b32 v18, a6
  v_accvgpr_read_b32 v19, a7
  v_accvgpr_read_b32 v20, a20
  v_accvgpr_read_b32 v21, a21
  v_accvgpr_read_b32 v22, a22
  v_accvgpr_read_b32 v23, a23
  v_mul_f32 v16, v16, v33
  v_mul_f32 v17, v17, v33
  v_mul_f32 v18, v18, v33
  v_mul_f32 v19, v19, v33
  v_mul_f32 v20, v20, v33
  v_mul_f32 v21, v21, v33
  v_mul_f32 v22, v22, v33
  v_mul_f32 v23, v23, v33
  v_cvt_pk_bf16_f32 v16, v16, v17
  v_cvt_pk_bf16_f32 v17, v18, v19
  v_cvt_pk_bf16_f32 v18, v20, v21
  v_cvt_pk_bf16_f32 v19, v22, v23
  s_add_u32 s57, s51, 0x0
  buffer_store_dwordx4 v[16:19], v1, s[28:31], s57 offen offset:1024 sc1
  v_accvgpr_read_b32 v24, a36
  v_accvgpr_read_b32 v25, a37
  v_accvgpr_read_b32 v26, a38
  v_accvgpr_read_b32 v27, a39
  v_accvgpr_read_b32 v28, a52
  v_accvgpr_read_b32 v29, a53
  v_accvgpr_read_b32 v30, a54
  v_accvgpr_read_b32 v31, a55
  v_mul_f32 v24, v24, v33
  v_mul_f32 v25, v25, v33
  v_mul_f32 v26, v26, v33
  v_mul_f32 v27, v27, v33
  v_mul_f32 v28, v28, v33
  v_mul_f32 v29, v29, v33
  v_mul_f32 v30, v30, v33
  v_mul_f32 v31, v31, v33
  v_cvt_pk_bf16_f32 v24, v24, v25
  v_cvt_pk_bf16_f32 v25, v26, v27
  v_cvt_pk_bf16_f32 v26, v28, v29
  v_cvt_pk_bf16_f32 v27, v30, v31
  s_add_u32 s58, s51, 0x1000
  buffer_store_dwordx4 v[24:27], v1, s[28:31], s58 offen offset:1024 sc1
  v_accvgpr_read_b32 v16, a68
  v_accvgpr_read_b32 v17, a69
  v_accvgpr_read_b32 v18, a70
  v_accvgpr_read_b32 v19, a71
  v_accvgpr_read_b32 v20, a84
  v_accvgpr_read_b32 v21, a85
  v_accvgpr_read_b32 v22, a86
  v_accvgpr_read_b32 v23, a87
  v_mul_f32 v16, v16, v33
  v_mul_f32 v17, v17, v33
  v_mul_f32 v18, v18, v33
  v_mul_f32 v19, v19, v33
  v_mul_f32 v20, v20, v33
  v_mul_f32 v21, v21, v33
  v_mul_f32 v22, v22, v33
  v_mul_f32 v23, v23, v33
  v_cvt_pk_bf16_f32 v16, v16, v17
  v_cvt_pk_bf16_f32 v17, v18, v19
  v_cvt_pk_bf16_f32 v18, v20, v21
  v_cvt_pk_bf16_f32 v19, v22, v23
  s_add_u32 s59, s51, 0x2000
  buffer_store_dwordx4 v[16:19], v1, s[28:31], s59 offen offset:1024 sc1
  v_accvgpr_read_b32 v24, a100
  v_accvgpr_read_b32 v25, a101
  v_accvgpr_read_b32 v26, a102
  v_accvgpr_read_b32 v27, a103
  v_accvgpr_read_b32 v28, a116
  v_accvgpr_read_b32 v29, a117
  v_accvgpr_read_b32 v30, a118
  v_accvgpr_read_b32 v31, a119
  v_mul_f32 v24, v24, v33
  v_mul_f32 v25, v25, v33
  v_mul_f32 v26, v26, v33
  v_mul_f32 v27, v27, v33
  v_mul_f32 v28, v28, v33
  v_mul_f32 v29, v29, v33
  v_mul_f32 v30, v30, v33
  v_mul_f32 v31, v31, v33
  v_cvt_pk_bf16_f32 v24, v24, v25
  v_cvt_pk_bf16_f32 v25, v26, v27
  v_cvt_pk_bf16_f32 v26, v28, v29
  v_cvt_pk_bf16_f32 v27, v30, v31
  s_add_u32 s56, s51, 0x3000
  buffer_store_dwordx4 v[24:27], v1, s[28:31], s56 offen offset:1024 sc1
L_ok_t1B:
  ds_read_b128 a[144:147], v248
  ds_read_b128 a[148:151], v248 offset:1024
  ds_read_b128 a[152:155], v248 offset:2048
  ds_read_b128 a[156:159], v248 offset:3072
  ds_read_b128 a[160:163], v248 offset:4096
  ds_read_b128 a[164:167], v248 offset:5120
  ds_read_b128 a[168:171], v248 offset:6144
  ds_read_b128 a[172:175], v248 offset:7168
  ds_read_b128 a[176:179], v248 offset:8192
  ds_read_b128 a[180:183], v248 offset:9216
  ds_read_b128 a[184:187], v248 offset:10240
  ds_read_b128 a[188:191], v248 offset:11264
  ds_read_b128 a[192:195], v248 offset:12288
  ds_read_b128 a[196:199], v248 offset:13312
  ds_read_b128 a[200:203], v248 offset:14336
  ds_read_b128 a[204:207], v248 offset:15360
  s_cmp_eq_u32 s92, 17
  s_cbranch_scc1 L_t2_B_nox
L_t2_B:
  s_waitcnt vmcnt(0) lgkmcnt(0)
  s_barrier
  ds_read_b128 a[208:211], v252 offset:16384
  s_waitcnt lgkmcnt(0)
  v_mfma_f32_16x16x32_bf16 v[80:83], a[208:211], a[144:147], v[208:211]
  s_add_u32 m0, s49, 0xc000
  ds_read_b128 a[212:215], v252 offset:17408
  ds_read_b128 a[216:219], v252 offset:18432
  s_waitcnt lgkmcnt(1)
  v_mfma_f32_16x16x32_bf16 v[80:83], a[212:215], a[148:151], v[80:83]
  s_waitcnt lgkmcnt(0)
  ds_read_b128 a[220:223], v252 offset:19456
  ds_read_b128 a[224:227], v252 offset:20480
  v_mfma_f32_16x16x32_bf16 v[80:83], a[216:219], a[152:155], v[80:83]
  s_waitcnt lgkmcnt(1)
  ds_read_b128 a[228:231], v252 offset:21504
  ds_read_b128 a[232:235], v252 offset:22528
  v_mfma_f32_16x16x32_bf16 v[80:83], a[220:223], a[156:159], v[80:83]
  s_add_u32 s57, s47, 0x0
  buffer_load_dwordx4 v1, s[28:31], s57 offen sc1 lds
  v_mfma_f32_16x16x32_bf16 v[84:87], a[208:211], a[160:163], v[212:215]
  s_add_u32 s58, s47, 0x1000
  ds_read_b128 a[236:239], v252 offset:23552
  ds_read_b128 a[240:243], v252 offset:24576
  v_mfma_f32_16x16x32_bf16 v[84:87], a[212:215], a[164:167], v[84:87]
  s_add_u32 s59, s48, 0x0
  ds_read_b128 a[244:247], v252 offset:25600
  ds_read_b128 a[248:251], v252 offset:26624
  v_mfma_f32_16x16x32_bf16 v[84:87], a[216:219], a[168:171], v[84:87]
  s_add_u32 s56, s48, 0x1000
  buffer_load_dwordx4 v1, s[28:31], s57 offen offset:1024 sc1 lds
  v_mfma_f32_16x16x32_bf16 v[84:87], a[220:223], a[172:175], v[84:87]
  s_sub_u32 s43, 15, s42
  ds_read_b128 a[252:255], v252 offset:27648
  v_accvgpr_read_b32 v34, a136
  v_mfma_f32_16x16x32_bf16 v[88:91], a[208:211], a[176:179], v[216:219]
  s_lshl_b32 s43, s43, 1
  v_rcp_f32 v34, v34
  v_mfma_f32_16x16x32_bf16 v[88:91], a[212:215], a[180:183], v[88:91]
  s_add_u32 s43, s43, 0
  v_accvgpr_read_b32 v16, a8
  v_accvgpr_read_b32 v17, a9
  v_mfma_f32_16x16x32_bf16 v[88:91], a[216:219], a[184:187], v[88:91]
  s_lshl_b32 s44, s41, 14
  v_accvgpr_read_b32 v18, a10
  v_accvgpr_read_b32 v19, a11
  v_mfma_f32_16x16x32_bf16 v[88:91], a[220:223], a[188:191], v[88:91]
  s_add_u32 s47, s47, 0x8000
  buffer_load_dwordx4 v1, s[28:31], s57 offen offset:2048 sc1 lds
  v_mfma_f32_16x16x32_bf16 v[92:95], a[208:211], a[192:195], v[220:223]
  s_add_u32 s48, s48, 0x8000
  ds_read_b128 a[208:211], v252 offset:28672
  v_mul_f32 v16, v16, v34
  v_mfma_f32_16x16x32_bf16 v[92:95], a[212:215], a[196:199], v[92:95]
  s_add_u32 s92, s92, 1
  ds_read_b128 a[212:215], v252 offset:29696
  v_mul_f32 v17, v17, v34
  v_mfma_f32_16x16x32_bf16 v[92:95], a[216:219], a[200:203], v[92:95]
  ds_read_b128 a[216:219], v252 offset:30720
  v_accvgpr_read_b32 v20, a24
  v_mfma_f32_16x16x32_bf16 v[92:95], a[220:223], a[204:207], v[92:95]
  s_waitcnt lgkmcnt(3)
  ds_read_b128 a[220:223], v252 offset:31744
  v_accvgpr_read_b32 v21, a25
  v_mfma_f32_16x16x32_bf16 v[96:99], a[224:227], a[144:147], v[208:211]
  buffer_load_dwordx4 v1, s[28:31], s57 offen offset:3072 sc1 lds
  v_mfma_f32_16x16x32_bf16 v[96:99], a[228:231], a[148:151], v[96:99]
  s_add_u32 m0, s49, 0xd000
  v_accvgpr_read_b32 v22, a26
  v_accvgpr_read_b32 v23, a27
  v_mfma_f32_16x16x32_bf16 v[96:99], a[232:235], a[152:155], v[96:99]
  s_add_u32 s57, s51, 0x0
  v_mul_f32 v18, v18, v34
  v_mul_f32 v19, v19, v34
  v_mfma_f32_16x16x32_bf16 v[96:99], a[236:239], a[156:159], v[96:99]
  v_cvt_pk_bf16_f32 v16, v16, v17
  v_mul_f32 v20, v20, v34
  v_mfma_f32_16x16x32_bf16 v[100:103], a[224:227], a[160:163], v[212:215]
  v_mul_f32 v21, v21, v34
  v_mul_f32 v22, v22, v34
  v_mfma_f32_16x16x32_bf16 v[100:103], a[228:231], a[164:167], v[100:103]
  buffer_load_dwordx4 v1, s[28:31], s58 offen sc1 lds
  v_mfma_f32_16x16x32_bf16 v[100:103], a[232:235], a[168:171], v[100:103]
  v_mul_f32 v23, v23, v34
  v_cvt_pk_bf16_f32 v17, v18, v19
  v_mfma_f32_16x16x32_bf16 v[100:103], a[236:239], a[172:175], v[100:103]
  v_cvt_pk_bf16_f32 v18, v20, v21
  v_cvt_pk_bf16_f32 v19, v22, v23
  v_mfma_f32_16x16x32_bf16 v[104:107], a[224:227], a[176:179], v[216:219]
  v_accvgpr_read_b32 v24, a40
  v_accvgpr_read_b32 v25, a41
  v_mfma_f32_16x16x32_bf16 v[104:107], a[228:231], a[180:183], v[104:107]
  v_accvgpr_read_b32 v26, a42
  v_accvgpr_read_b32 v27, a43
  v_mfma_f32_16x16x32_bf16 v[104:107], a[232:235], a[184:187], v[104:107]
  buffer_load_dwordx4 v1, s[28:31], s58 offen offset:1024 sc1 lds
  v_mfma_f32_16x16x32_bf16 v[104:107], a[236:239], a[188:191], v[104:107]
  v_mul_f32 v24, v24, v34
  v_mul_f32 v25, v25, v34
  v_mfma_f32_16x16x32_bf16 v[108:111], a[224:227], a[192:195], v[220:223]
  v_accvgpr_read_b32 v28, a56
  v_accvgpr_read_b32 v29, a57
  v_mfma_f32_16x16x32_bf16 v[108:111], a[228:231], a[196:199], v[108:111]
  v_accvgpr_read_b32 v30, a58
  v_accvgpr_read_b32 v31, a59
  v_mfma_f32_16x16x32_bf16 v[108:111], a[232:235], a[200:203], v[108:111]
  v_mul_f32 v26, v26, v34
  v_mul_f32 v27, v27, v34
  v_mfma_f32_16x16x32_bf16 v[108:111], a[236:239], a[204:207], v[108:111]
  buffer_load_dwordx4 v1, s[28:31], s58 offen offset:2048 sc1 lds
  v_mfma_f32_16x16x32_bf16 v[112:115], a[240:243], a[144:147], v[208:211]
  v_cvt_pk_bf16_f32 v24, v24, v25
  v_mul_f32 v28, v28, v34
  v_mfma_f32_16x16x32_bf16 v[112:115], a[244:247], a[148:151], v[112:115]
  v_mul_f32 v29, v29, v34
  v_mul_f32 v30, v30, v34
  v_mfma_f32_16x16x32_bf16 v[112:115], a[248:251], a[152:155], v[112:115]
  v_mul_f32 v31, v31, v34
  v_cvt_pk_bf16_f32 v25, v26, v27
  v_mfma_f32_16x16x32_bf16 v[112:115], a[252:255], a[156:159], v[112:115]
  v_accvgpr_read_b32 v20, a88
  v_accvgpr_read_b32 v21, a89
  v_mfma_f32_16x16x32_bf16 v[116:119], a[240:243], a[160:163], v[212:215]
  buffer_load_dwordx4 v1, s[28:31], s58 offen offset:3072 sc1 lds
  v_mfma_f32_16x16x32_bf16 v[116:119], a[244:247], a[164:167], v[116:119]
  s_add_u32 m0, s49, 0x0
  v_accvgpr_read_b32 v22, a90
  v_accvgpr_read_b32 v23, a91
  v_mfma_f32_16x16x32_bf16 v[116:119], a[248:251], a[168:171], v[116:119]
  s_add_u32 s58, s51, 0x1000
  v_mov_b32 v240, 0
  v_mov_b32 v241, 0
  v_mfma_f32_16x16x32_bf16 v[116:119], a[252:255], a[172:175], v[116:119]
  v_mov_b32 v242, 0
  v_mov_b32 v243, 0
  v_mfma_f32_16x16x32_bf16 v[120:123], a[240:243], a[176:179], v[216:219]
  v_cvt_pk_bf16_f32 v26, v28, v29
  v_cvt_pk_bf16_f32 v27, v30, v31
  v_mfma_f32_16x16x32_bf16 v[120:123], a[244:247], a[180:183], v[120:123]
  buffer_load_dwordx4 v1, s[28:31], s59 offen sc1 lds
  v_mfma_f32_16x16x32_bf16 v[120:123], a[248:251], a[184:187], v[120:123]
  v_mul_f32 v20, v20, v34
  v_mul_f32 v21, v21, v34
  v_mfma_f32_16x16x32_bf16 v[120:123], a[252:255], a[188:191], v[120:123]
  v_mul_f32 v22, v22, v34
  v_mul_f32 v23, v23, v34
  v_mfma_f32_16x16x32_bf16 v[124:127], a[240:243], a[192:195], v[220:223]
  v_accvgpr_read_b32 v28, a120
  v_accvgpr_read_b32 v29, a121
  v_mfma_f32_16x16x32_bf16 v[124:127], a[244:247], a[196:199], v[124:127]
  v_accvgpr_read_b32 v30, a122
  v_accvgpr_read_b32 v31, a123
  v_mfma_f32_16x16x32_bf16 v[124:127], a[248:251], a[200:203], v[124:127]
  buffer_load_dwordx4 v1, s[28:31], s59 offen offset:1024 sc1 lds
  v_mfma_f32_16x16x32_bf16 v[124:127], a[252:255], a[204:207], v[124:127]
  s_waitcnt lgkmcnt(0)
  v_mul_f32 v28, v28, v34
  v_mul_f32 v29, v29, v34
  v_mfma_f32_16x16x32_bf16 v[128:131], a[208:211], a[144:147], v[208:211]
  v_mul_f32 v30, v30, v34
  v_mul_f32 v31, v31, v34
  v_mfma_f32_16x16x32_bf16 v[128:131], a[212:215], a[148:151], v[128:131]
  v_accvgpr_read_b32 v35, a140
  v_mfma_f32_16x16x32_bf16 v[128:131], a[216:219], a[152:155], v[128:131]
  v_rcp_f32 v35, v35
  v_mfma_f32_16x16x32_bf16 v[128:131], a[220:223], a[156:159], v[128:131]
  buffer_load_dwordx4 v1, s[28:31], s59 offen offset:2048 sc1 lds
  v_mfma_f32_16x16x32_bf16 v[132:135], a[208:211], a[160:163], v[212:215]
  v_exp_f32 v80, v80
  v_mfma_f32_16x16x32_bf16 v[132:135], a[212:215], a[164:167], v[132:135]
  v_exp_f32 v81, v81
  v_mfma_f32_16x16x32_bf16 v[132:135], a[216:219], a[168:171], v[132:135]
  v_exp_f32 v82, v82
  v_mfma_f32_16x16x32_bf16 v[132:135], a[220:223], a[172:175], v[132:135]
  v_exp_f32 v83, v83
  v_mfma_f32_16x16x32_bf16 v[136:139], a[208:211], a[176:179], v[216:219]
  buffer_load_dwordx4 v1, s[28:31], s59 offen offset:3072 sc1 lds
  v_mfma_f32_16x16x32_bf16 v[136:139], a[212:215], a[180:183], v[136:139]
  s_add_u32 m0, s49, 0x1000
  v_exp_f32 v84, v84
  v_mfma_f32_16x16x32_bf16 v[136:139], a[216:219], a[184:187], v[136:139]
  s_add_u32 s59, s51, 0x2000
  v_exp_f32 v85, v85
  v_mfma_f32_16x16x32_bf16 v[136:139], a[220:223], a[188:191], v[136:139]
  v_exp_f32 v86, v86
  v_mfma_f32_16x16x32_bf16 v[140:143], a[208:211], a[192:195], v[220:223]
  v_exp_f32 v87, v87
  v_mfma_f32_16x16x32_bf16 v[140:143], a[212:215], a[196:199], v[140:143]
  buffer_load_dwordx4 v1, s[28:31], s56 offen sc1 lds
  v_mfma_f32_16x16x32_bf16 v[140:143], a[216:219], a[200:203], v[140:143]
  v_exp_f32 v88, v88
  v_mfma_f32_16x16x32_bf16 v[140:143], a[220:223], a[204:207], v[140:143]
  v_exp_f32 v89, v89
  buffer_load_dwordx4 v1, s[28:31], s56 offen offset:1024 sc1 lds
  buffer_load_dwordx4 v1, s[28:31], s56 offen offset:2048 sc1 lds
  buffer_load_dwordx4 v1, s[28:31], s56 offen offset:3072 sc1 lds
  buffer_store_dwordx4 v[16:19], v1, s[28:31], s57 offen offset:2048 sc1
  s_nop 1
  v_accvgpr_read_b32 v16, a72
  v_mul_f32 v16, v16, v34
  v_accvgpr_read_b32 v17, a73
  v_mul_f32 v17, v17, v34
  v_cvt_pk_bf16_f32 v16, v16, v17
  buffer_store_dwordx4 v[24:27], v1, s[28:31], s58 offen offset:2048 sc1
  v_accvgpr_read_b32 v18, a74
  v_mul_f32 v18, v18, v34
  v_accvgpr_read_b32 v19, a75
  v_mul_f32 v19, v19, v34
  v_cvt_pk_bf16_f32 v17, v18, v19
  v_cvt_pk_bf16_f32 v18, v20, v21
  v_cvt_pk_bf16_f32 v19, v22, v23
  buffer_store_dwordx4 v[16:19], v1, s[28:31], s59 offen offset:2048 sc1
  s_nop 1
  v_accvgpr_read_b32 v16, a12
  v_accvgpr_read_b32 v17, a13
  v_accvgpr_read_b32 v18, a14
  v_accvgpr_read_b32 v19, a15
  v_mfma_f32_32x32x16_bf16 a[0:15], v[240:243], v[240:243], 0
  s_add_u32 s56, s51, 0x3000
  v_accvgpr_read_b32 v24, a104
  v_accvgpr_read_b32 v25, a105
  v_accvgpr_read_b32 v26, a106
  v_accvgpr_read_b32 v27, a107
  v_mul_f32 v24, v24, v34
  v_mul_f32 v25, v25, v34
  v_accvgpr_read_b32 v20, a28
  v_accvgpr_read_b32 v21, a29
  v_accvgpr_read_b32 v22, a30
  v_accvgpr_read_b32 v23, a31
  v_mfma_f32_32x32x16_bf16 a[16:31], v[240:243], v[240:243], 0
  s_add_u32 s57, s51, 0x0
  v_mul_f32 v26, v26, v34
  v_mul_f32 v27, v27, v34
  v_cvt_pk_bf16_f32 v24, v24, v25
  v_cvt_pk_bf16_f32 v25, v26, v27
  v_cvt_pk_bf16_f32 v26, v28, v29
  v_cvt_pk_bf16_f32 v27, v30, v31
  buffer_store_dwordx4 v[24:27], v1, s[28:31], s56 offen offset:2048 sc1
  s_nop 1
  v_accvgpr_read_b32 v24, a44
  v_accvgpr_read_b32 v25, a45
  v_accvgpr_read_b32 v26, a46
  v_accvgpr_read_b32 v27, a47
  v_mfma_f32_32x32x16_bf16 a[32:47], v[240:243], v[240:243], 0
  s_add_u32 s58, s51, 0x1000
  v_mul_f32 v16, v16, v35
  v_mul_f32 v17, v17, v35
  v_mul_f32 v18, v18, v35
  v_mul_f32 v19, v19, v35
  v_cvt_pk_bf16_f32 v16, v16, v17
  v_accvgpr_read_b32 v28, a60
  v_accvgpr_read_b32 v29, a61
  v_accvgpr_read_b32 v30, a62
  v_accvgpr_read_b32 v31, a63
  v_mfma_f32_32x32x16_bf16 a[48:63], v[240:243], v[240:243], 0
  s_add_u32 s59, s51, 0x2000
  v_mul_f32 v20, v20, v35
  v_mul_f32 v21, v21, v35
  v_mul_f32 v22, v22, v35
  v_mul_f32 v23, v23, v35
  v_cvt_pk_bf16_f32 v17, v18, v19
  v_cvt_pk_bf16_f32 v18, v20, v21
  v_cvt_pk_bf16_f32 v19, v22, v23
  buffer_store_dwordx4 v[16:19], v1, s[28:31], s57 offen offset:3072 sc1
  s_nop 1
  v_accvgpr_read_b32 v16, a76
  v_accvgpr_read_b32 v17, a77
  v_accvgpr_read_b32 v18, a78
  v_accvgpr_read_b32 v19, a79
  v_mfma_f32_32x32x16_bf16 a[64:79], v[240:243], v[240:243], 0
  s_add_u32 s56, s51, 0x3000
  v_mul_f32 v24, v24, v35
  v_mul_f32 v25, v25, v35
  v_mul_f32 v26, v26, v35
  v_mul_f32 v27, v27, v35
  v_cvt_pk_bf16_f32 v24, v24, v25
  v_accvgpr_read_b32 v20, a92
  v_accvgpr_read_b32 v21, a93
  v_accvgpr_read_b32 v22, a94
  v_accvgpr_read_b32 v23, a95
  v_mfma_f32_32x32x16_bf16 a[80:95], v[240:243], v[240:243], 0
  s_mul_i32 s51, s43, 745472
  v_mul_f32 v28, v28, v35
  v_mul_f32 v29, v29, v35
  v_mul_f32 v30, v30, v35
  v_mul_f32 v31, v31, v35
  v_cvt_pk_bf16_f32 v25, v26, v27
  v_cvt_pk_bf16_f32 v26, v28, v29
  v_cvt_pk_bf16_f32 v27, v30, v31
  buffer_store_dwordx4 v[24:27], v1, s[28:31], s58 offen offset:3072 sc1
  s_nop 1
  v_accvgpr_read_b32 v24, a108
  v_accvgpr_read_b32 v25, a109
  v_accvgpr_read_b32 v26, a110
  v_accvgpr_read_b32 v27, a111
  v_mfma_f32_32x32x16_bf16 a[96:111], v[240:243], v[240:243], 0
  s_add_u32 s51, s51, s44
  v_accvgpr_read_b32 v28, a124
  v_accvgpr_read_b32 v29, a125
  v_accvgpr_read_b32 v30, a126
  v_accvgpr_read_b32 v31, a127
  v_mul_f32 v16, v16, v35
  v_mul_f32 v17, v17, v35
  v_mfma_f32_32x32x16_bf16 a[112:127], v[240:243], v[240:243], 0
  s_add_u32 s51, s51, 0x2400000
  v_mul_f32 v18, v18, v35
  v_mul_f32 v19, v19, v35
  v_cvt_pk_bf16_f32 v16, v16, v17
  v_mul_f32 v24, v24, v35
  v_mul_f32 v25, v25, v35
  v_mul_f32 v20, v20, v35
  v_mfma_f32_32x32x16_bf16 a[128:143], v[240:243], v[240:243], 0
  v_mul_f32 v21, v21, v35
  v_mul_f32 v22, v22, v35
  v_mul_f32 v23, v23, v35
  v_cvt_pk_bf16_f32 v17, v18, v19
  v_mul_f32 v26, v26, v35
  v_mul_f32 v27, v27, v35
  v_mfma_f32_32x32x16_bf16 v[144:159], v[240:243], v[240:243], 0
  v_cvt_pk_bf16_f32 v24, v24, v25
  v_cvt_pk_bf16_f32 v18, v20, v21
  v_cvt_pk_bf16_f32 v19, v22, v23
  v_mul_f32 v28, v28, v35
  v_mul_f32 v29, v29, v35
  v_mul_f32 v30, v30, v35
  v_mfma_f32_32x32x16_bf16 v[160:175], v[240:243], v[240:243], 0
  v_mul_f32 v31, v31, v35
  v_cvt_pk_bf16_f32 v25, v26, v27
  v_cvt_pk_bf16_f32 v26, v28, v29
  v_cvt_pk_bf16_f32 v27, v30, v31
  v_exp_f32 v90, v90
  v_mfma_f32_16x16x32_bf16 a[232:235], v[240:243], v[240:243], 0
  buffer_store_dwordx4 v[16:19], v1, s[28:31], s59 offen offset:3072 sc1
  v_mfma_f32_16x16x32_bf16 a[236:239], v[240:243], v[240:243], 0
  v_exp_f32 v91, v91
  buffer_store_dwordx4 v[24:27], v1, s[28:31], s56 offen offset:3072 sc1
  v_cvt_pk_bf16_f32 v176, v80, v81
  v_cvt_pk_bf16_f32 v177, v82, v83
  v_cvt_pk_bf16_f32 v184, v84, v85
  v_cvt_pk_bf16_f32 v185, v86, v87
  v_cvt_pk_bf16_f32 v192, v88, v89
  v_cvt_pk_bf16_f32 v193, v90, v91
  v_exp_f32 v92, v92
  v_exp_f32 v93, v93
  v_exp_f32 v94, v94
  v_cvt_pk_bf16_f32 v200, v92, v93
  v_exp_f32 v95, v95
  v_exp_f32 v96, v96
  v_cvt_pk_bf16_f32 v201, v94, v95
  v_exp_f32 v97, v97
  v_exp_f32 v98, v98
  v_cvt_pk_bf16_f32 v178, v96, v97
  v_exp_f32 v99, v99
  v_exp_f32 v100, v100
  v_cvt_pk_bf16_f32 v179, v98, v99
  v_exp_f32 v101, v101
  v_exp_f32 v102, v102
  v_cvt_pk_bf16_f32 v186, v100, v101
  v_exp_f32 v103, v103
  v_exp_f32 v104, v104
  v_cvt_pk_bf16_f32 v187, v102, v103
  v_exp_f32 v105, v105
  v_exp_f32 v106, v106
  v_cvt_pk_bf16_f32 v194, v104, v105
  v_exp_f32 v107, v107
  v_exp_f32 v108, v108
  v_cvt_pk_bf16_f32 v195, v106, v107
  v_exp_f32 v109, v109
  v_exp_f32 v110, v110
  v_cvt_pk_bf16_f32 v202, v108, v109
  v_exp_f32 v111, v111
  s_nop 0
  v_cvt_pk_bf16_f32 v203, v110, v111
  s_cmp_lg_u32 s92, 16
  s_cbranch_scc1 L_ed
  s_branch L_edd
L_t2_B_nox:
  s_waitcnt vmcnt(0) lgkmcnt(0)
  s_barrier
  s_sub_u32 s92, s73, 0x800
  v_mov_b32 v249, 0
  buffer_load_dword v250, v249, s[28:31], s92 offen sc1
  s_add_u32 m0, s71, 0x0
  s_nop 0
  buffer_load_dwordx4 v12, s[12:15], s69 offen lds
  s_add_u32 m0, s71, 0x400
  s_add_u32 s57, s69, 0x2800
  buffer_load_dwordx4 v12, s[12:15], s57 offen lds
  s_add_u32 m0, s71, 0x800
  s_add_u32 s57, s69, 0x80
  buffer_load_dwordx4 v12, s[12:15], s57 offen lds
  s_add_u32 m0, s71, 0xc00
  s_add_u32 s57, s69, 0x2880
  buffer_load_dwordx4 v12, s[12:15], s57 offen lds
  s_add_u32 m0, s71, 0x1000
  s_add_u32 s57, s69, s80
  buffer_load_dwordx4 v4, s[12:15], s57 offen lds
  s_add_u32 s69, s69, 81920
  s_add_u32 m0, s71, 0x20000
  s_nop 0
  buffer_load_dwordx4 v12, s[12:15], s69 offen lds
  s_add_u32 m0, s71, 0x20400
  s_add_u32 s58, s69, 0x2800
  buffer_load_dwordx4 v12, s[12:15], s58 offen lds
  s_add_u32 m0, s71, 0x20800
  s_add_u32 s58, s69, 0x80
  buffer_load_dwordx4 v12, s[12:15], s58 offen lds
  s_add_u32 m0, s71, 0x20c00
  s_add_u32 s58, s69, 0x2880
  buffer_load_dwordx4 v12, s[12:15], s58 offen lds
  s_add_u32 m0, s71, 0x21000
  s_add_u32 s58, s69, s80
  buffer_load_dwordx4 v4, s[12:15], s58 offen lds
  s_add_u32 s69, s69, 81920
  v_bfe_u32 v8, v0, 2, 3
  v_bfe_u32 v9, v0, 5, 1
  v_and_b32 v10, 3, v0
  v_lshlrev_b32 v10, 3, v10
  v_lshl_add_u32 v2, v8, 7, v10
  v_lshl_add_u32 v2, v9, 10, v2
  v_lshl_add_u32 v3, v8, 6, v10
  v_lshl_add_u32 v3, v9, 9, v3
  v_add_u32 v3, 0x1000, v3
  v_lshrrev_b32 v9, 1, v8
  v_lshrrev_b32 v8, 2, v8
  v_xor_b32 v10, 0, v9
  v_lshl_add_u32 v208, v10, 5, v2
  v_add_u32 v214, 0x20000, v208
  v_xor_b32 v10, 1, v9
  v_lshl_add_u32 v209, v10, 5, v2
  v_add_u32 v215, 0x20000, v209
  v_xor_b32 v10, 2, v9
  v_lshl_add_u32 v210, v10, 5, v2
  v_add_u32 v216, 0x20000, v210
  v_xor_b32 v10, 3, v9
  v_lshl_add_u32 v211, v10, 5, v2
  v_add_u32 v217, 0x20000, v211
  v_xor_b32 v10, 0, v8
  v_lshl_add_u32 v212, v10, 5, v3
  v_add_u32 v218, 0x20000, v212
  v_xor_b32 v10, 1, v8
  v_lshl_add_u32 v213, v10, 5, v3
  v_add_u32 v219, 0x20000, v213
  s_lshl_b32 s100, s40, 14
  s_cmp_eq_u32 s40, 3
  s_cselect_b32 s101, 16, 0
  s_add_u32 s101, s101, 48
  s_lshl_b32 s101, s101, 10
  s_add_u32 s101, s101, s100
  v_add_u32 v88, s101, v1
  s_cmp_eq_u32 s40, 0
  s_cselect_b32 s101, 16, 0
  s_add_u32 s101, s101, 96
  s_lshl_b32 s101, s101, 10
  s_sub_u32 s101, s101, s100
  v_add_u32 v89, s101, v1
  s_lshr_b32 s100, s100, 3
  s_add_u32 s101, s100, 0x5000
  v_add_u32 v90, s101, v1
  s_sub_u32 s101, 0x6800, s100
  v_add_u32 v91, s101, v1
  s_lshl_b32 s94, s42, 1
  s_sub_u32 s94, 31, s94
  s_add_u32 s100, s40, 1
  s_lshr_b32 s100, s100, 1
  s_and_b32 s100, s100, 1
  s_add_u32 s94, s94, s100
  s_waitcnt vmcnt(10)
  v_readfirstlane_b32 s43, v250
  s_nop 3
  s_cmp_ge_u32 s43, 32
  s_cbranch_scc1 L_pd_C2
  v_mov_b32 v249, 0
  s_mov_b32 s45, 0x30d40
L_poll_C2:
  buffer_load_dword v250, v249, s[28:31], s92 offen sc1
  s_waitcnt vmcnt(0)
  v_readfirstlane_b32 s43, v250
  s_nop 3
  s_cmp_ge_u32 s43, 32
  s_cbranch_scc1 L_pd_C2
  s_sleep 6
  s_sub_u32 s45, s45, 1
  s_cmp_lg_u32 s45, 0
  s_cbranch_scc1 L_poll_C2
L_pd_C2:
  v_accvgpr_read_b32 v16, a8
  v_accvgpr_read_b32 v17, a9
  v_accvgpr_read_b32 v18, a10
  v_accvgpr_read_b32 v19, a11
  v_accvgpr_read_b32 v34, a136
  v_rcp_f32 v34, v34
  s_nop 0
  v_mul_f32 v16, v16, v34
  v_mul_f32 v17, v17, v34
  v_cvt_pk_bf16_f32 v16, v16, v17
  buffer_load_dwordx4 v[176:179], v1, s[28:31], s68 offen sc1
  buffer_load_dwordx4 v[180:183], v1, s[28:31], s68 offen offset:1024 sc1
  buffer_load_dwordx4 v[184:187], v13, s[28:31], s68 offen sc1
  buffer_load_dwordx4 v[188:191], v13, s[28:31], s68 offen offset:1024 sc1
  s_add_u32 s68, s68, 8192
  buffer_load_dwordx4 v[192:195], v1, s[28:31], s68 offen sc1
  buffer_load_dwordx4 v[196:199], v1, s[28:31], s68 offen offset:1024 sc1
  buffer_load_dwordx4 v[200:203], v13, s[28:31], s68 offen sc1
  buffer_load_dwordx4 v[204:207], v13, s[28:31], s68 offen offset:1024 sc1
  v_mul_f32 v18, v18, v34
  v_mul_f32 v19, v19, v34
  v_cvt_pk_bf16_f32 v17, v18, v19
  v_accvgpr_read_b32 v20, a24
  v_mul_f32 v20, v20, v34
  v_accvgpr_read_b32 v21, a25
  v_mul_f32 v21, v21, v34
  v_cvt_pk_bf16_f32 v18, v20, v21
  v_accvgpr_read_b32 v22, a26
  v_mul_f32 v22, v22, v34
  v_accvgpr_read_b32 v23, a27
  v_mul_f32 v23, v23, v34
  v_cvt_pk_bf16_f32 v19, v22, v23
  s_add_u32 s59, s51, 0x0
  buffer_store_dwordx4 v[16:19], v1, s[28:31], s59 offen offset:2048 sc1
  s_nop 1
  v_accvgpr_read_b32 v16, a72
  v_mul_f32 v16, v16, v34
  v_accvgpr_read_b32 v17, a73
  v_mul_f32 v17, v17, v34
  v_cvt_pk_bf16_f32 v16, v16, v17
  v_accvgpr_read_b32 v24, a40
  v_mul_f32 v24, v24, v34
  v_accvgpr_read_b32 v25, a41
  v_mul_f32 v25, v25, v34
  v_cvt_pk_bf16_f32 v24, v24, v25
  v_accvgpr_read_b32 v26, a42
  v_mul_f32 v26, v26, v34
  v_accvgpr_read_b32 v27, a43
  v_mul_f32 v27, v27, v34
  v_cvt_pk_bf16_f32 v25, v26, v27
  v_accvgpr_read_b32 v28, a56
  v_mul_f32 v28, v28, v34
  v_accvgpr_read_b32 v29, a57
  v_mul_f32 v29, v29, v34
  v_cvt_pk_bf16_f32 v26, v28, v29
  v_accvgpr_read_b32 v30, a58
  v_mul_f32 v30, v30, v34
  v_accvgpr_read_b32 v31, a59
  v_mul_f32 v31, v31, v34
  v_cvt_pk_bf16_f32 v27, v30, v31
  s_add_u32 s56, s51, 0x1000
  buffer_store_dwordx4 v[24:27], v1, s[28:31], s56 offen offset:2048 sc1
  v_accvgpr_read_b32 v18, a74
  v_mul_f32 v18, v18, v34
  v_accvgpr_read_b32 v19, a75
  v_mul_f32 v19, v19, v34
  v_cvt_pk_bf16_f32 v17, v18, v19
  v_accvgpr_read_b32 v20, a88
  v_mul_f32 v20, v20, v34
  v_accvgpr_read_b32 v21, a89
  v_mul_f32 v21, v21, v34
  v_cvt_pk_bf16_f32 v18, v20, v21
  v_accvgpr_read_b32 v22, a90
  v_mul_f32 v22, v22, v34
  v_accvgpr_read_b32 v23, a91
  v_mul_f32 v23, v23, v34
  v_cvt_pk_bf16_f32 v19, v22, v23
  s_add_u32 s57, s51, 0x2000
  buffer_store_dwordx4 v[16:19], v1, s[28:31], s57 offen offset:2048 sc1
  s_nop 1
  v_accvgpr_read_b32 v16, a12
  v_accvgpr_read_b32 v17, a13
  v_accvgpr_read_b32 v18, a14
  v_accvgpr_read_b32 v19, a15
  v_mov_b32 v240, 0
  v_mov_b32 v241, 0
  v_mov_b32 v242, 0
  v_mov_b32 v243, 0
  s_nop 1
  v_mfma_f32_32x32x16_bf16 a[0:15], v[240:243], v[240:243], 0
  s_add_u32 s58, s51, 0x3000
  v_accvgpr_read_b32 v24, a104
  v_accvgpr_read_b32 v25, a105
  v_accvgpr_read_b32 v26, a106
  v_accvgpr_read_b32 v27, a107
  v_mul_f32 v24, v24, v34
  v_mul_f32 v25, v25, v34
  v_accvgpr_read_b32 v20, a28
  v_accvgpr_read_b32 v21, a29
  v_accvgpr_read_b32 v22, a30
  v_accvgpr_read_b32 v23, a31
  v_mfma_f32_32x32x16_bf16 a[16:31], v[240:243], v[240:243], 0
  s_add_u32 s59, s51, 0x0
  v_accvgpr_read_b32 v28, a120
  v_accvgpr_read_b32 v29, a121
  v_accvgpr_read_b32 v30, a122
  v_accvgpr_read_b32 v31, a123
  v_mul_f32 v26, v26, v34
  v_mul_f32 v27, v27, v34
  v_cvt_pk_bf16_f32 v24, v24, v25
  v_cvt_pk_bf16_f32 v25, v26, v27
  v_mul_f32 v28, v28, v34
  v_mul_f32 v29, v29, v34
  v_cvt_pk_bf16_f32 v26, v28, v29
  v_mul_f32 v30, v30, v34
  v_mul_f32 v31, v31, v34
  v_cvt_pk_bf16_f32 v27, v30, v31
  buffer_store_dwordx4 v[24:27], v1, s[28:31], s58 offen offset:2048 sc1
  s_nop 1
  v_accvgpr_read_b32 v24, a44
  v_accvgpr_read_b32 v25, a45
  v_accvgpr_read_b32 v26, a46
  v_accvgpr_read_b32 v27, a47
  v_mfma_f32_32x32x16_bf16 a[32:47], v[240:243], v[240:243], 0
  s_add_u32 s56, s51, 0x1000
  v_accvgpr_read_b32 v35, a140
  v_rcp_f32 v35, v35
  v_accvgpr_read_b32 v28, a60
  v_mul_f32 v16, v16, v35
  v_mul_f32 v17, v17, v35
  v_accvgpr_read_b32 v29, a61
  v_accvgpr_read_b32 v30, a62
  v_accvgpr_read_b32 v31, a63
  v_mfma_f32_32x32x16_bf16 a[48:63], v[240:243], v[240:243], 0
  s_sub_u32 s43, 15, s42
  v_mul_f32 v18, v18, v35
  v_mul_f32 v19, v19, v35
  v_cvt_pk_bf16_f32 v16, v16, v17
  v_mul_f32 v20, v20, v35
  v_mul_f32 v21, v21, v35
  v_mul_f32 v22, v22, v35
  v_cvt_pk_bf16_f32 v17, v18, v19
  v_cvt_pk_bf16_f32 v18, v20, v21
  v_mul_f32 v23, v23, v35
  v_cvt_pk_bf16_f32 v19, v22, v23
  buffer_store_dwordx4 v[16:19], v1, s[28:31], s59 offen offset:3072 sc1
  s_nop 1
  v_accvgpr_read_b32 v16, a76
  v_accvgpr_read_b32 v17, a77
  v_accvgpr_read_b32 v18, a78
  v_accvgpr_read_b32 v19, a79
  v_mfma_f32_32x32x16_bf16 a[64:79], v[240:243], v[240:243], 0
  s_lshl_b32 s43, s43, 1
  v_mul_f32 v24, v24, v35
  v_mul_f32 v25, v25, v35
  v_mul_f32 v26, v26, v35
  v_mul_f32 v27, v27, v35
  v_cvt_pk_bf16_f32 v24, v24, v25
  v_accvgpr_read_b32 v20, a92
  v_accvgpr_read_b32 v21, a93
  v_accvgpr_read_b32 v22, a94
  v_accvgpr_read_b32 v23, a95
  v_mfma_f32_32x32x16_bf16 a[80:95], v[240:243], v[240:243], 0
  s_add_u32 s57, s51, 0x2000
  v_mul_f32 v28, v28, v35
  v_mul_f32 v29, v29, v35
  v_mul_f32 v30, v30, v35
  v_mul_f32 v31, v31, v35
  v_cvt_pk_bf16_f32 v25, v26, v27
  v_cvt_pk_bf16_f32 v26, v28, v29
  v_cvt_pk_bf16_f32 v27, v30, v31
  buffer_store_dwordx4 v[24:27], v1, s[28:31], s56 offen offset:3072 sc1
  s_nop 1
  v_accvgpr_read_b32 v24, a108
  v_accvgpr_read_b32 v25, a109
  v_accvgpr_read_b32 v26, a110
  v_accvgpr_read_b32 v27, a111
  v_mfma_f32_32x32x16_bf16 a[96:111], v[240:243], v[240:243], 0
  s_add_u32 s58, s51, 0x3000
  v_accvgpr_read_b32 v28, a124
  v_accvgpr_read_b32 v29, a125
  v_accvgpr_read_b32 v30, a126
  v_accvgpr_read_b32 v31, a127
  v_mul_f32 v16, v16, v35
  v_mul_f32 v17, v17, v35
  v_mfma_f32_32x32x16_bf16 a[112:127], v[240:243], v[240:243], 0
  s_add_u32 s43, s43, 0
  v_mul_f32 v18, v18, v35
  v_mul_f32 v19, v19, v35
  v_cvt_pk_bf16_f32 v16, v16, v17
  v_mul_f32 v24, v24, v35
  v_mul_f32 v25, v25, v35
  v_mul_f32 v20, v20, v35
  v_mfma_f32_32x32x16_bf16 a[128:143], v[240:243], v[240:243], 0
  s_mul_i32 s51, s43, 745472
  v_mul_f32 v21, v21, v35
  v_mul_f32 v22, v22, v35
  v_mul_f32 v23, v23, v35
  v_cvt_pk_bf16_f32 v17, v18, v19
  v_mul_f32 v26, v26, v35
  v_mul_f32 v27, v27, v35
  v_mfma_f32_32x32x16_bf16 v[144:159], v[240:243], v[240:243], 0
  s_lshl_b32 s44, s41, 14
  v_cvt_pk_bf16_f32 v24, v24, v25
  v_cvt_pk_bf16_f32 v18, v20, v21
  v_cvt_pk_bf16_f32 v19, v22, v23
  v_mul_f32 v28, v28, v35
  v_mul_f32 v29, v29, v35
  v_mul_f32 v30, v30, v35
  v_mfma_f32_32x32x16_bf16 v[160:175], v[240:243], v[240:243], 0
  s_add_u32 s51, s51, s44
  v_mul_f32 v31, v31, v35
  v_cvt_pk_bf16_f32 v25, v26, v27
  v_cvt_pk_bf16_f32 v26, v28, v29
  v_cvt_pk_bf16_f32 v27, v30, v31
  v_mfma_f32_16x16x32_bf16 a[232:235], v[240:243], v[240:243], 0
  s_add_u32 s68, s68, 8192
  buffer_store_dwordx4 v[16:19], v1, s[28:31], s57 offen offset:3072 sc1
  v_mfma_f32_16x16x32_bf16 a[236:239], v[240:243], v[240:243], 0
  s_add_u32 s51, s51, 0x2400000
  buffer_store_dwordx4 v[24:27], v1, s[28:31], s58 offen offset:3072 sc1
  ds_write_b128 v90, a[128:131]
  ds_write_b128 v90, a[132:135] offset:1024
  ds_write_b128 v88, a[0:3]
  ds_write_b128 v88, a[4:7] offset:8192
  ds_write_b128 v88, a[16:19] offset:1024
  ds_write_b128 v88, a[20:23] offset:9216
  ds_write_b128 v88, a[32:35] offset:2048
  ds_write_b128 v88, a[36:39] offset:10240
  ds_write_b128 v88, a[48:51] offset:3072
  ds_write_b128 v88, a[52:55] offset:11264
  ds_write_b128 v88, a[64:67] offset:4096
  ds_write_b128 v88, a[68:71] offset:12288
  ds_write_b128 v88, a[80:83] offset:5120
  ds_write_b128 v88, a[84:87] offset:13312
  ds_write_b128 v88, a[96:99] offset:6144
  ds_write_b128 v88, a[100:103] offset:14336
  ds_write_b128 v88, a[112:115] offset:7168
  ds_write_b128 v88, a[116:119] offset:15360
  s_branch L_merge_hi
L_edn:
  s_waitcnt lgkmcnt(0)
  s_barrier
  v_mfma_f32_16x16x32_bf16 a[128:131], v[224:227], v[144:147], a[128:131]
  s_add_u32 s92, s92, 1
  ds_read_b128 a[208:211], v252
  ds_read_b128 a[212:215], v252 offset:1024
  v_mfma_f32_16x16x32_bf16 a[128:131], v[224:227], v[148:151], a[128:131]
  s_nop 0
  ds_read_b128 a[216:219], v252 offset:2048
  ds_read_b128 a[220:223], v252 offset:3072
  v_mfma_f32_16x16x32_bf16 a[132:135], v[224:227], v[152:155], a[132:135]
  v_cndmask_b32 v16, v5, v208, s[60:61]
  v_cndmask_b32 v17, v5, v209, s[62:63]
  v_mfma_f32_16x16x32_bf16 a[132:135], v[224:227], v[156:159], a[132:135]
  v_cndmask_b32 v18, v5, v210, s[64:65]
  v_cndmask_b32 v19, v5, v211, s[66:67]
  v_mfma_f32_16x16x32_bf16 a[136:139], v[224:227], v[160:163], a[136:139]
  s_nop 0
  ds_read_b128 a[224:227], v252 offset:4096
  ds_read_b128 a[228:231], v252 offset:5120
  v_mfma_f32_16x16x32_bf16 a[136:139], v[224:227], v[164:167], a[136:139]
  ds_read_b128 a[240:243], v252 offset:8192
  v_cndmask_b32 v36, v5, v212, s[60:61]
  v_mfma_f32_16x16x32_bf16 a[140:143], v[224:227], v[168:171], a[140:143]
  ds_read_b128 a[244:247], v252 offset:9216
  v_cndmask_b32 v37, v5, v213, s[62:63]
  v_mfma_f32_16x16x32_bf16 a[140:143], v[224:227], v[172:175], a[140:143]
  ds_read_b128 a[248:251], v252 offset:10240
  v_cndmask_b32 v38, v5, v214, s[64:65]
  v_mfma_f32_16x16x32_bf16 a[112:115], a[232:235], v[144:147], a[112:115]
  v_cndmask_b32 v39, v5, v215, s[66:67]
  v_cndmask_b32 v56, v5, v216, s[60:61]
  v_mfma_f32_16x16x32_bf16 a[112:115], a[236:239], v[148:151], a[112:115]
  ds_read_b128 a[252:255], v252 offset:11264
  v_cndmask_b32 v57, v5, v217, s[62:63]
  v_mfma_f32_16x16x32_bf16 a[116:119], a[232:235], v[152:155], a[116:119]
  v_cndmask_b32 v58, v5, v218, s[64:65]
  v_cndmask_b32 v59, v5, v219, s[66:67]
  v_mfma_f32_16x16x32_bf16 a[116:119], a[236:239], v[156:159], a[116:119]
  v_cndmask_b32 v76, v5, v220, s[60:61]
  v_cndmask_b32 v77, v5, v221, s[62:63]
  v_mfma_f32_16x16x32_bf16 a[120:123], a[232:235], v[160:163], a[120:123]
  v_cndmask_b32 v78, v5, v222, s[64:65]
  v_cndmask_b32 v79, v5, v223, s[66:67]
  v_mfma_f32_16x16x32_bf16 a[120:123], a[236:239], v[164:167], a[120:123]
  v_exp_f32 v112, v112
  v_mfma_f32_16x16x32_bf16 a[124:127], a[232:235], v[168:171], a[124:127]
  ds_read_b128 a[232:235], v252 offset:6144
  v_mov_b32 v32, 0xf149f2ca
  v_mfma_f32_16x16x32_bf16 a[124:127], a[236:239], v[172:175], a[124:127]
  s_waitcnt lgkmcnt(2)
  ds_read_b128 a[236:239], v252 offset:7168
  v_mov_b32 v33, 0xf149f2ca
  v_mfma_f32_16x16x32_bf16 v[16:19], a[208:211], a[144:147], v[16:19]
  v_exp_f32 v113, v113
  v_mfma_f32_16x16x32_bf16 v[16:19], a[212:215], a[148:151], v[16:19]
  v_exp_f32 v114, v114
  v_mfma_f32_16x16x32_bf16 v[16:19], a[216:219], a[152:155], v[16:19]
  v_exp_f32 v115, v115
  v_mfma_f32_16x16x32_bf16 v[16:19], a[220:223], a[156:159], v[16:19]
  v_exp_f32 v128, v128
  v_mfma_f32_16x16x32_bf16 v[20:23], a[208:211], a[160:163], v[212:215]
  v_exp_f32 v129, v129
  v_mfma_f32_16x16x32_bf16 v[20:23], a[212:215], a[164:167], v[20:23]
  v_exp_f32 v130, v130
  v_mfma_f32_16x16x32_bf16 v[20:23], a[216:219], a[168:171], v[20:23]
  v_exp_f32 v131, v131
  v_mfma_f32_16x16x32_bf16 v[20:23], a[220:223], a[172:175], v[20:23]
  v_cvt_pk_bf16_f32 v180, v112, v113
  v_cvt_pk_bf16_f32 v181, v114, v115
  v_mfma_f32_16x16x32_bf16 v[24:27], a[208:211], a[176:179], v[216:219]
  v_cvt_pk_bf16_f32 v182, v128, v129
  v_cvt_pk_bf16_f32 v183, v130, v131
  v_mfma_f32_16x16x32_bf16 v[24:27], a[212:215], a[180:183], v[24:27]
  v_exp_f32 v116, v116
  v_mfma_f32_16x16x32_bf16 v[24:27], a[216:219], a[184:187], v[24:27]
  v_exp_f32 v117, v117
  v_mfma_f32_16x16x32_bf16 v[24:27], a[220:223], a[188:191], v[24:27]
  v_exp_f32 v118, v118
  v_mfma_f32_16x16x32_bf16 v[28:31], a[208:211], a[192:195], v[220:223]
  ds_read_b128 a[208:211], v252 offset:12288
  v_cvt_pk_bf16_f32 v188, v116, v117
  v_mfma_f32_16x16x32_bf16 v[28:31], a[212:215], a[196:199], v[28:31]
  ds_read_b128 a[212:215], v252 offset:13312
  v_mov_b32 v34, 0xf149f2ca
  v_mfma_f32_16x16x32_bf16 v[28:31], a[216:219], a[200:203], v[28:31]
  ds_read_b128 a[216:219], v252 offset:14336
  v_mov_b32 v35, 0xf149f2ca
  v_mfma_f32_16x16x32_bf16 v[28:31], a[220:223], a[204:207], v[28:31]
  ds_read_b128 a[220:223], v252 offset:15360
  v_mov_b32 v48, 0xf149f2ca
  v_mfma_f32_16x16x32_bf16 v[36:39], a[224:227], a[160:163], v[36:39]
  v_exp_f32 v119, v119
  v_mfma_f32_16x16x32_bf16 v[36:39], a[228:231], a[164:167], v[36:39]
  s_waitcnt lgkmcnt(4)
  v_exp_f32 v132, v132
  v_mfma_f32_16x16x32_bf16 v[36:39], a[232:235], a[168:171], v[36:39]
  v_exp_f32 v133, v133
  v_mfma_f32_16x16x32_bf16 v[36:39], a[236:239], a[172:175], v[36:39]
  v_exp_f32 v134, v134
  v_mfma_f32_16x16x32_bf16 v[40:43], a[224:227], a[176:179], v[216:219]
  v_exp_f32 v135, v135
  v_mfma_f32_16x16x32_bf16 v[40:43], a[228:231], a[180:183], v[40:43]
  v_cvt_pk_bf16_f32 v189, v118, v119
  v_cvt_pk_bf16_f32 v190, v132, v133
  v_mfma_f32_16x16x32_bf16 v[40:43], a[232:235], a[184:187], v[40:43]
  v_cvt_pk_bf16_f32 v191, v134, v135
  v_mov_b32 v49, 0xf149f2ca
  v_mfma_f32_16x16x32_bf16 v[40:43], a[236:239], a[188:191], v[40:43]
  v_exp_f32 v120, v120
  v_mfma_f32_16x16x32_bf16 v[44:47], a[224:227], a[192:195], v[220:223]
  ds_read_b128 a[224:227], v252 offset:49152
  v_mov_b32 v50, 0xf149f2ca
  v_mfma_f32_16x16x32_bf16 v[44:47], a[228:231], a[196:199], v[44:47]
  ds_read_b128 a[228:231], v252 offset:50176
  v_mov_b32 v51, 0xf149f2ca
  v_mfma_f32_16x16x32_bf16 v[44:47], a[232:235], a[200:203], v[44:47]
  ds_read_b128 a[232:235], v252 offset:51200
  v_mov_b32 v52, 0xf149f2ca
  v_mfma_f32_16x16x32_bf16 v[44:47], a[236:239], a[204:207], v[44:47]
  ds_read_b128 a[236:239], v252 offset:52224
  v_mov_b32 v53, 0xf149f2ca
  v_mfma_f32_16x16x32_bf16 v[56:59], a[240:243], a[176:179], v[56:59]
  v_exp_f32 v121, v121
  v_mfma_f32_16x16x32_bf16 v[56:59], a[244:247], a[180:183], v[56:59]
  v_exp_f32 v122, v122
  v_mfma_f32_16x16x32_bf16 v[56:59], a[248:251], a[184:187], v[56:59]
  v_exp_f32 v123, v123
  v_mfma_f32_16x16x32_bf16 v[56:59], a[252:255], a[188:191], v[56:59]
  v_exp_f32 v136, v136
  v_mfma_f32_16x16x32_bf16 v[60:63], a[240:243], a[192:195], v[220:223]
  v_exp_f32 v137, v137
  v_mfma_f32_16x16x32_bf16 v[60:63], a[244:247], a[196:199], v[60:63]
  v_exp_f32 v138, v138
  v_mfma_f32_16x16x32_bf16 v[60:63], a[248:251], a[200:203], v[60:63]
  v_exp_f32 v139, v139
  v_mfma_f32_16x16x32_bf16 v[60:63], a[252:255], a[204:207], v[60:63]
  s_waitcnt lgkmcnt(0)
  ds_read_b128 a[240:243], v252 offset:53248
  v_cvt_pk_bf16_f32 v196, v120, v121
  v_mfma_f32_16x16x32_bf16 v[76:79], a[208:211], a[192:195], v[76:79]
  ds_read_b128 a[244:247], v252 offset:54272
  v_cvt_pk_bf16_f32 v197, v122, v123
  v_mfma_f32_16x16x32_bf16 v[76:79], a[212:215], a[196:199], v[76:79]
  v_cvt_pk_bf16_f32 v198, v136, v137
  v_cvt_pk_bf16_f32 v199, v138, v139
  v_mfma_f32_16x16x32_bf16 v[76:79], a[216:219], a[200:203], v[76:79]
  v_exp_f32 v124, v124
  v_mfma_f32_16x16x32_bf16 v[76:79], a[220:223], a[204:207], v[76:79]
  v_exp_f32 v125, v125
  v_mfma_f32_16x16x32_bf16 a[0:3], a[224:227], v[176:179], a[0:3]
  v_exp_f32 v126, v126
  v_mfma_f32_16x16x32_bf16 a[0:3], a[228:231], v[180:183], a[0:3]
  v_exp_f32 v127, v127
  v_mfma_f32_16x16x32_bf16 a[4:7], a[224:227], v[184:187], a[4:7]
  v_exp_f32 v140, v140
  v_mfma_f32_16x16x32_bf16 a[4:7], a[228:231], v[188:191], a[4:7]
  v_exp_f32 v141, v141
  v_mfma_f32_16x16x32_bf16 a[8:11], a[224:227], v[192:195], a[8:11]
  v_exp_f32 v142, v142
  v_mfma_f32_16x16x32_bf16 a[8:11], a[228:231], v[196:199], a[8:11]
  v_exp_f32 v143, v143
  v_mfma_f32_16x16x32_bf16 a[12:15], a[224:227], v[200:203], a[12:15]
  v_cvt_pk_bf16_f32 v204, v124, v125
  v_cvt_pk_bf16_f32 v205, v126, v127
  v_cvt_pk_bf16_f32 v206, v140, v141
  v_cvt_pk_bf16_f32 v207, v142, v143
  s_nop 1
  v_mfma_f32_16x16x32_bf16 a[12:15], a[228:231], v[204:207], a[12:15]
  s_nop 0
  ds_read_b128 a[248:251], v252 offset:55296
  ds_read_b128 a[252:255], v252 offset:56320
  v_mfma_f32_16x16x32_bf16 a[16:19], a[232:235], v[176:179], a[16:19]
  s_nop 0
  ds_read_b128 a[208:211], v252 offset:57344
  ds_read_b128 a[212:215], v252 offset:58368
  v_mfma_f32_16x16x32_bf16 a[16:19], a[236:239], v[180:183], a[16:19]
  s_nop 0
  ds_read_b128 a[216:219], v252 offset:59392
  ds_read_b128 a[220:223], v252 offset:60416
  v_mfma_f32_16x16x32_bf16 a[20:23], a[232:235], v[184:187], a[20:23]
  s_nop 0
  ds_read_b128 a[224:227], v252 offset:61440
  ds_read_b128 a[228:231], v252 offset:62464
  v_mfma_f32_16x16x32_bf16 a[20:23], a[236:239], v[188:191], a[20:23]
  v_exp_f32 v16, v16
  v_mfma_f32_16x16x32_bf16 a[24:27], a[232:235], v[192:195], a[24:27]
  v_exp_f32 v17, v17
  v_mfma_f32_16x16x32_bf16 a[24:27], a[236:239], v[196:199], a[24:27]
  v_exp_f32 v18, v18
  v_mfma_f32_16x16x32_bf16 a[28:31], a[232:235], v[200:203], a[28:31]
  v_exp_f32 v19, v19
  v_mfma_f32_16x16x32_bf16 a[28:31], a[236:239], v[204:207], a[28:31]
  s_waitcnt lgkmcnt(4)
  v_exp_f32 v20, v20
  v_mfma_f32_16x16x32_bf16 a[32:35], a[240:243], v[176:179], a[32:35]
  v_exp_f32 v21, v21
  v_mfma_f32_16x16x32_bf16 a[32:35], a[244:247], v[180:183], a[32:35]
  v_exp_f32 v22, v22
  v_mfma_f32_16x16x32_bf16 a[36:39], a[240:243], v[184:187], a[36:39]
  v_exp_f32 v23, v23
  v_mfma_f32_16x16x32_bf16 a[36:39], a[244:247], v[188:191], a[36:39]
  v_exp_f32 v24, v24
  v_mfma_f32_16x16x32_bf16 a[40:43], a[240:243], v[192:195], a[40:43]
  v_exp_f32 v25, v25
  v_mfma_f32_16x16x32_bf16 a[40:43], a[244:247], v[196:199], a[40:43]
  v_exp_f32 v26, v26
  v_mfma_f32_16x16x32_bf16 a[44:47], a[240:243], v[200:203], a[44:47]
  v_exp_f32 v27, v27
  v_mfma_f32_16x16x32_bf16 a[44:47], a[244:247], v[204:207], a[44:47]
  v_exp_f32 v28, v28
  v_mfma_f32_16x16x32_bf16 a[48:51], a[248:251], v[176:179], a[48:51]
  v_exp_f32 v29, v29
  v_mfma_f32_16x16x32_bf16 a[48:51], a[252:255], v[180:183], a[48:51]
  v_exp_f32 v30, v30
  v_mfma_f32_16x16x32_bf16 a[52:55], a[248:251], v[184:187], a[52:55]
  v_exp_f32 v31, v31
  v_mfma_f32_16x16x32_bf16 a[52:55], a[252:255], v[188:191], a[52:55]
  v_exp_f32 v32, v32
  v_mfma_f32_16x16x32_bf16 a[56:59], a[248:251], v[192:195], a[56:59]
  v_exp_f32 v33, v33
  v_mfma_f32_16x16x32_bf16 a[56:59], a[252:255], v[196:199], a[56:59]
  v_exp_f32 v34, v34
  v_mfma_f32_16x16x32_bf16 a[60:63], a[248:251], v[200:203], a[60:63]
  v_exp_f32 v35, v35
  v_mfma_f32_16x16x32_bf16 a[60:63], a[252:255], v[204:207], a[60:63]
  v_exp_f32 v36, v36
  v_mfma_f32_16x16x32_bf16 a[64:67], a[208:211], v[176:179], a[64:67]
  v_exp_f32 v37, v37
  v_mfma_f32_16x16x32_bf16 a[64:67], a[212:215], v[180:183], a[64:67]
  v_exp_f32 v38, v38
  v_mfma_f32_16x16x32_bf16 a[68:71], a[208:211], v[184:187], a[68:71]
  v_exp_f32 v39, v39
  v_mfma_f32_16x16x32_bf16 a[68:71], a[212:215], v[188:191], a[68:71]
  v_exp_f32 v40, v40
  v_mfma_f32_16x16x32_bf16 a[72:75], a[208:211], v[192:195], a[72:75]
  v_exp_f32 v41, v41
  v_mfma_f32_16x16x32_bf16 a[72:75], a[212:215], v[196:199], a[72:75]
  v_exp_f32 v42, v42
  v_mfma_f32_16x16x32_bf16 a[76:79], a[208:211], v[200:203], a[76:79]
  v_exp_f32 v43, v43
  v_mfma_f32_16x16x32_bf16 a[76:79], a[212:215], v[204:207], a[76:79]
  s_waitcnt lgkmcnt(0)
  v_exp_f32 v44, v44
  v_mfma_f32_16x16x32_bf16 a[80:83], a[216:219], v[176:179], a[80:83]
  v_exp_f32 v45, v45
  v_mfma_f32_16x16x32_bf16 a[80:83], a[220:223], v[180:183], a[80:83]
  v_exp_f32 v46, v46
  v_mfma_f32_16x16x32_bf16 a[84:87], a[216:219], v[184:187], a[84:87]
  v_exp_f32 v47, v47
  v_mfma_f32_16x16x32_bf16 a[84:87], a[220:223], v[188:191], a[84:87]
  ds_read_b128 a[232:235], v252 offset:63488
  v_mov_b32 v54, 0xf149f2ca
  v_mfma_f32_16x16x32_bf16 a[88:91], a[216:219], v[192:195], a[88:91]
  ds_read_b128 a[236:239], v252 offset:64512
  v_mov_b32 v55, 0xf149f2ca
  v_mfma_f32_16x16x32_bf16 a[88:91], a[220:223], v[196:199], a[88:91]
  v_mov_b32 v64, 0xf149f2ca
  v_mov_b32 v65, 0xf149f2ca
  v_mfma_f32_16x16x32_bf16 a[92:95], a[216:219], v[200:203], a[92:95]
  v_mov_b32 v66, 0xf149f2ca
  v_mov_b32 v67, 0xf149f2ca
  v_mfma_f32_16x16x32_bf16 a[92:95], a[220:223], v[204:207], a[92:95]
  v_mov_b32 v68, 0xf149f2ca
  v_mov_b32 v69, 0xf149f2ca
  v_mfma_f32_16x16x32_bf16 a[96:99], a[224:227], v[176:179], a[96:99]
  v_mov_b32 v70, 0xf149f2ca
  v_mov_b32 v71, 0xf149f2ca
  v_mfma_f32_16x16x32_bf16 a[96:99], a[228:231], v[180:183], a[96:99]
  v_mov_b32 v72, 0xf149f2ca
  v_mov_b32 v73, 0xf149f2ca
  v_mfma_f32_16x16x32_bf16 a[100:103], a[224:227], v[184:187], a[100:103]
  v_mov_b32 v74, 0xf149f2ca
  v_mov_b32 v75, 0xf149f2ca
  v_mfma_f32_16x16x32_bf16 a[100:103], a[228:231], v[188:191], a[100:103]
  v_cvt_pk_bf16_f32 v144, v16, v17
  v_cvt_pk_bf16_f32 v145, v18, v19
  v_mfma_f32_16x16x32_bf16 a[104:107], a[224:227], v[192:195], a[104:107]
  v_cvt_pk_bf16_f32 v152, v20, v21
  v_cvt_pk_bf16_f32 v153, v22, v23
  v_mfma_f32_16x16x32_bf16 a[104:107], a[228:231], v[196:199], a[104:107]
  v_cvt_pk_bf16_f32 v160, v24, v25
  v_cvt_pk_bf16_f32 v161, v26, v27
  v_mfma_f32_16x16x32_bf16 a[108:111], a[224:227], v[200:203], a[108:111]
  v_cvt_pk_bf16_f32 v168, v28, v29
  v_cvt_pk_bf16_f32 v169, v30, v31
  v_mfma_f32_16x16x32_bf16 a[108:111], a[228:231], v[204:207], a[108:111]
  v_cvt_pk_bf16_f32 v146, v32, v33
  v_cvt_pk_bf16_f32 v147, v34, v35
  v_cvt_pk_bf16_f32 v154, v36, v37
  v_cvt_pk_bf16_f32 v155, v38, v39
  v_cvt_pk_bf16_f32 v162, v40, v41
  v_cvt_pk_bf16_f32 v163, v42, v43
  v_cvt_pk_bf16_f32 v170, v44, v45
  v_cvt_pk_bf16_f32 v171, v46, v47
L_t1_A:
  s_waitcnt vmcnt(0) lgkmcnt(0)
  s_barrier
  v_mfma_f32_16x16x32_bf16 a[128:131], v[224:227], v[176:179], a[128:131]
  s_lshl_b32 s43, s42, 16
  ds_read_b128 a[208:211], v252 offset:32768
  ds_read_b128 a[212:215], v252 offset:34816
  v_mfma_f32_16x16x32_bf16 a[128:131], v[224:227], v[180:183], a[128:131]
  s_sub_u32 s48, s46, s43
  ds_read_b128 a[216:219], v252 offset:36864
  ds_read_b128 a[220:223], v252 offset:38912
  v_mfma_f32_16x16x32_bf16 a[132:135], v[224:227], v[184:187], a[132:135]
  s_add_u32 s48, s48, 0xf8000
  ds_read_b128 a[224:227], v252 offset:40960
  ds_read_b128 a[228:231], v252 offset:43008
  v_mfma_f32_16x16x32_bf16 a[132:135], v[224:227], v[188:191], a[132:135]
  s_add_u32 m0, s49, 0x0
  ds_read_b128 a[240:243], v252 offset:45056
  ds_read_b128 a[244:247], v252 offset:47104
  v_mfma_f32_16x16x32_bf16 a[136:139], v[224:227], v[192:195], a[136:139]
  s_add_u32 s57, s48, 0x0
  buffer_load_dwordx4 v1, s[28:31], s57 offen sc1 lds
  v_mfma_f32_16x16x32_bf16 a[136:139], v[224:227], v[196:199], a[136:139]
  s_add_u32 s58, s48, 0x1000
  ds_read_b128 a[248:251], v252 offset:33792
  ds_read_b128 a[252:255], v252 offset:35840
  v_mfma_f32_16x16x32_bf16 a[140:143], v[224:227], v[200:203], a[140:143]
  s_add_u32 s59, s48, 0x2000
  buffer_load_dwordx4 v1, s[28:31], s57 offen offset:1024 sc1 lds
  v_mfma_f32_16x16x32_bf16 a[140:143], v[224:227], v[204:207], a[140:143]
  s_add_u32 s56, s48, 0x3000
  v_exp_f32 v56, v56
  v_mfma_f32_16x16x32_bf16 a[112:115], a[232:235], v[176:179], a[112:115]
  s_lshl_b32 s94, s42, 1
  v_exp_f32 v57, v57
  v_mfma_f32_16x16x32_bf16 a[112:115], a[236:239], v[180:183], a[112:115]
  s_add_u32 s48, s48, 0x8000
  v_exp_f32 v58, v58
  v_mfma_f32_16x16x32_bf16 a[116:119], a[232:235], v[184:187], a[116:119]
  s_add_u32 s94, s94, 1
  v_exp_f32 v59, v59
  v_mfma_f32_16x16x32_bf16 a[116:119], a[236:239], v[188:191], a[116:119]
  s_add_u32 s92, s92, 1
  buffer_load_dwordx4 v1, s[28:31], s57 offen offset:2048 sc1 lds
  v_mfma_f32_16x16x32_bf16 a[120:123], a[232:235], v[192:195], a[120:123]
  v_exp_f32 v72, v72
  v_mfma_f32_16x16x32_bf16 a[120:123], a[236:239], v[196:199], a[120:123]
  v_exp_f32 v73, v73
  v_mfma_f32_16x16x32_bf16 a[124:127], a[232:235], v[200:203], a[124:127]
  ds_read_b128 a[232:235], v252 offset:37888
  v_cvt_pk_bf16_f32 v164, v56, v57
  v_mfma_f32_16x16x32_bf16 a[124:127], a[236:239], v[204:207], a[124:127]
  v_exp_f32 v74, v74
  v_mfma_f32_16x16x32_bf16 a[128:131], v[224:227], v[144:147], a[128:131]
  buffer_load_dwordx4 v1, s[28:31], s57 offen offset:3072 sc1 lds
  v_mfma_f32_16x16x32_bf16 a[132:135], v[224:227], v[152:155], a[132:135]
  s_add_u32 m0, s49, 0x1000
  v_exp_f32 v75, v75
  v_mfma_f32_16x16x32_bf16 a[136:139], v[224:227], v[160:163], a[136:139]
  s_add_u32 s57, s51, 0x0
  ds_read_b128 a[236:239], v252 offset:39936
  v_cvt_pk_bf16_f32 v165, v58, v59
  v_mfma_f32_16x16x32_bf16 a[140:143], v[224:227], v[168:171], a[140:143]
  s_waitcnt lgkmcnt(2)
  v_cvt_pk_bf16_f32 v166, v72, v73
  v_cvt_pk_bf16_f32 v167, v74, v75
  v_mfma_f32_16x16x32_bf16 a[0:3], a[208:211], v[144:147], a[0:3]
  v_exp_f32 v60, v60
  v_mfma_f32_16x16x32_bf16 a[4:7], a[208:211], v[152:155], a[4:7]
  buffer_load_dwordx4 v1, s[28:31], s58 offen sc1 lds
  v_mfma_f32_16x16x32_bf16 a[8:11], a[208:211], v[160:163], a[8:11]
  v_exp_f32 v61, v61
  v_mfma_f32_16x16x32_bf16 a[12:15], a[208:211], v[168:171], a[12:15]
  v_exp_f32 v62, v62
  v_mfma_f32_16x16x32_bf16 a[16:19], a[212:215], v[144:147], a[16:19]
  v_exp_f32 v63, v63
  v_mfma_f32_16x16x32_bf16 a[20:23], a[212:215], v[152:155], a[20:23]
  v_exp_f32 v76, v76
  v_mfma_f32_16x16x32_bf16 a[24:27], a[212:215], v[160:163], a[24:27]
  buffer_load_dwordx4 v1, s[28:31], s58 offen offset:1024 sc1 lds
  v_mfma_f32_16x16x32_bf16 a[28:31], a[212:215], v[168:171], a[28:31]
  v_exp_f32 v77, v77
  v_mfma_f32_16x16x32_bf16 a[32:35], a[216:219], v[144:147], a[32:35]
  v_exp_f32 v78, v78
  v_mfma_f32_16x16x32_bf16 a[36:39], a[216:219], v[152:155], a[36:39]
  v_exp_f32 v79, v79
  v_mfma_f32_16x16x32_bf16 a[40:43], a[216:219], v[160:163], a[40:43]
  ds_read_b128 a[208:211], v252 offset:41984
  v_cvt_pk_bf16_f32 v172, v60, v61
  v_mfma_f32_16x16x32_bf16 a[44:47], a[216:219], v[168:171], a[44:47]
  buffer_load_dwordx4 v1, s[28:31], s58 offen offset:2048 sc1 lds
  v_mfma_f32_16x16x32_bf16 a[48:51], a[220:223], v[144:147], a[48:51]
  ds_read_b128 a[212:215], v252 offset:44032
  v_cvt_pk_bf16_f32 v173, v62, v63
  v_mfma_f32_16x16x32_bf16 a[52:55], a[220:223], v[152:155], a[52:55]
  ds_read_b128 a[216:219], v252 offset:46080
  v_cvt_pk_bf16_f32 v174, v76, v77
  v_mfma_f32_16x16x32_bf16 a[56:59], a[220:223], v[160:163], a[56:59]
  v_cvt_pk_bf16_f32 v175, v78, v79
  v_add_u32 v249, 0x1c400, v1
  v_mfma_f32_16x16x32_bf16 a[60:63], a[220:223], v[168:171], a[60:63]
  s_nop 0
  ds_read_b128 a[220:223], v252 offset:48128
  ds_read_b128 v[240:243], v249
  v_mfma_f32_16x16x32_bf16 a[64:67], a[224:227], v[144:147], a[64:67]
  buffer_load_dwordx4 v1, s[28:31], s58 offen offset:3072 sc1 lds
  v_mfma_f32_16x16x32_bf16 a[68:71], a[224:227], v[152:155], a[68:71]
  s_add_u32 m0, s49, 0x2000
  v_accvgpr_read_b32 v96, a128
  v_accvgpr_read_b32 v80, a0
  v_mfma_f32_16x16x32_bf16 a[72:75], a[224:227], v[160:163], a[72:75]
  s_add_u32 s58, s51, 0x1000
  v_rcp_f32 v96, v96
  v_mfma_f32_16x16x32_bf16 a[76:79], a[224:227], v[168:171], a[76:79]
  v_accvgpr_read_b32 v81, a1
  v_accvgpr_read_b32 v82, a2
  v_mfma_f32_16x16x32_bf16 a[80:83], a[228:231], v[144:147], a[80:83]
  v_accvgpr_read_b32 v83, a3
  v_mul_f32 v80, v80, v96
  v_mfma_f32_16x16x32_bf16 a[84:87], a[228:231], v[152:155], a[84:87]
  buffer_load_dwordx4 v1, s[28:31], s59 offen sc1 lds
  v_mfma_f32_16x16x32_bf16 a[88:91], a[228:231], v[160:163], a[88:91]
  v_mul_f32 v81, v81, v96
  v_accvgpr_read_b32 v88, a32
  v_mfma_f32_16x16x32_bf16 a[92:95], a[228:231], v[168:171], a[92:95]
  v_accvgpr_read_b32 v89, a33
  v_accvgpr_read_b32 v84, a16
  v_mfma_f32_16x16x32_bf16 a[96:99], a[240:243], v[144:147], a[96:99]
  v_accvgpr_read_b32 v85, a17
  v_accvgpr_read_b32 v86, a18
  v_mfma_f32_16x16x32_bf16 a[100:103], a[240:243], v[152:155], a[100:103]
  v_accvgpr_read_b32 v87, a19
  v_mul_f32 v82, v82, v96
  v_mfma_f32_16x16x32_bf16 a[104:107], a[240:243], v[160:163], a[104:107]
  buffer_load_dwordx4 v1, s[28:31], s59 offen offset:1024 sc1 lds
  v_mfma_f32_16x16x32_bf16 a[108:111], a[240:243], v[168:171], a[108:111]
  v_mul_f32 v83, v83, v96
  v_cvt_pk_bf16_f32 v80, v80, v81
  v_mfma_f32_16x16x32_bf16 a[112:115], a[244:247], v[144:147], a[112:115]
  v_accvgpr_read_b32 v90, a34
  v_accvgpr_read_b32 v91, a35
  v_mfma_f32_16x16x32_bf16 a[116:119], a[244:247], v[152:155], a[116:119]
  v_mul_f32 v88, v88, v96
  v_mul_f32 v89, v89, v96
  v_mfma_f32_16x16x32_bf16 a[120:123], a[244:247], v[160:163], a[120:123]
  v_mul_f32 v84, v84, v96
  v_mul_f32 v85, v85, v96
  v_mfma_f32_16x16x32_bf16 a[124:127], a[244:247], v[168:171], a[124:127]
  buffer_load_dwordx4 v1, s[28:31], s59 offen offset:2048 sc1 lds
  v_mfma_f32_16x16x32_bf16 a[136:139], v[224:227], v[164:167], a[136:139]
  v_mul_f32 v86, v86, v96
  v_mul_f32 v87, v87, v96
  v_mfma_f32_16x16x32_bf16 a[140:143], v[224:227], v[172:175], a[140:143]
  v_cvt_pk_bf16_f32 v81, v82, v83
  v_accvgpr_read_b32 v92, a48
  v_mfma_f32_16x16x32_bf16 a[8:11], a[248:251], v[164:167], a[8:11]
  v_accvgpr_read_b32 v93, a49
  v_accvgpr_read_b32 v94, a50
  v_mfma_f32_16x16x32_bf16 a[12:15], a[248:251], v[172:175], a[12:15]
  v_accvgpr_read_b32 v95, a51
  v_mul_f32 v90, v90, v96
  v_mfma_f32_16x16x32_bf16 a[24:27], a[252:255], v[164:167], a[24:27]
  buffer_load_dwordx4 v1, s[28:31], s59 offen offset:3072 sc1 lds
  v_mfma_f32_16x16x32_bf16 a[28:31], a[252:255], v[172:175], a[28:31]
  s_waitcnt lgkmcnt(0)
  v_mul_f32 v91, v91, v96
  v_cvt_pk_bf16_f32 v88, v88, v89
  v_mfma_f32_16x16x32_bf16 a[40:43], a[232:235], v[164:167], a[40:43]
  s_add_u32 m0, s49, 0x3000
  v_cvt_pk_bf16_f32 v82, v84, v85
  v_cvt_pk_bf16_f32 v83, v86, v87
  v_mfma_f32_16x16x32_bf16 a[44:47], a[232:235], v[172:175], a[44:47]
  s_add_u32 s59, s51, 0x2000
  v_mul_f32 v92, v92, v96
  v_mul_f32 v93, v93, v96
  v_mfma_f32_16x16x32_bf16 a[56:59], a[236:239], v[164:167], a[56:59]
  v_mul_f32 v94, v94, v96
  v_mul_f32 v95, v95, v96
  v_mfma_f32_16x16x32_bf16 a[60:63], a[236:239], v[172:175], a[60:63]
  buffer_load_dwordx4 v1, s[28:31], s56 offen sc1 lds
  v_mfma_f32_16x16x32_bf16 a[72:75], a[208:211], v[164:167], a[72:75]
  v_cvt_pk_bf16_f32 v89, v90, v91
  v_cvt_pk_bf16_f32 v90, v92, v93
  v_mfma_f32_16x16x32_bf16 a[76:79], a[208:211], v[172:175], a[76:79]
  v_cvt_pk_bf16_f32 v91, v94, v95
  v_accvgpr_read_b32 v84, a80
  v_mfma_f32_16x16x32_bf16 a[88:91], a[212:215], v[164:167], a[88:91]
  v_accvgpr_read_b32 v85, a81
  v_accvgpr_read_b32 v86, a82
  v_mfma_f32_16x16x32_bf16 a[92:95], a[212:215], v[172:175], a[92:95]
  v_accvgpr_read_b32 v87, a83
  v_mul_f32 v84, v84, v96
  v_mfma_f32_16x16x32_bf16 a[104:107], a[216:219], v[164:167], a[104:107]
  buffer_load_dwordx4 v1, s[28:31], s56 offen offset:1024 sc1 lds
  v_mfma_f32_16x16x32_bf16 a[108:111], a[216:219], v[172:175], a[108:111]
  v_mul_f32 v85, v85, v96
  v_mul_f32 v86, v86, v96
  v_mfma_f32_16x16x32_bf16 a[120:123], a[220:223], v[164:167], a[120:123]
  v_mul_f32 v87, v87, v96
  v_accvgpr_read_b32 v92, a112
  v_mfma_f32_16x16x32_bf16 a[124:127], a[220:223], v[172:175], a[124:127]
  v_accvgpr_read_b32 v93, a113
  v_accvgpr_read_b32 v94, a114
  buffer_load_dwordx4 v1, s[28:31], s56 offen offset:2048 sc1 lds
  buffer_load_dwordx4 v1, s[28:31], s56 offen offset:3072 sc1 lds
  buffer_store_dwordx4 v[80:83], v1, s[28:31], s57 offen sc1
  buffer_store_dwordx4 v[88:91], v1, s[28:31], s58 offen sc1
  s_nop 0
  v_accvgpr_read_b32 v80, a64
  v_accvgpr_read_b32 v81, a65
  v_accvgpr_read_b32 v82, a66
  v_accvgpr_read_b32 v83, a67
  v_mul_f32 v80, v80, v96
  v_mul_f32 v81, v81, v96
  v_mul_f32 v82, v82, v96
  v_mul_f32 v83, v83, v96
  v_cvt_pk_bf16_f32 v80, v80, v81
  v_cvt_pk_bf16_f32 v81, v82, v83
  v_cvt_pk_bf16_f32 v82, v84, v85
  v_cvt_pk_bf16_f32 v83, v86, v87
  buffer_store_dwordx4 v[80:83], v1, s[28:31], s59 offen sc1
  v_accvgpr_read_b32 v88, a96
  v_accvgpr_read_b32 v89, a97
  v_accvgpr_read_b32 v90, a98
  v_accvgpr_read_b32 v91, a99
  v_accvgpr_read_b32 v95, a115
  v_mul_f32 v88, v88, v96
  v_mul_f32 v89, v89, v96
  v_mul_f32 v90, v90, v96
  v_mul_f32 v91, v91, v96
  v_mul_f32 v92, v92, v96
  v_mul_f32 v93, v93, v96
  v_mul_f32 v94, v94, v96
  v_mul_f32 v95, v95, v96
  v_cvt_pk_bf16_f32 v88, v88, v89
  v_cvt_pk_bf16_f32 v89, v90, v91
  v_cvt_pk_bf16_f32 v90, v92, v93
  v_cvt_pk_bf16_f32 v91, v94, v95
  s_add_u32 s56, s51, 0x3000
  buffer_store_dwordx4 v[88:91], v1, s[28:31], s56 offen sc1
  v_accvgpr_read_b32 v97, a132
  v_rcp_f32 v97, v97
  v_accvgpr_read_b32 v80, a4
  v_accvgpr_read_b32 v81, a5
  v_accvgpr_read_b32 v82, a6
  v_accvgpr_read_b32 v83, a7
  v_accvgpr_read_b32 v84, a20
  v_accvgpr_read_b32 v85, a21
  v_accvgpr_read_b32 v86, a22
  v_accvgpr_read_b32 v87, a23
  v_mul_f32 v80, v80, v97
  v_mul_f32 v81, v81, v97
  v_mul_f32 v82, v82, v97
  v_mul_f32 v83, v83, v97
  v_mul_f32 v84, v84, v97
  v_mul_f32 v85, v85, v97
  v_mul_f32 v86, v86, v97
  v_mul_f32 v87, v87, v97
  v_cvt_pk_bf16_f32 v80, v80, v81
  v_cvt_pk_bf16_f32 v81, v82, v83
  v_cvt_pk_bf16_f32 v82, v84, v85
  v_cvt_pk_bf16_f32 v83, v86, v87
  s_add_u32 s57, s51, 0x0
  buffer_store_dwordx4 v[80:83], v1, s[28:31], s57 offen offset:1024 sc1
  v_accvgpr_read_b32 v88, a36
  v_accvgpr_read_b32 v89, a37
  v_accvgpr_read_b32 v90, a38
  v_accvgpr_read_b32 v91, a39
  v_accvgpr_read_b32 v92, a52
  v_accvgpr_read_b32 v93, a53
  v_accvgpr_read_b32 v94, a54
  v_accvgpr_read_b32 v95, a55
  v_mul_f32 v88, v88, v97
  v_mul_f32 v89, v89, v97
  v_mul_f32 v90, v90, v97
  v_mul_f32 v91, v91, v97
  v_mul_f32 v92, v92, v97
  v_mul_f32 v93, v93, v97
  v_mul_f32 v94, v94, v97
  v_mul_f32 v95, v95, v97
  v_cvt_pk_bf16_f32 v88, v88, v89
  v_cvt_pk_bf16_f32 v89, v90, v91
  v_cvt_pk_bf16_f32 v90, v92, v93
  v_cvt_pk_bf16_f32 v91, v94, v95
  s_add_u32 s58, s51, 0x1000
  buffer_store_dwordx4 v[88:91], v1, s[28:31], s58 offen offset:1024 sc1
  v_accvgpr_read_b32 v80, a68
  v_accvgpr_read_b32 v81, a69
  v_accvgpr_read_b32 v82, a70
  v_accvgpr_read_b32 v83, a71
  v_accvgpr_read_b32 v84, a84
  v_accvgpr_read_b32 v85, a85
  v_accvgpr_read_b32 v86, a86
  v_accvgpr_read_b32 v87, a87
  v_mul_f32 v80, v80, v97
  v_mul_f32 v81, v81, v97
  v_mul_f32 v82, v82, v97
  v_mul_f32 v83, v83, v97
  v_mul_f32 v84, v84, v97
  v_mul_f32 v85, v85, v97
  v_mul_f32 v86, v86, v97
  v_mul_f32 v87, v87, v97
  v_cvt_pk_bf16_f32 v80, v80, v81
  v_cvt_pk_bf16_f32 v81, v82, v83
  v_cvt_pk_bf16_f32 v82, v84, v85
  v_cvt_pk_bf16_f32 v83, v86, v87
  s_add_u32 s59, s51, 0x2000
  buffer_store_dwordx4 v[80:83], v1, s[28:31], s59 offen offset:1024 sc1
  v_accvgpr_read_b32 v88, a100
  v_accvgpr_read_b32 v89, a101
  v_accvgpr_read_b32 v90, a102
  v_accvgpr_read_b32 v91, a103
  v_accvgpr_read_b32 v92, a116
  v_accvgpr_read_b32 v93, a117
  v_accvgpr_read_b32 v94, a118
  v_accvgpr_read_b32 v95, a119
  v_mul_f32 v88, v88, v97
  v_mul_f32 v89, v89, v97
  v_mul_f32 v90, v90, v97
  v_mul_f32 v91, v91, v97
  v_mul_f32 v92, v92, v97
  v_mul_f32 v93, v93, v97
  v_mul_f32 v94, v94, v97
  v_mul_f32 v95, v95, v97
  v_cvt_pk_bf16_f32 v88, v88, v89
  v_cvt_pk_bf16_f32 v89, v90, v91
  v_cvt_pk_bf16_f32 v90, v92, v93
  v_cvt_pk_bf16_f32 v91, v94, v95
  s_add_u32 s56, s51, 0x3000
  buffer_store_dwordx4 v[88:91], v1, s[28:31], s56 offen offset:1024 sc1
  v_accvgpr_read_b32 v232, a128
  v_accvgpr_read_b32 v233, a132
  v_accvgpr_read_b32 v234, a136
  v_accvgpr_read_b32 v235, a140
  v_add_u32 v248, 0x24000, v1
  v_add_u32 v252, 0x10000, v1
  v_sub_f32 v208, 0, v240
  v_sub_f32 v209, 0, v240
  v_sub_f32 v210, 0, v240
  v_sub_f32 v211, 0, v240
  v_sub_f32 v212, 0, v241
  v_sub_f32 v213, 0, v241
  v_sub_f32 v214, 0, v241
  v_sub_f32 v215, 0, v241
  v_sub_f32 v216, 0, v242
  v_sub_f32 v217, 0, v242
  v_sub_f32 v218, 0, v242
  v_sub_f32 v219, 0, v242
  v_sub_f32 v220, 0, v243
  v_sub_f32 v221, 0, v243
  v_sub_f32 v222, 0, v243
  v_sub_f32 v223, 0, v243
  v_add_f32 v228, v232, v233
  v_min_f32 v229, v232, v233
  v_add_f32 v228, v228, v234
  v_add_f32 v228, v228, v235
  v_min3_f32 v229, v229, v234, v235
  v_mov_b32 v230, 0x4e800000
  v_mov_b32 v231, 0x30800000
  v_cmp_nlt_f32 vcc, v228, v230
  v_cmp_nge_f32 s[98:99], v229, v231
  s_nop 3
  s_or_b64 vcc, vcc, s[98:99]
  s_cbranch_vccz L_ok_t1A
  s_mov_b32 s93, 0
  s_branch L_fallback
L_ret_0:
  v_accvgpr_read_b32 v96, a128
  v_rcp_f32 v96, v96
  v_accvgpr_read_b32 v80, a0
  v_accvgpr_read_b32 v81, a1
  v_accvgpr_read_b32 v82, a2
  v_accvgpr_read_b32 v83, a3
  v_accvgpr_read_b32 v84, a16
  v_accvgpr_read_b32 v85, a17
  v_accvgpr_read_b32 v86, a18
  v_accvgpr_read_b32 v87, a19
  v_mul_f32 v80, v80, v96
  v_mul_f32 v81, v81, v96
  v_mul_f32 v82, v82, v96
  v_mul_f32 v83, v83, v96
  v_mul_f32 v84, v84, v96
  v_mul_f32 v85, v85, v96
  v_mul_f32 v86, v86, v96
  v_mul_f32 v87, v87, v96
  v_cvt_pk_bf16_f32 v80, v80, v81
  v_cvt_pk_bf16_f32 v81, v82, v83
  v_cvt_pk_bf16_f32 v82, v84, v85
  v_cvt_pk_bf16_f32 v83, v86, v87
  s_add_u32 s57, s51, 0x0
  buffer_store_dwordx4 v[80:83], v1, s[28:31], s57 offen sc1
  v_accvgpr_read_b32 v88, a32
  v_accvgpr_read_b32 v89, a33
  v_accvgpr_read_b32 v90, a34
  v_accvgpr_read_b32 v91, a35
  v_accvgpr_read_b32 v92, a48
  v_accvgpr_read_b32 v93, a49
  v_accvgpr_read_b32 v94, a50
  v_accvgpr_read_b32 v95, a51
  v_mul_f32 v88, v88, v96
  v_mul_f32 v89, v89, v96
  v_mul_f32 v90, v90, v96
  v_mul_f32 v91, v91, v96
  v_mul_f32 v92, v92, v96
  v_mul_f32 v93, v93, v96
  v_mul_f32 v94, v94, v96
  v_mul_f32 v95, v95, v96
  v_cvt_pk_bf16_f32 v88, v88, v89
  v_cvt_pk_bf16_f32 v89, v90, v91
  v_cvt_pk_bf16_f32 v90, v92, v93
  v_cvt_pk_bf16_f32 v91, v94, v95
  s_add_u32 s58, s51, 0x1000
  buffer_store_dwordx4 v[88:91], v1, s[28:31], s58 offen sc1
  v_accvgpr_read_b32 v80, a64
  v_accvgpr_read_b32 v81, a65
  v_accvgpr_read_b32 v82, a66
  v_accvgpr_read_b32 v83, a67
  v_accvgpr_read_b32 v84, a80
  v_accvgpr_read_b32 v85, a81
  v_accvgpr_read_b32 v86, a82
  v_accvgpr_read_b32 v87, a83
  v_mul_f32 v80, v80, v96
  v_mul_f32 v81, v81, v96
  v_mul_f32 v82, v82, v96
  v_mul_f32 v83, v83, v96
  v_mul_f32 v84, v84, v96
  v_mul_f32 v85, v85, v96
  v_mul_f32 v86, v86, v96
  v_mul_f32 v87, v87, v96
  v_cvt_pk_bf16_f32 v80, v80, v81
  v_cvt_pk_bf16_f32 v81, v82, v83
  v_cvt_pk_bf16_f32 v82, v84, v85
  v_cvt_pk_bf16_f32 v83, v86, v87
  s_add_u32 s59, s51, 0x2000
  buffer_store_dwordx4 v[80:83], v1, s[28:31], s59 offen sc1
  v_accvgpr_read_b32 v88, a96
  v_accvgpr_read_b32 v89, a97
  v_accvgpr_read_b32 v90, a98
  v_accvgpr_read_b32 v91, a99
  v_accvgpr_read_b32 v92, a112
  v_accvgpr_read_b32 v93, a113
  v_accvgpr_read_b32 v94, a114
  v_accvgpr_read_b32 v95, a115
  v_mul_f32 v88, v88, v96
  v_mul_f32 v89, v89, v96
  v_mul_f32 v90, v90, v96
  v_mul_f32 v91, v91, v96
  v_mul_f32 v92, v92, v96
  v_mul_f32 v93, v93, v96
  v_mul_f32 v94, v94, v96
  v_mul_f32 v95, v95, v96
  v_cvt_pk_bf16_f32 v88, v88, v89
  v_cvt_pk_bf16_f32 v89, v90, v91
  v_cvt_pk_bf16_f32 v90, v92, v93
  v_cvt_pk_bf16_f32 v91, v94, v95
  s_add_u32 s56, s51, 0x3000
  buffer_store_dwordx4 v[88:91], v1, s[28:31], s56 offen sc1
  v_accvgpr_read_b32 v97, a132
  v_rcp_f32 v97, v97
  v_accvgpr_read_b32 v80, a4
  v_accvgpr_read_b32 v81, a5
  v_accvgpr_read_b32 v82, a6
  v_accvgpr_read_b32 v83, a7
  v_accvgpr_read_b32 v84, a20
  v_accvgpr_read_b32 v85, a21
  v_accvgpr_read_b32 v86, a22
  v_accvgpr_read_b32 v87, a23
  v_mul_f32 v80, v80, v97
  v_mul_f32 v81, v81, v97
  v_mul_f32 v82, v82, v97
  v_mul_f32 v83, v83, v97
  v_mul_f32 v84, v84, v97
  v_mul_f32 v85, v85, v97
  v_mul_f32 v86, v86, v97
  v_mul_f32 v87, v87, v97
  v_cvt_pk_bf16_f32 v80, v80, v81
  v_cvt_pk_bf16_f32 v81, v82, v83
  v_cvt_pk_bf16_f32 v82, v84, v85
  v_cvt_pk_bf16_f32 v83, v86, v87
  s_add_u32 s57, s51, 0x0
  buffer_store_dwordx4 v[80:83], v1, s[28:31], s57 offen offset:1024 sc1
  v_accvgpr_read_b32 v88, a36
  v_accvgpr_read_b32 v89, a37
  v_accvgpr_read_b32 v90, a38
  v_accvgpr_read_b32 v91, a39
  v_accvgpr_read_b32 v92, a52
  v_accvgpr_read_b32 v93, a53
  v_accvgpr_read_b32 v94, a54
  v_accvgpr_read_b32 v95, a55
  v_mul_f32 v88, v88, v97
  v_mul_f32 v89, v89, v97
  v_mul_f32 v90, v90, v97
  v_mul_f32 v91, v91, v97
  v_mul_f32 v92, v92, v97
  v_mul_f32 v93, v93, v97
  v_mul_f32 v94, v94, v97
  v_mul_f32 v95, v95, v97
  v_cvt_pk_bf16_f32 v88, v88, v89
  v_cvt_pk_bf16_f32 v89, v90, v91
  v_cvt_pk_bf16_f32 v90, v92, v93
  v_cvt_pk_bf16_f32 v91, v94, v95
  s_add_u32 s58, s51, 0x1000
  buffer_store_dwordx4 v[88:91], v1, s[28:31], s58 offen offset:1024 sc1
  v_accvgpr_read_b32 v80, a68
  v_accvgpr_read_b32 v81, a69
  v_accvgpr_read_b32 v82, a70
  v_accvgpr_read_b32 v83, a71
  v_accvgpr_read_b32 v84, a84
  v_accvgpr_read_b32 v85, a85
  v_accvgpr_read_b32 v86, a86
  v_accvgpr_read_b32 v87, a87
  v_mul_f32 v80, v80, v97
  v_mul_f32 v81, v81, v97
  v_mul_f32 v82, v82, v97
  v_mul_f32 v83, v83, v97
  v_mul_f32 v84, v84, v97
  v_mul_f32 v85, v85, v97
  v_mul_f32 v86, v86, v97
  v_mul_f32 v87, v87, v97
  v_cvt_pk_bf16_f32 v80, v80, v81
  v_cvt_pk_bf16_f32 v81, v82, v83
  v_cvt_pk_bf16_f32 v82, v84, v85
  v_cvt_pk_bf16_f32 v83, v86, v87
  s_add_u32 s59, s51, 0x2000
  buffer_store_dwordx4 v[80:83], v1, s[28:31], s59 offen offset:1024 sc1
  v_accvgpr_read_b32 v88, a100
  v_accvgpr_read_b32 v89, a101
  v_accvgpr_read_b32 v90, a102
  v_accvgpr_read_b32 v91, a103
  v_accvgpr_read_b32 v92, a116
  v_accvgpr_read_b32 v93, a117
  v_accvgpr_read_b32 v94, a118
  v_accvgpr_read_b32 v95, a119
  v_mul_f32 v88, v88, v97
  v_mul_f32 v89, v89, v97
  v_mul_f32 v90, v90, v97
  v_mul_f32 v91, v91, v97
  v_mul_f32 v92, v92, v97
  v_mul_f32 v93, v93, v97
  v_mul_f32 v94, v94, v97
  v_mul_f32 v95, v95, v97
  v_cvt_pk_bf16_f32 v88, v88, v89
  v_cvt_pk_bf16_f32 v89, v90, v91
  v_cvt_pk_bf16_f32 v90, v92, v93
  v_cvt_pk_bf16_f32 v91, v94, v95
  s_add_u32 s56, s51, 0x3000
  buffer_store_dwordx4 v[88:91], v1, s[28:31], s56 offen offset:1024 sc1
L_ok_t1A:
L_t2_A:
  s_waitcnt vmcnt(0) lgkmcnt(0)
  s_barrier
  ds_read_b128 a[144:147], v248
  ds_read_b128 a[148:151], v248 offset:1024
  ds_read_b128 a[152:155], v248 offset:2048
  ds_read_b128 a[156:159], v248 offset:3072
  ds_read_b128 a[160:163], v248 offset:4096
  ds_read_b128 a[164:167], v248 offset:5120
  ds_read_b128 a[168:171], v248 offset:6144
  ds_read_b128 a[172:175], v248 offset:7168
  ds_read_b128 a[176:179], v248 offset:8192
  ds_read_b128 a[180:183], v248 offset:9216
  ds_read_b128 a[184:187], v248 offset:10240
  ds_read_b128 a[188:191], v248 offset:11264
  ds_read_b128 a[192:195], v248 offset:12288
  ds_read_b128 a[196:199], v248 offset:13312
  ds_read_b128 a[200:203], v248 offset:14336
  ds_read_b128 a[204:207], v248 offset:15360
  ds_read_b128 a[208:211], v252
  v_cndmask_b32 v16, v5, v208, s[60:61]
  v_cndmask_b32 v17, v5, v209, s[62:63]
  v_cndmask_b32 v18, v5, v210, s[64:65]
  v_cndmask_b32 v19, v5, v211, s[66:67]
  s_waitcnt lgkmcnt(0)
  s_nop 0
  v_mfma_f32_16x16x32_bf16 v[16:19], a[208:211], a[144:147], v[16:19]
  s_cmp_eq_u32 s42, 0
  s_cselect_b32 s44, 0, 0x40000000
  s_add_u32 s44, s44, 0x5402000
  ds_read_b128 a[212:215], v252 offset:1024
  ds_read_b128 a[216:219], v252 offset:2048
  s_waitcnt lgkmcnt(1)
  v_mfma_f32_16x16x32_bf16 v[16:19], a[212:215], a[148:151], v[16:19]
  s_waitcnt lgkmcnt(0)
  ds_read_b128 a[220:223], v252 offset:3072
  ds_read_b128 a[224:227], v252 offset:4096
  v_mfma_f32_16x16x32_bf16 v[16:19], a[216:219], a[152:155], v[16:19]
  s_waitcnt lgkmcnt(1)
  buffer_atomic_add v15, v253, s[28:31], s44 offen sc1
  v_mfma_f32_16x16x32_bf16 v[16:19], a[220:223], a[156:159], v[16:19]
  s_and_b32 s44, s40, 1
  ds_read_b128 a[228:231], v252 offset:5120
  ds_read_b128 a[232:235], v252 offset:6144
  s_lshl_b32 s44, s44, 13
  s_add_u32 s44, s44, s46
  s_lshl_b32 s43, s42, 16
  v_mfma_f32_16x16x32_bf16 v[20:23], a[208:211], a[160:163], v[212:215]
  s_sub_u32 s47, s44, s43
  ds_read_b128 a[236:239], v252 offset:7168
  v_cndmask_b32 v36, v5, v212, s[60:61]
  s_add_u32 s47, s47, 0xfc000
  s_add_u32 m0, s49, 0x8000
  s_add_u32 s57, s47, 0x0
  v_mfma_f32_16x16x32_bf16 v[20:23], a[212:215], a[164:167], v[20:23]
  s_add_u32 s58, s47, 0x1000
  buffer_load_dwordx4 v1, s[28:31], s57 offen sc1 lds
  v_mfma_f32_16x16x32_bf16 v[20:23], a[216:219], a[168:171], v[20:23]
  s_add_u32 s48, s44, 0x88000
  buffer_load_dwordx4 v1, s[28:31], s57 offen offset:1024 sc1 lds
  v_mfma_f32_16x16x32_bf16 v[20:23], a[220:223], a[172:175], v[20:23]
  s_add_u32 s59, s48, 0x0
  ds_read_b128 a[240:243], v252 offset:8192
  v_cndmask_b32 v37, v5, v213, s[62:63]
  v_mfma_f32_16x16x32_bf16 v[24:27], a[208:211], a[176:179], v[216:219]
  s_add_u32 s56, s48, 0x1000
  ds_read_b128 a[244:247], v252 offset:9216
  v_cndmask_b32 v38, v5, v214, s[64:65]
  v_mfma_f32_16x16x32_bf16 v[24:27], a[212:215], a[180:183], v[24:27]
  s_sub_u32 s43, 15, s42
  ds_read_b128 a[248:251], v252 offset:10240
  v_cndmask_b32 v39, v5, v215, s[66:67]
  v_mfma_f32_16x16x32_bf16 v[24:27], a[216:219], a[184:187], v[24:27]
  s_lshl_b32 s43, s43, 1
  ds_read_b128 a[252:255], v252 offset:11264
  v_cndmask_b32 v56, v5, v216, s[60:61]
  v_mfma_f32_16x16x32_bf16 v[24:27], a[220:223], a[188:191], v[24:27]
  s_add_u32 s43, s43, 1
  buffer_load_dwordx4 v1, s[28:31], s57 offen offset:2048 sc1 lds
  v_mfma_f32_16x16x32_bf16 v[28:31], a[208:211], a[192:195], v[220:223]
  s_lshl_b32 s44, s41, 14
  ds_read_b128 a[208:211], v252 offset:12288
  v_cndmask_b32 v57, v5, v217, s[62:63]
  v_mfma_f32_16x16x32_bf16 v[28:31], a[212:215], a[196:199], v[28:31]
  s_add_u32 s47, s47, 0x8000
  ds_read_b128 a[212:215], v252 offset:13312
  v_cndmask_b32 v58, v5, v218, s[64:65]
  v_mfma_f32_16x16x32_bf16 v[28:31], a[216:219], a[200:203], v[28:31]
  s_add_u32 s48, s48, 0x8000
  ds_read_b128 a[216:219], v252 offset:14336
  v_cndmask_b32 v59, v5, v219, s[66:67]
  v_mfma_f32_16x16x32_bf16 v[28:31], a[220:223], a[204:207], v[28:31]
  s_waitcnt lgkmcnt(5)
  ds_read_b128 a[220:223], v252 offset:15360
  v_cndmask_b32 v76, v5, v220, s[60:61]
  v_mfma_f32_16x16x32_bf16 v[36:39], a[224:227], a[160:163], v[36:39]
  s_sub_u32 s47, s48, 0x4000
  buffer_load_dwordx4 v1, s[28:31], s57 offen offset:3072 sc1 lds
  v_mfma_f32_16x16x32_bf16 v[36:39], a[228:231], a[164:167], v[36:39]
  s_add_u32 m0, s49, 0x9000
  v_cndmask_b32 v77, v5, v221, s[62:63]
  v_cndmask_b32 v78, v5, v222, s[64:65]
  v_mfma_f32_16x16x32_bf16 v[36:39], a[232:235], a[168:171], v[36:39]
  s_add_u32 s57, s51, 0x0
  v_cndmask_b32 v79, v5, v223, s[66:67]
  v_accvgpr_read_b32 v98, a136
  v_mfma_f32_16x16x32_bf16 v[36:39], a[236:239], a[172:175], v[36:39]
  s_add_u32 s92, s92, 1
  v_rcp_f32 v98, v98
  v_mfma_f32_16x16x32_bf16 v[40:43], a[224:227], a[176:179], v[216:219]
  v_accvgpr_read_b32 v80, a8
  v_accvgpr_read_b32 v81, a9
  v_mfma_f32_16x16x32_bf16 v[40:43], a[228:231], a[180:183], v[40:43]
  buffer_load_dwordx4 v1, s[28:31], s58 offen sc1 lds
  v_mfma_f32_16x16x32_bf16 v[40:43], a[232:235], a[184:187], v[40:43]
  v_accvgpr_read_b32 v82, a10
  v_accvgpr_read_b32 v83, a11
  v_mfma_f32_16x16x32_bf16 v[40:43], a[236:239], a[188:191], v[40:43]
  v_mul_f32 v80, v80, v98
  v_mul_f32 v81, v81, v98
  v_mfma_f32_16x16x32_bf16 v[44:47], a[224:227], a[192:195], v[220:223]
  v_accvgpr_read_b32 v84, a24
  v_accvgpr_read_b32 v85, a25
  v_mfma_f32_16x16x32_bf16 v[44:47], a[228:231], a[196:199], v[44:47]
  v_accvgpr_read_b32 v86, a26
  v_accvgpr_read_b32 v87, a27
  v_mfma_f32_16x16x32_bf16 v[44:47], a[232:235], a[200:203], v[44:47]
  buffer_load_dwordx4 v1, s[28:31], s58 offen offset:1024 sc1 lds
  v_mfma_f32_16x16x32_bf16 v[44:47], a[236:239], a[204:207], v[44:47]
  v_mul_f32 v82, v82, v98
  v_mul_f32 v83, v83, v98
  v_mfma_f32_16x16x32_bf16 v[56:59], a[240:243], a[176:179], v[56:59]
  v_cvt_pk_bf16_f32 v80, v80, v81
  v_mul_f32 v84, v84, v98
  v_mfma_f32_16x16x32_bf16 v[56:59], a[244:247], a[180:183], v[56:59]
  s_waitcnt lgkmcnt(0)
  v_mul_f32 v85, v85, v98
  v_mul_f32 v86, v86, v98
  v_mfma_f32_16x16x32_bf16 v[56:59], a[248:251], a[184:187], v[56:59]
  v_mul_f32 v87, v87, v98
  v_cvt_pk_bf16_f32 v81, v82, v83
  v_mfma_f32_16x16x32_bf16 v[56:59], a[252:255], a[188:191], v[56:59]
  buffer_load_dwordx4 v1, s[28:31], s58 offen offset:2048 sc1 lds
  v_mfma_f32_16x16x32_bf16 v[60:63], a[240:243], a[192:195], v[220:223]
  v_cvt_pk_bf16_f32 v82, v84, v85
  v_cvt_pk_bf16_f32 v83, v86, v87
  v_mfma_f32_16x16x32_bf16 v[60:63], a[244:247], a[196:199], v[60:63]
  v_accvgpr_read_b32 v88, a40
  v_accvgpr_read_b32 v89, a41
  v_mfma_f32_16x16x32_bf16 v[60:63], a[248:251], a[200:203], v[60:63]
  v_accvgpr_read_b32 v90, a42
  v_accvgpr_read_b32 v91, a43
  v_mfma_f32_16x16x32_bf16 v[60:63], a[252:255], a[204:207], v[60:63]
  v_mul_f32 v88, v88, v98
  v_mul_f32 v89, v89, v98
  v_mfma_f32_16x16x32_bf16 v[76:79], a[208:211], a[192:195], v[76:79]
  buffer_load_dwordx4 v1, s[28:31], s58 offen offset:3072 sc1 lds
  s_add_u32 m0, s49, 0x4000
  v_mfma_f32_16x16x32_bf16 v[76:79], a[212:215], a[196:199], v[76:79]
  s_add_u32 s58, s51, 0x1000
  v_accvgpr_read_b32 v92, a56
  v_accvgpr_read_b32 v93, a57
  v_mfma_f32_16x16x32_bf16 v[76:79], a[216:219], a[200:203], v[76:79]
  v_accvgpr_read_b32 v94, a58
  v_accvgpr_read_b32 v95, a59
  v_mfma_f32_16x16x32_bf16 v[76:79], a[220:223], a[204:207], v[76:79]
  v_mul_f32 v90, v90, v98
  v_mul_f32 v91, v91, v98
  buffer_load_dwordx4 v1, s[28:31], s59 offen sc1 lds
  buffer_load_dwordx4 v1, s[28:31], s59 offen offset:1024 sc1 lds
  buffer_load_dwordx4 v1, s[28:31], s59 offen offset:2048 sc1 lds
  buffer_load_dwordx4 v1, s[28:31], s59 offen offset:3072 sc1 lds
  s_add_u32 m0, s49, 0x5000
  s_nop 0
  buffer_load_dwordx4 v1, s[28:31], s56 offen sc1 lds
  buffer_load_dwordx4 v1, s[28:31], s56 offen offset:1024 sc1 lds
  buffer_load_dwordx4 v1, s[28:31], s56 offen offset:2048 sc1 lds
  buffer_load_dwordx4 v1, s[28:31], s56 offen offset:3072 sc1 lds
  buffer_store_dwordx4 v[80:83], v1, s[28:31], s57 offen offset:2048 sc1
  s_nop 1
  v_accvgpr_read_b32 v80, a72
  v_mul_f32 v80, v80, v98
  v_accvgpr_read_b32 v81, a73
  v_mul_f32 v81, v81, v98
  v_cvt_pk_bf16_f32 v80, v80, v81
  v_cvt_pk_bf16_f32 v88, v88, v89
  v_cvt_pk_bf16_f32 v89, v90, v91
  v_mul_f32 v92, v92, v98
  v_mul_f32 v93, v93, v98
  v_cvt_pk_bf16_f32 v90, v92, v93
  v_mul_f32 v94, v94, v98
  v_mul_f32 v95, v95, v98
  v_cvt_pk_bf16_f32 v91, v94, v95
  buffer_store_dwordx4 v[88:91], v1, s[28:31], s58 offen offset:2048 sc1
  v_accvgpr_read_b32 v82, a74
  v_mul_f32 v82, v82, v98
  v_accvgpr_read_b32 v83, a75
  v_mul_f32 v83, v83, v98
  v_cvt_pk_bf16_f32 v81, v82, v83
  v_accvgpr_read_b32 v84, a88
  v_mul_f32 v84, v84, v98
  v_accvgpr_read_b32 v85, a89
  v_mul_f32 v85, v85, v98
  v_cvt_pk_bf16_f32 v82, v84, v85
  v_accvgpr_read_b32 v86, a90
  v_mul_f32 v86, v86, v98
  v_accvgpr_read_b32 v87, a91
  v_mul_f32 v87, v87, v98
  v_cvt_pk_bf16_f32 v83, v86, v87
  s_add_u32 s59, s51, 0x2000
  buffer_store_dwordx4 v[80:83], v1, s[28:31], s59 offen offset:2048 sc1
  s_nop 1
  v_accvgpr_read_b32 v80, a12
  v_accvgpr_read_b32 v81, a13
  v_accvgpr_read_b32 v82, a14
  v_accvgpr_read_b32 v83, a15
  v_mov_b32 v240, 0
  v_mov_b32 v241, 0
  v_mov_b32 v242, 0
  v_mov_b32 v243, 0
  s_nop 1
  v_mfma_f32_32x32x16_bf16 a[0:15], v[240:243], v[240:243], 0
  s_add_u32 s56, s51, 0x3000
  v_accvgpr_read_b32 v88, a104
  v_accvgpr_read_b32 v89, a105
  v_accvgpr_read_b32 v90, a106
  v_accvgpr_read_b32 v91, a107
  v_mul_f32 v88, v88, v98
  v_mul_f32 v89, v89, v98
  v_accvgpr_read_b32 v84, a28
  v_accvgpr_read_b32 v85, a29
  v_accvgpr_read_b32 v86, a30
  v_accvgpr_read_b32 v87, a31
  v_mfma_f32_32x32x16_bf16 a[16:31], v[240:243], v[240:243], 0
  s_add_u32 s57, s51, 0x0
  v_accvgpr_read_b32 v92, a120
  v_accvgpr_read_b32 v93, a121
  v_accvgpr_read_b32 v94, a122
  v_accvgpr_read_b32 v95, a123
  v_mul_f32 v90, v90, v98
  v_mul_f32 v91, v91, v98
  v_cvt_pk_bf16_f32 v88, v88, v89
  v_cvt_pk_bf16_f32 v89, v90, v91
  v_mul_f32 v92, v92, v98
  v_mul_f32 v93, v93, v98
  v_cvt_pk_bf16_f32 v90, v92, v93
  v_mul_f32 v94, v94, v98
  v_mul_f32 v95, v95, v98
  v_cvt_pk_bf16_f32 v91, v94, v95
  buffer_store_dwordx4 v[88:91], v1, s[28:31], s56 offen offset:2048 sc1
  s_nop 1
  v_accvgpr_read_b32 v88, a44
  v_accvgpr_read_b32 v89, a45
  v_accvgpr_read_b32 v90, a46
  v_accvgpr_read_b32 v91, a47
  v_mfma_f32_32x32x16_bf16 a[32:47], v[240:243], v[240:243], 0
  s_add_u32 s58, s51, 0x1000
  v_accvgpr_read_b32 v99, a140
  v_rcp_f32 v99, v99
  v_accvgpr_read_b32 v92, a60
  v_mul_f32 v80, v80, v99
  v_mul_f32 v81, v81, v99
  v_accvgpr_read_b32 v93, a61
  v_accvgpr_read_b32 v94, a62
  v_accvgpr_read_b32 v95, a63
  v_mfma_f32_32x32x16_bf16 a[48:63], v[240:243], v[240:243], 0
  s_add_u32 s59, s51, 0x2000
  v_mul_f32 v82, v82, v99
  v_mul_f32 v83, v83, v99
  v_cvt_pk_bf16_f32 v80, v80, v81
  v_mul_f32 v84, v84, v99
  v_mul_f32 v85, v85, v99
  v_mul_f32 v86, v86, v99
  v_cvt_pk_bf16_f32 v81, v82, v83
  v_cvt_pk_bf16_f32 v82, v84, v85
  v_mul_f32 v87, v87, v99
  v_cvt_pk_bf16_f32 v83, v86, v87
  buffer_store_dwordx4 v[80:83], v1, s[28:31], s57 offen offset:3072 sc1
  s_nop 1
  v_accvgpr_read_b32 v80, a76
  v_accvgpr_read_b32 v81, a77
  v_accvgpr_read_b32 v82, a78
  v_accvgpr_read_b32 v83, a79
  v_mfma_f32_32x32x16_bf16 a[64:79], v[240:243], v[240:243], 0
  s_add_u32 s56, s51, 0x3000
  v_mul_f32 v88, v88, v99
  v_mul_f32 v89, v89, v99
  v_mul_f32 v90, v90, v99
  v_mul_f32 v91, v91, v99
  v_cvt_pk_bf16_f32 v88, v88, v89
  v_accvgpr_read_b32 v84, a92
  v_accvgpr_read_b32 v85, a93
  v_accvgpr_read_b32 v86, a94
  v_accvgpr_read_b32 v87, a95
  v_mfma_f32_32x32x16_bf16 a[80:95], v[240:243], v[240:243], 0
  s_mul_i32 s51, s43, 745472
  v_mul_f32 v92, v92, v99
  v_mul_f32 v93, v93, v99
  v_mul_f32 v94, v94, v99
  v_mul_f32 v95, v95, v99
  v_cvt_pk_bf16_f32 v89, v90, v91
  v_cvt_pk_bf16_f32 v90, v92, v93
  v_cvt_pk_bf16_f32 v91, v94, v95
  buffer_store_dwordx4 v[88:91], v1, s[28:31], s58 offen offset:3072 sc1
  s_nop 1
  v_accvgpr_read_b32 v88, a108
  v_accvgpr_read_b32 v89, a109
  v_accvgpr_read_b32 v90, a110
  v_accvgpr_read_b32 v91, a111
  v_mfma_f32_32x32x16_bf16 a[96:111], v[240:243], v[240:243], 0
  s_add_u32 s51, s51, s44
  v_accvgpr_read_b32 v92, a124
  v_accvgpr_read_b32 v93, a125
  v_accvgpr_read_b32 v94, a126
  v_accvgpr_read_b32 v95, a127
  v_mul_f32 v80, v80, v99
  v_mul_f32 v81, v81, v99
  v_mfma_f32_32x32x16_bf16 a[112:127], v[240:243], v[240:243], 0
  s_add_u32 s51, s51, 0x2400000
  v_mul_f32 v82, v82, v99
  v_mul_f32 v83, v83, v99
  v_cvt_pk_bf16_f32 v80, v80, v81
  v_mul_f32 v88, v88, v99
  v_mul_f32 v89, v89, v99
  v_mul_f32 v84, v84, v99
  v_mfma_f32_32x32x16_bf16 a[128:143], v[240:243], v[240:243], 0
  v_mul_f32 v85, v85, v99
  v_mul_f32 v86, v86, v99
  v_mul_f32 v87, v87, v99
  v_cvt_pk_bf16_f32 v81, v82, v83
  v_mul_f32 v90, v90, v99
  v_mul_f32 v91, v91, v99
  v_mfma_f32_32x32x16_bf16 v[176:191], v[240:243], v[240:243], 0
  v_cvt_pk_bf16_f32 v88, v88, v89
  v_cvt_pk_bf16_f32 v82, v84, v85
  v_cvt_pk_bf16_f32 v83, v86, v87
  v_mul_f32 v92, v92, v99
  v_mul_f32 v93, v93, v99
  v_mul_f32 v94, v94, v99
  v_mfma_f32_32x32x16_bf16 v[192:207], v[240:243], v[240:243], 0
  v_mul_f32 v95, v95, v99
  v_cvt_pk_bf16_f32 v89, v90, v91
  v_mov_b32 v32, 0xf149f2ca
  v_mov_b32 v33, 0xf149f2ca
  v_mov_b32 v34, 0xf149f2ca
  v_mov_b32 v35, 0xf149f2ca
  v_mfma_f32_16x16x32_bf16 a[232:235], v[240:243], v[240:243], 0
  buffer_store_dwordx4 v[80:83], v1, s[28:31], s59 offen offset:3072 sc1
  v_mfma_f32_16x16x32_bf16 a[236:239], v[240:243], v[240:243], 0
  v_cvt_pk_bf16_f32 v90, v92, v93
  v_cvt_pk_bf16_f32 v91, v94, v95
  buffer_store_dwordx4 v[88:91], v1, s[28:31], s56 offen offset:3072 sc1
  v_mov_b32 v48, 0xf149f2ca
  v_mov_b32 v49, 0xf149f2ca
  v_mov_b32 v50, 0xf149f2ca
  v_mov_b32 v51, 0xf149f2ca
  v_mov_b32 v52, 0xf149f2ca
  v_mov_b32 v53, 0xf149f2ca
  v_mov_b32 v54, 0xf149f2ca
  v_mov_b32 v55, 0xf149f2ca
  v_mov_b32 v64, 0xf149f2ca
  v_mov_b32 v65, 0xf149f2ca
  v_mov_b32 v66, 0xf149f2ca
  v_mov_b32 v67, 0xf149f2ca
  v_mov_b32 v68, 0xf149f2ca
  v_mov_b32 v69, 0xf149f2ca
  v_mov_b32 v70, 0xf149f2ca
  v_mov_b32 v71, 0xf149f2ca
  v_mov_b32 v72, 0xf149f2ca
  v_mov_b32 v73, 0xf149f2ca
  v_mov_b32 v74, 0xf149f2ca
  v_mov_b32 v75, 0xf149f2ca
  v_exp_f32 v16, v16
  v_exp_f32 v17, v17
  v_exp_f32 v18, v18
  v_cvt_pk_bf16_f32 v144, v16, v17
  v_exp_f32 v19, v19
  v_exp_f32 v20, v20
  v_cvt_pk_bf16_f32 v145, v18, v19
  v_exp_f32 v21, v21
  v_exp_f32 v22, v22
  v_cvt_pk_bf16_f32 v152, v20, v21
  v_exp_f32 v23, v23
  v_exp_f32 v24, v24
  v_cvt_pk_bf16_f32 v153, v22, v23
  v_exp_f32 v25, v25
  v_exp_f32 v26, v26
  v_cvt_pk_bf16_f32 v160, v24, v25
  v_exp_f32 v27, v27
  v_exp_f32 v28, v28
  v_cvt_pk_bf16_f32 v161, v26, v27
  v_exp_f32 v29, v29
  v_exp_f32 v30, v30
  v_cvt_pk_bf16_f32 v168, v28, v29
  v_exp_f32 v31, v31
  v_exp_f32 v32, v32
  v_cvt_pk_bf16_f32 v169, v30, v31
  v_exp_f32 v33, v33
  v_exp_f32 v34, v34
  v_cvt_pk_bf16_f32 v146, v32, v33
  v_exp_f32 v35, v35
  v_exp_f32 v36, v36
  v_cvt_pk_bf16_f32 v147, v34, v35
  v_exp_f32 v37, v37
  v_exp_f32 v38, v38
  v_cvt_pk_bf16_f32 v154, v36, v37
  v_exp_f32 v39, v39
  v_exp_f32 v40, v40
  v_cvt_pk_bf16_f32 v155, v38, v39
  v_exp_f32 v41, v41
  v_exp_f32 v42, v42
  v_cvt_pk_bf16_f32 v162, v40, v41
  v_exp_f32 v43, v43
  v_exp_f32 v44, v44
  v_cvt_pk_bf16_f32 v163, v42, v43
  v_exp_f32 v45, v45
  v_exp_f32 v46, v46
  v_cvt_pk_bf16_f32 v170, v44, v45
  v_exp_f32 v47, v47
  s_nop 0
  v_cvt_pk_bf16_f32 v171, v46, v47
  s_cmp_lg_u32 s92, 17
  s_cbranch_scc1 L_od
  s_branch L_fin
L_od1:
  s_waitcnt vmcnt(8) lgkmcnt(0)
  s_barrier
  v_mfma_f32_16x16x32_bf16 a[128:131], v[224:227], v[176:179], a[128:131]
  s_add_u32 m0, s49, 0xc000
  buffer_load_dword v245, v11, s[24:27], s3 offen
  v_mfma_f32_16x16x32_bf16 a[128:131], v[224:227], v[180:183], a[128:131]
  s_add_u32 s57, s47, 0x0
  buffer_load_dwordx4 v1, s[28:31], s57 offen sc1 lds
  v_mfma_f32_16x16x32_bf16 a[132:135], v[224:227], v[184:187], a[132:135]
  s_add_u32 s58, s47, 0x1000
  ds_read_b128 a[208:211], v252 offset:16384
  ds_read_b128 a[212:215], v252 offset:17408
  v_mfma_f32_16x16x32_bf16 a[132:135], v[224:227], v[188:191], a[132:135]
  s_add_u32 s59, s48, 0x0
  ds_read_b128 a[216:219], v252 offset:18432
  ds_read_b128 a[220:223], v252 offset:19456
  v_mfma_f32_16x16x32_bf16 a[136:139], v[224:227], v[192:195], a[136:139]
  s_add_u32 s56, s48, 0x1000
  ds_read_b128 a[224:227], v252 offset:20480
  ds_read_b128 a[228:231], v252 offset:21504
  v_mfma_f32_16x16x32_bf16 a[136:139], v[224:227], v[196:199], a[136:139]
  s_add_u32 s47, s47, 0x8000
  ds_read_b128 a[240:243], v252 offset:24576
  ds_read_b128 a[244:247], v252 offset:25600
  v_mfma_f32_16x16x32_bf16 a[140:143], v[224:227], v[200:203], a[140:143]
  s_add_u32 s48, s48, 0x8000
  buffer_load_dwordx4 v1, s[28:31], s57 offen offset:1024 sc1 lds
  v_mfma_f32_16x16x32_bf16 a[140:143], v[224:227], v[204:207], a[140:143]
  s_add_u32 s92, s92, 1
  ds_read_b128 a[248:251], v252 offset:26624
  ds_read_b128 a[252:255], v252 offset:27648
  v_mfma_f32_16x16x32_bf16 a[112:115], a[232:235], v[176:179], a[112:115]
  v_exp_f32 v48, v48
  v_mfma_f32_16x16x32_bf16 a[112:115], a[236:239], v[180:183], a[112:115]
  v_exp_f32 v49, v49
  v_mfma_f32_16x16x32_bf16 a[116:119], a[232:235], v[184:187], a[116:119]
  v_exp_f32 v50, v50
  v_mfma_f32_16x16x32_bf16 a[116:119], a[236:239], v[188:191], a[116:119]
  buffer_load_dwordx4 v1, s[28:31], s57 offen offset:2048 sc1 lds
  v_mfma_f32_16x16x32_bf16 a[120:123], a[232:235], v[192:195], a[120:123]
  v_exp_f32 v51, v51
  v_mfma_f32_16x16x32_bf16 a[120:123], a[236:239], v[196:199], a[120:123]
  v_exp_f32 v64, v64
  v_mfma_f32_16x16x32_bf16 a[124:127], a[232:235], v[200:203], a[124:127]
  ds_read_b128 a[232:235], v252 offset:22528
  v_cvt_pk_bf16_f32 v148, v48, v49
  v_mfma_f32_16x16x32_bf16 a[124:127], a[236:239], v[204:207], a[124:127]
  s_waitcnt lgkmcnt(1)
  ds_read_b128 a[236:239], v252 offset:23552
  v_cvt_pk_bf16_f32 v149, v50, v51
  v_mfma_f32_16x16x32_bf16 v[80:83], a[208:211], a[144:147], v[208:211]
  buffer_load_dwordx4 v1, s[28:31], s57 offen offset:3072 sc1 lds
  v_mfma_f32_16x16x32_bf16 v[80:83], a[212:215], a[148:151], v[80:83]
  s_add_u32 m0, s49, 0xd000
  v_exp_f32 v65, v65
  v_mfma_f32_16x16x32_bf16 v[80:83], a[216:219], a[152:155], v[80:83]
  v_exp_f32 v66, v66
  v_mfma_f32_16x16x32_bf16 v[80:83], a[220:223], a[156:159], v[80:83]
  v_exp_f32 v67, v67
  v_mfma_f32_16x16x32_bf16 v[84:87], a[208:211], a[160:163], v[212:215]
  v_cvt_pk_bf16_f32 v150, v64, v65
  v_cvt_pk_bf16_f32 v151, v66, v67
  v_mfma_f32_16x16x32_bf16 v[84:87], a[212:215], a[164:167], v[84:87]
  buffer_load_dwordx4 v1, s[28:31], s58 offen sc1 lds
  v_mfma_f32_16x16x32_bf16 v[84:87], a[216:219], a[168:171], v[84:87]
  v_exp_f32 v52, v52
  v_mfma_f32_16x16x32_bf16 v[84:87], a[220:223], a[172:175], v[84:87]
  v_exp_f32 v53, v53
  v_mfma_f32_16x16x32_bf16 v[88:91], a[208:211], a[176:179], v[216:219]
  v_exp_f32 v54, v54
  v_mfma_f32_16x16x32_bf16 v[88:91], a[212:215], a[180:183], v[88:91]
  v_exp_f32 v55, v55
  v_mfma_f32_16x16x32_bf16 v[88:91], a[216:219], a[184:187], v[88:91]
  buffer_load_dwordx4 v1, s[28:31], s58 offen offset:1024 sc1 lds
  v_mfma_f32_16x16x32_bf16 v[88:91], a[220:223], a[188:191], v[88:91]
  v_exp_f32 v68, v68
  v_mfma_f32_16x16x32_bf16 v[92:95], a[208:211], a[192:195], v[220:223]
  ds_read_b128 a[208:211], v252 offset:28672
  v_cvt_pk_bf16_f32 v156, v52, v53
  v_mfma_f32_16x16x32_bf16 v[92:95], a[212:215], a[196:199], v[92:95]
  ds_read_b128 a[212:215], v252 offset:29696
  v_cvt_pk_bf16_f32 v157, v54, v55
  v_mfma_f32_16x16x32_bf16 v[92:95], a[216:219], a[200:203], v[92:95]
  ds_read_b128 a[216:219], v252 offset:30720
  v_mfma_f32_16x16x32_bf16 v[92:95], a[220:223], a[204:207], v[92:95]
  buffer_load_dwordx4 v1, s[28:31], s58 offen offset:2048 sc1 lds
  v_mfma_f32_16x16x32_bf16 v[96:99], a[224:227], a[144:147], v[208:211]
  ds_read_b128 a[220:223], v252 offset:31744
  v_mfma_f32_16x16x32_bf16 v[96:99], a[228:231], a[148:151], v[96:99]
  s_waitcnt lgkmcnt(4)
  v_exp_f32 v69, v69
  v_mfma_f32_16x16x32_bf16 v[96:99], a[232:235], a[152:155], v[96:99]
  v_exp_f32 v70, v70
  v_mfma_f32_16x16x32_bf16 v[96:99], a[236:239], a[156:159], v[96:99]
  v_exp_f32 v71, v71
  v_mfma_f32_16x16x32_bf16 v[100:103], a[224:227], a[160:163], v[212:215]
  buffer_load_dwordx4 v1, s[28:31], s58 offen offset:3072 sc1 lds
  v_mfma_f32_16x16x32_bf16 v[100:103], a[228:231], a[164:167], v[100:103]
  s_add_u32 m0, s49, 0x0
  v_cvt_pk_bf16_f32 v158, v68, v69
  v_cvt_pk_bf16_f32 v159, v70, v71
  v_mfma_f32_16x16x32_bf16 v[100:103], a[232:235], a[168:171], v[100:103]
  v_exp_f32 v56, v56
  v_mfma_f32_16x16x32_bf16 v[100:103], a[236:239], a[172:175], v[100:103]
  v_exp_f32 v57, v57
  v_mfma_f32_16x16x32_bf16 v[104:107], a[224:227], a[176:179], v[216:219]
  v_exp_f32 v58, v58
  v_mfma_f32_16x16x32_bf16 v[104:107], a[228:231], a[180:183], v[104:107]
  buffer_load_dwordx4 v1, s[28:31], s59 offen sc1 lds
  v_mfma_f32_16x16x32_bf16 v[104:107], a[232:235], a[184:187], v[104:107]
  v_exp_f32 v59, v59
  v_mfma_f32_16x16x32_bf16 v[104:107], a[236:239], a[188:191], v[104:107]
  v_exp_f32 v72, v72
  v_mfma_f32_16x16x32_bf16 v[108:111], a[224:227], a[192:195], v[220:223]
  ds_read_b128 a[224:227], v252 offset:32768
  v_cvt_pk_bf16_f32 v164, v56, v57
  v_mfma_f32_16x16x32_bf16 v[108:111], a[228:231], a[196:199], v[108:111]
  ds_read_b128 a[228:231], v252 offset:33792
  v_cvt_pk_bf16_f32 v165, v58, v59
  v_mfma_f32_16x16x32_bf16 v[108:111], a[232:235], a[200:203], v[108:111]
  buffer_load_dwordx4 v1, s[28:31], s59 offen offset:1024 sc1 lds
  v_mfma_f32_16x16x32_bf16 v[108:111], a[236:239], a[204:207], v[108:111]
  s_nop 0
  ds_read_b128 a[232:235], v252 offset:34816
  ds_read_b128 a[236:239], v252 offset:35840
  v_mfma_f32_16x16x32_bf16 v[112:115], a[240:243], a[144:147], v[208:211]
  v_exp_f32 v73, v73
  v_mfma_f32_16x16x32_bf16 v[112:115], a[244:247], a[148:151], v[112:115]
  v_exp_f32 v74, v74
  v_mfma_f32_16x16x32_bf16 v[112:115], a[248:251], a[152:155], v[112:115]
  v_exp_f32 v75, v75
  v_mfma_f32_16x16x32_bf16 v[112:115], a[252:255], a[156:159], v[112:115]
  buffer_load_dwordx4 v1, s[28:31], s59 offen offset:2048 sc1 lds
  v_mfma_f32_16x16x32_bf16 v[116:119], a[240:243], a[160:163], v[212:215]
  v_cvt_pk_bf16_f32 v166, v72, v73
  v_cvt_pk_bf16_f32 v167, v74, v75
  v_mfma_f32_16x16x32_bf16 v[116:119], a[244:247], a[164:167], v[116:119]
  v_exp_f32 v60, v60
  v_mfma_f32_16x16x32_bf16 v[116:119], a[248:251], a[168:171], v[116:119]
  v_exp_f32 v61, v61
  v_mfma_f32_16x16x32_bf16 v[116:119], a[252:255], a[172:175], v[116:119]
  v_exp_f32 v62, v62
  v_mfma_f32_16x16x32_bf16 v[120:123], a[240:243], a[176:179], v[216:219]
  buffer_load_dwordx4 v1, s[28:31], s59 offen offset:3072 sc1 lds
  v_mfma_f32_16x16x32_bf16 v[120:123], a[244:247], a[180:183], v[120:123]
  s_add_u32 m0, s49, 0x1000
  v_exp_f32 v63, v63
  v_mfma_f32_16x16x32_bf16 v[120:123], a[248:251], a[184:187], v[120:123]
  v_exp_f32 v76, v76
  v_mfma_f32_16x16x32_bf16 v[120:123], a[252:255], a[188:191], v[120:123]
  v_exp_f32 v77, v77
  v_mfma_f32_16x16x32_bf16 v[124:127], a[240:243], a[192:195], v[220:223]
  v_exp_f32 v78, v78
  v_mfma_f32_16x16x32_bf16 v[124:127], a[244:247], a[196:199], v[124:127]
  buffer_load_dwordx4 v1, s[28:31], s56 offen sc1 lds
  v_mfma_f32_16x16x32_bf16 v[124:127], a[248:251], a[200:203], v[124:127]
  v_exp_f32 v79, v79
  v_mfma_f32_16x16x32_bf16 v[124:127], a[252:255], a[204:207], v[124:127]
  s_waitcnt lgkmcnt(0)
  ds_read_b128 a[240:243], v252 offset:36864
  v_cvt_pk_bf16_f32 v172, v60, v61
  v_mfma_f32_16x16x32_bf16 v[128:131], a[208:211], a[144:147], v[208:211]
  ds_read_b128 a[244:247], v252 offset:37888
  v_cvt_pk_bf16_f32 v173, v62, v63
  v_mfma_f32_16x16x32_bf16 v[128:131], a[212:215], a[148:151], v[128:131]
  v_cvt_pk_bf16_f32 v174, v76, v77
  v_cvt_pk_bf16_f32 v175, v78, v79
  v_mfma_f32_16x16x32_bf16 v[128:131], a[216:219], a[152:155], v[128:131]
  buffer_load_dwordx4 v1, s[28:31], s56 offen offset:1024 sc1 lds
  v_mfma_f32_16x16x32_bf16 v[128:131], a[220:223], a[156:159], v[128:131]
  s_nop 0
  ds_read_b128 a[248:251], v252 offset:38912
  ds_read_b128 a[252:255], v252 offset:39936
  v_mfma_f32_16x16x32_bf16 v[132:135], a[208:211], a[160:163], v[212:215]
  v_exp_f32 v80, v80
  v_mfma_f32_16x16x32_bf16 v[132:135], a[212:215], a[164:167], v[132:135]
  v_exp_f32 v81, v81
  v_mfma_f32_16x16x32_bf16 v[132:135], a[216:219], a[168:171], v[132:135]
  ds_write_b128 v254, a[144:147]
  v_mfma_f32_16x16x32_bf16 v[132:135], a[220:223], a[172:175], v[132:135]
  buffer_load_dwordx4 v1, s[28:31], s56 offen offset:2048 sc1 lds
  v_mfma_f32_16x16x32_bf16 v[136:139], a[208:211], a[176:179], v[216:219]
  v_exp_f32 v82, v82
  v_mfma_f32_16x16x32_bf16 v[136:139], a[212:215], a[180:183], v[136:139]
  v_exp_f32 v83, v83
  v_mfma_f32_16x16x32_bf16 v[136:139], a[216:219], a[184:187], v[136:139]
  ds_write_b128 v254, a[148:151] offset:1024
  v_mfma_f32_16x16x32_bf16 v[136:139], a[220:223], a[188:191], v[136:139]
  v_exp_f32 v84, v84
  v_mfma_f32_16x16x32_bf16 v[140:143], a[208:211], a[192:195], v[220:223]
  buffer_load_dwordx4 v1, s[28:31], s56 offen offset:3072 sc1 lds
  v_mfma_f32_16x16x32_bf16 v[140:143], a[212:215], a[196:199], v[140:143]
  s_nop 0
  ds_read_b128 a[208:211], v252 offset:40960
  ds_read_b128 a[212:215], v252 offset:41984
  v_mfma_f32_16x16x32_bf16 v[140:143], a[216:219], a[200:203], v[140:143]
  ds_write_b128 v254, a[152:155] offset:2048
  v_mfma_f32_16x16x32_bf16 v[140:143], a[220:223], a[204:207], v[140:143]
  s_nop 0
  ds_read_b128 a[216:219], v252 offset:43008
  ds_read_b128 a[220:223], v252 offset:44032
  v_mfma_f32_16x16x32_bf16 a[0:3], a[224:227], v[144:147], a[0:3]
  v_exp_f32 v85, v85
  v_mfma_f32_16x16x32_bf16 a[0:3], a[228:231], v[148:151], a[0:3]
  v_exp_f32 v86, v86
  v_mfma_f32_16x16x32_bf16 a[4:7], a[224:227], v[152:155], a[4:7]
  ds_write_b128 v254, a[156:159] offset:3072
  v_mfma_f32_16x16x32_bf16 a[4:7], a[228:231], v[156:159], a[4:7]
  v_exp_f32 v87, v87
  v_mfma_f32_16x16x32_bf16 a[8:11], a[224:227], v[160:163], a[8:11]
  v_exp_f32 v88, v88
  v_mfma_f32_16x16x32_bf16 a[8:11], a[228:231], v[164:167], a[8:11]
  v_exp_f32 v89, v89
  v_mfma_f32_16x16x32_bf16 a[12:15], a[224:227], v[168:171], a[12:15]
  ds_write_b128 v254, a[160:163] offset:4096
  v_mfma_f32_16x16x32_bf16 a[12:15], a[228:231], v[172:175], a[12:15]
  s_nop 0
  ds_read_b128 a[224:227], v252 offset:45056
  ds_read_b128 a[228:231], v252 offset:46080
  v_mfma_f32_16x16x32_bf16 a[16:19], a[232:235], v[144:147], a[16:19]
  v_exp_f32 v90, v90
  v_mfma_f32_16x16x32_bf16 a[16:19], a[236:239], v[148:151], a[16:19]
  v_exp_f32 v91, v91
  v_mfma_f32_16x16x32_bf16 a[20:23], a[232:235], v[152:155], a[20:23]
  ds_write_b128 v254, a[164:167] offset:5120
  v_mfma_f32_16x16x32_bf16 a[20:23], a[236:239], v[156:159], a[20:23]
  v_exp_f32 v92, v92
  v_mfma_f32_16x16x32_bf16 a[24:27], a[232:235], v[160:163], a[24:27]
  v_exp_f32 v93, v93
  v_mfma_f32_16x16x32_bf16 a[24:27], a[236:239], v[164:167], a[24:27]
  v_exp_f32 v94, v94
  v_mfma_f32_16x16x32_bf16 a[28:31], a[232:235], v[168:171], a[28:31]
  ds_write_b128 v254, a[168:171] offset:6144
  v_mfma_f32_16x16x32_bf16 a[28:31], a[236:239], v[172:175], a[28:31]
  s_waitcnt lgkmcnt(2)
  v_exp_f32 v95, v95
  v_mfma_f32_16x16x32_bf16 a[32:35], a[240:243], v[144:147], a[32:35]
  v_exp_f32 v96, v96
  v_mfma_f32_16x16x32_bf16 a[32:35], a[244:247], v[148:151], a[32:35]
  v_exp_f32 v97, v97
  v_mfma_f32_16x16x32_bf16 a[36:39], a[240:243], v[152:155], a[36:39]
  ds_write_b128 v254, a[172:175] offset:7168
  v_mfma_f32_16x16x32_bf16 a[36:39], a[244:247], v[156:159], a[36:39]
  v_exp_f32 v98, v98
  v_mfma_f32_16x16x32_bf16 a[40:43], a[240:243], v[160:163], a[40:43]
  buffer_store_dwordx4 v[240:243], v1, s[28:31], s74 offen sc1
  v_mfma_f32_16x16x32_bf16 a[40:43], a[244:247], v[164:167], a[40:43]
  s_add_u32 s74, s74, 2048
  v_exp_f32 v99, v99
  v_mfma_f32_16x16x32_bf16 a[44:47], a[240:243], v[168:171], a[44:47]
  ds_write_b128 v254, a[176:179] offset:8192
  v_mfma_f32_16x16x32_bf16 a[44:47], a[244:247], v[172:175], a[44:47]
  v_exp_f32 v100, v100
  v_mfma_f32_16x16x32_bf16 a[48:51], a[248:251], v[144:147], a[48:51]
  v_exp_f32 v101, v101
  v_mfma_f32_16x16x32_bf16 a[48:51], a[252:255], v[148:151], a[48:51]
  v_exp_f32 v102, v102
  v_mfma_f32_16x16x32_bf16 a[52:55], a[248:251], v[152:155], a[52:55]
  ds_write_b128 v254, a[180:183] offset:9216
  v_mfma_f32_16x16x32_bf16 a[52:55], a[252:255], v[156:159], a[52:55]
  v_exp_f32 v103, v103
  v_mfma_f32_16x16x32_bf16 a[56:59], a[248:251], v[160:163], a[56:59]
  v_exp_f32 v104, v104
  v_mfma_f32_16x16x32_bf16 a[56:59], a[252:255], v[164:167], a[56:59]
  v_exp_f32 v105, v105
  v_mfma_f32_16x16x32_bf16 a[60:63], a[248:251], v[168:171], a[60:63]
  ds_write_b128 v254, a[184:187] offset:10240
  v_mfma_f32_16x16x32_bf16 a[60:63], a[252:255], v[172:175], a[60:63]
  v_exp_f32 v106, v106
  v_mfma_f32_16x16x32_bf16 a[64:67], a[208:211], v[144:147], a[64:67]
  v_exp_f32 v107, v107
  v_mfma_f32_16x16x32_bf16 a[64:67], a[212:215], v[148:151], a[64:67]
  v_exp_f32 v108, v108
  v_mfma_f32_16x16x32_bf16 a[68:71], a[208:211], v[152:155], a[68:71]
  ds_write_b128 v254, a[188:191] offset:11264
  v_mfma_f32_16x16x32_bf16 a[68:71], a[212:215], v[156:159], a[68:71]
  v_exp_f32 v109, v109
  v_mfma_f32_16x16x32_bf16 a[72:75], a[208:211], v[160:163], a[72:75]
  v_exp_f32 v110, v110
  v_mfma_f32_16x16x32_bf16 a[72:75], a[212:215], v[164:167], a[72:75]
  v_exp_f32 v111, v111
  v_mfma_f32_16x16x32_bf16 a[76:79], a[208:211], v[168:171], a[76:79]
  ds_write_b128 v254, a[192:195] offset:12288
  v_mfma_f32_16x16x32_bf16 a[76:79], a[212:215], v[172:175], a[76:79]
  ds_read_b128 a[232:235], v252 offset:47104
  v_cvt_pk_bf16_f32 v176, v80, v81
  v_mfma_f32_16x16x32_bf16 a[80:83], a[216:219], v[144:147], a[80:83]
  ds_read_b128 a[236:239], v252 offset:48128
  v_cvt_pk_bf16_f32 v177, v82, v83
  v_mfma_f32_16x16x32_bf16 a[80:83], a[220:223], v[148:151], a[80:83]
  v_cvt_pk_bf16_f32 v184, v84, v85
  v_cvt_pk_bf16_f32 v185, v86, v87
  v_mfma_f32_16x16x32_bf16 a[84:87], a[216:219], v[152:155], a[84:87]
  ds_write_b128 v254, a[196:199] offset:13312
  v_mfma_f32_16x16x32_bf16 a[84:87], a[220:223], v[156:159], a[84:87]
  v_cvt_pk_bf16_f32 v192, v88, v89
  v_cvt_pk_bf16_f32 v193, v90, v91
  v_mfma_f32_16x16x32_bf16 a[88:91], a[216:219], v[160:163], a[88:91]
  v_cvt_pk_bf16_f32 v200, v92, v93
  v_cvt_pk_bf16_f32 v201, v94, v95
  v_mfma_f32_16x16x32_bf16 a[88:91], a[220:223], v[164:167], a[88:91]
  v_cvt_pk_bf16_f32 v178, v96, v97
  v_cvt_pk_bf16_f32 v179, v98, v99
  v_mfma_f32_16x16x32_bf16 a[92:95], a[216:219], v[168:171], a[92:95]
  ds_write_b128 v254, a[200:203] offset:14336
  v_mfma_f32_16x16x32_bf16 a[92:95], a[220:223], v[172:175], a[92:95]
  v_cvt_pk_bf16_f32 v186, v100, v101
  v_cvt_pk_bf16_f32 v187, v102, v103
  v_mfma_f32_16x16x32_bf16 a[96:99], a[224:227], v[144:147], a[96:99]
  v_cvt_pk_bf16_f32 v194, v104, v105
  v_cvt_pk_bf16_f32 v195, v106, v107
  v_mfma_f32_16x16x32_bf16 a[96:99], a[228:231], v[148:151], a[96:99]
  v_cvt_pk_bf16_f32 v202, v108, v109
  v_cvt_pk_bf16_f32 v203, v110, v111
  v_mfma_f32_16x16x32_bf16 a[100:103], a[224:227], v[152:155], a[100:103]
  ds_write_b128 v254, a[204:207] offset:15360
  v_mfma_f32_16x16x32_bf16 a[100:103], a[228:231], v[156:159], a[100:103]
  v_mfma_f32_16x16x32_bf16 a[104:107], a[224:227], v[160:163], a[104:107]
  v_mfma_f32_16x16x32_bf16 a[104:107], a[228:231], v[164:167], a[104:107]
  v_mfma_f32_16x16x32_bf16 a[108:111], a[224:227], v[168:171], a[108:111]
  v_mfma_f32_16x16x32_bf16 a[108:111], a[228:231], v[172:175], a[108:111]
  s_branch L_ed
L_od:
  s_waitcnt vmcnt(1) lgkmcnt(0)
  s_barrier
  v_mfma_f32_16x16x32_bf16 a[128:131], v[224:227], v[176:179], a[128:131]
  s_add_u32 m0, s49, 0xc000
  buffer_load_dword v245, v11, s[24:27], s3 offen
  v_mfma_f32_16x16x32_bf16 a[128:131], v[224:227], v[180:183], a[128:131]
  s_add_u32 s57, s47, 0x0
  buffer_load_dwordx4 v1, s[28:31], s57 offen sc1 lds
  v_mfma_f32_16x16x32_bf16 a[132:135], v[224:227], v[184:187], a[132:135]
  s_add_u32 s58, s47, 0x1000
  ds_read_b128 a[208:211], v252 offset:16384
  ds_read_b128 a[212:215], v252 offset:17408
  v_mfma_f32_16x16x32_bf16 a[132:135], v[224:227], v[188:191], a[132:135]
  s_add_u32 s59, s48, 0x0
  ds_read_b128 a[216:219], v252 offset:18432
  ds_read_b128 a[220:223], v252 offset:19456
  v_mfma_f32_16x16x32_bf16 a[136:139], v[224:227], v[192:195], a[136:139]
  s_add_u32 s56, s48, 0x1000
  ds_read_b128 a[224:227], v252 offset:20480
  ds_read_b128 a[228:231], v252 offset:21504
  v_mfma_f32_16x16x32_bf16 a[136:139], v[224:227], v[196:199], a[136:139]
  s_add_u32 s47, s47, 0x8000
  ds_read_b128 a[240:243], v252 offset:24576
  ds_read_b128 a[244:247], v252 offset:25600
  v_mfma_f32_16x16x32_bf16 a[140:143], v[224:227], v[200:203], a[140:143]
  s_add_u32 s48, s48, 0x8000
  buffer_load_dwordx4 v1, s[28:31], s57 offen offset:1024 sc1 lds
  v_mfma_f32_16x16x32_bf16 a[140:143], v[224:227], v[204:207], a[140:143]
  s_add_u32 s92, s92, 1
  ds_read_b128 a[248:251], v252 offset:26624
  ds_read_b128 a[252:255], v252 offset:27648
  v_mfma_f32_16x16x32_bf16 a[112:115], a[232:235], v[176:179], a[112:115]
  v_exp_f32 v48, v48
  v_mfma_f32_16x16x32_bf16 a[112:115], a[236:239], v[180:183], a[112:115]
  v_exp_f32 v49, v49
  v_mfma_f32_16x16x32_bf16 a[116:119], a[232:235], v[184:187], a[116:119]
  v_exp_f32 v50, v50
  v_mfma_f32_16x16x32_bf16 a[116:119], a[236:239], v[188:191], a[116:119]
  buffer_load_dwordx4 v1, s[28:31], s57 offen offset:2048 sc1 lds
  v_mfma_f32_16x16x32_bf16 a[120:123], a[232:235], v[192:195], a[120:123]
  v_exp_f32 v51, v51
  v_mfma_f32_16x16x32_bf16 a[120:123], a[236:239], v[196:199], a[120:123]
  v_exp_f32 v64, v64
  v_mfma_f32_16x16x32_bf16 a[124:127], a[232:235], v[200:203], a[124:127]
  ds_read_b128 a[232:235], v252 offset:22528
  v_cvt_pk_bf16_f32 v148, v48, v49
  v_mfma_f32_16x16x32_bf16 a[124:127], a[236:239], v[204:207], a[124:127]
  s_waitcnt lgkmcnt(1)
  ds_read_b128 a[236:239], v252 offset:23552
  v_cvt_pk_bf16_f32 v149, v50, v51
  v_mfma_f32_16x16x32_bf16 v[80:83], a[208:211], a[144:147], v[208:211]
  buffer_load_dwordx4 v1, s[28:31], s57 offen offset:3072 sc1 lds
  v_mfma_f32_16x16x32_bf16 v[80:83], a[212:215], a[148:151], v[80:83]
  s_add_u32 m0, s49, 0xd000
  v_exp_f32 v65, v65
  v_mfma_f32_16x16x32_bf16 v[80:83], a[216:219], a[152:155], v[80:83]
  v_exp_f32 v66, v66
  v_mfma_f32_16x16x32_bf16 v[80:83], a[220:223], a[156:159], v[80:83]
  v_exp_f32 v67, v67
  v_mfma_f32_16x16x32_bf16 v[84:87], a[208:211], a[160:163], v[212:215]
  v_cvt_pk_bf16_f32 v150, v64, v65
  v_cvt_pk_bf16_f32 v151, v66, v67
  v_mfma_f32_16x16x32_bf16 v[84:87], a[212:215], a[164:167], v[84:87]
  buffer_load_dwordx4 v1, s[28:31], s58 offen sc1 lds
  v_mfma_f32_16x16x32_bf16 v[84:87], a[216:219], a[168:171], v[84:87]
  v_exp_f32 v52, v52
  v_mfma_f32_16x16x32_bf16 v[84:87], a[220:223], a[172:175], v[84:87]
  v_exp_f32 v53, v53
  v_mfma_f32_16x16x32_bf16 v[88:91], a[208:211], a[176:179], v[216:219]
  v_exp_f32 v54, v54
  v_mfma_f32_16x16x32_bf16 v[88:91], a[212:215], a[180:183], v[88:91]
  v_exp_f32 v55, v55
  v_mfma_f32_16x16x32_bf16 v[88:91], a[216:219], a[184:187], v[88:91]
  buffer_load_dwordx4 v1, s[28:31], s58 offen offset:1024 sc1 lds
  v_mfma_f32_16x16x32_bf16 v[88:91], a[220:223], a[188:191], v[88:91]
  v_exp_f32 v68, v68
  v_mfma_f32_16x16x32_bf16 v[92:95], a[208:211], a[192:195], v[220:223]
  ds_read_b128 a[208:211], v252 offset:28672
  v_cvt_pk_bf16_f32 v156, v52, v53
  v_mfma_f32_16x16x32_bf16 v[92:95], a[212:215], a[196:199], v[92:95]
  ds_read_b128 a[212:215], v252 offset:29696
  v_cvt_pk_bf16_f32 v157, v54, v55
  v_mfma_f32_16x16x32_bf16 v[92:95], a[216:219], a[200:203], v[92:95]
  ds_read_b128 a[216:219], v252 offset:30720
  v_mfma_f32_16x16x32_bf16 v[92:95], a[220:223], a[204:207], v[92:95]
  buffer_load_dwordx4 v1, s[28:31], s58 offen offset:2048 sc1 lds
  v_mfma_f32_16x16x32_bf16 v[96:99], a[224:227], a[144:147], v[208:211]
  ds_read_b128 a[220:223], v252 offset:31744
  v_mfma_f32_16x16x32_bf16 v[96:99], a[228:231], a[148:151], v[96:99]
  s_waitcnt lgkmcnt(4)
  v_exp_f32 v69, v69
  v_mfma_f32_16x16x32_bf16 v[96:99], a[232:235], a[152:155], v[96:99]
  v_exp_f32 v70, v70
  v_mfma_f32_16x16x32_bf16 v[96:99], a[236:239], a[156:159], v[96:99]
  v_exp_f32 v71, v71
  v_mfma_f32_16x16x32_bf16 v[100:103], a[224:227], a[160:163], v[212:215]
  buffer_load_dwordx4 v1, s[28:31], s58 offen offset:3072 sc1 lds
  v_mfma_f32_16x16x32_bf16 v[100:103], a[228:231], a[164:167], v[100:103]
  s_add_u32 m0, s49, 0x0
  v_cvt_pk_bf16_f32 v158, v68, v69
  v_cvt_pk_bf16_f32 v159, v70, v71
  v_mfma_f32_16x16x32_bf16 v[100:103], a[232:235], a[168:171], v[100:103]
  v_exp_f32 v56, v56
  v_mfma_f32_16x16x32_bf16 v[100:103], a[236:239], a[172:175], v[100:103]
  v_exp_f32 v57, v57
  v_mfma_f32_16x16x32_bf16 v[104:107], a[224:227], a[176:179], v[216:219]
  v_exp_f32 v58, v58
  v_mfma_f32_16x16x32_bf16 v[104:107], a[228:231], a[180:183], v[104:107]
  buffer_load_dwordx4 v1, s[28:31], s59 offen sc1 lds
  v_mfma_f32_16x16x32_bf16 v[104:107], a[232:235], a[184:187], v[104:107]
  v_exp_f32 v59, v59
  v_mfma_f32_16x16x32_bf16 v[104:107], a[236:239], a[188:191], v[104:107]
  v_exp_f32 v72, v72
  v_mfma_f32_16x16x32_bf16 v[108:111], a[224:227], a[192:195], v[220:223]
  ds_read_b128 a[224:227], v252 offset:32768
  v_cvt_pk_bf16_f32 v164, v56, v57
  v_mfma_f32_16x16x32_bf16 v[108:111], a[228:231], a[196:199], v[108:111]
  ds_read_b128 a[228:231], v252 offset:33792
  v_cvt_pk_bf16_f32 v165, v58, v59
  v_mfma_f32_16x16x32_bf16 v[108:111], a[232:235], a[200:203], v[108:111]
  buffer_load_dwordx4 v1, s[28:31], s59 offen offset:1024 sc1 lds
  v_mfma_f32_16x16x32_bf16 v[108:111], a[236:239], a[204:207], v[108:111]
  s_nop 0
  ds_read_b128 a[232:235], v252 offset:34816
  ds_read_b128 a[236:239], v252 offset:35840
  v_mfma_f32_16x16x32_bf16 v[112:115], a[240:243], a[144:147], v[208:211]
  v_exp_f32 v73, v73
  v_mfma_f32_16x16x32_bf16 v[112:115], a[244:247], a[148:151], v[112:115]
  v_exp_f32 v74, v74
  v_mfma_f32_16x16x32_bf16 v[112:115], a[248:251], a[152:155], v[112:115]
  v_exp_f32 v75, v75
  v_mfma_f32_16x16x32_bf16 v[112:115], a[252:255], a[156:159], v[112:115]
  buffer_load_dwordx4 v1, s[28:31], s59 offen offset:2048 sc1 lds
  v_mfma_f32_16x16x32_bf16 v[116:119], a[240:243], a[160:163], v[212:215]
  v_cvt_pk_bf16_f32 v166, v72, v73
  v_cvt_pk_bf16_f32 v167, v74, v75
  v_mfma_f32_16x16x32_bf16 v[116:119], a[244:247], a[164:167], v[116:119]
  v_exp_f32 v60, v60
  v_mfma_f32_16x16x32_bf16 v[116:119], a[248:251], a[168:171], v[116:119]
  v_exp_f32 v61, v61
  v_mfma_f32_16x16x32_bf16 v[116:119], a[252:255], a[172:175], v[116:119]
  v_exp_f32 v62, v62
  v_mfma_f32_16x16x32_bf16 v[120:123], a[240:243], a[176:179], v[216:219]
  buffer_load_dwordx4 v1, s[28:31], s59 offen offset:3072 sc1 lds
  v_mfma_f32_16x16x32_bf16 v[120:123], a[244:247], a[180:183], v[120:123]
  s_add_u32 m0, s49, 0x1000
  v_exp_f32 v63, v63
  v_mfma_f32_16x16x32_bf16 v[120:123], a[248:251], a[184:187], v[120:123]
  v_exp_f32 v76, v76
  v_mfma_f32_16x16x32_bf16 v[120:123], a[252:255], a[188:191], v[120:123]
  v_exp_f32 v77, v77
  v_mfma_f32_16x16x32_bf16 v[124:127], a[240:243], a[192:195], v[220:223]
  v_exp_f32 v78, v78
  v_mfma_f32_16x16x32_bf16 v[124:127], a[244:247], a[196:199], v[124:127]
  buffer_load_dwordx4 v1, s[28:31], s56 offen sc1 lds
  v_mfma_f32_16x16x32_bf16 v[124:127], a[248:251], a[200:203], v[124:127]
  v_exp_f32 v79, v79
  v_mfma_f32_16x16x32_bf16 v[124:127], a[252:255], a[204:207], v[124:127]
  s_waitcnt lgkmcnt(0)
  ds_read_b128 a[240:243], v252 offset:36864
  v_cvt_pk_bf16_f32 v172, v60, v61
  v_mfma_f32_16x16x32_bf16 v[128:131], a[208:211], a[144:147], v[208:211]
  ds_read_b128 a[244:247], v252 offset:37888
  v_cvt_pk_bf16_f32 v173, v62, v63
  v_mfma_f32_16x16x32_bf16 v[128:131], a[212:215], a[148:151], v[128:131]
  v_cvt_pk_bf16_f32 v174, v76, v77
  v_cvt_pk_bf16_f32 v175, v78, v79
  v_mfma_f32_16x16x32_bf16 v[128:131], a[216:219], a[152:155], v[128:131]
  buffer_load_dwordx4 v1, s[28:31], s56 offen offset:1024 sc1 lds
  v_mfma_f32_16x16x32_bf16 v[128:131], a[220:223], a[156:159], v[128:131]
  s_nop 0
  ds_read_b128 a[248:251], v252 offset:38912
  ds_read_b128 a[252:255], v252 offset:39936
  v_mfma_f32_16x16x32_bf16 v[132:135], a[208:211], a[160:163], v[212:215]
  v_exp_f32 v80, v80
  v_mfma_f32_16x16x32_bf16 v[132:135], a[212:215], a[164:167], v[132:135]
  v_exp_f32 v81, v81
  v_mfma_f32_16x16x32_bf16 v[132:135], a[216:219], a[168:171], v[132:135]
  v_exp_f32 v82, v82
  v_mfma_f32_16x16x32_bf16 v[132:135], a[220:223], a[172:175], v[132:135]
  buffer_load_dwordx4 v1, s[28:31], s56 offen offset:2048 sc1 lds
  v_mfma_f32_16x16x32_bf16 v[136:139], a[208:211], a[176:179], v[216:219]
  v_exp_f32 v83, v83
  v_mfma_f32_16x16x32_bf16 v[136:139], a[212:215], a[180:183], v[136:139]
  v_exp_f32 v84, v84
  v_mfma_f32_16x16x32_bf16 v[136:139], a[216:219], a[184:187], v[136:139]
  v_exp_f32 v85, v85
  v_mfma_f32_16x16x32_bf16 v[136:139], a[220:223], a[188:191], v[136:139]
  v_exp_f32 v86, v86
  v_mfma_f32_16x16x32_bf16 v[140:143], a[208:211], a[192:195], v[220:223]
  buffer_load_dwordx4 v1, s[28:31], s56 offen offset:3072 sc1 lds
  v_mfma_f32_16x16x32_bf16 v[140:143], a[212:215], a[196:199], v[140:143]
  s_nop 0
  ds_read_b128 a[208:211], v252 offset:40960
  ds_read_b128 a[212:215], v252 offset:41984
  v_mfma_f32_16x16x32_bf16 v[140:143], a[216:219], a[200:203], v[140:143]
  ds_read_b128 a[216:219], v252 offset:43008
  v_cvt_pk_bf16_f32 v176, v80, v81
  v_mfma_f32_16x16x32_bf16 v[140:143], a[220:223], a[204:207], v[140:143]
  ds_read_b128 a[220:223], v252 offset:44032
  v_cvt_pk_bf16_f32 v177, v82, v83
  v_mfma_f32_16x16x32_bf16 a[0:3], a[224:227], v[144:147], a[0:3]
  v_exp_f32 v87, v87
  v_mfma_f32_16x16x32_bf16 a[0:3], a[228:231], v[148:151], a[0:3]
  v_exp_f32 v88, v88
  v_mfma_f32_16x16x32_bf16 a[4:7], a[224:227], v[152:155], a[4:7]
  v_exp_f32 v89, v89
  v_mfma_f32_16x16x32_bf16 a[4:7], a[228:231], v[156:159], a[4:7]
  v_exp_f32 v90, v90
  v_mfma_f32_16x16x32_bf16 a[8:11], a[224:227], v[160:163], a[8:11]
  v_exp_f32 v91, v91
  v_mfma_f32_16x16x32_bf16 a[8:11], a[228:231], v[164:167], a[8:11]
  v_exp_f32 v92, v92
  v_mfma_f32_16x16x32_bf16 a[12:15], a[224:227], v[168:171], a[12:15]
  ds_read_b128 a[224:227], v252 offset:45056
  v_cvt_pk_bf16_f32 v184, v84, v85
  v_mfma_f32_16x16x32_bf16 a[12:15], a[228:231], v[172:175], a[12:15]
  ds_read_b128 a[228:231], v252 offset:46080
  v_cvt_pk_bf16_f32 v185, v86, v87
  v_mfma_f32_16x16x32_bf16 a[16:19], a[232:235], v[144:147], a[16:19]
  v_exp_f32 v93, v93
  v_mfma_f32_16x16x32_bf16 a[16:19], a[236:239], v[148:151], a[16:19]
  v_exp_f32 v94, v94
  v_mfma_f32_16x16x32_bf16 a[20:23], a[232:235], v[152:155], a[20:23]
  v_exp_f32 v95, v95
  v_mfma_f32_16x16x32_bf16 a[20:23], a[236:239], v[156:159], a[20:23]
  v_exp_f32 v96, v96
  v_mfma_f32_16x16x32_bf16 a[24:27], a[232:235], v[160:163], a[24:27]
  v_exp_f32 v97, v97
  v_mfma_f32_16x16x32_bf16 a[24:27], a[236:239], v[164:167], a[24:27]
  v_exp_f32 v98, v98
  v_mfma_f32_16x16x32_bf16 a[28:31], a[232:235], v[168:171], a[28:31]
  v_exp_f32 v99, v99
  v_mfma_f32_16x16x32_bf16 a[28:31], a[236:239], v[172:175], a[28:31]
  s_waitcnt lgkmcnt(0)
  v_exp_f32 v100, v100
  v_mfma_f32_16x16x32_bf16 a[32:35], a[240:243], v[144:147], a[32:35]
  v_exp_f32 v101, v101
  v_mfma_f32_16x16x32_bf16 a[32:35], a[244:247], v[148:151], a[32:35]
  v_exp_f32 v102, v102
  v_mfma_f32_16x16x32_bf16 a[36:39], a[240:243], v[152:155], a[36:39]
  v_exp_f32 v103, v103
  v_mfma_f32_16x16x32_bf16 a[36:39], a[244:247], v[156:159], a[36:39]
  v_exp_f32 v104, v104
  v_mfma_f32_16x16x32_bf16 a[40:43], a[240:243], v[160:163], a[40:43]
  buffer_store_dwordx4 v[240:243], v1, s[28:31], s74 offen sc1
  v_mfma_f32_16x16x32_bf16 a[40:43], a[244:247], v[164:167], a[40:43]
  s_add_u32 s74, s74, 2048
  v_exp_f32 v105, v105
  v_mfma_f32_16x16x32_bf16 a[44:47], a[240:243], v[168:171], a[44:47]
  v_exp_f32 v106, v106
  v_mfma_f32_16x16x32_bf16 a[44:47], a[244:247], v[172:175], a[44:47]
  v_exp_f32 v107, v107
  v_mfma_f32_16x16x32_bf16 a[48:51], a[248:251], v[144:147], a[48:51]
  v_exp_f32 v108, v108
  v_mfma_f32_16x16x32_bf16 a[48:51], a[252:255], v[148:151], a[48:51]
  v_exp_f32 v109, v109
  v_mfma_f32_16x16x32_bf16 a[52:55], a[248:251], v[152:155], a[52:55]
  v_exp_f32 v110, v110
  v_mfma_f32_16x16x32_bf16 a[52:55], a[252:255], v[156:159], a[52:55]
  v_exp_f32 v111, v111
  v_mfma_f32_16x16x32_bf16 a[56:59], a[248:251], v[160:163], a[56:59]
  ds_read_b128 a[232:235], v252 offset:47104
  v_cvt_pk_bf16_f32 v192, v88, v89
  v_mfma_f32_16x16x32_bf16 a[56:59], a[252:255], v[164:167], a[56:59]
  ds_read_b128 a[236:239], v252 offset:48128
  v_cvt_pk_bf16_f32 v193, v90, v91
  v_mfma_f32_16x16x32_bf16 a[60:63], a[248:251], v[168:171], a[60:63]
  v_cvt_pk_bf16_f32 v200, v92, v93
  v_cvt_pk_bf16_f32 v201, v94, v95
  v_mfma_f32_16x16x32_bf16 a[60:63], a[252:255], v[172:175], a[60:63]
  v_cvt_pk_bf16_f32 v178, v96, v97
  v_cvt_pk_bf16_f32 v179, v98, v99
  v_mfma_f32_16x16x32_bf16 a[64:67], a[208:211], v[144:147], a[64:67]
  v_cvt_pk_bf16_f32 v186, v100, v101
  v_cvt_pk_bf16_f32 v187, v102, v103
  v_mfma_f32_16x16x32_bf16 a[64:67], a[212:215], v[148:151], a[64:67]
  v_cvt_pk_bf16_f32 v194, v104, v105
  v_cvt_pk_bf16_f32 v195, v106, v107
  v_mfma_f32_16x16x32_bf16 a[68:71], a[208:211], v[152:155], a[68:71]
  v_cvt_pk_bf16_f32 v202, v108, v109
  v_cvt_pk_bf16_f32 v203, v110, v111
  v_mfma_f32_16x16x32_bf16 a[68:71], a[212:215], v[156:159], a[68:71]
  v_mfma_f32_16x16x32_bf16 a[72:75], a[208:211], v[160:163], a[72:75]
  v_mfma_f32_16x16x32_bf16 a[72:75], a[212:215], v[164:167], a[72:75]
  v_mfma_f32_16x16x32_bf16 a[76:79], a[208:211], v[168:171], a[76:79]
  v_mfma_f32_16x16x32_bf16 a[76:79], a[212:215], v[172:175], a[76:79]
  v_mfma_f32_16x16x32_bf16 a[80:83], a[216:219], v[144:147], a[80:83]
  v_mfma_f32_16x16x32_bf16 a[80:83], a[220:223], v[148:151], a[80:83]
  v_mfma_f32_16x16x32_bf16 a[84:87], a[216:219], v[152:155], a[84:87]
  v_mfma_f32_16x16x32_bf16 a[84:87], a[220:223], v[156:159], a[84:87]
  v_mfma_f32_16x16x32_bf16 a[88:91], a[216:219], v[160:163], a[88:91]
  v_mfma_f32_16x16x32_bf16 a[88:91], a[220:223], v[164:167], a[88:91]
  v_mfma_f32_16x16x32_bf16 a[92:95], a[216:219], v[168:171], a[92:95]
  v_mfma_f32_16x16x32_bf16 a[92:95], a[220:223], v[172:175], a[92:95]
  v_mfma_f32_16x16x32_bf16 a[96:99], a[224:227], v[144:147], a[96:99]
  v_mfma_f32_16x16x32_bf16 a[96:99], a[228:231], v[148:151], a[96:99]
  v_mfma_f32_16x16x32_bf16 a[100:103], a[224:227], v[152:155], a[100:103]
  v_mfma_f32_16x16x32_bf16 a[100:103], a[228:231], v[156:159], a[100:103]
  v_mfma_f32_16x16x32_bf16 a[104:107], a[224:227], v[160:163], a[104:107]
  v_mfma_f32_16x16x32_bf16 a[104:107], a[228:231], v[164:167], a[104:107]
  v_mfma_f32_16x16x32_bf16 a[108:111], a[224:227], v[168:171], a[108:111]
  v_mfma_f32_16x16x32_bf16 a[108:111], a[228:231], v[172:175], a[108:111]
  s_cmp_lg_u32 s92, 16
  s_cbranch_scc1 L_ed
  s_cmp_eq_u32 s40, 3
  s_cbranch_scc1 L_edd
  s_lshl_b32 s43, s42, 2
  s_add_u32 s43, s43, s40
  s_cmp_eq_u32 s43, 28
  s_cbranch_scc1 L_edd
L_ed:
  s_waitcnt vmcnt(1) lgkmcnt(0)
  s_barrier
  v_mfma_f32_16x16x32_bf16 a[128:131], v[224:227], v[144:147], a[128:131]
  s_add_u32 m0, s49, 0x8000
  ds_read_b128 a[208:211], v252
  ds_read_b128 a[212:215], v252 offset:1024
  v_mfma_f32_16x16x32_bf16 a[128:131], v[224:227], v[148:151], a[128:131]
  s_add_u32 s57, s47, 0x0
  buffer_load_dwordx4 v1, s[28:31], s57 offen sc1 lds
  v_mfma_f32_16x16x32_bf16 a[132:135], v[224:227], v[152:155], a[132:135]
  s_add_u32 s58, s47, 0x1000
  ds_read_b128 a[216:219], v252 offset:2048
  ds_read_b128 a[220:223], v252 offset:3072
  v_mfma_f32_16x16x32_bf16 a[132:135], v[224:227], v[156:159], a[132:135]
  s_add_u32 s59, s48, 0x0
  ds_read_b128 a[224:227], v252 offset:4096
  ds_read_b128 a[228:231], v252 offset:5120
  v_mfma_f32_16x16x32_bf16 a[136:139], v[224:227], v[160:163], a[136:139]
  s_add_u32 s56, s48, 0x1000
  ds_read_b128 a[240:243], v252 offset:8192
  ds_read_b128 a[244:247], v252 offset:9216
  v_mfma_f32_16x16x32_bf16 a[136:139], v[224:227], v[164:167], a[136:139]
  s_add_u32 s47, s47, 0x8000
  ds_read_b128 a[248:251], v252 offset:10240
  ds_read_b128 a[252:255], v252 offset:11264
  v_mfma_f32_16x16x32_bf16 a[140:143], v[224:227], v[168:171], a[140:143]
  s_add_u32 s48, s48, 0x8000
  buffer_load_dwordx4 v1, s[28:31], s57 offen offset:1024 sc1 lds
  v_mfma_f32_16x16x32_bf16 a[140:143], v[224:227], v[172:175], a[140:143]
  s_add_u32 s92, s92, 1
  v_exp_f32 v112, v112
  v_mfma_f32_16x16x32_bf16 a[112:115], a[232:235], v[144:147], a[112:115]
  v_exp_f32 v113, v113
  v_mfma_f32_16x16x32_bf16 a[112:115], a[236:239], v[148:151], a[112:115]
  v_exp_f32 v114, v114
  v_mfma_f32_16x16x32_bf16 a[116:119], a[232:235], v[152:155], a[116:119]
  v_exp_f32 v115, v115
  v_mfma_f32_16x16x32_bf16 a[116:119], a[236:239], v[156:159], a[116:119]
  buffer_load_dwordx4 v1, s[28:31], s57 offen offset:2048 sc1 lds
  v_mfma_f32_16x16x32_bf16 a[120:123], a[232:235], v[160:163], a[120:123]
  v_exp_f32 v128, v128
  v_mfma_f32_16x16x32_bf16 a[120:123], a[236:239], v[164:167], a[120:123]
  v_exp_f32 v129, v129
  v_mfma_f32_16x16x32_bf16 a[124:127], a[232:235], v[168:171], a[124:127]
  ds_read_b128 a[232:235], v252 offset:6144
  v_cvt_pk_bf16_f32 v180, v112, v113
  v_mfma_f32_16x16x32_bf16 a[124:127], a[236:239], v[172:175], a[124:127]
  s_waitcnt lgkmcnt(1)
  ds_read_b128 a[236:239], v252 offset:7168
  v_cvt_pk_bf16_f32 v181, v114, v115
  v_mfma_f32_16x16x32_bf16 v[16:19], a[208:211], a[144:147], v[208:211]
  buffer_load_dwordx4 v1, s[28:31], s57 offen offset:3072 sc1 lds
  v_mfma_f32_16x16x32_bf16 v[16:19], a[212:215], a[148:151], v[16:19]
  s_add_u32 m0, s49, 0x9000
  v_exp_f32 v130, v130
  v_mfma_f32_16x16x32_bf16 v[16:19], a[216:219], a[152:155], v[16:19]
  v_exp_f32 v131, v131
  v_mfma_f32_16x16x32_bf16 v[16:19], a[220:223], a[156:159], v[16:19]
  v_cvt_pk_bf16_f32 v182, v128, v129
  v_cvt_pk_bf16_f32 v183, v130, v131
  v_mfma_f32_16x16x32_bf16 v[20:23], a[208:211], a[160:163], v[212:215]
  v_exp_f32 v116, v116
  v_mfma_f32_16x16x32_bf16 v[20:23], a[212:215], a[164:167], v[20:23]
  buffer_load_dwordx4 v1, s[28:31], s58 offen sc1 lds
  v_mfma_f32_16x16x32_bf16 v[20:23], a[216:219], a[168:171], v[20:23]
  v_exp_f32 v117, v117
  v_mfma_f32_16x16x32_bf16 v[20:23], a[220:223], a[172:175], v[20:23]
  v_exp_f32 v118, v118
  v_mfma_f32_16x16x32_bf16 v[24:27], a[208:211], a[176:179], v[216:219]
  v_exp_f32 v119, v119
  v_mfma_f32_16x16x32_bf16 v[24:27], a[212:215], a[180:183], v[24:27]
  v_exp_f32 v132, v132
  v_mfma_f32_16x16x32_bf16 v[24:27], a[216:219], a[184:187], v[24:27]
  buffer_load_dwordx4 v1, s[28:31], s58 offen offset:1024 sc1 lds
  v_mfma_f32_16x16x32_bf16 v[24:27], a[220:223], a[188:191], v[24:27]
  v_exp_f32 v133, v133
  v_mfma_f32_16x16x32_bf16 v[28:31], a[208:211], a[192:195], v[220:223]
  ds_read_b128 a[208:211], v252 offset:12288
  v_cvt_pk_bf16_f32 v188, v116, v117
  v_mfma_f32_16x16x32_bf16 v[28:31], a[212:215], a[196:199], v[28:31]
  ds_read_b128 a[212:215], v252 offset:13312
  v_cvt_pk_bf16_f32 v189, v118, v119
  v_mfma_f32_16x16x32_bf16 v[28:31], a[216:219], a[200:203], v[28:31]
  ds_read_b128 a[216:219], v252 offset:14336
  v_cvt_pk_bf16_f32 v190, v132, v133
  v_mfma_f32_16x16x32_bf16 v[28:31], a[220:223], a[204:207], v[28:31]
  buffer_load_dwordx4 v1, s[28:31], s58 offen offset:2048 sc1 lds
  v_mfma_f32_16x16x32_bf16 v[32:35], a[224:227], a[144:147], v[208:211]
  ds_read_b128 a[220:223], v252 offset:15360
  v_mfma_f32_16x16x32_bf16 v[32:35], a[228:231], a[148:151], v[32:35]
  s_waitcnt lgkmcnt(4)
  v_exp_f32 v134, v134
  v_mfma_f32_16x16x32_bf16 v[32:35], a[232:235], a[152:155], v[32:35]
  v_exp_f32 v135, v135
  v_mfma_f32_16x16x32_bf16 v[32:35], a[236:239], a[156:159], v[32:35]
  v_cvt_pk_bf16_f32 v191, v134, v135
  v_mfma_f32_16x16x32_bf16 v[36:39], a[224:227], a[160:163], v[212:215]
  buffer_load_dwordx4 v1, s[28:31], s58 offen offset:3072 sc1 lds
  v_mfma_f32_16x16x32_bf16 v[36:39], a[228:231], a[164:167], v[36:39]
  s_add_u32 m0, s49, 0x4000
  v_exp_f32 v120, v120
  v_mfma_f32_16x16x32_bf16 v[36:39], a[232:235], a[168:171], v[36:39]
  v_exp_f32 v121, v121
  v_mfma_f32_16x16x32_bf16 v[36:39], a[236:239], a[172:175], v[36:39]
  v_exp_f32 v122, v122
  v_mfma_f32_16x16x32_bf16 v[40:43], a[224:227], a[176:179], v[216:219]
  v_exp_f32 v123, v123
  v_mfma_f32_16x16x32_bf16 v[40:43], a[228:231], a[180:183], v[40:43]
  buffer_load_dwordx4 v1, s[28:31], s59 offen sc1 lds
  v_mfma_f32_16x16x32_bf16 v[40:43], a[232:235], a[184:187], v[40:43]
  v_exp_f32 v136, v136
  v_mfma_f32_16x16x32_bf16 v[40:43], a[236:239], a[188:191], v[40:43]
  v_exp_f32 v137, v137
  v_mfma_f32_16x16x32_bf16 v[44:47], a[224:227], a[192:195], v[220:223]
  ds_read_b128 a[224:227], v252 offset:49152
  v_cvt_pk_bf16_f32 v196, v120, v121
  v_mfma_f32_16x16x32_bf16 v[44:47], a[228:231], a[196:199], v[44:47]
  ds_read_b128 a[228:231], v252 offset:50176
  v_cvt_pk_bf16_f32 v197, v122, v123
  v_mfma_f32_16x16x32_bf16 v[44:47], a[232:235], a[200:203], v[44:47]
  buffer_load_dwordx4 v1, s[28:31], s59 offen offset:1024 sc1 lds
  v_mfma_f32_16x16x32_bf16 v[44:47], a[236:239], a[204:207], v[44:47]
  s_nop 0
  ds_read_b128 a[232:235], v252 offset:51200
  ds_read_b128 a[236:239], v252 offset:52224
  v_mfma_f32_16x16x32_bf16 v[48:51], a[240:243], a[144:147], v[208:211]
  v_exp_f32 v138, v138
  v_mfma_f32_16x16x32_bf16 v[48:51], a[244:247], a[148:151], v[48:51]
  v_exp_f32 v139, v139
  v_mfma_f32_16x16x32_bf16 v[48:51], a[248:251], a[152:155], v[48:51]
  v_cvt_pk_bf16_f32 v198, v136, v137
  v_cvt_pk_bf16_f32 v199, v138, v139
  v_mfma_f32_16x16x32_bf16 v[48:51], a[252:255], a[156:159], v[48:51]
  buffer_load_dwordx4 v1, s[28:31], s59 offen offset:2048 sc1 lds
  v_mfma_f32_16x16x32_bf16 v[52:55], a[240:243], a[160:163], v[212:215]
  v_exp_f32 v124, v124
  v_mfma_f32_16x16x32_bf16 v[52:55], a[244:247], a[164:167], v[52:55]
  v_exp_f32 v125, v125
  v_mfma_f32_16x16x32_bf16 v[52:55], a[248:251], a[168:171], v[52:55]
  v_exp_f32 v126, v126
  v_mfma_f32_16x16x32_bf16 v[52:55], a[252:255], a[172:175], v[52:55]
  v_exp_f32 v127, v127
  v_mfma_f32_16x16x32_bf16 v[56:59], a[240:243], a[176:179], v[216:219]
  buffer_load_dwordx4 v1, s[28:31], s59 offen offset:3072 sc1 lds
  v_mfma_f32_16x16x32_bf16 v[56:59], a[244:247], a[180:183], v[56:59]
  s_add_u32 m0, s49, 0x5000
  v_exp_f32 v140, v140
  v_mfma_f32_16x16x32_bf16 v[56:59], a[248:251], a[184:187], v[56:59]
  v_exp_f32 v141, v141
  v_mfma_f32_16x16x32_bf16 v[56:59], a[252:255], a[188:191], v[56:59]
  v_exp_f32 v142, v142
  v_mfma_f32_16x16x32_bf16 v[60:63], a[240:243], a[192:195], v[220:223]
  v_exp_f32 v143, v143
  v_mfma_f32_16x16x32_bf16 v[60:63], a[244:247], a[196:199], v[60:63]
  buffer_load_dwordx4 v1, s[28:31], s56 offen sc1 lds
  v_mfma_f32_16x16x32_bf16 v[60:63], a[248:251], a[200:203], v[60:63]
  ds_read_b128 a[240:243], v252 offset:53248
  v_cvt_pk_bf16_f32 v204, v124, v125
  v_mfma_f32_16x16x32_bf16 v[60:63], a[252:255], a[204:207], v[60:63]
  s_waitcnt lgkmcnt(1)
  ds_read_b128 a[244:247], v252 offset:54272
  v_cvt_pk_bf16_f32 v205, v126, v127
  v_mfma_f32_16x16x32_bf16 v[64:67], a[208:211], a[144:147], v[208:211]
  v_cvt_pk_bf16_f32 v206, v140, v141
  v_cvt_pk_bf16_f32 v207, v142, v143
  v_mfma_f32_16x16x32_bf16 v[64:67], a[212:215], a[148:151], v[64:67]
  s_nop 0
  ds_read_b128 a[248:251], v252 offset:55296
  ds_read_b128 a[252:255], v252 offset:56320
  v_mfma_f32_16x16x32_bf16 v[64:67], a[216:219], a[152:155], v[64:67]
  buffer_load_dwordx4 v1, s[28:31], s56 offen offset:1024 sc1 lds
  v_mfma_f32_16x16x32_bf16 v[64:67], a[220:223], a[156:159], v[64:67]
  v_exp_f32 v16, v16
  v_mfma_f32_16x16x32_bf16 v[68:71], a[208:211], a[160:163], v[212:215]
  v_exp_f32 v17, v17
  v_mfma_f32_16x16x32_bf16 v[68:71], a[212:215], a[164:167], v[68:71]
  v_exp_f32 v18, v18
  v_mfma_f32_16x16x32_bf16 v[68:71], a[216:219], a[168:171], v[68:71]
  v_exp_f32 v19, v19
  v_mfma_f32_16x16x32_bf16 v[68:71], a[220:223], a[172:175], v[68:71]
  buffer_load_dwordx4 v1, s[28:31], s56 offen offset:2048 sc1 lds
  v_mfma_f32_16x16x32_bf16 v[72:75], a[208:211], a[176:179], v[216:219]
  v_exp_f32 v20, v20
  v_mfma_f32_16x16x32_bf16 v[72:75], a[212:215], a[180:183], v[72:75]
  v_exp_f32 v21, v21
  v_mfma_f32_16x16x32_bf16 v[72:75], a[216:219], a[184:187], v[72:75]
  v_exp_f32 v22, v22
  v_mfma_f32_16x16x32_bf16 v[72:75], a[220:223], a[188:191], v[72:75]
  v_exp_f32 v23, v23
  v_mfma_f32_16x16x32_bf16 v[76:79], a[208:211], a[192:195], v[220:223]
  buffer_load_dwordx4 v1, s[28:31], s56 offen offset:3072 sc1 lds
  v_mfma_f32_16x16x32_bf16 v[76:79], a[212:215], a[196:199], v[76:79]
  s_nop 0
  ds_read_b128 a[208:211], v252 offset:57344
  ds_read_b128 a[212:215], v252 offset:58368
  v_mfma_f32_16x16x32_bf16 v[76:79], a[216:219], a[200:203], v[76:79]
  ds_read_b128 a[216:219], v252 offset:59392
  v_cvt_pk_bf16_f32 v144, v16, v17
  v_mfma_f32_16x16x32_bf16 v[76:79], a[220:223], a[204:207], v[76:79]
  ds_read_b128 a[220:223], v252 offset:60416
  v_cvt_pk_bf16_f32 v145, v18, v19
  v_mfma_f32_16x16x32_bf16 a[0:3], a[224:227], v[176:179], a[0:3]
  v_exp_f32 v24, v24
  v_mfma_f32_16x16x32_bf16 a[0:3], a[228:231], v[180:183], a[0:3]
  v_exp_f32 v25, v25
  v_mfma_f32_16x16x32_bf16 a[4:7], a[224:227], v[184:187], a[4:7]
  v_exp_f32 v26, v26
  v_mfma_f32_16x16x32_bf16 a[4:7], a[228:231], v[188:191], a[4:7]
  v_exp_f32 v27, v27
  v_mfma_f32_16x16x32_bf16 a[8:11], a[224:227], v[192:195], a[8:11]
  v_exp_f32 v28, v28
  v_mfma_f32_16x16x32_bf16 a[8:11], a[228:231], v[196:199], a[8:11]
  v_exp_f32 v29, v29
  v_mfma_f32_16x16x32_bf16 a[12:15], a[224:227], v[200:203], a[12:15]
  ds_read_b128 a[224:227], v252 offset:61440
  v_cvt_pk_bf16_f32 v152, v20, v21
  v_mfma_f32_16x16x32_bf16 a[12:15], a[228:231], v[204:207], a[12:15]
  ds_read_b128 a[228:231], v252 offset:62464
  v_cvt_pk_bf16_f32 v153, v22, v23
  v_mfma_f32_16x16x32_bf16 a[16:19], a[232:235], v[176:179], a[16:19]
  v_exp_f32 v30, v30
  v_mfma_f32_16x16x32_bf16 a[16:19], a[236:239], v[180:183], a[16:19]
  v_exp_f32 v31, v31
  v_mfma_f32_16x16x32_bf16 a[20:23], a[232:235], v[184:187], a[20:23]
  v_exp_f32 v32, v32
  v_mfma_f32_16x16x32_bf16 a[20:23], a[236:239], v[188:191], a[20:23]
  v_exp_f32 v33, v33
  v_mfma_f32_16x16x32_bf16 a[24:27], a[232:235], v[192:195], a[24:27]
  v_exp_f32 v34, v34
  v_mfma_f32_16x16x32_bf16 a[24:27], a[236:239], v[196:199], a[24:27]
  v_exp_f32 v35, v35
  v_mfma_f32_16x16x32_bf16 a[28:31], a[232:235], v[200:203], a[28:31]
  v_exp_f32 v36, v36
  v_mfma_f32_16x16x32_bf16 a[28:31], a[236:239], v[204:207], a[28:31]
  s_waitcnt lgkmcnt(0)
  v_exp_f32 v37, v37
  v_mfma_f32_16x16x32_bf16 a[32:35], a[240:243], v[176:179], a[32:35]
  v_exp_f32 v38, v38
  v_mfma_f32_16x16x32_bf16 a[32:35], a[244:247], v[180:183], a[32:35]
  v_exp_f32 v39, v39
  v_mfma_f32_16x16x32_bf16 a[36:39], a[240:243], v[184:187], a[36:39]
  v_exp_f32 v40, v40
  v_mfma_f32_16x16x32_bf16 a[36:39], a[244:247], v[188:191], a[36:39]
  v_exp_f32 v41, v41
  v_mfma_f32_16x16x32_bf16 a[40:43], a[240:243], v[192:195], a[40:43]
  buffer_store_dwordx4 v[240:243], v1, s[28:31], s74 offen sc1
  v_mfma_f32_16x16x32_bf16 a[40:43], a[244:247], v[196:199], a[40:43]
  s_add_u32 s74, s74, 2048
  v_exp_f32 v42, v42
  v_mfma_f32_16x16x32_bf16 a[44:47], a[240:243], v[200:203], a[44:47]
  v_exp_f32 v43, v43
  v_mfma_f32_16x16x32_bf16 a[44:47], a[244:247], v[204:207], a[44:47]
  v_exp_f32 v44, v44
  v_mfma_f32_16x16x32_bf16 a[48:51], a[248:251], v[176:179], a[48:51]
  v_exp_f32 v45, v45
  v_mfma_f32_16x16x32_bf16 a[48:51], a[252:255], v[180:183], a[48:51]
  v_exp_f32 v46, v46
  v_mfma_f32_16x16x32_bf16 a[52:55], a[248:251], v[184:187], a[52:55]
  v_exp_f32 v47, v47
  v_mfma_f32_16x16x32_bf16 a[52:55], a[252:255], v[188:191], a[52:55]
  ds_read_b128 a[232:235], v252 offset:63488
  v_cvt_pk_bf16_f32 v160, v24, v25
  v_mfma_f32_16x16x32_bf16 a[56:59], a[248:251], v[192:195], a[56:59]
  ds_read_b128 a[236:239], v252 offset:64512
  v_cvt_pk_bf16_f32 v161, v26, v27
  v_mfma_f32_16x16x32_bf16 a[56:59], a[252:255], v[196:199], a[56:59]
  v_cvt_pk_bf16_f32 v168, v28, v29
  v_cvt_pk_bf16_f32 v169, v30, v31
  v_mfma_f32_16x16x32_bf16 a[60:63], a[248:251], v[200:203], a[60:63]
  v_cvt_pk_bf16_f32 v146, v32, v33
  v_cvt_pk_bf16_f32 v147, v34, v35
  v_mfma_f32_16x16x32_bf16 a[60:63], a[252:255], v[204:207], a[60:63]
  v_cvt_pk_bf16_f32 v154, v36, v37
  v_cvt_pk_bf16_f32 v155, v38, v39
  v_mfma_f32_16x16x32_bf16 a[64:67], a[208:211], v[176:179], a[64:67]
  v_cvt_pk_bf16_f32 v162, v40, v41
  v_cvt_pk_bf16_f32 v163, v42, v43
  v_mfma_f32_16x16x32_bf16 a[64:67], a[212:215], v[180:183], a[64:67]
  v_cvt_pk_bf16_f32 v170, v44, v45
  v_cvt_pk_bf16_f32 v171, v46, v47
  v_mfma_f32_16x16x32_bf16 a[68:71], a[208:211], v[184:187], a[68:71]
  v_mfma_f32_16x16x32_bf16 a[68:71], a[212:215], v[188:191], a[68:71]
  v_mfma_f32_16x16x32_bf16 a[72:75], a[208:211], v[192:195], a[72:75]
  v_mfma_f32_16x16x32_bf16 a[72:75], a[212:215], v[196:199], a[72:75]
  v_mfma_f32_16x16x32_bf16 a[76:79], a[208:211], v[200:203], a[76:79]
  v_mfma_f32_16x16x32_bf16 a[76:79], a[212:215], v[204:207], a[76:79]
  v_mfma_f32_16x16x32_bf16 a[80:83], a[216:219], v[176:179], a[80:83]
  v_mfma_f32_16x16x32_bf16 a[80:83], a[220:223], v[180:183], a[80:83]
  v_mfma_f32_16x16x32_bf16 a[84:87], a[216:219], v[184:187], a[84:87]
  v_mfma_f32_16x16x32_bf16 a[84:87], a[220:223], v[188:191], a[84:87]
  v_mfma_f32_16x16x32_bf16 a[88:91], a[216:219], v[192:195], a[88:91]
  v_mfma_f32_16x16x32_bf16 a[88:91], a[220:223], v[196:199], a[88:91]
  v_mfma_f32_16x16x32_bf16 a[92:95], a[216:219], v[200:203], a[92:95]
  v_mfma_f32_16x16x32_bf16 a[92:95], a[220:223], v[204:207], a[92:95]
  v_mfma_f32_16x16x32_bf16 a[96:99], a[224:227], v[176:179], a[96:99]
  v_mfma_f32_16x16x32_bf16 a[96:99], a[228:231], v[180:183], a[96:99]
  v_mfma_f32_16x16x32_bf16 a[100:103], a[224:227], v[184:187], a[100:103]
  v_mfma_f32_16x16x32_bf16 a[100:103], a[228:231], v[188:191], a[100:103]
  v_mfma_f32_16x16x32_bf16 a[104:107], a[224:227], v[192:195], a[104:107]
  v_mfma_f32_16x16x32_bf16 a[104:107], a[228:231], v[196:199], a[104:107]
  v_mfma_f32_16x16x32_bf16 a[108:111], a[224:227], v[200:203], a[108:111]
  v_mfma_f32_16x16x32_bf16 a[108:111], a[228:231], v[204:207], a[108:111]
  s_cmp_lg_u32 s92, 17
  s_cbranch_scc1 L_od
  s_branch L_fin
L_edd:
  s_waitcnt vmcnt(1) lgkmcnt(0)
  s_barrier
  v_mfma_f32_16x16x32_bf16 a[128:131], v[224:227], v[144:147], a[128:131]
  s_add_u32 m0, s49, 0x8000
  ds_read_b128 a[208:211], v252
  ds_read_b128 a[212:215], v252 offset:1024
  v_mfma_f32_16x16x32_bf16 a[128:131], v[224:227], v[148:151], a[128:131]
  s_add_u32 s57, s47, 0x0
  buffer_load_dwordx4 v1, s[28:31], s57 offen sc1 lds
  v_mfma_f32_16x16x32_bf16 a[132:135], v[224:227], v[152:155], a[132:135]
  s_add_u32 s58, s47, 0x1000
  ds_read_b128 a[216:219], v252 offset:2048
  ds_read_b128 a[220:223], v252 offset:3072
  v_mfma_f32_16x16x32_bf16 a[132:135], v[224:227], v[156:159], a[132:135]
  s_add_u32 s59, s48, 0x0
  v_cndmask_b32 v16, v5, v208, s[60:61]
  v_cndmask_b32 v17, v5, v209, s[62:63]
  v_mfma_f32_16x16x32_bf16 a[136:139], v[224:227], v[160:163], a[136:139]
  s_add_u32 s56, s48, 0x1000
  v_cndmask_b32 v18, v5, v210, s[64:65]
  v_cndmask_b32 v19, v5, v211, s[66:67]
  v_mfma_f32_16x16x32_bf16 a[136:139], v[224:227], v[164:167], a[136:139]
  s_add_u32 s47, s47, 0x8000
  ds_read_b128 a[224:227], v252 offset:4096
  ds_read_b128 a[228:231], v252 offset:5120
  v_mfma_f32_16x16x32_bf16 a[140:143], v[224:227], v[168:171], a[140:143]
  s_add_u32 s48, s48, 0x8000
  buffer_load_dwordx4 v1, s[28:31], s57 offen offset:1024 sc1 lds
  v_mfma_f32_16x16x32_bf16 a[140:143], v[224:227], v[172:175], a[140:143]
  s_add_u32 s92, s92, 1
  ds_read_b128 a[240:243], v252 offset:8192
  v_cndmask_b32 v36, v5, v212, s[60:61]
  v_mfma_f32_16x16x32_bf16 a[112:115], a[232:235], v[144:147], a[112:115]
  ds_read_b128 a[244:247], v252 offset:9216
  v_cndmask_b32 v37, v5, v213, s[62:63]
  v_mfma_f32_16x16x32_bf16 a[112:115], a[236:239], v[148:151], a[112:115]
  ds_read_b128 a[248:251], v252 offset:10240
  v_cndmask_b32 v38, v5, v214, s[64:65]
  v_mfma_f32_16x16x32_bf16 a[116:119], a[232:235], v[152:155], a[116:119]
  v_cndmask_b32 v39, v5, v215, s[66:67]
  v_cndmask_b32 v56, v5, v216, s[60:61]
  v_mfma_f32_16x16x32_bf16 a[116:119], a[236:239], v[156:159], a[116:119]
  buffer_load_dwordx4 v1, s[28:31], s57 offen offset:2048 sc1 lds
  v_mfma_f32_16x16x32_bf16 a[120:123], a[232:235], v[160:163], a[120:123]
  ds_read_b128 a[252:255], v252 offset:11264
  v_cndmask_b32 v57, v5, v217, s[62:63]
  v_mfma_f32_16x16x32_bf16 a[120:123], a[236:239], v[164:167], a[120:123]
  v_cndmask_b32 v58, v5, v218, s[64:65]
  v_cndmask_b32 v59, v5, v219, s[66:67]
  v_mfma_f32_16x16x32_bf16 a[124:127], a[232:235], v[168:171], a[124:127]
  ds_read_b128 a[232:235], v252 offset:6144
  v_cndmask_b32 v76, v5, v220, s[60:61]
  v_mfma_f32_16x16x32_bf16 a[124:127], a[236:239], v[172:175], a[124:127]
  s_waitcnt lgkmcnt(3)
  ds_read_b128 a[236:239], v252 offset:7168
  v_cndmask_b32 v77, v5, v221, s[62:63]
  v_mfma_f32_16x16x32_bf16 v[16:19], a[208:211], a[144:147], v[16:19]
  buffer_load_dwordx4 v1, s[28:31], s57 offen offset:3072 sc1 lds
  v_mfma_f32_16x16x32_bf16 v[16:19], a[212:215], a[148:151], v[16:19]
  s_add_u32 m0, s49, 0x9000
  v_cndmask_b32 v78, v5, v222, s[64:65]
  v_cndmask_b32 v79, v5, v223, s[66:67]
  v_mfma_f32_16x16x32_bf16 v[16:19], a[216:219], a[152:155], v[16:19]
  v_exp_f32 v112, v112
  v_mfma_f32_16x16x32_bf16 v[16:19], a[220:223], a[156:159], v[16:19]
  v_exp_f32 v113, v113
  v_mfma_f32_16x16x32_bf16 v[20:23], a[208:211], a[160:163], v[212:215]
  v_exp_f32 v114, v114
  v_mfma_f32_16x16x32_bf16 v[20:23], a[212:215], a[164:167], v[20:23]
  buffer_load_dwordx4 v1, s[28:31], s58 offen sc1 lds
  v_mfma_f32_16x16x32_bf16 v[20:23], a[216:219], a[168:171], v[20:23]
  v_exp_f32 v115, v115
  v_mfma_f32_16x16x32_bf16 v[20:23], a[220:223], a[172:175], v[20:23]
  v_exp_f32 v128, v128
  v_mfma_f32_16x16x32_bf16 v[24:27], a[208:211], a[176:179], v[216:219]
  v_exp_f32 v129, v129
  v_mfma_f32_16x16x32_bf16 v[24:27], a[212:215], a[180:183], v[24:27]
  v_exp_f32 v130, v130
  v_mfma_f32_16x16x32_bf16 v[24:27], a[216:219], a[184:187], v[24:27]
  buffer_load_dwordx4 v1, s[28:31], s58 offen offset:1024 sc1 lds
  v_mfma_f32_16x16x32_bf16 v[24:27], a[220:223], a[188:191], v[24:27]
  v_exp_f32 v131, v131
  v_mfma_f32_16x16x32_bf16 v[28:31], a[208:211], a[192:195], v[220:223]
  ds_read_b128 a[208:211], v252 offset:12288
  v_cvt_pk_bf16_f32 v180, v112, v113
  v_mfma_f32_16x16x32_bf16 v[28:31], a[212:215], a[196:199], v[28:31]
  ds_read_b128 a[212:215], v252 offset:13312
  v_cvt_pk_bf16_f32 v181, v114, v115
  v_mfma_f32_16x16x32_bf16 v[28:31], a[216:219], a[200:203], v[28:31]
  ds_read_b128 a[216:219], v252 offset:14336
  v_cvt_pk_bf16_f32 v182, v128, v129
  v_mfma_f32_16x16x32_bf16 v[28:31], a[220:223], a[204:207], v[28:31]
  buffer_load_dwordx4 v1, s[28:31], s58 offen offset:2048 sc1 lds
  v_mfma_f32_16x16x32_bf16 v[36:39], a[224:227], a[160:163], v[36:39]
  ds_read_b128 a[220:223], v252 offset:15360
  v_cvt_pk_bf16_f32 v183, v130, v131
  v_mfma_f32_16x16x32_bf16 v[36:39], a[228:231], a[164:167], v[36:39]
  s_waitcnt lgkmcnt(4)
  v_exp_f32 v116, v116
  v_mfma_f32_16x16x32_bf16 v[36:39], a[232:235], a[168:171], v[36:39]
  v_exp_f32 v117, v117
  v_mfma_f32_16x16x32_bf16 v[36:39], a[236:239], a[172:175], v[36:39]
  v_exp_f32 v118, v118
  v_mfma_f32_16x16x32_bf16 v[40:43], a[224:227], a[176:179], v[216:219]
  buffer_load_dwordx4 v1, s[28:31], s58 offen offset:3072 sc1 lds
  v_mfma_f32_16x16x32_bf16 v[40:43], a[228:231], a[180:183], v[40:43]
  s_add_u32 m0, s49, 0x4000
  v_exp_f32 v119, v119
  v_mfma_f32_16x16x32_bf16 v[40:43], a[232:235], a[184:187], v[40:43]
  v_exp_f32 v132, v132
  v_mfma_f32_16x16x32_bf16 v[40:43], a[236:239], a[188:191], v[40:43]
  v_exp_f32 v133, v133
  v_mfma_f32_16x16x32_bf16 v[44:47], a[224:227], a[192:195], v[220:223]
  ds_read_b128 a[224:227], v252 offset:49152
  v_cvt_pk_bf16_f32 v188, v116, v117
  v_mfma_f32_16x16x32_bf16 v[44:47], a[228:231], a[196:199], v[44:47]
  buffer_load_dwordx4 v1, s[28:31], s59 offen sc1 lds
  v_mfma_f32_16x16x32_bf16 v[44:47], a[232:235], a[200:203], v[44:47]
  s_nop 0
  ds_read_b128 a[228:231], v252 offset:50176
  ds_read_b128 a[232:235], v252 offset:51200
  v_mfma_f32_16x16x32_bf16 v[44:47], a[236:239], a[204:207], v[44:47]
  ds_read_b128 a[236:239], v252 offset:52224
  v_cvt_pk_bf16_f32 v189, v118, v119
  v_mfma_f32_16x16x32_bf16 v[56:59], a[240:243], a[176:179], v[56:59]
  v_exp_f32 v134, v134
  v_mfma_f32_16x16x32_bf16 v[56:59], a[244:247], a[180:183], v[56:59]
  v_exp_f32 v135, v135
  v_mfma_f32_16x16x32_bf16 v[56:59], a[248:251], a[184:187], v[56:59]
  buffer_load_dwordx4 v1, s[28:31], s59 offen offset:1024 sc1 lds
  v_mfma_f32_16x16x32_bf16 v[56:59], a[252:255], a[188:191], v[56:59]
  v_cvt_pk_bf16_f32 v190, v132, v133
  v_cvt_pk_bf16_f32 v191, v134, v135
  v_mfma_f32_16x16x32_bf16 v[60:63], a[240:243], a[192:195], v[220:223]
  v_exp_f32 v120, v120
  v_mfma_f32_16x16x32_bf16 v[60:63], a[244:247], a[196:199], v[60:63]
  v_exp_f32 v121, v121
  v_mfma_f32_16x16x32_bf16 v[60:63], a[248:251], a[200:203], v[60:63]
  v_exp_f32 v122, v122
  v_mfma_f32_16x16x32_bf16 v[60:63], a[252:255], a[204:207], v[60:63]
  s_waitcnt lgkmcnt(0)
  buffer_load_dwordx4 v1, s[28:31], s59 offen offset:2048 sc1 lds
  v_mfma_f32_16x16x32_bf16 v[76:79], a[208:211], a[192:195], v[76:79]
  v_exp_f32 v123, v123
  v_mfma_f32_16x16x32_bf16 v[76:79], a[212:215], a[196:199], v[76:79]
  v_exp_f32 v136, v136
  v_mfma_f32_16x16x32_bf16 v[76:79], a[216:219], a[200:203], v[76:79]
  v_exp_f32 v137, v137
  v_mfma_f32_16x16x32_bf16 v[76:79], a[220:223], a[204:207], v[76:79]
  v_exp_f32 v138, v138
  v_mfma_f32_16x16x32_bf16 a[0:3], a[224:227], v[176:179], a[0:3]
  v_exp_f32 v139, v139
  v_mfma_f32_16x16x32_bf16 a[0:3], a[228:231], v[180:183], a[0:3]
  buffer_load_dwordx4 v1, s[28:31], s59 offen offset:3072 sc1 lds
  v_mfma_f32_16x16x32_bf16 a[4:7], a[224:227], v[184:187], a[4:7]
  s_add_u32 m0, s49, 0x5000
  ds_read_b128 a[240:243], v252 offset:53248
  v_cvt_pk_bf16_f32 v196, v120, v121
  v_mfma_f32_16x16x32_bf16 a[4:7], a[228:231], v[188:191], a[4:7]
  ds_read_b128 a[244:247], v252 offset:54272
  v_cvt_pk_bf16_f32 v197, v122, v123
  v_mfma_f32_16x16x32_bf16 a[8:11], a[224:227], v[192:195], a[8:11]
  v_cvt_pk_bf16_f32 v198, v136, v137
  v_cvt_pk_bf16_f32 v199, v138, v139
  s_nop 1
  v_mfma_f32_16x16x32_bf16 a[8:11], a[228:231], v[196:199], a[8:11]
  v_exp_f32 v124, v124
  v_mfma_f32_16x16x32_bf16 a[12:15], a[224:227], v[200:203], a[12:15]
  v_exp_f32 v125, v125
  s_nop 0
  v_cvt_pk_bf16_f32 v204, v124, v125
  v_exp_f32 v126, v126
  v_exp_f32 v127, v127
  s_nop 0
  v_cvt_pk_bf16_f32 v205, v126, v127
  v_exp_f32 v140, v140
  v_exp_f32 v141, v141
  s_nop 0
  v_cvt_pk_bf16_f32 v206, v140, v141
  v_exp_f32 v142, v142
  v_exp_f32 v143, v143
  s_nop 0
  v_cvt_pk_bf16_f32 v207, v142, v143
  s_nop 1
  v_mfma_f32_16x16x32_bf16 a[12:15], a[228:231], v[204:207], a[12:15]
  buffer_load_dwordx4 v1, s[28:31], s56 offen sc1 lds
  v_mfma_f32_16x16x32_bf16 a[16:19], a[232:235], v[176:179], a[16:19]
  s_nop 0
  ds_read_b128 a[248:251], v252 offset:55296
  ds_read_b128 a[252:255], v252 offset:56320
  v_mfma_f32_16x16x32_bf16 a[16:19], a[236:239], v[180:183], a[16:19]
  s_nop 0
  ds_read_b128 a[208:211], v252 offset:57344
  ds_read_b128 a[212:215], v252 offset:58368
  v_mfma_f32_16x16x32_bf16 a[20:23], a[232:235], v[184:187], a[20:23]
  buffer_load_dwordx4 v1, s[28:31], s56 offen offset:1024 sc1 lds
  v_mfma_f32_16x16x32_bf16 a[20:23], a[236:239], v[188:191], a[20:23]
  s_nop 0
  ds_read_b128 a[216:219], v252 offset:59392
  ds_read_b128 a[220:223], v252 offset:60416
  v_mfma_f32_16x16x32_bf16 a[24:27], a[232:235], v[192:195], a[24:27]
  s_nop 0
  ds_read_b128 a[224:227], v252 offset:61440
  ds_read_b128 a[228:231], v252 offset:62464
  v_mfma_f32_16x16x32_bf16 a[24:27], a[236:239], v[196:199], a[24:27]
  v_mov_b32 v32, 0xf149f2ca
  v_mov_b32 v33, 0xf149f2ca
  v_mfma_f32_16x16x32_bf16 a[28:31], a[232:235], v[200:203], a[28:31]
  ds_read_b128 a[232:235], v252 offset:63488
  v_mov_b32 v34, 0xf149f2ca
  v_mfma_f32_16x16x32_bf16 a[28:31], a[236:239], v[204:207], a[28:31]
  s_waitcnt lgkmcnt(7)
  buffer_load_dwordx4 v1, s[28:31], s56 offen offset:2048 sc1 lds
  v_mfma_f32_16x16x32_bf16 a[32:35], a[240:243], v[176:179], a[32:35]
  ds_read_b128 a[236:239], v252 offset:64512
  v_mov_b32 v35, 0xf149f2ca
  v_mfma_f32_16x16x32_bf16 a[32:35], a[244:247], v[180:183], a[32:35]
  v_exp_f32 v16, v16
  v_mfma_f32_16x16x32_bf16 a[36:39], a[240:243], v[184:187], a[36:39]
  v_exp_f32 v17, v17
  v_mfma_f32_16x16x32_bf16 a[36:39], a[244:247], v[188:191], a[36:39]
  v_exp_f32 v18, v18
  v_mfma_f32_16x16x32_bf16 a[40:43], a[240:243], v[192:195], a[40:43]
  buffer_load_dwordx4 v1, s[28:31], s56 offen offset:3072 sc1 lds
  v_mfma_f32_16x16x32_bf16 a[40:43], a[244:247], v[196:199], a[40:43]
  v_exp_f32 v19, v19
  v_mfma_f32_16x16x32_bf16 a[44:47], a[240:243], v[200:203], a[44:47]
  v_exp_f32 v20, v20
  v_mfma_f32_16x16x32_bf16 a[44:47], a[244:247], v[204:207], a[44:47]
  v_exp_f32 v21, v21
  v_mfma_f32_16x16x32_bf16 a[48:51], a[248:251], v[176:179], a[48:51]
  v_exp_f32 v22, v22
  v_mfma_f32_16x16x32_bf16 a[48:51], a[252:255], v[180:183], a[48:51]
  v_exp_f32 v23, v23
  v_mfma_f32_16x16x32_bf16 a[52:55], a[248:251], v[184:187], a[52:55]
  v_exp_f32 v24, v24
  v_mfma_f32_16x16x32_bf16 a[52:55], a[252:255], v[188:191], a[52:55]
  v_exp_f32 v25, v25
  v_mfma_f32_16x16x32_bf16 a[56:59], a[248:251], v[192:195], a[56:59]
  buffer_store_dwordx4 v[240:243], v1, s[28:31], s74 offen sc1
  v_mfma_f32_16x16x32_bf16 a[56:59], a[252:255], v[196:199], a[56:59]
  s_add_u32 s74, s74, 2048
  v_exp_f32 v26, v26
  v_mfma_f32_16x16x32_bf16 a[60:63], a[248:251], v[200:203], a[60:63]
  v_exp_f32 v27, v27
  v_mfma_f32_16x16x32_bf16 a[60:63], a[252:255], v[204:207], a[60:63]
  s_waitcnt lgkmcnt(0)
  v_exp_f32 v28, v28
  v_mfma_f32_16x16x32_bf16 a[64:67], a[208:211], v[176:179], a[64:67]
  v_exp_f32 v29, v29
  v_mfma_f32_16x16x32_bf16 a[64:67], a[212:215], v[180:183], a[64:67]
  v_exp_f32 v30, v30
  v_mfma_f32_16x16x32_bf16 a[68:71], a[208:211], v[184:187], a[68:71]
  v_exp_f32 v31, v31
  v_mfma_f32_16x16x32_bf16 a[68:71], a[212:215], v[188:191], a[68:71]
  v_exp_f32 v32, v32
  v_mfma_f32_16x16x32_bf16 a[72:75], a[208:211], v[192:195], a[72:75]
  v_exp_f32 v33, v33
  v_mfma_f32_16x16x32_bf16 a[72:75], a[212:215], v[196:199], a[72:75]
  v_exp_f32 v34, v34
  v_mfma_f32_16x16x32_bf16 a[76:79], a[208:211], v[200:203], a[76:79]
  v_exp_f32 v35, v35
  v_mfma_f32_16x16x32_bf16 a[76:79], a[212:215], v[204:207], a[76:79]
  v_exp_f32 v36, v36
  v_mfma_f32_16x16x32_bf16 a[80:83], a[216:219], v[176:179], a[80:83]
  v_exp_f32 v37, v37
  v_mfma_f32_16x16x32_bf16 a[80:83], a[220:223], v[180:183], a[80:83]
  v_exp_f32 v38, v38
  v_mfma_f32_16x16x32_bf16 a[84:87], a[216:219], v[184:187], a[84:87]
  v_exp_f32 v39, v39
  v_mfma_f32_16x16x32_bf16 a[84:87], a[220:223], v[188:191], a[84:87]
  v_exp_f32 v40, v40
  v_mfma_f32_16x16x32_bf16 a[88:91], a[216:219], v[192:195], a[88:91]
  v_exp_f32 v41, v41
  v_mfma_f32_16x16x32_bf16 a[88:91], a[220:223], v[196:199], a[88:91]
  v_exp_f32 v42, v42
  v_mfma_f32_16x16x32_bf16 a[92:95], a[216:219], v[200:203], a[92:95]
  v_exp_f32 v43, v43
  v_mfma_f32_16x16x32_bf16 a[92:95], a[220:223], v[204:207], a[92:95]
  v_exp_f32 v44, v44
  v_mfma_f32_16x16x32_bf16 a[96:99], a[224:227], v[176:179], a[96:99]
  v_exp_f32 v45, v45
  v_mfma_f32_16x16x32_bf16 a[96:99], a[228:231], v[180:183], a[96:99]
  v_exp_f32 v46, v46
  v_mfma_f32_16x16x32_bf16 a[100:103], a[224:227], v[184:187], a[100:103]
  v_exp_f32 v47, v47
  v_mfma_f32_16x16x32_bf16 a[100:103], a[228:231], v[188:191], a[100:103]
  v_mov_b32 v48, 0xf149f2ca
  v_mov_b32 v49, 0xf149f2ca
  v_mfma_f32_16x16x32_bf16 a[104:107], a[224:227], v[192:195], a[104:107]
  v_mov_b32 v50, 0xf149f2ca
  v_mov_b32 v51, 0xf149f2ca
  v_mfma_f32_16x16x32_bf16 a[104:107], a[228:231], v[196:199], a[104:107]
  v_mov_b32 v52, 0xf149f2ca
  v_mov_b32 v53, 0xf149f2ca
  v_mfma_f32_16x16x32_bf16 a[108:111], a[224:227], v[200:203], a[108:111]
  v_mov_b32 v54, 0xf149f2ca
  v_mov_b32 v55, 0xf149f2ca
  v_mfma_f32_16x16x32_bf16 a[108:111], a[228:231], v[204:207], a[108:111]
  v_mov_b32 v64, 0xf149f2ca
  v_mov_b32 v65, 0xf149f2ca
  v_mov_b32 v66, 0xf149f2ca
  v_mov_b32 v67, 0xf149f2ca
  v_mov_b32 v68, 0xf149f2ca
  v_mov_b32 v69, 0xf149f2ca
  v_mov_b32 v70, 0xf149f2ca
  v_mov_b32 v71, 0xf149f2ca
  v_mov_b32 v72, 0xf149f2ca
  v_mov_b32 v73, 0xf149f2ca
  v_mov_b32 v74, 0xf149f2ca
  v_mov_b32 v75, 0xf149f2ca
  v_cvt_pk_bf16_f32 v144, v16, v17
  v_cvt_pk_bf16_f32 v145, v18, v19
  v_cvt_pk_bf16_f32 v152, v20, v21
  v_cvt_pk_bf16_f32 v153, v22, v23
  v_cvt_pk_bf16_f32 v160, v24, v25
  v_cvt_pk_bf16_f32 v161, v26, v27
  v_cvt_pk_bf16_f32 v168, v28, v29
  v_cvt_pk_bf16_f32 v169, v30, v31
  v_cvt_pk_bf16_f32 v146, v32, v33
  v_cvt_pk_bf16_f32 v147, v34, v35
  v_cvt_pk_bf16_f32 v154, v36, v37
  v_cvt_pk_bf16_f32 v155, v38, v39
  v_cvt_pk_bf16_f32 v162, v40, v41
  v_cvt_pk_bf16_f32 v163, v42, v43
  v_cvt_pk_bf16_f32 v170, v44, v45
  v_cvt_pk_bf16_f32 v171, v46, v47
L_fin:
  s_cmp_lt_u32 s40, 2
  s_cbranch_scc0 L_fin_hi
L_fin_lo:
  s_waitcnt vmcnt(1) lgkmcnt(0)
  s_barrier
  v_mfma_f32_16x16x32_bf16 a[128:131], v[224:227], v[176:179], a[128:131]
  s_sub_u32 s92, s73, 0x800
  ds_read_b128 a[208:211], v252 offset:32768
  v_mov_b32 v249, 0
  v_mfma_f32_16x16x32_bf16 a[128:131], v[224:227], v[180:183], a[128:131]
  s_add_u32 m0, s71, 0x0
  buffer_load_dword v250, v249, s[28:31], s92 offen sc1
  v_mfma_f32_16x16x32_bf16 a[132:135], v[224:227], v[184:187], a[132:135]
  s_add_u32 s59, s69, 0x2800
  ds_read_b128 a[212:215], v252 offset:34816
  ds_read_b128 a[216:219], v252 offset:36864
  v_mfma_f32_16x16x32_bf16 a[132:135], v[224:227], v[188:191], a[132:135]
  s_cmp_eq_u32 s40, 3
  s_cselect_b32 s101, 16, 0
  buffer_load_dwordx4 v12, s[12:15], s69 offen lds
  v_mfma_f32_16x16x32_bf16 a[136:139], v[224:227], v[192:195], a[136:139]
  s_add_u32 m0, s71, 0x400
  ds_read_b128 a[220:223], v252 offset:38912
  ds_read_b128 a[224:227], v252 offset:40960
  v_mfma_f32_16x16x32_bf16 a[136:139], v[224:227], v[196:199], a[136:139]
  s_add_u32 s101, s101, 48
  ds_read_b128 a[228:231], v252 offset:43008
  ds_read_b128 a[240:243], v252 offset:45056
  v_mfma_f32_16x16x32_bf16 a[140:143], v[224:227], v[200:203], a[140:143]
  s_lshl_b32 s100, s40, 14
  ds_read_b128 a[244:247], v252 offset:47104
  ds_read_b128 a[248:251], v252 offset:33792
  v_mfma_f32_16x16x32_bf16 a[140:143], v[224:227], v[204:207], a[140:143]
  s_lshl_b32 s101, s101, 10
  buffer_load_dwordx4 v12, s[12:15], s59 offen lds
  v_mfma_f32_16x16x32_bf16 a[112:115], a[232:235], v[176:179], a[112:115]
  s_add_u32 m0, s71, 0x800
  ds_read_b128 a[252:255], v252 offset:35840
  v_and_b32 v10, 3, v0
  v_mfma_f32_16x16x32_bf16 a[112:115], a[236:239], v[180:183], a[112:115]
  s_add_u32 s59, s69, 0x80
  v_exp_f32 v56, v56
  v_mfma_f32_16x16x32_bf16 a[116:119], a[232:235], v[184:187], a[116:119]
  s_add_u32 s101, s101, s100
  v_exp_f32 v57, v57
  v_mfma_f32_16x16x32_bf16 a[116:119], a[236:239], v[188:191], a[116:119]
  s_lshl_b32 s94, s42, 1
  buffer_load_dwordx4 v12, s[12:15], s59 offen lds
  v_mfma_f32_16x16x32_bf16 a[120:123], a[232:235], v[192:195], a[120:123]
  s_add_u32 m0, s71, 0xc00
  v_exp_f32 v58, v58
  v_mfma_f32_16x16x32_bf16 a[120:123], a[236:239], v[196:199], a[120:123]
  s_add_u32 s59, s69, 0x2880
  v_exp_f32 v59, v59
  v_mfma_f32_16x16x32_bf16 a[124:127], a[232:235], v[200:203], a[124:127]
  s_sub_u32 s94, 31, s94
  ds_read_b128 a[232:235], v252 offset:37888
  v_cvt_pk_bf16_f32 v164, v56, v57
  v_mfma_f32_16x16x32_bf16 a[124:127], a[236:239], v[204:207], a[124:127]
  buffer_load_dwordx4 v12, s[12:15], s59 offen lds
  v_mfma_f32_16x16x32_bf16 a[136:139], v[224:227], v[160:163], a[136:139]
  s_add_u32 m0, s71, 0x1000
  v_exp_f32 v72, v72
  v_mfma_f32_16x16x32_bf16 a[140:143], v[224:227], v[168:171], a[140:143]
  s_waitcnt lgkmcnt(1)
  v_exp_f32 v73, v73
  v_mfma_f32_16x16x32_bf16 a[8:11], a[208:211], v[160:163], a[8:11]
  s_add_u32 s59, s69, s80
  v_exp_f32 v74, v74
  v_mfma_f32_16x16x32_bf16 a[12:15], a[208:211], v[168:171], a[12:15]
  s_add_u32 s69, s69, 81920
  buffer_load_dwordx4 v4, s[12:15], s59 offen lds
  v_mfma_f32_16x16x32_bf16 a[24:27], a[212:215], v[160:163], a[24:27]
  s_add_u32 m0, s71, 0x20000
  v_exp_f32 v75, v75
  v_mfma_f32_16x16x32_bf16 a[28:31], a[212:215], v[168:171], a[28:31]
  s_add_u32 s56, s69, 0x2800
  ds_read_b128 a[236:239], v252 offset:39936
  v_cvt_pk_bf16_f32 v165, v58, v59
  v_mfma_f32_16x16x32_bf16 a[40:43], a[216:219], v[160:163], a[40:43]
  ds_read_b128 a[208:211], v252 offset:41984
  v_cvt_pk_bf16_f32 v166, v72, v73
  v_mfma_f32_16x16x32_bf16 a[44:47], a[216:219], v[168:171], a[44:47]
  buffer_load_dwordx4 v12, s[12:15], s69 offen lds
  v_mfma_f32_16x16x32_bf16 a[56:59], a[220:223], v[160:163], a[56:59]
  s_add_u32 m0, s71, 0x20400
  ds_read_b128 a[212:215], v252 offset:44032
  v_cvt_pk_bf16_f32 v167, v74, v75
  v_mfma_f32_16x16x32_bf16 a[60:63], a[220:223], v[168:171], a[60:63]
  v_exp_f32 v60, v60
  v_mfma_f32_16x16x32_bf16 a[72:75], a[224:227], v[160:163], a[72:75]
  v_exp_f32 v61, v61
  v_mfma_f32_16x16x32_bf16 a[76:79], a[224:227], v[168:171], a[76:79]
  buffer_load_dwordx4 v12, s[12:15], s56 offen lds
  v_mfma_f32_16x16x32_bf16 a[88:91], a[228:231], v[160:163], a[88:91]
  s_add_u32 m0, s71, 0x20800
  v_exp_f32 v62, v62
  v_mfma_f32_16x16x32_bf16 a[92:95], a[228:231], v[168:171], a[92:95]
  s_add_u32 s56, s69, 0x80
  v_exp_f32 v63, v63
  v_mfma_f32_16x16x32_bf16 a[104:107], a[240:243], v[160:163], a[104:107]
  v_exp_f32 v76, v76
  v_mfma_f32_16x16x32_bf16 a[108:111], a[240:243], v[168:171], a[108:111]
  v_exp_f32 v77, v77
  v_mfma_f32_16x16x32_bf16 a[120:123], a[244:247], v[160:163], a[120:123]
  v_exp_f32 v78, v78
  v_mfma_f32_16x16x32_bf16 a[124:127], a[244:247], v[168:171], a[124:127]
  v_exp_f32 v79, v79
  v_mfma_f32_16x16x32_bf16 a[136:139], v[224:227], v[164:167], a[136:139]
  buffer_load_dwordx4 v12, s[12:15], s56 offen lds
  v_cvt_pk_bf16_f32 v172, v60, v61
  v_cvt_pk_bf16_f32 v173, v62, v63
  v_cvt_pk_bf16_f32 v174, v76, v77
  v_cvt_pk_bf16_f32 v175, v78, v79
  s_nop 1
  v_mfma_f32_16x16x32_bf16 a[140:143], v[224:227], v[172:175], a[140:143]
  s_add_u32 m0, s71, 0x20c00
  ds_read_b128 a[216:219], v252 offset:46080
  ds_read_b128 a[220:223], v252 offset:48128
  v_mfma_f32_16x16x32_bf16 a[8:11], a[248:251], v[164:167], a[8:11]
  s_add_u32 s56, s69, 0x2880
  buffer_load_dwordx4 v12, s[12:15], s56 offen lds
  v_mfma_f32_16x16x32_bf16 a[12:15], a[248:251], v[172:175], a[12:15]
  s_add_u32 m0, s71, 0x21000
  ds_read_b128 a[224:227], v252 offset:32768
  ds_read_b128 a[228:231], v252 offset:33792
  v_mfma_f32_16x16x32_bf16 a[24:27], a[252:255], v[164:167], a[24:27]
  s_add_u32 s56, s69, s80
  ds_read_b128 a[240:243], v252 offset:34816
  v_add_u32 v88, s101, v1
  v_mfma_f32_16x16x32_bf16 a[28:31], a[252:255], v[172:175], a[28:31]
  s_waitcnt lgkmcnt(5)
  buffer_load_dwordx4 v4, s[12:15], s56 offen lds
  v_mfma_f32_16x16x32_bf16 a[40:43], a[232:235], v[164:167], a[40:43]
  s_cmp_eq_u32 s40, 0
  s_cselect_b32 s101, 16, 0
  v_exp_f32 v48, v48
  v_mfma_f32_16x16x32_bf16 a[44:47], a[232:235], v[172:175], a[44:47]
  s_add_u32 s101, s101, 96
  v_exp_f32 v49, v49
  v_mfma_f32_16x16x32_bf16 a[56:59], a[236:239], v[164:167], a[56:59]
  s_lshl_b32 s101, s101, 10
  v_exp_f32 v50, v50
  v_mfma_f32_16x16x32_bf16 a[60:63], a[236:239], v[172:175], a[60:63]
  s_sub_u32 s101, s101, s100
  ds_read_b128 a[244:247], v252 offset:35840
  v_add_u32 v89, s101, v1
  v_mfma_f32_16x16x32_bf16 a[72:75], a[208:211], v[164:167], a[72:75]
  s_lshr_b32 s100, s100, 3
  v_exp_f32 v51, v51
  v_mfma_f32_16x16x32_bf16 a[76:79], a[208:211], v[172:175], a[76:79]
  s_add_u32 s101, s100, 0x5000
  ds_read_b128 a[248:251], v252 offset:36864
  v_add_u32 v90, s101, v1
  v_mfma_f32_16x16x32_bf16 a[88:91], a[212:215], v[164:167], a[88:91]
  s_sub_u32 s101, 0x6800, s100
  v_exp_f32 v64, v64
  v_mfma_f32_16x16x32_bf16 a[92:95], a[212:215], v[172:175], a[92:95]
  s_waitcnt lgkmcnt(2)
  v_exp_f32 v65, v65
  v_mfma_f32_16x16x32_bf16 a[104:107], a[216:219], v[164:167], a[104:107]
  s_add_u32 s100, s40, 1
  v_exp_f32 v66, v66
  v_mfma_f32_16x16x32_bf16 a[108:111], a[216:219], v[172:175], a[108:111]
  s_lshr_b32 s100, s100, 1
  v_exp_f32 v67, v67
  v_mfma_f32_16x16x32_bf16 a[120:123], a[220:223], v[164:167], a[120:123]
  s_and_b32 s100, s100, 1
  ds_write_b128 v90, a[136:139]
  v_mfma_f32_16x16x32_bf16 a[124:127], a[220:223], v[172:175], a[124:127]
  ds_read_b128 a[252:255], v252 offset:37888
  v_cvt_pk_bf16_f32 v148, v48, v49
  s_waitcnt vmcnt(10)
  v_readfirstlane_b32 s43, v250
  s_nop 3
  s_cmp_ge_u32 s43, 32
  s_cbranch_scc1 L_pd_Clo
  v_mov_b32 v249, 0
  s_mov_b32 s45, 0x30d40
L_poll_Clo:
  buffer_load_dword v250, v249, s[28:31], s92 offen sc1
  s_waitcnt vmcnt(0)
  v_readfirstlane_b32 s43, v250
  s_nop 3
  s_cmp_ge_u32 s43, 32
  s_cbranch_scc1 L_pd_Clo
  s_sleep 6
  s_sub_u32 s45, s45, 1
  s_cmp_lg_u32 s45, 0
  s_cbranch_scc1 L_poll_Clo
L_pd_Clo:
  v_mfma_f32_16x16x32_bf16 a[128:131], v[224:227], v[144:147], a[128:131]
  s_add_u32 s69, s69, 81920
  v_cvt_pk_bf16_f32 v149, v50, v51
  v_cvt_pk_bf16_f32 v150, v64, v65
  v_cvt_pk_bf16_f32 v151, v66, v67
  s_nop 1
  v_mfma_f32_16x16x32_bf16 a[128:131], v[224:227], v[148:151], a[128:131]
  s_add_u32 s94, s94, s100
  ds_write_b128 v90, a[140:143] offset:1024
  v_mfma_f32_16x16x32_bf16 a[132:135], v[224:227], v[152:155], a[132:135]
  v_exp_f32 v52, v52
  v_exp_f32 v53, v53
  s_nop 0
  v_cvt_pk_bf16_f32 v156, v52, v53
  v_exp_f32 v54, v54
  v_exp_f32 v55, v55
  s_nop 0
  v_cvt_pk_bf16_f32 v157, v54, v55
  v_exp_f32 v68, v68
  v_exp_f32 v69, v69
  s_nop 0
  v_cvt_pk_bf16_f32 v158, v68, v69
  v_exp_f32 v70, v70
  v_exp_f32 v71, v71
  s_nop 0
  v_cvt_pk_bf16_f32 v159, v70, v71
  s_nop 1
  v_mfma_f32_16x16x32_bf16 a[132:135], v[224:227], v[156:159], a[132:135]
  buffer_load_dwordx4 v[176:179], v1, s[28:31], s68 offen sc1
  v_mfma_f32_16x16x32_bf16 a[0:3], a[224:227], v[144:147], a[0:3]
  ds_write_b128 v88, a[8:11]
  v_mfma_f32_16x16x32_bf16 a[0:3], a[228:231], v[148:151], a[0:3]
  ds_write_b128 v88, a[12:15] offset:8192
  v_mfma_f32_16x16x32_bf16 a[4:7], a[224:227], v[152:155], a[4:7]
  buffer_load_dwordx4 v[180:183], v1, s[28:31], s68 offen offset:1024 sc1
  v_mfma_f32_16x16x32_bf16 a[4:7], a[228:231], v[156:159], a[4:7]
  ds_write_b128 v88, a[24:27] offset:1024
  v_mfma_f32_16x16x32_bf16 a[16:19], a[240:243], v[144:147], a[16:19]
  s_waitcnt lgkmcnt(3)
  ds_read_b128 a[232:235], v252 offset:38912
  ds_read_b128 a[236:239], v252 offset:39936
  v_mfma_f32_16x16x32_bf16 a[16:19], a[244:247], v[148:151], a[16:19]
  ds_write_b128 v88, a[28:31] offset:9216
  v_mfma_f32_16x16x32_bf16 a[20:23], a[240:243], v[152:155], a[20:23]
  buffer_load_dwordx4 v[184:187], v13, s[28:31], s68 offen sc1
  v_mfma_f32_16x16x32_bf16 a[20:23], a[244:247], v[156:159], a[20:23]
  ds_write_b128 v88, a[40:43] offset:2048
  v_mfma_f32_16x16x32_bf16 a[32:35], a[248:251], v[144:147], a[32:35]
  s_nop 0
  ds_read_b128 a[208:211], v252 offset:40960
  ds_read_b128 a[212:215], v252 offset:41984
  v_mfma_f32_16x16x32_bf16 a[32:35], a[252:255], v[148:151], a[32:35]
  ds_write_b128 v88, a[44:47] offset:10240
  v_mfma_f32_16x16x32_bf16 a[36:39], a[248:251], v[152:155], a[36:39]
  buffer_load_dwordx4 v[188:191], v13, s[28:31], s68 offen offset:1024 sc1
  v_mfma_f32_16x16x32_bf16 a[36:39], a[252:255], v[156:159], a[36:39]
  s_waitcnt lgkmcnt(5)
  ds_write_b128 v88, a[56:59] offset:3072
  v_mfma_f32_16x16x32_bf16 a[48:51], a[232:235], v[144:147], a[48:51]
  s_add_u32 s68, s68, 8192
  ds_read_b128 a[216:219], v252 offset:43008
  ds_read_b128 a[220:223], v252 offset:44032
  v_mfma_f32_16x16x32_bf16 a[48:51], a[236:239], v[148:151], a[48:51]
  ds_write_b128 v88, a[60:63] offset:11264
  v_mfma_f32_16x16x32_bf16 a[52:55], a[232:235], v[152:155], a[52:55]
  buffer_load_dwordx4 v[192:195], v1, s[28:31], s68 offen sc1
  v_mfma_f32_16x16x32_bf16 a[52:55], a[236:239], v[156:159], a[52:55]
  s_waitcnt lgkmcnt(5)
  ds_write_b128 v88, a[72:75] offset:4096
  v_mfma_f32_16x16x32_bf16 a[64:67], a[208:211], v[144:147], a[64:67]
  s_nop 0
  ds_read_b128 a[224:227], v252 offset:45056
  ds_read_b128 a[228:231], v252 offset:46080
  v_mfma_f32_16x16x32_bf16 a[64:67], a[212:215], v[148:151], a[64:67]
  ds_write_b128 v88, a[76:79] offset:12288
  v_mfma_f32_16x16x32_bf16 a[68:71], a[208:211], v[152:155], a[68:71]
  buffer_load_dwordx4 v[196:199], v1, s[28:31], s68 offen offset:1024 sc1
  v_mfma_f32_16x16x32_bf16 a[68:71], a[212:215], v[156:159], a[68:71]
  s_waitcnt lgkmcnt(5)
  ds_write_b128 v88, a[88:91] offset:5120
  v_mfma_f32_16x16x32_bf16 a[80:83], a[216:219], v[144:147], a[80:83]
  s_nop 0
  ds_read_b128 a[240:243], v252 offset:47104
  ds_read_b128 a[244:247], v252 offset:48128
  v_mfma_f32_16x16x32_bf16 a[80:83], a[220:223], v[148:151], a[80:83]
  ds_write_b128 v88, a[92:95] offset:13312
  v_mfma_f32_16x16x32_bf16 a[84:87], a[216:219], v[152:155], a[84:87]
  buffer_load_dwordx4 v[200:203], v13, s[28:31], s68 offen sc1
  v_mfma_f32_16x16x32_bf16 a[84:87], a[220:223], v[156:159], a[84:87]
  s_waitcnt lgkmcnt(5)
  ds_write_b128 v88, a[104:107] offset:6144
  v_mfma_f32_16x16x32_bf16 a[96:99], a[224:227], v[144:147], a[96:99]
  ds_write_b128 v88, a[108:111] offset:14336
  v_mfma_f32_16x16x32_bf16 a[96:99], a[228:231], v[148:151], a[96:99]
  buffer_load_dwordx4 v[204:207], v13, s[28:31], s68 offen offset:1024 sc1
  v_mfma_f32_16x16x32_bf16 a[100:103], a[224:227], v[152:155], a[100:103]
  s_add_u32 s68, s68, 8192
  ds_write_b128 v88, a[120:123] offset:7168
  v_mfma_f32_16x16x32_bf16 a[100:103], a[228:231], v[156:159], a[100:103]
  s_waitcnt lgkmcnt(4)
  v_bfe_u32 v8, v0, 2, 3
  v_lshlrev_b32 v10, 3, v10
  v_mfma_f32_16x16x32_bf16 a[112:115], a[240:243], v[144:147], a[112:115]
  ds_write_b128 v88, a[124:127] offset:15360
  v_mfma_f32_16x16x32_bf16 a[112:115], a[244:247], v[148:151], a[112:115]
  v_bfe_u32 v9, v0, 5, 1
  v_lshl_add_u32 v2, v8, 7, v10
  v_mfma_f32_16x16x32_bf16 a[116:119], a[240:243], v[152:155], a[116:119]
  v_lshl_add_u32 v3, v8, 6, v10
  v_lshl_add_u32 v2, v9, 10, v2
  v_mfma_f32_16x16x32_bf16 a[116:119], a[244:247], v[156:159], a[116:119]
  v_lshl_add_u32 v3, v9, 9, v3
  v_lshrrev_b32 v9, 1, v8
  v_add_u32 v91, s101, v1
  v_add_u32 v3, 0x1000, v3
  v_lshrrev_b32 v8, 2, v8
  v_xor_b32 v10, 0, v9
  v_lshl_add_u32 v208, v10, 5, v2
  v_add_u32 v214, 0x20000, v208
  v_xor_b32 v10, 1, v9
  v_lshl_add_u32 v209, v10, 5, v2
  v_add_u32 v215, 0x20000, v209
  v_xor_b32 v10, 2, v9
  v_lshl_add_u32 v210, v10, 5, v2
  v_add_u32 v216, 0x20000, v210
  v_xor_b32 v10, 3, v9
  v_lshl_add_u32 v211, v10, 5, v2
  v_add_u32 v217, 0x20000, v211
  v_xor_b32 v10, 0, v8
  v_lshl_add_u32 v212, v10, 5, v3
  v_add_u32 v218, 0x20000, v212
  v_xor_b32 v10, 1, v8
  v_lshl_add_u32 v213, v10, 5, v3
  v_add_u32 v219, 0x20000, v213
L_merge_lo:
  s_waitcnt lgkmcnt(0)
  s_barrier
  ds_read_b128 v[48:51], v91
  ds_read_b128 v[84:87], v91 offset:1024
  ds_read_b128 v[16:19], v89
  ds_read_b128 v[20:23], v89 offset:1024
  ds_read_b128 v[24:27], v89 offset:2048
  ds_read_b128 v[28:31], v89 offset:3072
  ds_read_b128 v[32:35], v89 offset:4096
  ds_read_b128 v[36:39], v89 offset:5120
  ds_read_b128 v[40:43], v89 offset:6144
  ds_read_b128 v[44:47], v89 offset:7168
  ds_read_b128 v[52:55], v89 offset:8192
  ds_read_b128 v[56:59], v89 offset:9216
  ds_read_b128 v[60:63], v89 offset:10240
  ds_read_b128 v[64:67], v89 offset:11264
  ds_read_b128 v[68:71], v89 offset:12288
  ds_read_b128 v[72:75], v89 offset:13312
  ds_read_b128 v[76:79], v89 offset:14336
  ds_read_b128 v[80:83], v89 offset:15360
  v_accvgpr_read_b32 v232, a128
  s_waitcnt lgkmcnt(15)
  v_add_f32 v232, v232, v48
  v_accvgpr_read_b32 v233, a132
  v_add_f32 v233, v233, v84
  s_waitcnt lgkmcnt(0)
  s_barrier
  v_add_f32 v228, v232, v233
  v_min_f32 v229, v232, v233
  v_mov_b32 v230, 0x4e800000
  v_mov_b32 v231, 0x30800000
  v_cmp_nlt_f32 vcc, v228, v230
  v_cmp_nge_f32 s[98:99], v229, v231
  s_nop 3
  s_or_b64 vcc, vcc, s[98:99]
  s_cbranch_vccz L_ok_mlo
  s_mov_b32 s93, 2
  s_branch L_fallback
L_ret_2:
  v_accvgpr_read_b32 v112, a128
  v_rcp_f32 v112, v112
  v_accvgpr_read_b32 v96, a0
  v_accvgpr_read_b32 v97, a1
  v_accvgpr_read_b32 v98, a2
  v_accvgpr_read_b32 v99, a3
  v_accvgpr_read_b32 v100, a16
  v_accvgpr_read_b32 v101, a17
  v_accvgpr_read_b32 v102, a18
  v_accvgpr_read_b32 v103, a19
  v_mul_f32 v96, v96, v112
  v_mul_f32 v97, v97, v112
  v_mul_f32 v98, v98, v112
  v_mul_f32 v99, v99, v112
  v_mul_f32 v100, v100, v112
  v_mul_f32 v101, v101, v112
  v_mul_f32 v102, v102, v112
  v_mul_f32 v103, v103, v112
  v_cvt_pk_bf16_f32 v96, v96, v97
  v_cvt_pk_bf16_f32 v97, v98, v99
  v_cvt_pk_bf16_f32 v98, v100, v101
  v_cvt_pk_bf16_f32 v99, v102, v103
  s_add_u32 s59, s51, 0x0
  buffer_store_dwordx4 v[96:99], v1, s[28:31], s59 offen sc1
  v_accvgpr_read_b32 v104, a32
  v_accvgpr_read_b32 v105, a33
  v_accvgpr_read_b32 v106, a34
  v_accvgpr_read_b32 v107, a35
  v_accvgpr_read_b32 v108, a48
  v_accvgpr_read_b32 v109, a49
  v_accvgpr_read_b32 v110, a50
  v_accvgpr_read_b32 v111, a51
  v_mul_f32 v104, v104, v112
  v_mul_f32 v105, v105, v112
  v_mul_f32 v106, v106, v112
  v_mul_f32 v107, v107, v112
  v_mul_f32 v108, v108, v112
  v_mul_f32 v109, v109, v112
  v_mul_f32 v110, v110, v112
  v_mul_f32 v111, v111, v112
  v_cvt_pk_bf16_f32 v104, v104, v105
  v_cvt_pk_bf16_f32 v105, v106, v107
  v_cvt_pk_bf16_f32 v106, v108, v109
  v_cvt_pk_bf16_f32 v107, v110, v111
  s_add_u32 s56, s51, 0x1000
  buffer_store_dwordx4 v[104:107], v1, s[28:31], s56 offen sc1
  v_accvgpr_read_b32 v96, a64
  v_accvgpr_read_b32 v97, a65
  v_accvgpr_read_b32 v98, a66
  v_accvgpr_read_b32 v99, a67
  v_accvgpr_read_b32 v100, a80
  v_accvgpr_read_b32 v101, a81
  v_accvgpr_read_b32 v102, a82
  v_accvgpr_read_b32 v103, a83
  v_mul_f32 v96, v96, v112
  v_mul_f32 v97, v97, v112
  v_mul_f32 v98, v98, v112
  v_mul_f32 v99, v99, v112
  v_mul_f32 v100, v100, v112
  v_mul_f32 v101, v101, v112
  v_mul_f32 v102, v102, v112
  v_mul_f32 v103, v103, v112
  v_cvt_pk_bf16_f32 v96, v96, v97
  v_cvt_pk_bf16_f32 v97, v98, v99
  v_cvt_pk_bf16_f32 v98, v100, v101
  v_cvt_pk_bf16_f32 v99, v102, v103
  s_add_u32 s57, s51, 0x2000
  buffer_store_dwordx4 v[96:99], v1, s[28:31], s57 offen sc1
  v_accvgpr_read_b32 v104, a96
  v_accvgpr_read_b32 v105, a97
  v_accvgpr_read_b32 v106, a98
  v_accvgpr_read_b32 v107, a99
  v_accvgpr_read_b32 v108, a112
  v_accvgpr_read_b32 v109, a113
  v_accvgpr_read_b32 v110, a114
  v_accvgpr_read_b32 v111, a115
  v_mul_f32 v104, v104, v112
  v_mul_f32 v105, v105, v112
  v_mul_f32 v106, v106, v112
  v_mul_f32 v107, v107, v112
  v_mul_f32 v108, v108, v112
  v_mul_f32 v109, v109, v112
  v_mul_f32 v110, v110, v112
  v_mul_f32 v111, v111, v112
  v_cvt_pk_bf16_f32 v104, v104, v105
  v_cvt_pk_bf16_f32 v105, v106, v107
  v_cvt_pk_bf16_f32 v106, v108, v109
  v_cvt_pk_bf16_f32 v107, v110, v111
  s_add_u32 s58, s51, 0x3000
  buffer_store_dwordx4 v[104:107], v1, s[28:31], s58 offen sc1
  v_accvgpr_read_b32 v113, a132
  v_rcp_f32 v113, v113
  v_accvgpr_read_b32 v96, a4
  v_accvgpr_read_b32 v97, a5
  v_accvgpr_read_b32 v98, a6
  v_accvgpr_read_b32 v99, a7
  v_accvgpr_read_b32 v100, a20
  v_accvgpr_read_b32 v101, a21
  v_accvgpr_read_b32 v102, a22
  v_accvgpr_read_b32 v103, a23
  v_mul_f32 v96, v96, v113
  v_mul_f32 v97, v97, v113
  v_mul_f32 v98, v98, v113
  v_mul_f32 v99, v99, v113
  v_mul_f32 v100, v100, v113
  v_mul_f32 v101, v101, v113
  v_mul_f32 v102, v102, v113
  v_mul_f32 v103, v103, v113
  v_cvt_pk_bf16_f32 v96, v96, v97
  v_cvt_pk_bf16_f32 v97, v98, v99
  v_cvt_pk_bf16_f32 v98, v100, v101
  v_cvt_pk_bf16_f32 v99, v102, v103
  s_add_u32 s59, s51, 0x0
  buffer_store_dwordx4 v[96:99], v1, s[28:31], s59 offen offset:1024 sc1
  v_accvgpr_read_b32 v104, a36
  v_accvgpr_read_b32 v105, a37
  v_accvgpr_read_b32 v106, a38
  v_accvgpr_read_b32 v107, a39
  v_accvgpr_read_b32 v108, a52
  v_accvgpr_read_b32 v109, a53
  v_accvgpr_read_b32 v110, a54
  v_accvgpr_read_b32 v111, a55
  v_mul_f32 v104, v104, v113
  v_mul_f32 v105, v105, v113
  v_mul_f32 v106, v106, v113
  v_mul_f32 v107, v107, v113
  v_mul_f32 v108, v108, v113
  v_mul_f32 v109, v109, v113
  v_mul_f32 v110, v110, v113
  v_mul_f32 v111, v111, v113
  v_cvt_pk_bf16_f32 v104, v104, v105
  v_cvt_pk_bf16_f32 v105, v106, v107
  v_cvt_pk_bf16_f32 v106, v108, v109
  v_cvt_pk_bf16_f32 v107, v110, v111
  s_add_u32 s56, s51, 0x1000
  buffer_store_dwordx4 v[104:107], v1, s[28:31], s56 offen offset:1024 sc1
  v_accvgpr_read_b32 v96, a68
  v_accvgpr_read_b32 v97, a69
  v_accvgpr_read_b32 v98, a70
  v_accvgpr_read_b32 v99, a71
  v_accvgpr_read_b32 v100, a84
  v_accvgpr_read_b32 v101, a85
  v_accvgpr_read_b32 v102, a86
  v_accvgpr_read_b32 v103, a87
  v_mul_f32 v96, v96, v113
  v_mul_f32 v97, v97, v113
  v_mul_f32 v98, v98, v113
  v_mul_f32 v99, v99, v113
  v_mul_f32 v100, v100, v113
  v_mul_f32 v101, v101, v113
  v_mul_f32 v102, v102, v113
  v_mul_f32 v103, v103, v113
  v_cvt_pk_bf16_f32 v96, v96, v97
  v_cvt_pk_bf16_f32 v97, v98, v99
  v_cvt_pk_bf16_f32 v98, v100, v101
  v_cvt_pk_bf16_f32 v99, v102, v103
  s_add_u32 s57, s51, 0x2000
  buffer_store_dwordx4 v[96:99], v1, s[28:31], s57 offen offset:1024 sc1
  v_accvgpr_read_b32 v104, a100
  v_accvgpr_read_b32 v105, a101
  v_accvgpr_read_b32 v106, a102
  v_accvgpr_read_b32 v107, a103
  v_accvgpr_read_b32 v108, a116
  v_accvgpr_read_b32 v109, a117
  v_accvgpr_read_b32 v110, a118
  v_accvgpr_read_b32 v111, a119
  v_mul_f32 v104, v104, v113
  v_mul_f32 v105, v105, v113
  v_mul_f32 v106, v106, v113
  v_mul_f32 v107, v107, v113
  v_mul_f32 v108, v108, v113
  v_mul_f32 v109, v109, v113
  v_mul_f32 v110, v110, v113
  v_mul_f32 v111, v111, v113
  v_cvt_pk_bf16_f32 v104, v104, v105
  v_cvt_pk_bf16_f32 v105, v106, v107
  v_cvt_pk_bf16_f32 v106, v108, v109
  v_cvt_pk_bf16_f32 v107, v110, v111
  s_add_u32 s58, s51, 0x3000
  buffer_store_dwordx4 v[104:107], v1, s[28:31], s58 offen offset:1024 sc1
  s_add_u32 m0, s71, 0x5000
  s_nop 0
  buffer_load_dwordx4 v12, s[12:15], s69 offen lds
  s_add_u32 m0, s71, 0x5400
  s_add_u32 s59, s69, 0x2800
  buffer_load_dwordx4 v12, s[12:15], s59 offen lds
  s_add_u32 m0, s71, 0x5800
  s_add_u32 s59, s69, 0x80
  buffer_load_dwordx4 v12, s[12:15], s59 offen lds
  s_add_u32 m0, s71, 0x5c00
  s_add_u32 s59, s69, 0x2880
  buffer_load_dwordx4 v12, s[12:15], s59 offen lds
  s_add_u32 m0, s71, 0x6000
  s_add_u32 s59, s69, s80
  buffer_load_dwordx4 v4, s[12:15], s59 offen lds
  s_add_u32 s69, s69, 81920
  buffer_load_dwordx4 a[160:163], v1, s[28:31], s68 offen sc1
  buffer_load_dwordx4 a[164:167], v1, s[28:31], s68 offen offset:1024 sc1
  buffer_load_dwordx4 a[168:171], v13, s[28:31], s68 offen sc1
  buffer_load_dwordx4 a[172:175], v13, s[28:31], s68 offen offset:1024 sc1
  s_add_u32 s68, s68, 8192
  s_add_u32 m0, s71, 0xa000
  s_nop 0
  buffer_load_dwordx4 v12, s[12:15], s69 offen lds
  s_add_u32 m0, s71, 0xa400
  s_add_u32 s56, s69, 0x2800
  buffer_load_dwordx4 v12, s[12:15], s56 offen lds
  s_add_u32 m0, s71, 0xa800
  s_add_u32 s56, s69, 0x80
  buffer_load_dwordx4 v12, s[12:15], s56 offen lds
  s_add_u32 m0, s71, 0xac00
  s_add_u32 s56, s69, 0x2880
  buffer_load_dwordx4 v12, s[12:15], s56 offen lds
  s_add_u32 m0, s71, 0xb000
  s_add_u32 s56, s69, s80
  buffer_load_dwordx4 v4, s[12:15], s56 offen lds
  s_add_u32 s69, s69, 81920
  s_branch L_k3
L_ok_mlo:
  v_rcp_f32 v234, v232
  v_rcp_f32 v236, v233
  v_mov_b32 v235, v234
  v_mov_b32 v237, v236
  v_accvgpr_read_b32 v96, a0
  v_accvgpr_read_b32 v97, a1
  v_accvgpr_read_b32 v98, a2
  v_accvgpr_read_b32 v99, a3
  v_accvgpr_read_b32 v100, a16
  v_accvgpr_read_b32 v101, a17
  v_accvgpr_read_b32 v102, a18
  v_accvgpr_read_b32 v103, a19
  v_pk_add_f32 v[96:97], v[96:97], v[16:17]
  v_pk_add_f32 v[98:99], v[98:99], v[18:19]
  v_pk_add_f32 v[100:101], v[100:101], v[20:21]
  v_pk_add_f32 v[102:103], v[102:103], v[22:23]
  v_pk_mul_f32 v[96:97], v[96:97], v[234:235]
  v_pk_mul_f32 v[98:99], v[98:99], v[234:235]
  v_pk_mul_f32 v[100:101], v[100:101], v[234:235]
  v_pk_mul_f32 v[102:103], v[102:103], v[234:235]
  v_cvt_pk_bf16_f32 v96, v96, v97
  v_cvt_pk_bf16_f32 v97, v98, v99
  v_cvt_pk_bf16_f32 v98, v100, v101
  v_cvt_pk_bf16_f32 v99, v102, v103
  s_add_u32 s44, s51, 0x0
  buffer_store_dwordx4 v[96:99], v1, s[28:31], s44 offen sc1
  s_add_u32 m0, s71, 0x5000
  s_nop 0
  buffer_load_dwordx4 v12, s[12:15], s69 offen lds
  s_add_u32 m0, s71, 0x5400
  s_add_u32 s57, s69, 0x2800
  buffer_load_dwordx4 v12, s[12:15], s57 offen lds
  v_accvgpr_read_b32 v104, a32
  v_accvgpr_read_b32 v105, a33
  v_accvgpr_read_b32 v106, a34
  v_accvgpr_read_b32 v107, a35
  v_accvgpr_read_b32 v108, a48
  v_accvgpr_read_b32 v109, a49
  v_accvgpr_read_b32 v110, a50
  v_accvgpr_read_b32 v111, a51
  v_pk_add_f32 v[104:105], v[104:105], v[24:25]
  v_pk_add_f32 v[106:107], v[106:107], v[26:27]
  v_pk_add_f32 v[108:109], v[108:109], v[28:29]
  v_pk_add_f32 v[110:111], v[110:111], v[30:31]
  v_pk_mul_f32 v[104:105], v[104:105], v[234:235]
  v_pk_mul_f32 v[106:107], v[106:107], v[234:235]
  v_pk_mul_f32 v[108:109], v[108:109], v[234:235]
  v_pk_mul_f32 v[110:111], v[110:111], v[234:235]
  v_cvt_pk_bf16_f32 v104, v104, v105
  v_cvt_pk_bf16_f32 v105, v106, v107
  v_cvt_pk_bf16_f32 v106, v108, v109
  v_cvt_pk_bf16_f32 v107, v110, v111
  s_add_u32 s44, s51, 0x1000
  buffer_store_dwordx4 v[104:107], v1, s[28:31], s44 offen sc1
  s_add_u32 m0, s71, 0x5800
  s_add_u32 s57, s69, 0x80
  buffer_load_dwordx4 v12, s[12:15], s57 offen lds
  s_add_u32 m0, s71, 0x5c00
  s_add_u32 s57, s69, 0x2880
  buffer_load_dwordx4 v12, s[12:15], s57 offen lds
  v_accvgpr_read_b32 v96, a64
  v_accvgpr_read_b32 v97, a65
  v_accvgpr_read_b32 v98, a66
  v_accvgpr_read_b32 v99, a67
  v_accvgpr_read_b32 v100, a80
  v_accvgpr_read_b32 v101, a81
  v_accvgpr_read_b32 v102, a82
  v_accvgpr_read_b32 v103, a83
  v_pk_add_f32 v[96:97], v[96:97], v[32:33]
  v_pk_add_f32 v[98:99], v[98:99], v[34:35]
  v_pk_add_f32 v[100:101], v[100:101], v[36:37]
  v_pk_add_f32 v[102:103], v[102:103], v[38:39]
  v_pk_mul_f32 v[96:97], v[96:97], v[234:235]
  v_pk_mul_f32 v[98:99], v[98:99], v[234:235]
  v_pk_mul_f32 v[100:101], v[100:101], v[234:235]
  v_pk_mul_f32 v[102:103], v[102:103], v[234:235]
  v_cvt_pk_bf16_f32 v96, v96, v97
  v_cvt_pk_bf16_f32 v97, v98, v99
  v_cvt_pk_bf16_f32 v98, v100, v101
  v_cvt_pk_bf16_f32 v99, v102, v103
  s_add_u32 s44, s51, 0x2000
  buffer_store_dwordx4 v[96:99], v1, s[28:31], s44 offen sc1
  s_add_u32 m0, s71, 0x6000
  s_add_u32 s57, s69, s80
  buffer_load_dwordx4 v4, s[12:15], s57 offen lds
  s_add_u32 s69, s69, 81920
  buffer_load_dwordx4 a[160:163], v1, s[28:31], s68 offen sc1
  v_accvgpr_read_b32 v104, a96
  v_accvgpr_read_b32 v105, a97
  v_accvgpr_read_b32 v106, a98
  v_accvgpr_read_b32 v107, a99
  v_accvgpr_read_b32 v108, a112
  v_accvgpr_read_b32 v109, a113
  v_accvgpr_read_b32 v110, a114
  v_accvgpr_read_b32 v111, a115
  v_pk_add_f32 v[104:105], v[104:105], v[40:41]
  v_pk_add_f32 v[106:107], v[106:107], v[42:43]
  v_pk_add_f32 v[108:109], v[108:109], v[44:45]
  v_pk_add_f32 v[110:111], v[110:111], v[46:47]
  v_pk_mul_f32 v[104:105], v[104:105], v[234:235]
  v_pk_mul_f32 v[106:107], v[106:107], v[234:235]
  v_pk_mul_f32 v[108:109], v[108:109], v[234:235]
  v_pk_mul_f32 v[110:111], v[110:111], v[234:235]
  v_cvt_pk_bf16_f32 v104, v104, v105
  v_cvt_pk_bf16_f32 v105, v106, v107
  v_cvt_pk_bf16_f32 v106, v108, v109
  v_cvt_pk_bf16_f32 v107, v110, v111
  s_add_u32 s44, s51, 0x3000
  buffer_store_dwordx4 v[104:107], v1, s[28:31], s44 offen sc1
  buffer_load_dwordx4 a[164:167], v1, s[28:31], s68 offen offset:1024 sc1
  buffer_load_dwordx4 a[168:171], v13, s[28:31], s68 offen sc1
  v_accvgpr_read_b32 v96, a4
  v_accvgpr_read_b32 v97, a5
  v_accvgpr_read_b32 v98, a6
  v_accvgpr_read_b32 v99, a7
  v_accvgpr_read_b32 v100, a20
  v_accvgpr_read_b32 v101, a21
  v_accvgpr_read_b32 v102, a22
  v_accvgpr_read_b32 v103, a23
  v_pk_add_f32 v[96:97], v[96:97], v[52:53]
  v_pk_add_f32 v[98:99], v[98:99], v[54:55]
  v_pk_add_f32 v[100:101], v[100:101], v[56:57]
  v_pk_add_f32 v[102:103], v[102:103], v[58:59]
  v_pk_mul_f32 v[96:97], v[96:97], v[236:237]
  v_pk_mul_f32 v[98:99], v[98:99], v[236:237]
  v_pk_mul_f32 v[100:101], v[100:101], v[236:237]
  v_pk_mul_f32 v[102:103], v[102:103], v[236:237]
  v_cvt_pk_bf16_f32 v96, v96, v97
  v_cvt_pk_bf16_f32 v97, v98, v99
  v_cvt_pk_bf16_f32 v98, v100, v101
  v_cvt_pk_bf16_f32 v99, v102, v103
  s_add_u32 s44, s51, 0x0
  buffer_store_dwordx4 v[96:99], v1, s[28:31], s44 offen offset:1024 sc1
  buffer_load_dwordx4 a[172:175], v13, s[28:31], s68 offen offset:1024 sc1
  s_add_u32 s68, s68, 8192
  s_add_u32 m0, s71, 0xa000
  s_nop 0
  buffer_load_dwordx4 v12, s[12:15], s69 offen lds
  v_accvgpr_read_b32 v104, a36
  v_accvgpr_read_b32 v105, a37
  v_accvgpr_read_b32 v106, a38
  v_accvgpr_read_b32 v107, a39
  v_accvgpr_read_b32 v108, a52
  v_accvgpr_read_b32 v109, a53
  v_accvgpr_read_b32 v110, a54
  v_accvgpr_read_b32 v111, a55
  v_pk_add_f32 v[104:105], v[104:105], v[60:61]
  v_pk_add_f32 v[106:107], v[106:107], v[62:63]
  v_pk_add_f32 v[108:109], v[108:109], v[64:65]
  v_pk_add_f32 v[110:111], v[110:111], v[66:67]
  v_pk_mul_f32 v[104:105], v[104:105], v[236:237]
  v_pk_mul_f32 v[106:107], v[106:107], v[236:237]
  v_pk_mul_f32 v[108:109], v[108:109], v[236:237]
  v_pk_mul_f32 v[110:111], v[110:111], v[236:237]
  v_cvt_pk_bf16_f32 v104, v104, v105
  v_cvt_pk_bf16_f32 v105, v106, v107
  v_cvt_pk_bf16_f32 v106, v108, v109
  v_cvt_pk_bf16_f32 v107, v110, v111
  s_add_u32 s44, s51, 0x1000
  buffer_store_dwordx4 v[104:107], v1, s[28:31], s44 offen offset:1024 sc1
  s_add_u32 m0, s71, 0xa400
  s_add_u32 s58, s69, 0x2800
  buffer_load_dwordx4 v12, s[12:15], s58 offen lds
  s_add_u32 m0, s71, 0xa800
  s_add_u32 s58, s69, 0x80
  buffer_load_dwordx4 v12, s[12:15], s58 offen lds
  v_accvgpr_read_b32 v96, a68
  v_accvgpr_read_b32 v97, a69
  v_accvgpr_read_b32 v98, a70
  v_accvgpr_read_b32 v99, a71
  v_accvgpr_read_b32 v100, a84
  v_accvgpr_read_b32 v101, a85
  v_accvgpr_read_b32 v102, a86
  v_accvgpr_read_b32 v103, a87
  v_pk_add_f32 v[96:97], v[96:97], v[68:69]
  v_pk_add_f32 v[98:99], v[98:99], v[70:71]
  v_pk_add_f32 v[100:101], v[100:101], v[72:73]
  v_pk_add_f32 v[102:103], v[102:103], v[74:75]
  v_pk_mul_f32 v[96:97], v[96:97], v[236:237]
  v_pk_mul_f32 v[98:99], v[98:99], v[236:237]
  v_pk_mul_f32 v[100:101], v[100:101], v[236:237]
  v_pk_mul_f32 v[102:103], v[102:103], v[236:237]
  v_cvt_pk_bf16_f32 v96, v96, v97
  v_cvt_pk_bf16_f32 v97, v98, v99
  v_cvt_pk_bf16_f32 v98, v100, v101
  v_cvt_pk_bf16_f32 v99, v102, v103
  s_add_u32 s44, s51, 0x2000
  buffer_store_dwordx4 v[96:99], v1, s[28:31], s44 offen offset:1024 sc1
  s_add_u32 m0, s71, 0xac00
  s_add_u32 s58, s69, 0x2880
  buffer_load_dwordx4 v12, s[12:15], s58 offen lds
  s_add_u32 m0, s71, 0xb000
  s_add_u32 s58, s69, s80
  buffer_load_dwordx4 v4, s[12:15], s58 offen lds
  s_add_u32 s69, s69, 81920
  v_accvgpr_read_b32 v104, a100
  v_accvgpr_read_b32 v105, a101
  v_accvgpr_read_b32 v106, a102
  v_accvgpr_read_b32 v107, a103
  v_accvgpr_read_b32 v108, a116
  v_accvgpr_read_b32 v109, a117
  v_accvgpr_read_b32 v110, a118
  v_accvgpr_read_b32 v111, a119
  v_pk_add_f32 v[104:105], v[104:105], v[76:77]
  v_pk_add_f32 v[106:107], v[106:107], v[78:79]
  v_pk_add_f32 v[108:109], v[108:109], v[80:81]
  v_pk_add_f32 v[110:111], v[110:111], v[82:83]
  v_pk_mul_f32 v[104:105], v[104:105], v[236:237]
  v_pk_mul_f32 v[106:107], v[106:107], v[236:237]
  v_pk_mul_f32 v[108:109], v[108:109], v[236:237]
  v_pk_mul_f32 v[110:111], v[110:111], v[236:237]
  v_cvt_pk_bf16_f32 v104, v104, v105
  v_cvt_pk_bf16_f32 v105, v106, v107
  v_cvt_pk_bf16_f32 v106, v108, v109
  v_cvt_pk_bf16_f32 v107, v110, v111
  s_add_u32 s44, s51, 0x3000
  buffer_store_dwordx4 v[104:107], v1, s[28:31], s44 offen offset:1024 sc1
  s_branch L_k3
L_fin_hi:
  s_waitcnt vmcnt(1) lgkmcnt(0)
  s_barrier
  v_mfma_f32_16x16x32_bf16 a[128:131], v[224:227], v[176:179], a[128:131]
  s_sub_u32 s92, s73, 0x800
  ds_read_b128 a[208:211], v252 offset:32768
  v_mov_b32 v249, 0
  v_mfma_f32_16x16x32_bf16 a[128:131], v[224:227], v[180:183], a[128:131]
  s_add_u32 m0, s71, 0x0
  buffer_load_dword v250, v249, s[28:31], s92 offen sc1
  v_mfma_f32_16x16x32_bf16 a[132:135], v[224:227], v[184:187], a[132:135]
  s_add_u32 s57, s69, 0x2800
  ds_read_b128 a[212:215], v252 offset:34816
  ds_read_b128 a[216:219], v252 offset:36864
  v_mfma_f32_16x16x32_bf16 a[132:135], v[224:227], v[188:191], a[132:135]
  s_cmp_eq_u32 s40, 3
  s_cselect_b32 s101, 16, 0
  buffer_load_dwordx4 v12, s[12:15], s69 offen lds
  v_mfma_f32_16x16x32_bf16 a[136:139], v[224:227], v[192:195], a[136:139]
  s_add_u32 m0, s71, 0x400
  ds_read_b128 a[220:223], v252 offset:38912
  ds_read_b128 a[224:227], v252 offset:40960
  v_mfma_f32_16x16x32_bf16 a[136:139], v[224:227], v[196:199], a[136:139]
  s_add_u32 s101, s101, 48
  ds_read_b128 a[228:231], v252 offset:43008
  ds_read_b128 a[240:243], v252 offset:45056
  v_mfma_f32_16x16x32_bf16 a[140:143], v[224:227], v[200:203], a[140:143]
  s_lshl_b32 s100, s40, 14
  ds_read_b128 a[244:247], v252 offset:47104
  ds_read_b128 a[248:251], v252 offset:33792
  v_mfma_f32_16x16x32_bf16 a[140:143], v[224:227], v[204:207], a[140:143]
  s_lshl_b32 s101, s101, 10
  buffer_load_dwordx4 v12, s[12:15], s57 offen lds
  v_mfma_f32_16x16x32_bf16 a[112:115], a[232:235], v[176:179], a[112:115]
  s_add_u32 m0, s71, 0x800
  ds_read_b128 a[252:255], v252 offset:35840
  v_and_b32 v10, 3, v0
  v_mfma_f32_16x16x32_bf16 a[112:115], a[236:239], v[180:183], a[112:115]
  s_add_u32 s57, s69, 0x80
  v_exp_f32 v48, v48
  v_mfma_f32_16x16x32_bf16 a[116:119], a[232:235], v[184:187], a[116:119]
  s_add_u32 s101, s101, s100
  v_exp_f32 v49, v49
  v_mfma_f32_16x16x32_bf16 a[116:119], a[236:239], v[188:191], a[116:119]
  s_lshl_b32 s94, s42, 1
  buffer_load_dwordx4 v12, s[12:15], s57 offen lds
  v_mfma_f32_16x16x32_bf16 a[120:123], a[232:235], v[192:195], a[120:123]
  s_add_u32 m0, s71, 0xc00
  v_exp_f32 v50, v50
  v_mfma_f32_16x16x32_bf16 a[120:123], a[236:239], v[196:199], a[120:123]
  s_add_u32 s57, s69, 0x2880
  v_exp_f32 v51, v51
  v_mfma_f32_16x16x32_bf16 a[124:127], a[232:235], v[200:203], a[124:127]
  s_sub_u32 s94, 31, s94
  ds_read_b128 a[232:235], v252 offset:37888
  v_cvt_pk_bf16_f32 v148, v48, v49
  v_mfma_f32_16x16x32_bf16 a[124:127], a[236:239], v[204:207], a[124:127]
  buffer_load_dwordx4 v12, s[12:15], s57 offen lds
  v_mfma_f32_16x16x32_bf16 a[128:131], v[224:227], v[144:147], a[128:131]
  s_add_u32 m0, s71, 0x1000
  v_exp_f32 v64, v64
  v_mfma_f32_16x16x32_bf16 a[132:135], v[224:227], v[152:155], a[132:135]
  s_waitcnt lgkmcnt(1)
  v_exp_f32 v65, v65
  v_mfma_f32_16x16x32_bf16 a[0:3], a[208:211], v[144:147], a[0:3]
  s_add_u32 s57, s69, s80
  v_exp_f32 v66, v66
  v_mfma_f32_16x16x32_bf16 a[4:7], a[208:211], v[152:155], a[4:7]
  s_add_u32 s69, s69, 81920
  buffer_load_dwordx4 v4, s[12:15], s57 offen lds
  v_mfma_f32_16x16x32_bf16 a[16:19], a[212:215], v[144:147], a[16:19]
  s_add_u32 m0, s71, 0x20000
  v_exp_f32 v67, v67
  v_mfma_f32_16x16x32_bf16 a[20:23], a[212:215], v[152:155], a[20:23]
  s_add_u32 s58, s69, 0x2800
  ds_read_b128 a[236:239], v252 offset:39936
  v_cvt_pk_bf16_f32 v149, v50, v51
  v_mfma_f32_16x16x32_bf16 a[32:35], a[216:219], v[144:147], a[32:35]
  ds_read_b128 a[208:211], v252 offset:41984
  v_cvt_pk_bf16_f32 v150, v64, v65
  v_mfma_f32_16x16x32_bf16 a[36:39], a[216:219], v[152:155], a[36:39]
  buffer_load_dwordx4 v12, s[12:15], s69 offen lds
  v_mfma_f32_16x16x32_bf16 a[48:51], a[220:223], v[144:147], a[48:51]
  s_add_u32 m0, s71, 0x20400
  ds_read_b128 a[212:215], v252 offset:44032
  v_cvt_pk_bf16_f32 v151, v66, v67
  v_mfma_f32_16x16x32_bf16 a[52:55], a[220:223], v[152:155], a[52:55]
  v_exp_f32 v52, v52
  v_mfma_f32_16x16x32_bf16 a[64:67], a[224:227], v[144:147], a[64:67]
  v_exp_f32 v53, v53
  v_mfma_f32_16x16x32_bf16 a[68:71], a[224:227], v[152:155], a[68:71]
  buffer_load_dwordx4 v12, s[12:15], s58 offen lds
  v_mfma_f32_16x16x32_bf16 a[80:83], a[228:231], v[144:147], a[80:83]
  s_add_u32 m0, s71, 0x20800
  v_exp_f32 v54, v54
  v_mfma_f32_16x16x32_bf16 a[84:87], a[228:231], v[152:155], a[84:87]
  s_add_u32 s58, s69, 0x80
  v_exp_f32 v55, v55
  v_mfma_f32_16x16x32_bf16 a[96:99], a[240:243], v[144:147], a[96:99]
  v_exp_f32 v68, v68
  v_mfma_f32_16x16x32_bf16 a[100:103], a[240:243], v[152:155], a[100:103]
  v_exp_f32 v69, v69
  v_mfma_f32_16x16x32_bf16 a[112:115], a[244:247], v[144:147], a[112:115]
  v_exp_f32 v70, v70
  v_mfma_f32_16x16x32_bf16 a[116:119], a[244:247], v[152:155], a[116:119]
  v_exp_f32 v71, v71
  v_mfma_f32_16x16x32_bf16 a[128:131], v[224:227], v[148:151], a[128:131]
  buffer_load_dwordx4 v12, s[12:15], s58 offen lds
  v_cvt_pk_bf16_f32 v156, v52, v53
  v_cvt_pk_bf16_f32 v157, v54, v55
  v_cvt_pk_bf16_f32 v158, v68, v69
  v_cvt_pk_bf16_f32 v159, v70, v71
  s_nop 1
  v_mfma_f32_16x16x32_bf16 a[132:135], v[224:227], v[156:159], a[132:135]
  s_add_u32 m0, s71, 0x20c00
  ds_read_b128 a[216:219], v252 offset:46080
  ds_read_b128 a[220:223], v252 offset:48128
  v_mfma_f32_16x16x32_bf16 a[0:3], a[248:251], v[148:151], a[0:3]
  s_add_u32 s58, s69, 0x2880
  buffer_load_dwordx4 v12, s[12:15], s58 offen lds
  v_mfma_f32_16x16x32_bf16 a[4:7], a[248:251], v[156:159], a[4:7]
  s_add_u32 m0, s71, 0x21000
  ds_read_b128 a[224:227], v252 offset:32768
  ds_read_b128 a[228:231], v252 offset:33792
  v_mfma_f32_16x16x32_bf16 a[16:19], a[252:255], v[148:151], a[16:19]
  s_add_u32 s58, s69, s80
  ds_read_b128 a[240:243], v252 offset:34816
  v_add_u32 v88, s101, v1
  v_mfma_f32_16x16x32_bf16 a[20:23], a[252:255], v[156:159], a[20:23]
  s_waitcnt lgkmcnt(5)
  buffer_load_dwordx4 v4, s[12:15], s58 offen lds
  v_mfma_f32_16x16x32_bf16 a[32:35], a[232:235], v[148:151], a[32:35]
  s_cmp_eq_u32 s40, 0
  s_cselect_b32 s101, 16, 0
  v_exp_f32 v56, v56
  v_mfma_f32_16x16x32_bf16 a[36:39], a[232:235], v[156:159], a[36:39]
  s_add_u32 s101, s101, 96
  v_exp_f32 v57, v57
  v_mfma_f32_16x16x32_bf16 a[48:51], a[236:239], v[148:151], a[48:51]
  s_lshl_b32 s101, s101, 10
  v_exp_f32 v58, v58
  v_mfma_f32_16x16x32_bf16 a[52:55], a[236:239], v[156:159], a[52:55]
  s_sub_u32 s101, s101, s100
  ds_read_b128 a[244:247], v252 offset:35840
  v_add_u32 v89, s101, v1
  v_mfma_f32_16x16x32_bf16 a[64:67], a[208:211], v[148:151], a[64:67]
  s_lshr_b32 s100, s100, 3
  v_exp_f32 v59, v59
  v_mfma_f32_16x16x32_bf16 a[68:71], a[208:211], v[156:159], a[68:71]
  s_add_u32 s101, s100, 0x5000
  ds_read_b128 a[248:251], v252 offset:36864
  v_add_u32 v90, s101, v1
  v_mfma_f32_16x16x32_bf16 a[80:83], a[212:215], v[148:151], a[80:83]
  s_sub_u32 s101, 0x6800, s100
  v_exp_f32 v72, v72
  v_mfma_f32_16x16x32_bf16 a[84:87], a[212:215], v[156:159], a[84:87]
  s_waitcnt lgkmcnt(2)
  v_exp_f32 v73, v73
  v_mfma_f32_16x16x32_bf16 a[96:99], a[216:219], v[148:151], a[96:99]
  s_add_u32 s100, s40, 1
  v_exp_f32 v74, v74
  v_mfma_f32_16x16x32_bf16 a[100:103], a[216:219], v[156:159], a[100:103]
  s_lshr_b32 s100, s100, 1
  v_exp_f32 v75, v75
  v_mfma_f32_16x16x32_bf16 a[112:115], a[220:223], v[148:151], a[112:115]
  s_and_b32 s100, s100, 1
  ds_write_b128 v90, a[128:131]
  v_mfma_f32_16x16x32_bf16 a[116:119], a[220:223], v[156:159], a[116:119]
  ds_read_b128 a[252:255], v252 offset:37888
  v_cvt_pk_bf16_f32 v164, v56, v57
  s_waitcnt vmcnt(10)
  v_readfirstlane_b32 s43, v250
  s_nop 3
  s_cmp_ge_u32 s43, 32
  s_cbranch_scc1 L_pd_Chi
  v_mov_b32 v249, 0
  s_mov_b32 s45, 0x30d40
L_poll_Chi:
  buffer_load_dword v250, v249, s[28:31], s92 offen sc1
  s_waitcnt vmcnt(0)
  v_readfirstlane_b32 s43, v250
  s_nop 3
  s_cmp_ge_u32 s43, 32
  s_cbranch_scc1 L_pd_Chi
  s_sleep 6
  s_sub_u32 s45, s45, 1
  s_cmp_lg_u32 s45, 0
  s_cbranch_scc1 L_poll_Chi
L_pd_Chi:
  v_mfma_f32_16x16x32_bf16 a[136:139], v[224:227], v[160:163], a[136:139]
  s_add_u32 s69, s69, 81920
  v_cvt_pk_bf16_f32 v165, v58, v59
  v_cvt_pk_bf16_f32 v166, v72, v73
  v_cvt_pk_bf16_f32 v167, v74, v75
  s_nop 1
  v_mfma_f32_16x16x32_bf16 a[136:139], v[224:227], v[164:167], a[136:139]
  s_add_u32 s94, s94, s100
  ds_write_b128 v90, a[132:135] offset:1024
  v_mfma_f32_16x16x32_bf16 a[140:143], v[224:227], v[168:171], a[140:143]
  v_exp_f32 v60, v60
  v_exp_f32 v61, v61
  s_nop 0
  v_cvt_pk_bf16_f32 v172, v60, v61
  v_exp_f32 v62, v62
  v_exp_f32 v63, v63
  s_nop 0
  v_cvt_pk_bf16_f32 v173, v62, v63
  v_exp_f32 v76, v76
  v_exp_f32 v77, v77
  s_nop 0
  v_cvt_pk_bf16_f32 v174, v76, v77
  v_exp_f32 v78, v78
  v_exp_f32 v79, v79
  s_nop 0
  v_cvt_pk_bf16_f32 v175, v78, v79
  s_nop 1
  v_mfma_f32_16x16x32_bf16 a[140:143], v[224:227], v[172:175], a[140:143]
  buffer_load_dwordx4 v[176:179], v1, s[28:31], s68 offen sc1
  v_mfma_f32_16x16x32_bf16 a[8:11], a[224:227], v[160:163], a[8:11]
  ds_write_b128 v88, a[0:3]
  v_mfma_f32_16x16x32_bf16 a[8:11], a[228:231], v[164:167], a[8:11]
  ds_write_b128 v88, a[4:7] offset:8192
  v_mfma_f32_16x16x32_bf16 a[12:15], a[224:227], v[168:171], a[12:15]
  buffer_load_dwordx4 v[180:183], v1, s[28:31], s68 offen offset:1024 sc1
  v_mfma_f32_16x16x32_bf16 a[12:15], a[228:231], v[172:175], a[12:15]
  ds_write_b128 v88, a[16:19] offset:1024
  v_mfma_f32_16x16x32_bf16 a[24:27], a[240:243], v[160:163], a[24:27]
  s_waitcnt lgkmcnt(3)
  ds_read_b128 a[232:235], v252 offset:38912
  ds_read_b128 a[236:239], v252 offset:39936
  v_mfma_f32_16x16x32_bf16 a[24:27], a[244:247], v[164:167], a[24:27]
  ds_write_b128 v88, a[20:23] offset:9216
  v_mfma_f32_16x16x32_bf16 a[28:31], a[240:243], v[168:171], a[28:31]
  buffer_load_dwordx4 v[184:187], v13, s[28:31], s68 offen sc1
  v_mfma_f32_16x16x32_bf16 a[28:31], a[244:247], v[172:175], a[28:31]
  ds_write_b128 v88, a[32:35] offset:2048
  v_mfma_f32_16x16x32_bf16 a[40:43], a[248:251], v[160:163], a[40:43]
  s_nop 0
  ds_read_b128 a[208:211], v252 offset:40960
  ds_read_b128 a[212:215], v252 offset:41984
  v_mfma_f32_16x16x32_bf16 a[40:43], a[252:255], v[164:167], a[40:43]
  ds_write_b128 v88, a[36:39] offset:10240
  v_mfma_f32_16x16x32_bf16 a[44:47], a[248:251], v[168:171], a[44:47]
  buffer_load_dwordx4 v[188:191], v13, s[28:31], s68 offen offset:1024 sc1
  v_mfma_f32_16x16x32_bf16 a[44:47], a[252:255], v[172:175], a[44:47]
  s_waitcnt lgkmcnt(5)
  ds_write_b128 v88, a[48:51] offset:3072
  v_mfma_f32_16x16x32_bf16 a[56:59], a[232:235], v[160:163], a[56:59]
  s_add_u32 s68, s68, 8192
  ds_read_b128 a[216:219], v252 offset:43008
  ds_read_b128 a[220:223], v252 offset:44032
  v_mfma_f32_16x16x32_bf16 a[56:59], a[236:239], v[164:167], a[56:59]
  ds_write_b128 v88, a[52:55] offset:11264
  v_mfma_f32_16x16x32_bf16 a[60:63], a[232:235], v[168:171], a[60:63]
  buffer_load_dwordx4 v[192:195], v1, s[28:31], s68 offen sc1
  v_mfma_f32_16x16x32_bf16 a[60:63], a[236:239], v[172:175], a[60:63]
  s_waitcnt lgkmcnt(5)
  ds_write_b128 v88, a[64:67] offset:4096
  v_mfma_f32_16x16x32_bf16 a[72:75], a[208:211], v[160:163], a[72:75]
  s_nop 0
  ds_read_b128 a[224:227], v252 offset:45056
  ds_read_b128 a[228:231], v252 offset:46080
  v_mfma_f32_16x16x32_bf16 a[72:75], a[212:215], v[164:167], a[72:75]
  ds_write_b128 v88, a[68:71] offset:12288
  v_mfma_f32_16x16x32_bf16 a[76:79], a[208:211], v[168:171], a[76:79]
  buffer_load_dwordx4 v[196:199], v1, s[28:31], s68 offen offset:1024 sc1
  v_mfma_f32_16x16x32_bf16 a[76:79], a[212:215], v[172:175], a[76:79]
  s_waitcnt lgkmcnt(5)
  ds_write_b128 v88, a[80:83] offset:5120
  v_mfma_f32_16x16x32_bf16 a[88:91], a[216:219], v[160:163], a[88:91]
  s_nop 0
  ds_read_b128 a[240:243], v252 offset:47104
  ds_read_b128 a[244:247], v252 offset:48128
  v_mfma_f32_16x16x32_bf16 a[88:91], a[220:223], v[164:167], a[88:91]
  ds_write_b128 v88, a[84:87] offset:13312
  v_mfma_f32_16x16x32_bf16 a[92:95], a[216:219], v[168:171], a[92:95]
  buffer_load_dwordx4 v[200:203], v13, s[28:31], s68 offen sc1
  v_mfma_f32_16x16x32_bf16 a[92:95], a[220:223], v[172:175], a[92:95]
  s_waitcnt lgkmcnt(5)
  ds_write_b128 v88, a[96:99] offset:6144
  v_mfma_f32_16x16x32_bf16 a[104:107], a[224:227], v[160:163], a[104:107]
  ds_write_b128 v88, a[100:103] offset:14336
  v_mfma_f32_16x16x32_bf16 a[104:107], a[228:231], v[164:167], a[104:107]
  buffer_load_dwordx4 v[204:207], v13, s[28:31], s68 offen offset:1024 sc1
  v_mfma_f32_16x16x32_bf16 a[108:111], a[224:227], v[168:171], a[108:111]
  s_add_u32 s68, s68, 8192
  ds_write_b128 v88, a[112:115] offset:7168
  v_mfma_f32_16x16x32_bf16 a[108:111], a[228:231], v[172:175], a[108:111]
  s_waitcnt lgkmcnt(4)
  v_bfe_u32 v8, v0, 2, 3
  v_lshlrev_b32 v10, 3, v10
  v_mfma_f32_16x16x32_bf16 a[120:123], a[240:243], v[160:163], a[120:123]
  ds_write_b128 v88, a[116:119] offset:15360
  v_mfma_f32_16x16x32_bf16 a[120:123], a[244:247], v[164:167], a[120:123]
  v_bfe_u32 v9, v0, 5, 1
  v_lshl_add_u32 v2, v8, 7, v10
  v_mfma_f32_16x16x32_bf16 a[124:127], a[240:243], v[168:171], a[124:127]
  v_lshl_add_u32 v3, v8, 6, v10
  v_lshl_add_u32 v2, v9, 10, v2
  v_mfma_f32_16x16x32_bf16 a[124:127], a[244:247], v[172:175], a[124:127]
  v_lshl_add_u32 v3, v9, 9, v3
  v_lshrrev_b32 v9, 1, v8
  v_add_u32 v91, s101, v1
  v_add_u32 v3, 0x1000, v3
  v_lshrrev_b32 v8, 2, v8
  v_xor_b32 v10, 0, v9
  v_lshl_add_u32 v208, v10, 5, v2
  v_add_u32 v214, 0x20000, v208
  v_xor_b32 v10, 1, v9
  v_lshl_add_u32 v209, v10, 5, v2
  v_add_u32 v215, 0x20000, v209
  v_xor_b32 v10, 2, v9
  v_lshl_add_u32 v210, v10, 5, v2
  v_add_u32 v216, 0x20000, v210
  v_xor_b32 v10, 3, v9
  v_lshl_add_u32 v211, v10, 5, v2
  v_add_u32 v217, 0x20000, v211
  v_xor_b32 v10, 0, v8
  v_lshl_add_u32 v212, v10, 5, v3
  v_add_u32 v218, 0x20000, v212
  v_xor_b32 v10, 1, v8
  v_lshl_add_u32 v213, v10, 5, v3
  v_add_u32 v219, 0x20000, v213
L_merge_hi:
  s_waitcnt lgkmcnt(0)
  s_barrier
  ds_read_b128 v[48:51], v91
  ds_read_b128 v[84:87], v91 offset:1024
  ds_read_b128 v[16:19], v89
  ds_read_b128 v[20:23], v89 offset:1024
  ds_read_b128 v[24:27], v89 offset:2048
  ds_read_b128 v[28:31], v89 offset:3072
  ds_read_b128 v[32:35], v89 offset:4096
  ds_read_b128 v[36:39], v89 offset:5120
  ds_read_b128 v[40:43], v89 offset:6144
  ds_read_b128 v[44:47], v89 offset:7168
  ds_read_b128 v[52:55], v89 offset:8192
  ds_read_b128 v[56:59], v89 offset:9216
  ds_read_b128 v[60:63], v89 offset:10240
  ds_read_b128 v[64:67], v89 offset:11264
  ds_read_b128 v[68:71], v89 offset:12288
  ds_read_b128 v[72:75], v89 offset:13312
  ds_read_b128 v[76:79], v89 offset:14336
  ds_read_b128 v[80:83], v89 offset:15360
  v_accvgpr_read_b32 v232, a136
  s_waitcnt lgkmcnt(15)
  v_add_f32 v232, v232, v48
  v_accvgpr_read_b32 v233, a140
  v_add_f32 v233, v233, v84
  s_waitcnt lgkmcnt(0)
  s_barrier
  v_add_f32 v228, v232, v233
  v_min_f32 v229, v232, v233
  v_mov_b32 v230, 0x4e800000
  v_mov_b32 v231, 0x30800000
  v_cmp_nlt_f32 vcc, v228, v230
  v_cmp_nge_f32 s[98:99], v229, v231
  s_nop 3
  s_or_b64 vcc, vcc, s[98:99]
  s_cbranch_vccz L_ok_mhi
  s_mov_b32 s93, 3
  s_branch L_fallback
L_ret_3:
  v_accvgpr_read_b32 v114, a136
  v_rcp_f32 v114, v114
  v_accvgpr_read_b32 v96, a8
  v_accvgpr_read_b32 v97, a9
  v_accvgpr_read_b32 v98, a10
  v_accvgpr_read_b32 v99, a11
  v_accvgpr_read_b32 v100, a24
  v_accvgpr_read_b32 v101, a25
  v_accvgpr_read_b32 v102, a26
  v_accvgpr_read_b32 v103, a27
  v_mul_f32 v96, v96, v114
  v_mul_f32 v97, v97, v114
  v_mul_f32 v98, v98, v114
  v_mul_f32 v99, v99, v114
  v_mul_f32 v100, v100, v114
  v_mul_f32 v101, v101, v114
  v_mul_f32 v102, v102, v114
  v_mul_f32 v103, v103, v114
  v_cvt_pk_bf16_f32 v96, v96, v97
  v_cvt_pk_bf16_f32 v97, v98, v99
  v_cvt_pk_bf16_f32 v98, v100, v101
  v_cvt_pk_bf16_f32 v99, v102, v103
  s_add_u32 s59, s51, 0x0
  buffer_store_dwordx4 v[96:99], v1, s[28:31], s59 offen offset:2048 sc1
  v_accvgpr_read_b32 v104, a40
  v_accvgpr_read_b32 v105, a41
  v_accvgpr_read_b32 v106, a42
  v_accvgpr_read_b32 v107, a43
  v_accvgpr_read_b32 v108, a56
  v_accvgpr_read_b32 v109, a57
  v_accvgpr_read_b32 v110, a58
  v_accvgpr_read_b32 v111, a59
  v_mul_f32 v104, v104, v114
  v_mul_f32 v105, v105, v114
  v_mul_f32 v106, v106, v114
  v_mul_f32 v107, v107, v114
  v_mul_f32 v108, v108, v114
  v_mul_f32 v109, v109, v114
  v_mul_f32 v110, v110, v114
  v_mul_f32 v111, v111, v114
  v_cvt_pk_bf16_f32 v104, v104, v105
  v_cvt_pk_bf16_f32 v105, v106, v107
  v_cvt_pk_bf16_f32 v106, v108, v109
  v_cvt_pk_bf16_f32 v107, v110, v111
  s_add_u32 s56, s51, 0x1000
  buffer_store_dwordx4 v[104:107], v1, s[28:31], s56 offen offset:2048 sc1
  v_accvgpr_read_b32 v96, a72
  v_accvgpr_read_b32 v97, a73
  v_accvgpr_read_b32 v98, a74
  v_accvgpr_read_b32 v99, a75
  v_accvgpr_read_b32 v100, a88
  v_accvgpr_read_b32 v101, a89
  v_accvgpr_read_b32 v102, a90
  v_accvgpr_read_b32 v103, a91
  v_mul_f32 v96, v96, v114
  v_mul_f32 v97, v97, v114
  v_mul_f32 v98, v98, v114
  v_mul_f32 v99, v99, v114
  v_mul_f32 v100, v100, v114
  v_mul_f32 v101, v101, v114
  v_mul_f32 v102, v102, v114
  v_mul_f32 v103, v103, v114
  v_cvt_pk_bf16_f32 v96, v96, v97
  v_cvt_pk_bf16_f32 v97, v98, v99
  v_cvt_pk_bf16_f32 v98, v100, v101
  v_cvt_pk_bf16_f32 v99, v102, v103
  s_add_u32 s57, s51, 0x2000
  buffer_store_dwordx4 v[96:99], v1, s[28:31], s57 offen offset:2048 sc1
  v_accvgpr_read_b32 v104, a104
  v_accvgpr_read_b32 v105, a105
  v_accvgpr_read_b32 v106, a106
  v_accvgpr_read_b32 v107, a107
  v_accvgpr_read_b32 v108, a120
  v_accvgpr_read_b32 v109, a121
  v_accvgpr_read_b32 v110, a122
  v_accvgpr_read_b32 v111, a123
  v_mul_f32 v104, v104, v114
  v_mul_f32 v105, v105, v114
  v_mul_f32 v106, v106, v114
  v_mul_f32 v107, v107, v114
  v_mul_f32 v108, v108, v114
  v_mul_f32 v109, v109, v114
  v_mul_f32 v110, v110, v114
  v_mul_f32 v111, v111, v114
  v_cvt_pk_bf16_f32 v104, v104, v105
  v_cvt_pk_bf16_f32 v105, v106, v107
  v_cvt_pk_bf16_f32 v106, v108, v109
  v_cvt_pk_bf16_f32 v107, v110, v111
  s_add_u32 s58, s51, 0x3000
  buffer_store_dwordx4 v[104:107], v1, s[28:31], s58 offen offset:2048 sc1
  v_accvgpr_read_b32 v115, a140
  v_rcp_f32 v115, v115
  v_accvgpr_read_b32 v96, a12
  v_accvgpr_read_b32 v97, a13
  v_accvgpr_read_b32 v98, a14
  v_accvgpr_read_b32 v99, a15
  v_accvgpr_read_b32 v100, a28
  v_accvgpr_read_b32 v101, a29
  v_accvgpr_read_b32 v102, a30
  v_accvgpr_read_b32 v103, a31
  v_mul_f32 v96, v96, v115
  v_mul_f32 v97, v97, v115
  v_mul_f32 v98, v98, v115
  v_mul_f32 v99, v99, v115
  v_mul_f32 v100, v100, v115
  v_mul_f32 v101, v101, v115
  v_mul_f32 v102, v102, v115
  v_mul_f32 v103, v103, v115
  v_cvt_pk_bf16_f32 v96, v96, v97
  v_cvt_pk_bf16_f32 v97, v98, v99
  v_cvt_pk_bf16_f32 v98, v100, v101
  v_cvt_pk_bf16_f32 v99, v102, v103
  s_add_u32 s59, s51, 0x0
  buffer_store_dwordx4 v[96:99], v1, s[28:31], s59 offen offset:3072 sc1
  v_accvgpr_read_b32 v104, a44
  v_accvgpr_read_b32 v105, a45
  v_accvgpr_read_b32 v106, a46
  v_accvgpr_read_b32 v107, a47
  v_accvgpr_read_b32 v108, a60
  v_accvgpr_read_b32 v109, a61
  v_accvgpr_read_b32 v110, a62
  v_accvgpr_read_b32 v111, a63
  v_mul_f32 v104, v104, v115
  v_mul_f32 v105, v105, v115
  v_mul_f32 v106, v106, v115
  v_mul_f32 v107, v107, v115
  v_mul_f32 v108, v108, v115
  v_mul_f32 v109, v109, v115
  v_mul_f32 v110, v110, v115
  v_mul_f32 v111, v111, v115
  v_cvt_pk_bf16_f32 v104, v104, v105
  v_cvt_pk_bf16_f32 v105, v106, v107
  v_cvt_pk_bf16_f32 v106, v108, v109
  v_cvt_pk_bf16_f32 v107, v110, v111
  s_add_u32 s56, s51, 0x1000
  buffer_store_dwordx4 v[104:107], v1, s[28:31], s56 offen offset:3072 sc1
  v_accvgpr_read_b32 v96, a76
  v_accvgpr_read_b32 v97, a77
  v_accvgpr_read_b32 v98, a78
  v_accvgpr_read_b32 v99, a79
  v_accvgpr_read_b32 v100, a92
  v_accvgpr_read_b32 v101, a93
  v_accvgpr_read_b32 v102, a94
  v_accvgpr_read_b32 v103, a95
  v_mul_f32 v96, v96, v115
  v_mul_f32 v97, v97, v115
  v_mul_f32 v98, v98, v115
  v_mul_f32 v99, v99, v115
  v_mul_f32 v100, v100, v115
  v_mul_f32 v101, v101, v115
  v_mul_f32 v102, v102, v115
  v_mul_f32 v103, v103, v115
  v_cvt_pk_bf16_f32 v96, v96, v97
  v_cvt_pk_bf16_f32 v97, v98, v99
  v_cvt_pk_bf16_f32 v98, v100, v101
  v_cvt_pk_bf16_f32 v99, v102, v103
  s_add_u32 s57, s51, 0x2000
  buffer_store_dwordx4 v[96:99], v1, s[28:31], s57 offen offset:3072 sc1
  v_accvgpr_read_b32 v104, a108
  v_accvgpr_read_b32 v105, a109
  v_accvgpr_read_b32 v106, a110
  v_accvgpr_read_b32 v107, a111
  v_accvgpr_read_b32 v108, a124
  v_accvgpr_read_b32 v109, a125
  v_accvgpr_read_b32 v110, a126
  v_accvgpr_read_b32 v111, a127
  v_mul_f32 v104, v104, v115
  v_mul_f32 v105, v105, v115
  v_mul_f32 v106, v106, v115
  v_mul_f32 v107, v107, v115
  v_mul_f32 v108, v108, v115
  v_mul_f32 v109, v109, v115
  v_mul_f32 v110, v110, v115
  v_mul_f32 v111, v111, v115
  v_cvt_pk_bf16_f32 v104, v104, v105
  v_cvt_pk_bf16_f32 v105, v106, v107
  v_cvt_pk_bf16_f32 v106, v108, v109
  v_cvt_pk_bf16_f32 v107, v110, v111
  s_add_u32 s58, s51, 0x3000
  buffer_store_dwordx4 v[104:107], v1, s[28:31], s58 offen offset:3072 sc1
  s_add_u32 m0, s71, 0x5000
  s_nop 0
  buffer_load_dwordx4 v12, s[12:15], s69 offen lds
  s_add_u32 m0, s71, 0x5400
  s_add_u32 s59, s69, 0x2800
  buffer_load_dwordx4 v12, s[12:15], s59 offen lds
  s_add_u32 m0, s71, 0x5800
  s_add_u32 s59, s69, 0x80
  buffer_load_dwordx4 v12, s[12:15], s59 offen lds
  s_add_u32 m0, s71, 0x5c00
  s_add_u32 s59, s69, 0x2880
  buffer_load_dwordx4 v12, s[12:15], s59 offen lds
  s_add_u32 m0, s71, 0x6000
  s_add_u32 s59, s69, s80
  buffer_load_dwordx4 v4, s[12:15], s59 offen lds
  s_add_u32 s69, s69, 81920
  buffer_load_dwordx4 a[160:163], v1, s[28:31], s68 offen sc1
  buffer_load_dwordx4 a[164:167], v1, s[28:31], s68 offen offset:1024 sc1
  buffer_load_dwordx4 a[168:171], v13, s[28:31], s68 offen sc1
  buffer_load_dwordx4 a[172:175], v13, s[28:31], s68 offen offset:1024 sc1
  s_add_u32 s68, s68, 8192
  s_add_u32 m0, s71, 0xa000
  s_nop 0
  buffer_load_dwordx4 v12, s[12:15], s69 offen lds
  s_add_u32 m0, s71, 0xa400
  s_add_u32 s56, s69, 0x2800
  buffer_load_dwordx4 v12, s[12:15], s56 offen lds
  s_add_u32 m0, s71, 0xa800
  s_add_u32 s56, s69, 0x80
  buffer_load_dwordx4 v12, s[12:15], s56 offen lds
  s_add_u32 m0, s71, 0xac00
  s_add_u32 s56, s69, 0x2880
  buffer_load_dwordx4 v12, s[12:15], s56 offen lds
  s_add_u32 m0, s71, 0xb000
  s_add_u32 s56, s69, s80
  buffer_load_dwordx4 v4, s[12:15], s56 offen lds
  s_add_u32 s69, s69, 81920
  s_branch L_k3
L_ok_mhi:
  v_rcp_f32 v234, v232
  v_rcp_f32 v236, v233
  v_mov_b32 v235, v234
  v_mov_b32 v237, v236
  v_accvgpr_read_b32 v96, a8
  v_accvgpr_read_b32 v97, a9
  v_accvgpr_read_b32 v98, a10
  v_accvgpr_read_b32 v99, a11
  v_accvgpr_read_b32 v100, a24
  v_accvgpr_read_b32 v101, a25
  v_accvgpr_read_b32 v102, a26
  v_accvgpr_read_b32 v103, a27
  v_pk_add_f32 v[96:97], v[96:97], v[16:17]
  v_pk_add_f32 v[98:99], v[98:99], v[18:19]
  v_pk_add_f32 v[100:101], v[100:101], v[20:21]
  v_pk_add_f32 v[102:103], v[102:103], v[22:23]
  v_pk_mul_f32 v[96:97], v[96:97], v[234:235]
  v_pk_mul_f32 v[98:99], v[98:99], v[234:235]
  v_pk_mul_f32 v[100:101], v[100:101], v[234:235]
  v_pk_mul_f32 v[102:103], v[102:103], v[234:235]
  v_cvt_pk_bf16_f32 v96, v96, v97
  v_cvt_pk_bf16_f32 v97, v98, v99
  v_cvt_pk_bf16_f32 v98, v100, v101
  v_cvt_pk_bf16_f32 v99, v102, v103
  s_add_u32 s44, s51, 0x0
  buffer_store_dwordx4 v[96:99], v1, s[28:31], s44 offen offset:2048 sc1
  s_add_u32 m0, s71, 0x5000
  s_nop 0
  buffer_load_dwordx4 v12, s[12:15], s69 offen lds
  s_add_u32 m0, s71, 0x5400
  s_add_u32 s57, s69, 0x2800
  buffer_load_dwordx4 v12, s[12:15], s57 offen lds
  v_accvgpr_read_b32 v104, a40
  v_accvgpr_read_b32 v105, a41
  v_accvgpr_read_b32 v106, a42
  v_accvgpr_read_b32 v107, a43
  v_accvgpr_read_b32 v108, a56
  v_accvgpr_read_b32 v109, a57
  v_accvgpr_read_b32 v110, a58
  v_accvgpr_read_b32 v111, a59
  v_pk_add_f32 v[104:105], v[104:105], v[24:25]
  v_pk_add_f32 v[106:107], v[106:107], v[26:27]
  v_pk_add_f32 v[108:109], v[108:109], v[28:29]
  v_pk_add_f32 v[110:111], v[110:111], v[30:31]
  v_pk_mul_f32 v[104:105], v[104:105], v[234:235]
  v_pk_mul_f32 v[106:107], v[106:107], v[234:235]
  v_pk_mul_f32 v[108:109], v[108:109], v[234:235]
  v_pk_mul_f32 v[110:111], v[110:111], v[234:235]
  v_cvt_pk_bf16_f32 v104, v104, v105
  v_cvt_pk_bf16_f32 v105, v106, v107
  v_cvt_pk_bf16_f32 v106, v108, v109
  v_cvt_pk_bf16_f32 v107, v110, v111
  s_add_u32 s44, s51, 0x1000
  buffer_store_dwordx4 v[104:107], v1, s[28:31], s44 offen offset:2048 sc1
  s_add_u32 m0, s71, 0x5800
  s_add_u32 s57, s69, 0x80
  buffer_load_dwordx4 v12, s[12:15], s57 offen lds
  s_add_u32 m0, s71, 0x5c00
  s_add_u32 s57, s69, 0x2880
  buffer_load_dwordx4 v12, s[12:15], s57 offen lds
  v_accvgpr_read_b32 v96, a72
  v_accvgpr_read_b32 v97, a73
  v_accvgpr_read_b32 v98, a74
  v_accvgpr_read_b32 v99, a75
  v_accvgpr_read_b32 v100, a88
  v_accvgpr_read_b32 v101, a89
  v_accvgpr_read_b32 v102, a90
  v_accvgpr_read_b32 v103, a91
  v_pk_add_f32 v[96:97], v[96:97], v[32:33]
  v_pk_add_f32 v[98:99], v[98:99], v[34:35]
  v_pk_add_f32 v[100:101], v[100:101], v[36:37]
  v_pk_add_f32 v[102:103], v[102:103], v[38:39]
  v_pk_mul_f32 v[96:97], v[96:97], v[234:235]
  v_pk_mul_f32 v[98:99], v[98:99], v[234:235]
  v_pk_mul_f32 v[100:101], v[100:101], v[234:235]
  v_pk_mul_f32 v[102:103], v[102:103], v[234:235]
  v_cvt_pk_bf16_f32 v96, v96, v97
  v_cvt_pk_bf16_f32 v97, v98, v99
  v_cvt_pk_bf16_f32 v98, v100, v101
  v_cvt_pk_bf16_f32 v99, v102, v103
  s_add_u32 s44, s51, 0x2000
  buffer_store_dwordx4 v[96:99], v1, s[28:31], s44 offen offset:2048 sc1
  s_add_u32 m0, s71, 0x6000
  s_add_u32 s57, s69, s80
  buffer_load_dwordx4 v4, s[12:15], s57 offen lds
  s_add_u32 s69, s69, 81920
  buffer_load_dwordx4 a[160:163], v1, s[28:31], s68 offen sc1
  v_accvgpr_read_b32 v104, a104
  v_accvgpr_read_b32 v105, a105
  v_accvgpr_read_b32 v106, a106
  v_accvgpr_read_b32 v107, a107
  v_accvgpr_read_b32 v108, a120
  v_accvgpr_read_b32 v109, a121
  v_accvgpr_read_b32 v110, a122
  v_accvgpr_read_b32 v111, a123
  v_pk_add_f32 v[104:105], v[104:105], v[40:41]
  v_pk_add_f32 v[106:107], v[106:107], v[42:43]
  v_pk_add_f32 v[108:109], v[108:109], v[44:45]
  v_pk_add_f32 v[110:111], v[110:111], v[46:47]
  v_pk_mul_f32 v[104:105], v[104:105], v[234:235]
  v_pk_mul_f32 v[106:107], v[106:107], v[234:235]
  v_pk_mul_f32 v[108:109], v[108:109], v[234:235]
  v_pk_mul_f32 v[110:111], v[110:111], v[234:235]
  v_cvt_pk_bf16_f32 v104, v104, v105
  v_cvt_pk_bf16_f32 v105, v106, v107
  v_cvt_pk_bf16_f32 v106, v108, v109
  v_cvt_pk_bf16_f32 v107, v110, v111
  s_add_u32 s44, s51, 0x3000
  buffer_store_dwordx4 v[104:107], v1, s[28:31], s44 offen offset:2048 sc1
  buffer_load_dwordx4 a[164:167], v1, s[28:31], s68 offen offset:1024 sc1
  buffer_load_dwordx4 a[168:171], v13, s[28:31], s68 offen sc1
  v_accvgpr_read_b32 v96, a12
  v_accvgpr_read_b32 v97, a13
  v_accvgpr_read_b32 v98, a14
  v_accvgpr_read_b32 v99, a15
  v_accvgpr_read_b32 v100, a28
  v_accvgpr_read_b32 v101, a29
  v_accvgpr_read_b32 v102, a30
  v_accvgpr_read_b32 v103, a31
  v_pk_add_f32 v[96:97], v[96:97], v[52:53]
  v_pk_add_f32 v[98:99], v[98:99], v[54:55]
  v_pk_add_f32 v[100:101], v[100:101], v[56:57]
  v_pk_add_f32 v[102:103], v[102:103], v[58:59]
  v_pk_mul_f32 v[96:97], v[96:97], v[236:237]
  v_pk_mul_f32 v[98:99], v[98:99], v[236:237]
  v_pk_mul_f32 v[100:101], v[100:101], v[236:237]
  v_pk_mul_f32 v[102:103], v[102:103], v[236:237]
  v_cvt_pk_bf16_f32 v96, v96, v97
  v_cvt_pk_bf16_f32 v97, v98, v99
  v_cvt_pk_bf16_f32 v98, v100, v101
  v_cvt_pk_bf16_f32 v99, v102, v103
  s_add_u32 s44, s51, 0x0
  buffer_store_dwordx4 v[96:99], v1, s[28:31], s44 offen offset:3072 sc1
  buffer_load_dwordx4 a[172:175], v13, s[28:31], s68 offen offset:1024 sc1
  s_add_u32 s68, s68, 8192
  s_add_u32 m0, s71, 0xa000
  s_nop 0
  buffer_load_dwordx4 v12, s[12:15], s69 offen lds
  v_accvgpr_read_b32 v104, a44
  v_accvgpr_read_b32 v105, a45
  v_accvgpr_read_b32 v106, a46
  v_accvgpr_read_b32 v107, a47
  v_accvgpr_read_b32 v108, a60
  v_accvgpr_read_b32 v109, a61
  v_accvgpr_read_b32 v110, a62
  v_accvgpr_read_b32 v111, a63
  v_pk_add_f32 v[104:105], v[104:105], v[60:61]
  v_pk_add_f32 v[106:107], v[106:107], v[62:63]
  v_pk_add_f32 v[108:109], v[108:109], v[64:65]
  v_pk_add_f32 v[110:111], v[110:111], v[66:67]
  v_pk_mul_f32 v[104:105], v[104:105], v[236:237]
  v_pk_mul_f32 v[106:107], v[106:107], v[236:237]
  v_pk_mul_f32 v[108:109], v[108:109], v[236:237]
  v_pk_mul_f32 v[110:111], v[110:111], v[236:237]
  v_cvt_pk_bf16_f32 v104, v104, v105
  v_cvt_pk_bf16_f32 v105, v106, v107
  v_cvt_pk_bf16_f32 v106, v108, v109
  v_cvt_pk_bf16_f32 v107, v110, v111
  s_add_u32 s44, s51, 0x1000
  buffer_store_dwordx4 v[104:107], v1, s[28:31], s44 offen offset:3072 sc1
  s_add_u32 m0, s71, 0xa400
  s_add_u32 s58, s69, 0x2800
  buffer_load_dwordx4 v12, s[12:15], s58 offen lds
  s_add_u32 m0, s71, 0xa800
  s_add_u32 s58, s69, 0x80
  buffer_load_dwordx4 v12, s[12:15], s58 offen lds
  v_accvgpr_read_b32 v96, a76
  v_accvgpr_read_b32 v97, a77
  v_accvgpr_read_b32 v98, a78
  v_accvgpr_read_b32 v99, a79
  v_accvgpr_read_b32 v100, a92
  v_accvgpr_read_b32 v101, a93
  v_accvgpr_read_b32 v102, a94
  v_accvgpr_read_b32 v103, a95
  v_pk_add_f32 v[96:97], v[96:97], v[68:69]
  v_pk_add_f32 v[98:99], v[98:99], v[70:71]
  v_pk_add_f32 v[100:101], v[100:101], v[72:73]
  v_pk_add_f32 v[102:103], v[102:103], v[74:75]
  v_pk_mul_f32 v[96:97], v[96:97], v[236:237]
  v_pk_mul_f32 v[98:99], v[98:99], v[236:237]
  v_pk_mul_f32 v[100:101], v[100:101], v[236:237]
  v_pk_mul_f32 v[102:103], v[102:103], v[236:237]
  v_cvt_pk_bf16_f32 v96, v96, v97
  v_cvt_pk_bf16_f32 v97, v98, v99
  v_cvt_pk_bf16_f32 v98, v100, v101
  v_cvt_pk_bf16_f32 v99, v102, v103
  s_add_u32 s44, s51, 0x2000
  buffer_store_dwordx4 v[96:99], v1, s[28:31], s44 offen offset:3072 sc1
  s_add_u32 m0, s71, 0xac00
  s_add_u32 s58, s69, 0x2880
  buffer_load_dwordx4 v12, s[12:15], s58 offen lds
  s_add_u32 m0, s71, 0xb000
  s_add_u32 s58, s69, s80
  buffer_load_dwordx4 v4, s[12:15], s58 offen lds
  s_add_u32 s69, s69, 81920
  v_accvgpr_read_b32 v104, a108
  v_accvgpr_read_b32 v105, a109
  v_accvgpr_read_b32 v106, a110
  v_accvgpr_read_b32 v107, a111
  v_accvgpr_read_b32 v108, a124
  v_accvgpr_read_b32 v109, a125
  v_accvgpr_read_b32 v110, a126
  v_accvgpr_read_b32 v111, a127
  v_pk_add_f32 v[104:105], v[104:105], v[76:77]
  v_pk_add_f32 v[106:107], v[106:107], v[78:79]
  v_pk_add_f32 v[108:109], v[108:109], v[80:81]
  v_pk_add_f32 v[110:111], v[110:111], v[82:83]
  v_pk_mul_f32 v[104:105], v[104:105], v[236:237]
  v_pk_mul_f32 v[106:107], v[106:107], v[236:237]
  v_pk_mul_f32 v[108:109], v[108:109], v[236:237]
  v_pk_mul_f32 v[110:111], v[110:111], v[236:237]
  v_cvt_pk_bf16_f32 v104, v104, v105
  v_cvt_pk_bf16_f32 v105, v106, v107
  v_cvt_pk_bf16_f32 v106, v108, v109
  v_cvt_pk_bf16_f32 v107, v110, v111
  s_add_u32 s44, s51, 0x3000
  buffer_store_dwordx4 v[104:107], v1, s[28:31], s44 offen offset:3072 sc1
L_k3:
  s_waitcnt vmcnt(22) lgkmcnt(0)
  s_barrier
  ds_read_b64_tr_b16 a[0:1], v208
  ds_read_b64_tr_b16 a[2:3], v208 offset:5120
  ds_read_b64_tr_b16 a[4:5], v208 offset:10240
  ds_read_b64_tr_b16 a[6:7], v208 offset:15360
  ds_read_b64_tr_b16 a[8:9], v209
  ds_read_b64_tr_b16 a[10:11], v209 offset:5120
  ds_read_b64_tr_b16 a[12:13], v209 offset:10240
  ds_read_b64_tr_b16 a[14:15], v209 offset:15360
  ds_read_b64_tr_b16 a[16:17], v210
  ds_read_b64_tr_b16 a[18:19], v210 offset:5120
  ds_read_b64_tr_b16 a[20:21], v210 offset:10240
  ds_read_b64_tr_b16 a[22:23], v210 offset:15360
  ds_read_b64_tr_b16 a[24:25], v211
  ds_read_b64_tr_b16 a[26:27], v211 offset:5120
  ds_read_b64_tr_b16 a[28:29], v211 offset:10240
  ds_read_b64_tr_b16 a[30:31], v211 offset:15360
  ds_read_b64_tr_b16 a[32:33], v208 offset:2048
  ds_read_b64_tr_b16 a[34:35], v208 offset:7168
  ds_read_b64_tr_b16 a[36:37], v208 offset:12288
  ds_read_b64_tr_b16 a[38:39], v208 offset:17408
  ds_read_b64_tr_b16 a[40:41], v209 offset:2048
  ds_read_b64_tr_b16 a[42:43], v209 offset:7168
  ds_read_b64_tr_b16 a[44:45], v209 offset:12288
  ds_read_b64_tr_b16 a[46:47], v209 offset:17408
  ds_read_b64_tr_b16 a[48:49], v210 offset:2048
  ds_read_b64_tr_b16 a[50:51], v210 offset:7168
  ds_read_b64_tr_b16 a[52:53], v210 offset:12288
  ds_read_b64_tr_b16 a[54:55], v210 offset:17408
  ds_read_b64_tr_b16 a[56:57], v211 offset:2048
  ds_read_b64_tr_b16 a[58:59], v211 offset:7168
  ds_read_b64_tr_b16 a[60:61], v211 offset:12288
  ds_read_b64_tr_b16 a[62:63], v211 offset:17408
  ds_read_b64_tr_b16 a[64:65], v212
  ds_read_b64_tr_b16 a[66:67], v212 offset:5120
  ds_read_b64_tr_b16 a[68:69], v212 offset:10240
  ds_read_b64_tr_b16 a[70:71], v212 offset:15360
  ds_read_b64_tr_b16 a[72:73], v213
  ds_read_b64_tr_b16 a[74:75], v213 offset:5120
  ds_read_b64_tr_b16 a[76:77], v213 offset:10240
  ds_read_b64_tr_b16 a[78:79], v213 offset:15360
  v_lshrrev_b32 v9, 1, v1
  s_mov_b32 s65, 3
  s_waitcnt lgkmcnt(0)
  s_barrier
  v_mfma_f32_16x16x32_bf16 v[16:19], a[0:3], v[176:179], 0
  s_add_u32 m0, s71, 0x0
  ds_read_b64_tr_b16 a[80:81], v214
  ds_read_b64_tr_b16 a[82:83], v214 offset:5120
  v_mfma_f32_16x16x32_bf16 v[16:19], a[4:7], v[184:187], v[16:19]
  s_add_u32 s59, s69, 0x2800
  buffer_load_dwordx4 a[176:179], v1, s[28:31], s68 offen sc1
  v_mfma_f32_16x16x32_bf16 v[20:23], a[0:3], v[180:183], 0
  s_nop 0
  ds_read_b64_tr_b16 a[84:85], v214 offset:10240
  ds_read_b64_tr_b16 a[86:87], v214 offset:15360
  v_mfma_f32_16x16x32_bf16 v[20:23], a[4:7], v[188:191], v[20:23]
  s_nop 0
  ds_read_b64_tr_b16 a[88:89], v215
  ds_read_b64_tr_b16 a[90:91], v215 offset:5120
  v_mfma_f32_16x16x32_bf16 v[24:27], a[8:11], v[176:179], 0
  ds_read_b64_tr_b16 a[92:93], v215 offset:10240
  v_mov_b32 v111, 0
  v_mfma_f32_16x16x32_bf16 v[24:27], a[12:15], v[184:187], v[24:27]
  buffer_load_dwordx4 a[180:183], v1, s[28:31], s68 offen offset:1024 sc1
  v_mfma_f32_16x16x32_bf16 v[28:31], a[8:11], v[180:183], 0
  s_nop 0
  ds_read_b64_tr_b16 a[94:95], v215 offset:15360
  ds_read_b64_tr_b16 a[96:97], v216
  v_mfma_f32_16x16x32_bf16 v[28:31], a[12:15], v[188:191], v[28:31]
  s_nop 0
  ds_read_b64_tr_b16 a[98:99], v216 offset:5120
  ds_read_b64_tr_b16 a[100:101], v216 offset:10240
  v_mfma_f32_16x16x32_bf16 v[32:35], a[16:19], v[176:179], 0
  ds_read_b64_tr_b16 a[102:103], v216 offset:15360
  v_mfma_f32_16x16x32_bf16 v[32:35], a[20:23], v[184:187], v[32:35]
  buffer_load_dwordx4 a[184:187], v13, s[28:31], s68 offen sc1
  v_mfma_f32_16x16x32_bf16 v[36:39], a[16:19], v[180:183], 0
  s_nop 0
  ds_read_b64_tr_b16 a[104:105], v217
  ds_read_b64_tr_b16 a[106:107], v217 offset:5120
  v_mfma_f32_16x16x32_bf16 v[36:39], a[20:23], v[188:191], v[36:39]
  s_nop 0
  ds_read_b64_tr_b16 a[108:109], v217 offset:10240
  ds_read_b64_tr_b16 a[110:111], v217 offset:15360
  v_mfma_f32_16x16x32_bf16 v[40:43], a[24:27], v[176:179], 0
  s_nop 0
  ds_read_b64_tr_b16 a[112:113], v214 offset:2048
  ds_read_b64_tr_b16 a[114:115], v214 offset:7168
  v_mfma_f32_16x16x32_bf16 v[40:43], a[28:31], v[184:187], v[40:43]
  buffer_load_dwordx4 a[188:191], v13, s[28:31], s68 offen offset:1024 sc1
  v_mfma_f32_16x16x32_bf16 v[44:47], a[24:27], v[180:183], 0
  s_add_u32 s68, s68, 8192
  ds_read_b64_tr_b16 a[116:117], v214 offset:12288
  ds_read_b64_tr_b16 a[118:119], v214 offset:17408
  v_mfma_f32_16x16x32_bf16 v[44:47], a[28:31], v[188:191], v[44:47]
  s_nop 0
  ds_read_b64_tr_b16 a[120:121], v215 offset:2048
  ds_read_b64_tr_b16 a[122:123], v215 offset:7168
  v_mfma_f32_16x16x32_bf16 v[48:51], a[32:35], v[176:179], 0
  ds_read_b64_tr_b16 a[124:125], v215 offset:12288
  v_mfma_f32_16x16x32_bf16 v[48:51], a[36:39], v[184:187], v[48:51]
  buffer_load_dwordx4 v12, s[12:15], s69 offen lds
  v_mfma_f32_16x16x32_bf16 v[52:55], a[32:35], v[180:183], 0
  s_add_u32 m0, s71, 0x400
  ds_read_b64_tr_b16 a[126:127], v215 offset:17408
  ds_read_b64_tr_b16 a[128:129], v216 offset:2048
  v_mfma_f32_16x16x32_bf16 v[52:55], a[36:39], v[188:191], v[52:55]
  s_nop 0
  ds_read_b64_tr_b16 a[130:131], v216 offset:7168
  ds_read_b64_tr_b16 a[132:133], v216 offset:12288
  v_mfma_f32_16x16x32_bf16 v[56:59], a[40:43], v[176:179], 0
  ds_read_b64_tr_b16 a[134:135], v216 offset:17408
  v_mfma_f32_16x16x32_bf16 v[56:59], a[44:47], v[184:187], v[56:59]
  buffer_load_dwordx4 v12, s[12:15], s59 offen lds
  v_mfma_f32_16x16x32_bf16 v[60:63], a[40:43], v[180:183], 0
  s_add_u32 m0, s71, 0x800
  ds_read_b64_tr_b16 a[136:137], v217 offset:2048
  ds_read_b64_tr_b16 a[138:139], v217 offset:7168
  v_mfma_f32_16x16x32_bf16 v[60:63], a[44:47], v[188:191], v[60:63]
  s_add_u32 s59, s69, 0x80
  ds_read_b64_tr_b16 a[140:141], v217 offset:12288
  ds_read_b64_tr_b16 a[142:143], v217 offset:17408
  v_mfma_f32_16x16x32_bf16 v[64:67], a[48:51], v[176:179], 0
  s_nop 0
  ds_read_b64_tr_b16 a[144:145], v218
  ds_read_b64_tr_b16 a[146:147], v218 offset:5120
  v_mfma_f32_16x16x32_bf16 v[64:67], a[52:55], v[184:187], v[64:67]
  buffer_load_dwordx4 v12, s[12:15], s59 offen lds
  v_mfma_f32_16x16x32_bf16 v[68:71], a[48:51], v[180:183], 0
  s_add_u32 m0, s71, 0xc00
  ds_read_b64_tr_b16 a[148:149], v218 offset:10240
  ds_read_b64_tr_b16 a[150:151], v218 offset:15360
  v_mfma_f32_16x16x32_bf16 v[68:71], a[52:55], v[188:191], v[68:71]
  s_add_u32 s59, s69, 0x2880
  ds_read_b64_tr_b16 a[152:153], v219
  ds_read_b64_tr_b16 a[154:155], v219 offset:5120
  v_mfma_f32_16x16x32_bf16 v[72:75], a[56:59], v[176:179], 0
  ds_read_b64_tr_b16 a[156:157], v219 offset:10240
  v_mfma_f32_16x16x32_bf16 v[72:75], a[60:63], v[184:187], v[72:75]
  buffer_load_dwordx4 v12, s[12:15], s59 offen lds
  v_mfma_f32_16x16x32_bf16 v[76:79], a[56:59], v[180:183], 0
  s_add_u32 m0, s71, 0x1000
  ds_read_b64_tr_b16 a[158:159], v219 offset:15360
  v_mfma_f32_16x16x32_bf16 v[76:79], a[60:63], v[188:191], v[76:79]
  s_add_u32 s59, s69, s80
  v_mfma_f32_16x16x32_bf16 v[80:83], a[64:67], v[176:179], 0
  s_add_u32 s69, s69, 81920
  v_mfma_f32_16x16x32_bf16 v[80:83], a[68:71], v[184:187], v[80:83]
  s_add_u32 s56, s69, 0x2800
  buffer_load_dwordx4 v4, s[12:15], s59 offen lds
  v_mfma_f32_16x16x32_bf16 v[84:87], a[64:67], v[180:183], 0
  s_add_u32 m0, s71, 0x20000
  v_mfma_f32_16x16x32_bf16 v[84:87], a[68:71], v[188:191], v[84:87]
  v_mfma_f32_16x16x32_bf16 v[88:91], a[72:75], v[176:179], 0
  v_mfma_f32_16x16x32_bf16 v[88:91], a[76:79], v[184:187], v[88:91]
  v_mfma_f32_16x16x32_bf16 v[92:95], a[72:75], v[180:183], 0
  v_mfma_f32_16x16x32_bf16 v[92:95], a[76:79], v[188:191], v[92:95]
  s_waitcnt vmcnt(9) lgkmcnt(0)
  s_barrier
  v_mfma_f32_16x16x32_bf16 v[16:19], a[80:83], v[192:195], v[16:19]
  buffer_atomic_add v15, v14, s[28:31], s73 offen sc1
  v_mfma_f32_16x16x32_bf16 v[16:19], a[84:87], v[200:203], v[16:19]
  buffer_load_dwordx4 v[176:179], v1, s[28:31], s68 offen sc1
  v_mfma_f32_16x16x32_bf16 v[20:23], a[80:83], v[196:199], v[20:23]
  s_nop 0
  ds_read_b64_tr_b16 a[0:1], v208 offset:20480
  ds_read_b64_tr_b16 a[2:3], v208 offset:25600
  v_mfma_f32_16x16x32_bf16 v[20:23], a[84:87], v[204:207], v[20:23]
  s_nop 0
  ds_read_b64_tr_b16 a[4:5], v208 offset:30720
  ds_read_b64_tr_b16 a[6:7], v208 offset:35840
  v_mfma_f32_16x16x32_bf16 v[24:27], a[88:91], v[192:195], v[24:27]
  s_nop 0
  ds_read_b64_tr_b16 a[8:9], v209 offset:20480
  ds_read_b64_tr_b16 a[10:11], v209 offset:25600
  v_mfma_f32_16x16x32_bf16 v[24:27], a[92:95], v[200:203], v[24:27]
  buffer_load_dwordx4 v[180:183], v1, s[28:31], s68 offen offset:1024 sc1
  v_mfma_f32_16x16x32_bf16 v[28:31], a[88:91], v[196:199], v[28:31]
  s_nop 0
  ds_read_b64_tr_b16 a[12:13], v209 offset:30720
  ds_read_b64_tr_b16 a[14:15], v209 offset:35840
  v_mfma_f32_16x16x32_bf16 v[28:31], a[92:95], v[204:207], v[28:31]
  s_nop 0
  ds_read_b64_tr_b16 a[16:17], v210 offset:20480
  ds_read_b64_tr_b16 a[18:19], v210 offset:25600
  v_mfma_f32_16x16x32_bf16 v[32:35], a[96:99], v[192:195], v[32:35]
  s_nop 0
  ds_read_b64_tr_b16 a[20:21], v210 offset:30720
  ds_read_b64_tr_b16 a[22:23], v210 offset:35840
  v_mfma_f32_16x16x32_bf16 v[32:35], a[100:103], v[200:203], v[32:35]
  buffer_load_dwordx4 v[184:187], v13, s[28:31], s68 offen sc1
  v_mfma_f32_16x16x32_bf16 v[36:39], a[96:99], v[196:199], v[36:39]
  s_nop 0
  ds_read_b64_tr_b16 a[24:25], v211 offset:20480
  ds_read_b64_tr_b16 a[26:27], v211 offset:25600
  v_mfma_f32_16x16x32_bf16 v[36:39], a[100:103], v[204:207], v[36:39]
  s_nop 0
  ds_read_b64_tr_b16 a[28:29], v211 offset:30720
  ds_read_b64_tr_b16 a[30:31], v211 offset:35840
  v_mfma_f32_16x16x32_bf16 v[40:43], a[104:107], v[192:195], v[40:43]
  s_nop 0
  ds_read_b64_tr_b16 a[32:33], v208 offset:22528
  ds_read_b64_tr_b16 a[34:35], v208 offset:27648
  v_mfma_f32_16x16x32_bf16 v[40:43], a[108:111], v[200:203], v[40:43]
  buffer_load_dwordx4 v[188:191], v13, s[28:31], s68 offen offset:1024 sc1
  v_mfma_f32_16x16x32_bf16 v[44:47], a[104:107], v[196:199], v[44:47]
  s_add_u32 s68, s68, 8192
  ds_read_b64_tr_b16 a[36:37], v208 offset:32768
  ds_read_b64_tr_b16 a[38:39], v208 offset:37888
  v_mfma_f32_16x16x32_bf16 v[44:47], a[108:111], v[204:207], v[44:47]
  s_nop 0
  ds_read_b64_tr_b16 a[40:41], v209 offset:22528
  ds_read_b64_tr_b16 a[42:43], v209 offset:27648
  v_mfma_f32_16x16x32_bf16 v[48:51], a[112:115], v[192:195], v[48:51]
  ds_read_b64_tr_b16 a[44:45], v209 offset:32768
  v_mfma_f32_16x16x32_bf16 v[48:51], a[116:119], v[200:203], v[48:51]
  buffer_load_dwordx4 v12, s[12:15], s69 offen lds
  v_mfma_f32_16x16x32_bf16 v[52:55], a[112:115], v[196:199], v[52:55]
  s_add_u32 m0, s71, 0x20400
  ds_read_b64_tr_b16 a[46:47], v209 offset:37888
  ds_read_b64_tr_b16 a[48:49], v210 offset:22528
  v_mfma_f32_16x16x32_bf16 v[52:55], a[116:119], v[204:207], v[52:55]
  s_nop 0
  ds_read_b64_tr_b16 a[50:51], v210 offset:27648
  ds_read_b64_tr_b16 a[52:53], v210 offset:32768
  v_mfma_f32_16x16x32_bf16 v[56:59], a[120:123], v[192:195], v[56:59]
  ds_read_b64_tr_b16 a[54:55], v210 offset:37888
  v_mfma_f32_16x16x32_bf16 v[56:59], a[124:127], v[200:203], v[56:59]
  buffer_load_dwordx4 v12, s[12:15], s56 offen lds
  v_mfma_f32_16x16x32_bf16 v[60:63], a[120:123], v[196:199], v[60:63]
  s_add_u32 m0, s71, 0x20800
  ds_read_b64_tr_b16 a[56:57], v211 offset:22528
  ds_read_b64_tr_b16 a[58:59], v211 offset:27648
  v_mfma_f32_16x16x32_bf16 v[60:63], a[124:127], v[204:207], v[60:63]
  s_add_u32 s56, s69, 0x80
  ds_read_b64_tr_b16 a[60:61], v211 offset:32768
  ds_read_b64_tr_b16 a[62:63], v211 offset:37888
  v_mfma_f32_16x16x32_bf16 v[64:67], a[128:131], v[192:195], v[64:67]
  s_nop 0
  ds_read_b64_tr_b16 a[64:65], v212 offset:20480
  ds_read_b64_tr_b16 a[66:67], v212 offset:25600
  v_mfma_f32_16x16x32_bf16 v[64:67], a[132:135], v[200:203], v[64:67]
  buffer_load_dwordx4 v12, s[12:15], s56 offen lds
  v_mfma_f32_16x16x32_bf16 v[68:71], a[128:131], v[196:199], v[68:71]
  s_add_u32 m0, s71, 0x20c00
  ds_read_b64_tr_b16 a[68:69], v212 offset:30720
  ds_read_b64_tr_b16 a[70:71], v212 offset:35840
  v_mfma_f32_16x16x32_bf16 v[68:71], a[132:135], v[204:207], v[68:71]
  s_add_u32 s56, s69, 0x2880
  ds_read_b64_tr_b16 a[72:73], v213 offset:20480
  ds_read_b64_tr_b16 a[74:75], v213 offset:25600
  v_mfma_f32_16x16x32_bf16 v[72:75], a[136:139], v[192:195], v[72:75]
  ds_read_b64_tr_b16 a[76:77], v213 offset:30720
  v_mfma_f32_16x16x32_bf16 v[72:75], a[140:143], v[200:203], v[72:75]
  buffer_load_dwordx4 v12, s[12:15], s56 offen lds
  v_mfma_f32_16x16x32_bf16 v[76:79], a[136:139], v[196:199], v[76:79]
  s_add_u32 m0, s71, 0x21000
  ds_read_b64_tr_b16 a[78:79], v213 offset:35840
  v_mfma_f32_16x16x32_bf16 v[76:79], a[140:143], v[204:207], v[76:79]
  s_add_u32 s56, s69, s80
  v_mfma_f32_16x16x32_bf16 v[80:83], a[144:147], v[192:195], v[80:83]
  s_add_u32 s69, s69, 81920
  v_mfma_f32_16x16x32_bf16 v[80:83], a[148:151], v[200:203], v[80:83]
  s_add_u32 s57, s69, 0x2800
  buffer_load_dwordx4 v4, s[12:15], s56 offen lds
  v_mfma_f32_16x16x32_bf16 v[84:87], a[144:147], v[196:199], v[84:87]
  s_add_u32 m0, s71, 0x5000
  v_mfma_f32_16x16x32_bf16 v[84:87], a[148:151], v[204:207], v[84:87]
  v_mfma_f32_16x16x32_bf16 v[88:91], a[152:155], v[192:195], v[88:91]
  v_mfma_f32_16x16x32_bf16 v[88:91], a[156:159], v[200:203], v[88:91]
  v_mfma_f32_16x16x32_bf16 v[92:95], a[152:155], v[196:199], v[92:95]
  v_mfma_f32_16x16x32_bf16 v[92:95], a[156:159], v[204:207], v[92:95]
  s_waitcnt vmcnt(19) lgkmcnt(0)
  s_barrier
  v_mfma_f32_16x16x32_bf16 v[16:19], a[0:3], a[160:163], v[16:19]
  s_nop 0
  ds_read_b64_tr_b16 a[80:81], v208 offset:40960
  ds_read_b64_tr_b16 a[82:83], v208 offset:46080
  v_mfma_f32_16x16x32_bf16 v[16:19], a[4:7], a[168:171], v[16:19]
  buffer_load_dwordx4 v[192:195], v1, s[28:31], s68 offen sc1
  v_mfma_f32_16x16x32_bf16 v[20:23], a[0:3], a[164:167], v[20:23]
  s_nop 0
  ds_read_b64_tr_b16 a[84:85], v208 offset:51200
  ds_read_b64_tr_b16 a[86:87], v208 offset:56320
  v_mfma_f32_16x16x32_bf16 v[20:23], a[4:7], a[172:175], v[20:23]
  s_nop 0
  ds_read_b64_tr_b16 a[88:89], v209 offset:40960
  ds_read_b64_tr_b16 a[90:91], v209 offset:46080
  v_mfma_f32_16x16x32_bf16 v[24:27], a[8:11], a[160:163], v[24:27]
  ds_read_b64_tr_b16 a[92:93], v209 offset:51200
  v_mfma_f32_16x16x32_bf16 v[24:27], a[12:15], a[168:171], v[24:27]
  buffer_load_dwordx4 v[196:199], v1, s[28:31], s68 offen offset:1024 sc1
  v_mfma_f32_16x16x32_bf16 v[28:31], a[8:11], a[164:167], v[28:31]
  s_nop 0
  ds_read_b64_tr_b16 a[94:95], v209 offset:56320
  ds_read_b64_tr_b16 a[96:97], v210 offset:40960
  v_mfma_f32_16x16x32_bf16 v[28:31], a[12:15], a[172:175], v[28:31]
  s_nop 0
  ds_read_b64_tr_b16 a[98:99], v210 offset:46080
  ds_read_b64_tr_b16 a[100:101], v210 offset:51200
  v_mfma_f32_16x16x32_bf16 v[32:35], a[16:19], a[160:163], v[32:35]
  ds_read_b64_tr_b16 a[102:103], v210 offset:56320
  v_mfma_f32_16x16x32_bf16 v[32:35], a[20:23], a[168:171], v[32:35]
  buffer_load_dwordx4 v[200:203], v13, s[28:31], s68 offen sc1
  v_mfma_f32_16x16x32_bf16 v[36:39], a[16:19], a[164:167], v[36:39]
  s_nop 0
  ds_read_b64_tr_b16 a[104:105], v211 offset:40960
  ds_read_b64_tr_b16 a[106:107], v211 offset:46080
  v_mfma_f32_16x16x32_bf16 v[36:39], a[20:23], a[172:175], v[36:39]
  s_nop 0
  ds_read_b64_tr_b16 a[108:109], v211 offset:51200
  ds_read_b64_tr_b16 a[110:111], v211 offset:56320
  v_mfma_f32_16x16x32_bf16 v[40:43], a[24:27], a[160:163], v[40:43]
  s_nop 0
  ds_read_b64_tr_b16 a[112:113], v208 offset:43008
  ds_read_b64_tr_b16 a[114:115], v208 offset:48128
  v_mfma_f32_16x16x32_bf16 v[40:43], a[28:31], a[168:171], v[40:43]
  buffer_load_dwordx4 v[204:207], v13, s[28:31], s68 offen offset:1024 sc1
  v_mfma_f32_16x16x32_bf16 v[44:47], a[24:27], a[164:167], v[44:47]
  s_add_u32 s68, s68, 8192
  ds_read_b64_tr_b16 a[116:117], v208 offset:53248
  ds_read_b64_tr_b16 a[118:119], v208 offset:58368
  v_mfma_f32_16x16x32_bf16 v[44:47], a[28:31], a[172:175], v[44:47]
  s_min_u32 s68, s68, s82
  ds_read_b64_tr_b16 a[120:121], v209 offset:43008
  ds_read_b64_tr_b16 a[122:123], v209 offset:48128
  v_mfma_f32_16x16x32_bf16 v[48:51], a[32:35], a[160:163], v[48:51]
  ds_read_b64_tr_b16 a[124:125], v209 offset:53248
  v_mfma_f32_16x16x32_bf16 v[48:51], a[36:39], a[168:171], v[48:51]
  buffer_load_dwordx4 v12, s[12:15], s69 offen lds
  v_mfma_f32_16x16x32_bf16 v[52:55], a[32:35], a[164:167], v[52:55]
  s_add_u32 m0, s71, 0x5400
  ds_read_b64_tr_b16 a[126:127], v209 offset:58368
  ds_read_b64_tr_b16 a[128:129], v210 offset:43008
  v_mfma_f32_16x16x32_bf16 v[52:55], a[36:39], a[172:175], v[52:55]
  s_nop 0
  ds_read_b64_tr_b16 a[130:131], v210 offset:48128
  ds_read_b64_tr_b16 a[132:133], v210 offset:53248
  v_mfma_f32_16x16x32_bf16 v[56:59], a[40:43], a[160:163], v[56:59]
  ds_read_b64_tr_b16 a[134:135], v210 offset:58368
  v_mfma_f32_16x16x32_bf16 v[56:59], a[44:47], a[168:171], v[56:59]
  buffer_load_dwordx4 v12, s[12:15], s57 offen lds
  v_mfma_f32_16x16x32_bf16 v[60:63], a[40:43], a[164:167], v[60:63]
  s_add_u32 m0, s71, 0x5800
  ds_read_b64_tr_b16 a[136:137], v211 offset:43008
  ds_read_b64_tr_b16 a[138:139], v211 offset:48128
  v_mfma_f32_16x16x32_bf16 v[60:63], a[44:47], a[172:175], v[60:63]
  s_add_u32 s57, s69, 0x80
  ds_read_b64_tr_b16 a[140:141], v211 offset:53248
  ds_read_b64_tr_b16 a[142:143], v211 offset:58368
  v_mfma_f32_16x16x32_bf16 v[64:67], a[48:51], a[160:163], v[64:67]
  s_nop 0
  ds_read_b64_tr_b16 a[144:145], v212 offset:40960
  ds_read_b64_tr_b16 a[146:147], v212 offset:46080
  v_mfma_f32_16x16x32_bf16 v[64:67], a[52:55], a[168:171], v[64:67]
  buffer_load_dwordx4 v12, s[12:15], s57 offen lds
  v_mfma_f32_16x16x32_bf16 v[68:71], a[48:51], a[164:167], v[68:71]
  s_add_u32 m0, s71, 0x5c00
  ds_read_b64_tr_b16 a[148:149], v212 offset:51200
  ds_read_b64_tr_b16 a[150:151], v212 offset:56320
  v_mfma_f32_16x16x32_bf16 v[68:71], a[52:55], a[172:175], v[68:71]
  s_add_u32 s57, s69, 0x2880
  ds_read_b64_tr_b16 a[152:153], v213 offset:40960
  ds_read_b64_tr_b16 a[154:155], v213 offset:46080
  v_mfma_f32_16x16x32_bf16 v[72:75], a[56:59], a[160:163], v[72:75]
  ds_read_b64_tr_b16 a[156:157], v213 offset:51200
  v_mfma_f32_16x16x32_bf16 v[72:75], a[60:63], a[168:171], v[72:75]
  buffer_load_dwordx4 v12, s[12:15], s57 offen lds
  v_mfma_f32_16x16x32_bf16 v[76:79], a[56:59], a[164:167], v[76:79]
  s_add_u32 m0, s71, 0x6000
  ds_read_b64_tr_b16 a[158:159], v213 offset:56320
  v_mfma_f32_16x16x32_bf16 v[76:79], a[60:63], a[172:175], v[76:79]
  s_add_u32 s57, s69, s80
  v_mfma_f32_16x16x32_bf16 v[80:83], a[64:67], a[160:163], v[80:83]
  s_mov_b32 s69, s81
  v_mfma_f32_16x16x32_bf16 v[80:83], a[68:71], a[168:171], v[80:83]
  s_add_u32 s58, s69, 0x2800
  buffer_load_dwordx4 v4, s[12:15], s57 offen lds
  v_mfma_f32_16x16x32_bf16 v[84:87], a[64:67], a[164:167], v[84:87]
  s_add_u32 m0, s71, 0xa000
  v_mfma_f32_16x16x32_bf16 v[84:87], a[68:71], a[172:175], v[84:87]
  v_mfma_f32_16x16x32_bf16 v[88:91], a[72:75], a[160:163], v[88:91]
  v_mfma_f32_16x16x32_bf16 v[88:91], a[76:79], a[168:171], v[88:91]
  v_mfma_f32_16x16x32_bf16 v[92:95], a[72:75], a[164:167], v[92:95]
  v_mfma_f32_16x16x32_bf16 v[92:95], a[76:79], a[172:175], v[92:95]
  s_waitcnt vmcnt(19) lgkmcnt(0)
  s_barrier
  v_mfma_f32_16x16x32_bf16 v[16:19], a[80:83], a[176:179], v[16:19]
  s_nop 0
  ds_read_b64_tr_b16 a[0:1], v208
  ds_read_b64_tr_b16 a[2:3], v208 offset:5120
  v_mfma_f32_16x16x32_bf16 v[16:19], a[84:87], a[184:187], v[16:19]
  buffer_load_dwordx4 a[160:163], v1, s[28:31], s68 offen sc1
  v_mfma_f32_16x16x32_bf16 v[20:23], a[80:83], a[180:183], v[20:23]
  s_nop 0
  ds_read_b64_tr_b16 a[4:5], v208 offset:10240
  ds_read_b64_tr_b16 a[6:7], v208 offset:15360
  v_mfma_f32_16x16x32_bf16 v[20:23], a[84:87], a[188:191], v[20:23]
  s_nop 0
  ds_read_b64_tr_b16 a[8:9], v209
  ds_read_b64_tr_b16 a[10:11], v209 offset:5120
  v_mfma_f32_16x16x32_bf16 v[24:27], a[88:91], a[176:179], v[24:27]
  ds_read_b64_tr_b16 a[12:13], v209 offset:10240
  v_mfma_f32_16x16x32_bf16 v[24:27], a[92:95], a[184:187], v[24:27]
  buffer_load_dwordx4 a[164:167], v1, s[28:31], s68 offen offset:1024 sc1
  v_mfma_f32_16x16x32_bf16 v[28:31], a[88:91], a[180:183], v[28:31]
  s_nop 0
  ds_read_b64_tr_b16 a[14:15], v209 offset:15360
  ds_read_b64_tr_b16 a[16:17], v210
  v_mfma_f32_16x16x32_bf16 v[28:31], a[92:95], a[188:191], v[28:31]
  s_nop 0
  ds_read_b64_tr_b16 a[18:19], v210 offset:5120
  ds_read_b64_tr_b16 a[20:21], v210 offset:10240
  v_mfma_f32_16x16x32_bf16 v[32:35], a[96:99], a[176:179], v[32:35]
  ds_read_b64_tr_b16 a[22:23], v210 offset:15360
  v_mfma_f32_16x16x32_bf16 v[32:35], a[100:103], a[184:187], v[32:35]
  buffer_load_dwordx4 a[168:171], v13, s[28:31], s68 offen sc1
  v_mfma_f32_16x16x32_bf16 v[36:39], a[96:99], a[180:183], v[36:39]
  s_nop 0
  ds_read_b64_tr_b16 a[24:25], v211
  ds_read_b64_tr_b16 a[26:27], v211 offset:5120
  v_mfma_f32_16x16x32_bf16 v[36:39], a[100:103], a[188:191], v[36:39]
  s_nop 0
  ds_read_b64_tr_b16 a[28:29], v211 offset:10240
  ds_read_b64_tr_b16 a[30:31], v211 offset:15360
  v_mfma_f32_16x16x32_bf16 v[40:43], a[104:107], a[176:179], v[40:43]
  s_nop 0
  ds_read_b64_tr_b16 a[32:33], v208 offset:2048
  ds_read_b64_tr_b16 a[34:35], v208 offset:7168
  v_mfma_f32_16x16x32_bf16 v[40:43], a[108:111], a[184:187], v[40:43]
  buffer_load_dwordx4 a[172:175], v13, s[28:31], s68 offen offset:1024 sc1
  v_mfma_f32_16x16x32_bf16 v[44:47], a[104:107], a[180:183], v[44:47]
  s_mov_b32 s68, s70
  ds_read_b64_tr_b16 a[36:37], v208 offset:12288
  ds_read_b64_tr_b16 a[38:39], v208 offset:17408
  v_mfma_f32_16x16x32_bf16 v[44:47], a[108:111], a[188:191], v[44:47]
  s_nop 0
  ds_read_b64_tr_b16 a[40:41], v209 offset:2048
  ds_read_b64_tr_b16 a[42:43], v209 offset:7168
  v_mfma_f32_16x16x32_bf16 v[48:51], a[112:115], a[176:179], v[48:51]
  ds_read_b64_tr_b16 a[44:45], v209 offset:12288
  v_mfma_f32_16x16x32_bf16 v[48:51], a[116:119], a[184:187], v[48:51]
  buffer_load_dwordx4 v12, s[8:11], s69 offen lds
  v_mfma_f32_16x16x32_bf16 v[52:55], a[112:115], a[180:183], v[52:55]
  s_add_u32 m0, s71, 0xa400
  ds_read_b64_tr_b16 a[46:47], v209 offset:17408
  ds_read_b64_tr_b16 a[48:49], v210 offset:2048
  v_mfma_f32_16x16x32_bf16 v[52:55], a[116:119], a[188:191], v[52:55]
  s_nop 0
  ds_read_b64_tr_b16 a[50:51], v210 offset:7168
  ds_read_b64_tr_b16 a[52:53], v210 offset:12288
  v_mfma_f32_16x16x32_bf16 v[56:59], a[120:123], a[176:179], v[56:59]
  ds_read_b64_tr_b16 a[54:55], v210 offset:17408
  v_mfma_f32_16x16x32_bf16 v[56:59], a[124:127], a[184:187], v[56:59]
  buffer_load_dwordx4 v12, s[8:11], s58 offen lds
  v_mfma_f32_16x16x32_bf16 v[60:63], a[120:123], a[180:183], v[60:63]
  s_add_u32 m0, s71, 0xa800
  ds_read_b64_tr_b16 a[56:57], v211 offset:2048
  ds_read_b64_tr_b16 a[58:59], v211 offset:7168
  v_mfma_f32_16x16x32_bf16 v[60:63], a[124:127], a[188:191], v[60:63]
  s_add_u32 s58, s69, 0x80
  ds_read_b64_tr_b16 a[60:61], v211 offset:12288
  ds_read_b64_tr_b16 a[62:63], v211 offset:17408
  v_mfma_f32_16x16x32_bf16 v[64:67], a[128:131], a[176:179], v[64:67]
  s_nop 0
  ds_read_b64_tr_b16 a[64:65], v212
  ds_read_b64_tr_b16 a[66:67], v212 offset:5120
  v_mfma_f32_16x16x32_bf16 v[64:67], a[132:135], a[184:187], v[64:67]
  buffer_load_dwordx4 v12, s[8:11], s58 offen lds
  v_mfma_f32_16x16x32_bf16 v[68:71], a[128:131], a[180:183], v[68:71]
  s_add_u32 m0, s71, 0xac00
  ds_read_b64_tr_b16 a[68:69], v212 offset:10240
  ds_read_b64_tr_b16 a[70:71], v212 offset:15360
  v_mfma_f32_16x16x32_bf16 v[68:71], a[132:135], a[188:191], v[68:71]
  s_add_u32 s58, s69, 0x2880
  ds_read_b64_tr_b16 a[72:73], v213
  ds_read_b64_tr_b16 a[74:75], v213 offset:5120
  v_mfma_f32_16x16x32_bf16 v[72:75], a[136:139], a[176:179], v[72:75]
  ds_read_b64_tr_b16 a[76:77], v213 offset:10240
  v_mfma_f32_16x16x32_bf16 v[72:75], a[140:143], a[184:187], v[72:75]
  buffer_load_dwordx4 v12, s[8:11], s58 offen lds
  v_mfma_f32_16x16x32_bf16 v[76:79], a[136:139], a[180:183], v[76:79]
  s_add_u32 m0, s71, 0xb000
  ds_read_b64_tr_b16 a[78:79], v213 offset:15360
  v_mfma_f32_16x16x32_bf16 v[76:79], a[140:143], a[188:191], v[76:79]
  s_add_u32 s58, s69, s80
  v_mfma_f32_16x16x32_bf16 v[80:83], a[144:147], a[176:179], v[80:83]
  s_add_u32 s69, s69, 81920
  v_mfma_f32_16x16x32_bf16 v[80:83], a[148:151], a[184:187], v[80:83]
  s_add_u32 s59, s69, 0x2800
  buffer_load_dwordx4 v4, s[8:11], s58 offen lds
  v_mfma_f32_16x16x32_bf16 v[84:87], a[144:147], a[180:183], v[84:87]
  s_add_u32 m0, s71, 0x0
  v_mfma_f32_16x16x32_bf16 v[84:87], a[148:151], a[188:191], v[84:87]
  v_mfma_f32_16x16x32_bf16 v[88:91], a[152:155], a[176:179], v[88:91]
  v_mfma_f32_16x16x32_bf16 v[88:91], a[156:159], a[184:187], v[88:91]
  v_mfma_f32_16x16x32_bf16 v[92:95], a[152:155], a[180:183], v[92:95]
  v_mfma_f32_16x16x32_bf16 v[92:95], a[156:159], a[188:191], v[92:95]
  s_waitcnt vmcnt(18) lgkmcnt(0)
  s_barrier
  v_mfma_f32_16x16x32_bf16 v[16:19], a[0:3], v[176:179], v[16:19]
  s_nop 0
  ds_read_b64_tr_b16 a[80:81], v214
  ds_read_b64_tr_b16 a[82:83], v214 offset:5120
  v_mfma_f32_16x16x32_bf16 v[16:19], a[4:7], v[184:187], v[16:19]
  buffer_load_dwordx4 v12, s[8:11], s69 offen lds
  v_mfma_f32_16x16x32_bf16 v[20:23], a[0:3], v[180:183], v[20:23]
  s_add_u32 m0, s71, 0x400
  ds_read_b64_tr_b16 a[84:85], v214 offset:10240
  ds_read_b64_tr_b16 a[86:87], v214 offset:15360
  v_mfma_f32_16x16x32_bf16 v[20:23], a[4:7], v[188:191], v[20:23]
  s_nop 0
  ds_read_b64_tr_b16 a[88:89], v215
  ds_read_b64_tr_b16 a[90:91], v215 offset:5120
  v_mfma_f32_16x16x32_bf16 v[24:27], a[8:11], v[176:179], v[24:27]
  ds_read_b64_tr_b16 a[92:93], v215 offset:10240
  v_mfma_f32_16x16x32_bf16 v[24:27], a[12:15], v[184:187], v[24:27]
  buffer_load_dwordx4 v12, s[8:11], s59 offen lds
  v_mfma_f32_16x16x32_bf16 v[28:31], a[8:11], v[180:183], v[28:31]
  s_add_u32 m0, s71, 0x800
  ds_read_b64_tr_b16 a[94:95], v215 offset:15360
  ds_read_b64_tr_b16 a[96:97], v216
  v_mfma_f32_16x16x32_bf16 v[28:31], a[12:15], v[188:191], v[28:31]
  s_add_u32 s59, s69, 0x80
  ds_read_b64_tr_b16 a[98:99], v216 offset:5120
  ds_read_b64_tr_b16 a[100:101], v216 offset:10240
  v_mfma_f32_16x16x32_bf16 v[32:35], a[16:19], v[176:179], v[32:35]
  ds_read_b64_tr_b16 a[102:103], v216 offset:15360
  v_mfma_f32_16x16x32_bf16 v[32:35], a[20:23], v[184:187], v[32:35]
  buffer_load_dwordx4 v12, s[8:11], s59 offen lds
  v_mfma_f32_16x16x32_bf16 v[36:39], a[16:19], v[180:183], v[36:39]
  s_add_u32 m0, s71, 0xc00
  ds_read_b64_tr_b16 a[104:105], v217
  ds_read_b64_tr_b16 a[106:107], v217 offset:5120
  v_mfma_f32_16x16x32_bf16 v[36:39], a[20:23], v[188:191], v[36:39]
  s_add_u32 s59, s69, 0x2880
  ds_read_b64_tr_b16 a[108:109], v217 offset:10240
  ds_read_b64_tr_b16 a[110:111], v217 offset:15360
  v_mfma_f32_16x16x32_bf16 v[40:43], a[24:27], v[176:179], v[40:43]
  s_nop 0
  ds_read_b64_tr_b16 a[112:113], v214 offset:2048
  ds_read_b64_tr_b16 a[114:115], v214 offset:7168
  v_mfma_f32_16x16x32_bf16 v[40:43], a[28:31], v[184:187], v[40:43]
  buffer_load_dwordx4 v12, s[8:11], s59 offen lds
  v_mfma_f32_16x16x32_bf16 v[44:47], a[24:27], v[180:183], v[44:47]
  s_add_u32 m0, s71, 0x1000
  ds_read_b64_tr_b16 a[116:117], v214 offset:12288
  ds_read_b64_tr_b16 a[118:119], v214 offset:17408
  v_mfma_f32_16x16x32_bf16 v[44:47], a[28:31], v[188:191], v[44:47]
  s_add_u32 s59, s69, s80
  ds_read_b64_tr_b16 a[120:121], v215 offset:2048
  ds_read_b64_tr_b16 a[122:123], v215 offset:7168
  v_mfma_f32_16x16x32_bf16 v[48:51], a[32:35], v[176:179], v[48:51]
  s_add_u32 s69, s69, 81920
  ds_read_b64_tr_b16 a[124:125], v215 offset:12288
  v_mfma_f32_16x16x32_bf16 v[48:51], a[36:39], v[184:187], v[48:51]
  s_add_u32 s56, s69, 0x2800
  buffer_load_dwordx4 v4, s[8:11], s59 offen lds
  v_mfma_f32_16x16x32_bf16 v[52:55], a[32:35], v[180:183], v[52:55]
  s_add_u32 m0, s71, 0x20000
  ds_read_b64_tr_b16 a[126:127], v215 offset:17408
  ds_read_b64_tr_b16 a[128:129], v216 offset:2048
  v_mfma_f32_16x16x32_bf16 v[52:55], a[36:39], v[188:191], v[52:55]
  s_nop 0
  ds_read_b64_tr_b16 a[130:131], v216 offset:7168
  ds_read_b64_tr_b16 a[132:133], v216 offset:12288
  v_mfma_f32_16x16x32_bf16 v[56:59], a[40:43], v[176:179], v[56:59]
  ds_read_b64_tr_b16 a[134:135], v216 offset:17408
  v_mfma_f32_16x16x32_bf16 v[56:59], a[44:47], v[184:187], v[56:59]
  s_nop 0
  ds_read_b64_tr_b16 a[136:137], v217 offset:2048
  ds_read_b64_tr_b16 a[138:139], v217 offset:7168
  v_mfma_f32_16x16x32_bf16 v[60:63], a[40:43], v[180:183], v[60:63]
  ds_read_b64_tr_b16 a[140:141], v217 offset:12288
  v_mfma_f32_16x16x32_bf16 v[60:63], a[44:47], v[188:191], v[60:63]
  ds_read_b64_tr_b16 a[142:143], v217 offset:17408
  v_mfma_f32_16x16x32_bf16 v[64:67], a[48:51], v[176:179], v[64:67]
  s_nop 0
  ds_read_b64_tr_b16 a[144:145], v218
  ds_read_b64_tr_b16 a[146:147], v218 offset:5120
  v_mfma_f32_16x16x32_bf16 v[64:67], a[52:55], v[184:187], v[64:67]
  ds_read_b64_tr_b16 a[148:149], v218 offset:10240
  v_mfma_f32_16x16x32_bf16 v[68:71], a[48:51], v[180:183], v[68:71]
  ds_read_b64_tr_b16 a[150:151], v218 offset:15360
  v_mfma_f32_16x16x32_bf16 v[68:71], a[52:55], v[188:191], v[68:71]
  s_nop 0
  ds_read_b64_tr_b16 a[152:153], v219
  ds_read_b64_tr_b16 a[154:155], v219 offset:5120
  v_mfma_f32_16x16x32_bf16 v[72:75], a[56:59], v[176:179], v[72:75]
  ds_read_b64_tr_b16 a[156:157], v219 offset:10240
  v_mfma_f32_16x16x32_bf16 v[72:75], a[60:63], v[184:187], v[72:75]
  ds_read_b64_tr_b16 a[158:159], v219 offset:15360
  v_mfma_f32_16x16x32_bf16 v[76:79], a[56:59], v[180:183], v[76:79]
  v_mfma_f32_16x16x32_bf16 v[76:79], a[60:63], v[188:191], v[76:79]
  v_mfma_f32_16x16x32_bf16 v[80:83], a[64:67], v[176:179], v[80:83]
  v_mfma_f32_16x16x32_bf16 v[80:83], a[68:71], v[184:187], v[80:83]
  v_mfma_f32_16x16x32_bf16 v[84:87], a[64:67], v[180:183], v[84:87]
  v_mfma_f32_16x16x32_bf16 v[84:87], a[68:71], v[188:191], v[84:87]
  v_mfma_f32_16x16x32_bf16 v[88:91], a[72:75], v[176:179], v[88:91]
  v_mfma_f32_16x16x32_bf16 v[88:91], a[76:79], v[184:187], v[88:91]
  v_mfma_f32_16x16x32_bf16 v[92:95], a[72:75], v[180:183], v[92:95]
  v_mfma_f32_16x16x32_bf16 v[92:95], a[76:79], v[188:191], v[92:95]
  s_waitcnt vmcnt(14) lgkmcnt(0)
  s_barrier
  v_mfma_f32_16x16x32_bf16 v[16:19], a[80:83], v[192:195], v[16:19]
  s_nop 0
  ds_read_b64_tr_b16 a[0:1], v208 offset:20480
  ds_read_b64_tr_b16 a[2:3], v208 offset:25600
  v_mfma_f32_16x16x32_bf16 v[16:19], a[84:87], v[200:203], v[16:19]
  buffer_load_dwordx4 v12, s[8:11], s69 offen lds
  v_mfma_f32_16x16x32_bf16 v[20:23], a[80:83], v[196:199], v[20:23]
  s_add_u32 m0, s71, 0x20400
  ds_read_b64_tr_b16 a[4:5], v208 offset:30720
  ds_read_b64_tr_b16 a[6:7], v208 offset:35840
  v_mfma_f32_16x16x32_bf16 v[20:23], a[84:87], v[204:207], v[20:23]
  s_nop 0
  ds_read_b64_tr_b16 a[8:9], v209 offset:20480
  ds_read_b64_tr_b16 a[10:11], v209 offset:25600
  v_mfma_f32_16x16x32_bf16 v[24:27], a[88:91], v[192:195], v[24:27]
  ds_read_b64_tr_b16 a[12:13], v209 offset:30720
  v_mfma_f32_16x16x32_bf16 v[24:27], a[92:95], v[200:203], v[24:27]
  buffer_load_dwordx4 v12, s[8:11], s56 offen lds
  v_mfma_f32_16x16x32_bf16 v[28:31], a[88:91], v[196:199], v[28:31]
  s_add_u32 m0, s71, 0x20800
  ds_read_b64_tr_b16 a[14:15], v209 offset:35840
  ds_read_b64_tr_b16 a[16:17], v210 offset:20480
  v_mfma_f32_16x16x32_bf16 v[28:31], a[92:95], v[204:207], v[28:31]
  s_add_u32 s56, s69, 0x80
  ds_read_b64_tr_b16 a[18:19], v210 offset:25600
  ds_read_b64_tr_b16 a[20:21], v210 offset:30720
  v_mfma_f32_16x16x32_bf16 v[32:35], a[96:99], v[192:195], v[32:35]
  ds_read_b64_tr_b16 a[22:23], v210 offset:35840
  v_mfma_f32_16x16x32_bf16 v[32:35], a[100:103], v[200:203], v[32:35]
  buffer_load_dwordx4 v12, s[8:11], s56 offen lds
  v_mfma_f32_16x16x32_bf16 v[36:39], a[96:99], v[196:199], v[36:39]
  s_add_u32 m0, s71, 0x20c00
  ds_read_b64_tr_b16 a[24:25], v211 offset:20480
  ds_read_b64_tr_b16 a[26:27], v211 offset:25600
  v_mfma_f32_16x16x32_bf16 v[36:39], a[100:103], v[204:207], v[36:39]
  s_add_u32 s56, s69, 0x2880
  ds_read_b64_tr_b16 a[28:29], v211 offset:30720
  ds_read_b64_tr_b16 a[30:31], v211 offset:35840
  v_mfma_f32_16x16x32_bf16 v[40:43], a[104:107], v[192:195], v[40:43]
  s_nop 0
  ds_read_b64_tr_b16 a[32:33], v208 offset:22528
  ds_read_b64_tr_b16 a[34:35], v208 offset:27648
  v_mfma_f32_16x16x32_bf16 v[40:43], a[108:111], v[200:203], v[40:43]
  buffer_load_dwordx4 v12, s[8:11], s56 offen lds
  v_mfma_f32_16x16x32_bf16 v[44:47], a[104:107], v[196:199], v[44:47]
  s_add_u32 m0, s71, 0x21000
  ds_read_b64_tr_b16 a[36:37], v208 offset:32768
  ds_read_b64_tr_b16 a[38:39], v208 offset:37888
  v_mfma_f32_16x16x32_bf16 v[44:47], a[108:111], v[204:207], v[44:47]
  s_add_u32 s56, s69, s80
  ds_read_b64_tr_b16 a[40:41], v209 offset:22528
  ds_read_b64_tr_b16 a[42:43], v209 offset:27648
  v_mfma_f32_16x16x32_bf16 v[48:51], a[112:115], v[192:195], v[48:51]
  s_add_u32 s69, s69, 81920
  ds_read_b64_tr_b16 a[44:45], v209 offset:32768
  v_mfma_f32_16x16x32_bf16 v[48:51], a[116:119], v[200:203], v[48:51]
  s_add_u32 s57, s69, 0x2800
  buffer_load_dwordx4 v4, s[8:11], s56 offen lds
  v_mfma_f32_16x16x32_bf16 v[52:55], a[112:115], v[196:199], v[52:55]
  s_add_u32 m0, s71, 0x5000
  ds_read_b64_tr_b16 a[46:47], v209 offset:37888
  ds_read_b64_tr_b16 a[48:49], v210 offset:22528
  v_mfma_f32_16x16x32_bf16 v[52:55], a[116:119], v[204:207], v[52:55]
  s_nop 0
  ds_read_b64_tr_b16 a[50:51], v210 offset:27648
  ds_read_b64_tr_b16 a[52:53], v210 offset:32768
  v_mfma_f32_16x16x32_bf16 v[56:59], a[120:123], v[192:195], v[56:59]
  ds_read_b64_tr_b16 a[54:55], v210 offset:37888
  v_mfma_f32_16x16x32_bf16 v[56:59], a[124:127], v[200:203], v[56:59]
  s_nop 0
  ds_read_b64_tr_b16 a[56:57], v211 offset:22528
  ds_read_b64_tr_b16 a[58:59], v211 offset:27648
  v_mfma_f32_16x16x32_bf16 v[60:63], a[120:123], v[196:199], v[60:63]
  buffer_load_dword v110, v111, s[28:31], s73 offen sc1
  v_mfma_f32_16x16x32_bf16 v[60:63], a[124:127], v[204:207], v[60:63]
  s_nop 0
  ds_read_b64_tr_b16 a[60:61], v211 offset:32768
  ds_read_b64_tr_b16 a[62:63], v211 offset:37888
  v_mfma_f32_16x16x32_bf16 v[64:67], a[128:131], v[192:195], v[64:67]
  s_nop 0
  ds_read_b64_tr_b16 a[64:65], v212 offset:20480
  ds_read_b64_tr_b16 a[66:67], v212 offset:25600
  v_mfma_f32_16x16x32_bf16 v[64:67], a[132:135], v[200:203], v[64:67]
  ds_read_b64_tr_b16 a[68:69], v212 offset:30720
  v_mfma_f32_16x16x32_bf16 v[68:71], a[128:131], v[196:199], v[68:71]
  ds_read_b64_tr_b16 a[70:71], v212 offset:35840
  v_mfma_f32_16x16x32_bf16 v[68:71], a[132:135], v[204:207], v[68:71]
  s_nop 0
  ds_read_b64_tr_b16 a[72:73], v213 offset:20480
  ds_read_b64_tr_b16 a[74:75], v213 offset:25600
  v_mfma_f32_16x16x32_bf16 v[72:75], a[136:139], v[192:195], v[72:75]
  ds_read_b64_tr_b16 a[76:77], v213 offset:30720
  v_mfma_f32_16x16x32_bf16 v[72:75], a[140:143], v[200:203], v[72:75]
  ds_read_b64_tr_b16 a[78:79], v213 offset:35840
  v_mfma_f32_16x16x32_bf16 v[76:79], a[136:139], v[196:199], v[76:79]
  v_mfma_f32_16x16x32_bf16 v[76:79], a[140:143], v[204:207], v[76:79]
  v_mfma_f32_16x16x32_bf16 v[80:83], a[144:147], v[192:195], v[80:83]
  v_mfma_f32_16x16x32_bf16 v[80:83], a[148:151], v[200:203], v[80:83]
  v_mfma_f32_16x16x32_bf16 v[84:87], a[144:147], v[196:199], v[84:87]
  v_mfma_f32_16x16x32_bf16 v[84:87], a[148:151], v[204:207], v[84:87]
  v_mfma_f32_16x16x32_bf16 v[88:91], a[152:155], v[192:195], v[88:91]
  v_mfma_f32_16x16x32_bf16 v[88:91], a[156:159], v[200:203], v[88:91]
  v_mfma_f32_16x16x32_bf16 v[92:95], a[152:155], v[196:199], v[92:95]
  v_mfma_f32_16x16x32_bf16 v[92:95], a[156:159], v[204:207], v[92:95]
  s_waitcnt vmcnt(0) lgkmcnt(0)
  s_barrier
  v_readfirstlane_b32 s43, v110
  s_nop 3
  s_cmp_ge_u32 s43, 32
  s_cbranch_scc1 L_pd_D
  v_mov_b32 v111, 0
  s_mov_b32 s45, 0x30d40
L_poll_D:
  buffer_load_dword v110, v111, s[28:31], s73 offen sc1
  s_waitcnt vmcnt(0)
  v_readfirstlane_b32 s43, v110
  s_nop 3
  s_cmp_ge_u32 s43, 32
  s_cbranch_scc1 L_pd_D
  s_sleep 6
  s_sub_u32 s45, s45, 1
  s_cmp_lg_u32 s45, 0
  s_cbranch_scc1 L_poll_D
L_pd_D:
  v_mfma_f32_16x16x32_bf16 v[16:19], a[0:3], a[160:163], v[16:19]
  buffer_load_dwordx4 a[176:179], v1, s[28:31], s68 offen sc1
  v_mfma_f32_16x16x32_bf16 v[16:19], a[4:7], a[168:171], v[16:19]
  buffer_load_dwordx4 a[180:183], v1, s[28:31], s68 offen offset:1024 sc1
  v_mfma_f32_16x16x32_bf16 v[20:23], a[0:3], a[164:167], v[20:23]
  buffer_load_dwordx4 a[184:187], v13, s[28:31], s68 offen sc1
  v_mfma_f32_16x16x32_bf16 v[20:23], a[4:7], a[172:175], v[20:23]
  buffer_load_dwordx4 a[188:191], v13, s[28:31], s68 offen offset:1024 sc1
  v_mfma_f32_16x16x32_bf16 v[24:27], a[8:11], a[160:163], v[24:27]
  s_add_u32 s68, s68, 8192
  buffer_load_dwordx4 v[176:179], v1, s[28:31], s68 offen sc1
  v_mfma_f32_16x16x32_bf16 v[24:27], a[12:15], a[168:171], v[24:27]
  buffer_load_dwordx4 v[180:183], v1, s[28:31], s68 offen offset:1024 sc1
  v_mfma_f32_16x16x32_bf16 v[28:31], a[8:11], a[164:167], v[28:31]
  buffer_load_dwordx4 v[184:187], v13, s[28:31], s68 offen sc1
  v_mfma_f32_16x16x32_bf16 v[28:31], a[12:15], a[172:175], v[28:31]
  buffer_load_dwordx4 v[188:191], v13, s[28:31], s68 offen offset:1024 sc1
  v_mfma_f32_16x16x32_bf16 v[32:35], a[16:19], a[160:163], v[32:35]
  s_add_u32 s68, s68, 8192
  ds_read_b64_tr_b16 a[80:81], v208 offset:40960
  ds_read_b64_tr_b16 a[82:83], v208 offset:46080
  v_mfma_f32_16x16x32_bf16 v[32:35], a[20:23], a[168:171], v[32:35]
  buffer_load_dwordx4 v[192:195], v1, s[28:31], s68 offen sc1
  v_mfma_f32_16x16x32_bf16 v[36:39], a[16:19], a[164:167], v[36:39]
  s_nop 0
  ds_read_b64_tr_b16 a[84:85], v208 offset:51200
  ds_read_b64_tr_b16 a[86:87], v208 offset:56320
  v_mfma_f32_16x16x32_bf16 v[36:39], a[20:23], a[172:175], v[36:39]
  s_nop 0
  ds_read_b64_tr_b16 a[88:89], v209 offset:40960
  ds_read_b64_tr_b16 a[90:91], v209 offset:46080
  v_mfma_f32_16x16x32_bf16 v[40:43], a[24:27], a[160:163], v[40:43]
  buffer_load_dwordx4 v[196:199], v1, s[28:31], s68 offen offset:1024 sc1
  v_mfma_f32_16x16x32_bf16 v[40:43], a[28:31], a[168:171], v[40:43]
  s_nop 0
  ds_read_b64_tr_b16 a[92:93], v209 offset:51200
  ds_read_b64_tr_b16 a[94:95], v209 offset:56320
  v_mfma_f32_16x16x32_bf16 v[44:47], a[24:27], a[164:167], v[44:47]
  s_nop 0
  ds_read_b64_tr_b16 a[96:97], v210 offset:40960
  ds_read_b64_tr_b16 a[98:99], v210 offset:46080
  v_mfma_f32_16x16x32_bf16 v[44:47], a[28:31], a[172:175], v[44:47]
  buffer_load_dwordx4 v[200:203], v13, s[28:31], s68 offen sc1
  v_mfma_f32_16x16x32_bf16 v[48:51], a[32:35], a[160:163], v[48:51]
  s_nop 0
  ds_read_b64_tr_b16 a[100:101], v210 offset:51200
  ds_read_b64_tr_b16 a[102:103], v210 offset:56320
  v_mfma_f32_16x16x32_bf16 v[48:51], a[36:39], a[168:171], v[48:51]
  s_nop 0
  ds_read_b64_tr_b16 a[104:105], v211 offset:40960
  ds_read_b64_tr_b16 a[106:107], v211 offset:46080
  v_mfma_f32_16x16x32_bf16 v[52:55], a[32:35], a[164:167], v[52:55]
  buffer_load_dwordx4 v[204:207], v13, s[28:31], s68 offen offset:1024 sc1
  v_mfma_f32_16x16x32_bf16 v[52:55], a[36:39], a[172:175], v[52:55]
  s_add_u32 s68, s68, 8192
  ds_read_b64_tr_b16 a[108:109], v211 offset:51200
  ds_read_b64_tr_b16 a[110:111], v211 offset:56320
  v_mfma_f32_16x16x32_bf16 v[56:59], a[40:43], a[160:163], v[56:59]
  s_nop 0
  ds_read_b64_tr_b16 a[112:113], v208 offset:43008
  ds_read_b64_tr_b16 a[114:115], v208 offset:48128
  v_mfma_f32_16x16x32_bf16 v[56:59], a[44:47], a[168:171], v[56:59]
  buffer_load_dwordx4 v12, s[8:11], s69 offen lds
  v_mfma_f32_16x16x32_bf16 v[60:63], a[40:43], a[164:167], v[60:63]
  s_add_u32 m0, s71, 0x5400
  ds_read_b64_tr_b16 a[116:117], v208 offset:53248
  ds_read_b64_tr_b16 a[118:119], v208 offset:58368
  v_mfma_f32_16x16x32_bf16 v[60:63], a[44:47], a[172:175], v[60:63]
  s_nop 0
  ds_read_b64_tr_b16 a[120:121], v209 offset:43008
  ds_read_b64_tr_b16 a[122:123], v209 offset:48128
  v_mfma_f32_16x16x32_bf16 v[64:67], a[48:51], a[160:163], v[64:67]
  buffer_load_dwordx4 v12, s[8:11], s57 offen lds
  v_mfma_f32_16x16x32_bf16 v[64:67], a[52:55], a[168:171], v[64:67]
  s_add_u32 m0, s71, 0x5800
  ds_read_b64_tr_b16 a[124:125], v209 offset:53248
  ds_read_b64_tr_b16 a[126:127], v209 offset:58368
  v_mfma_f32_16x16x32_bf16 v[68:71], a[48:51], a[164:167], v[68:71]
  s_add_u32 s57, s69, 0x80
  ds_read_b64_tr_b16 a[128:129], v210 offset:43008
  ds_read_b64_tr_b16 a[130:131], v210 offset:48128
  v_mfma_f32_16x16x32_bf16 v[68:71], a[52:55], a[172:175], v[68:71]
  buffer_load_dwordx4 v12, s[8:11], s57 offen lds
  v_mfma_f32_16x16x32_bf16 v[72:75], a[56:59], a[160:163], v[72:75]
  s_add_u32 m0, s71, 0x5c00
  ds_read_b64_tr_b16 a[132:133], v210 offset:53248
  ds_read_b64_tr_b16 a[134:135], v210 offset:58368
  v_mfma_f32_16x16x32_bf16 v[72:75], a[60:63], a[168:171], v[72:75]
  s_add_u32 s57, s69, 0x2880
  ds_read_b64_tr_b16 a[136:137], v211 offset:43008
  ds_read_b64_tr_b16 a[138:139], v211 offset:48128
  v_mfma_f32_16x16x32_bf16 v[76:79], a[56:59], a[164:167], v[76:79]
  buffer_load_dwordx4 v12, s[8:11], s57 offen lds
  v_mfma_f32_16x16x32_bf16 v[76:79], a[60:63], a[172:175], v[76:79]
  s_add_u32 m0, s71, 0x6000
  ds_read_b64_tr_b16 a[140:141], v211 offset:53248
  ds_read_b64_tr_b16 a[142:143], v211 offset:58368
  v_mfma_f32_16x16x32_bf16 v[80:83], a[64:67], a[160:163], v[80:83]
  s_add_u32 s57, s69, s80
  ds_read_b64_tr_b16 a[144:145], v212 offset:40960
  ds_read_b64_tr_b16 a[146:147], v212 offset:46080
  v_mfma_f32_16x16x32_bf16 v[80:83], a[68:71], a[168:171], v[80:83]
  s_add_u32 s69, s69, 81920
  buffer_load_dwordx4 v4, s[8:11], s57 offen lds
  v_mfma_f32_16x16x32_bf16 v[84:87], a[64:67], a[164:167], v[84:87]
  s_add_u32 m0, s71, 0xa000
  ds_read_b64_tr_b16 a[148:149], v212 offset:51200
  ds_read_b64_tr_b16 a[150:151], v212 offset:56320
  v_mfma_f32_16x16x32_bf16 v[84:87], a[68:71], a[172:175], v[84:87]
  s_add_u32 s58, s69, 0x2800
  ds_read_b64_tr_b16 a[152:153], v213 offset:40960
  ds_read_b64_tr_b16 a[154:155], v213 offset:46080
  v_mfma_f32_16x16x32_bf16 v[88:91], a[72:75], a[160:163], v[88:91]
  s_nop 0
  ds_read_b64_tr_b16 a[156:157], v213 offset:51200
  ds_read_b64_tr_b16 a[158:159], v213 offset:56320
  v_mfma_f32_16x16x32_bf16 v[88:91], a[76:79], a[168:171], v[88:91]
  v_mfma_f32_16x16x32_bf16 v[92:95], a[72:75], a[164:167], v[92:95]
  v_mfma_f32_16x16x32_bf16 v[92:95], a[76:79], a[172:175], v[92:95]
  s_waitcnt vmcnt(13) lgkmcnt(0)
  s_barrier
  v_mfma_f32_16x16x32_bf16 v[16:19], a[80:83], a[176:179], v[16:19]
  s_nop 0
  ds_read_b64_tr_b16 a[0:1], v208
  ds_read_b64_tr_b16 a[2:3], v208 offset:5120
  v_mfma_f32_16x16x32_bf16 v[16:19], a[84:87], a[184:187], v[16:19]
  buffer_load_dwordx4 a[160:163], v1, s[28:31], s68 offen sc1
  v_mfma_f32_16x16x32_bf16 v[20:23], a[80:83], a[180:183], v[20:23]
  s_nop 0
  ds_read_b64_tr_b16 a[4:5], v208 offset:10240
  ds_read_b64_tr_b16 a[6:7], v208 offset:15360
  v_mfma_f32_16x16x32_bf16 v[20:23], a[84:87], a[188:191], v[20:23]
  s_nop 0
  ds_read_b64_tr_b16 a[8:9], v209
  ds_read_b64_tr_b16 a[10:11], v209 offset:5120
  v_mfma_f32_16x16x32_bf16 v[24:27], a[88:91], a[176:179], v[24:27]
  ds_read_b64_tr_b16 a[12:13], v209 offset:10240
  v_mfma_f32_16x16x32_bf16 v[24:27], a[92:95], a[184:187], v[24:27]
  buffer_load_dwordx4 a[164:167], v1, s[28:31], s68 offen offset:1024 sc1
  v_mfma_f32_16x16x32_bf16 v[28:31], a[88:91], a[180:183], v[28:31]
  s_nop 0
  ds_read_b64_tr_b16 a[14:15], v209 offset:15360
  ds_read_b64_tr_b16 a[16:17], v210
  v_mfma_f32_16x16x32_bf16 v[28:31], a[92:95], a[188:191], v[28:31]
  s_nop 0
  ds_read_b64_tr_b16 a[18:19], v210 offset:5120
  ds_read_b64_tr_b16 a[20:21], v210 offset:10240
  v_mfma_f32_16x16x32_bf16 v[32:35], a[96:99], a[176:179], v[32:35]
  ds_read_b64_tr_b16 a[22:23], v210 offset:15360
  v_mfma_f32_16x16x32_bf16 v[32:35], a[100:103], a[184:187], v[32:35]
  buffer_load_dwordx4 a[168:171], v13, s[28:31], s68 offen sc1
  v_mfma_f32_16x16x32_bf16 v[36:39], a[96:99], a[180:183], v[36:39]
  s_nop 0
  ds_read_b64_tr_b16 a[24:25], v211
  ds_read_b64_tr_b16 a[26:27], v211 offset:5120
  v_mfma_f32_16x16x32_bf16 v[36:39], a[100:103], a[188:191], v[36:39]
  s_nop 0
  ds_read_b64_tr_b16 a[28:29], v211 offset:10240
  ds_read_b64_tr_b16 a[30:31], v211 offset:15360
  v_mfma_f32_16x16x32_bf16 v[40:43], a[104:107], a[176:179], v[40:43]
  s_nop 0
  ds_read_b64_tr_b16 a[32:33], v208 offset:2048
  ds_read_b64_tr_b16 a[34:35], v208 offset:7168
  v_mfma_f32_16x16x32_bf16 v[40:43], a[108:111], a[184:187], v[40:43]
  buffer_load_dwordx4 a[172:175], v13, s[28:31], s68 offen offset:1024 sc1
  v_mfma_f32_16x16x32_bf16 v[44:47], a[104:107], a[180:183], v[44:47]
  s_add_u32 s68, s68, 8192
  ds_read_b64_tr_b16 a[36:37], v208 offset:12288
  ds_read_b64_tr_b16 a[38:39], v208 offset:17408
  v_mfma_f32_16x16x32_bf16 v[44:47], a[108:111], a[188:191], v[44:47]
  s_nop 0
  ds_read_b64_tr_b16 a[40:41], v209 offset:2048
  ds_read_b64_tr_b16 a[42:43], v209 offset:7168
  v_mfma_f32_16x16x32_bf16 v[48:51], a[112:115], a[176:179], v[48:51]
  ds_read_b64_tr_b16 a[44:45], v209 offset:12288
  v_mfma_f32_16x16x32_bf16 v[48:51], a[116:119], a[184:187], v[48:51]
  buffer_load_dwordx4 v12, s[8:11], s69 offen lds
  v_mfma_f32_16x16x32_bf16 v[52:55], a[112:115], a[180:183], v[52:55]
  s_add_u32 m0, s71, 0xa400
  ds_read_b64_tr_b16 a[46:47], v209 offset:17408
  ds_read_b64_tr_b16 a[48:49], v210 offset:2048
  v_mfma_f32_16x16x32_bf16 v[52:55], a[116:119], a[188:191], v[52:55]
  s_nop 0
  ds_read_b64_tr_b16 a[50:51], v210 offset:7168
  ds_read_b64_tr_b16 a[52:53], v210 offset:12288
  v_mfma_f32_16x16x32_bf16 v[56:59], a[120:123], a[176:179], v[56:59]
  ds_read_b64_tr_b16 a[54:55], v210 offset:17408
  v_mfma_f32_16x16x32_bf16 v[56:59], a[124:127], a[184:187], v[56:59]
  buffer_load_dwordx4 v12, s[8:11], s58 offen lds
  v_mfma_f32_16x16x32_bf16 v[60:63], a[120:123], a[180:183], v[60:63]
  s_add_u32 m0, s71, 0xa800
  ds_read_b64_tr_b16 a[56:57], v211 offset:2048
  ds_read_b64_tr_b16 a[58:59], v211 offset:7168
  v_mfma_f32_16x16x32_bf16 v[60:63], a[124:127], a[188:191], v[60:63]
  s_add_u32 s58, s69, 0x80
  ds_read_b64_tr_b16 a[60:61], v211 offset:12288
  ds_read_b64_tr_b16 a[62:63], v211 offset:17408
  v_mfma_f32_16x16x32_bf16 v[64:67], a[128:131], a[176:179], v[64:67]
  s_nop 0
  ds_read_b64_tr_b16 a[64:65], v212
  ds_read_b64_tr_b16 a[66:67], v212 offset:5120
  v_mfma_f32_16x16x32_bf16 v[64:67], a[132:135], a[184:187], v[64:67]
  buffer_load_dwordx4 v12, s[8:11], s58 offen lds
  v_mfma_f32_16x16x32_bf16 v[68:71], a[128:131], a[180:183], v[68:71]
  s_add_u32 m0, s71, 0xac00
  ds_read_b64_tr_b16 a[68:69], v212 offset:10240
  ds_read_b64_tr_b16 a[70:71], v212 offset:15360
  v_mfma_f32_16x16x32_bf16 v[68:71], a[132:135], a[188:191], v[68:71]
  s_add_u32 s58, s69, 0x2880
  ds_read_b64_tr_b16 a[72:73], v213
  ds_read_b64_tr_b16 a[74:75], v213 offset:5120
  v_mfma_f32_16x16x32_bf16 v[72:75], a[136:139], a[176:179], v[72:75]
  ds_read_b64_tr_b16 a[76:77], v213 offset:10240
  v_mfma_f32_16x16x32_bf16 v[72:75], a[140:143], a[184:187], v[72:75]
  buffer_load_dwordx4 v12, s[8:11], s58 offen lds
  v_mfma_f32_16x16x32_bf16 v[76:79], a[136:139], a[180:183], v[76:79]
  s_add_u32 m0, s71, 0xb000
  ds_read_b64_tr_b16 a[78:79], v213 offset:15360
  v_mfma_f32_16x16x32_bf16 v[76:79], a[140:143], a[188:191], v[76:79]
  s_add_u32 s58, s69, s80
  v_mfma_f32_16x16x32_bf16 v[80:83], a[144:147], a[176:179], v[80:83]
  s_add_u32 s69, s69, 81920
  v_mfma_f32_16x16x32_bf16 v[80:83], a[148:151], a[184:187], v[80:83]
  buffer_load_dwordx4 v4, s[8:11], s58 offen lds
  v_mfma_f32_16x16x32_bf16 v[84:87], a[144:147], a[180:183], v[84:87]
  v_mfma_f32_16x16x32_bf16 v[84:87], a[148:151], a[188:191], v[84:87]
  v_mfma_f32_16x16x32_bf16 v[88:91], a[152:155], a[176:179], v[88:91]
  v_mfma_f32_16x16x32_bf16 v[88:91], a[156:159], a[184:187], v[88:91]
  v_mfma_f32_16x16x32_bf16 v[92:95], a[152:155], a[180:183], v[92:95]
  v_mfma_f32_16x16x32_bf16 v[92:95], a[156:159], a[188:191], v[92:95]
  s_nop 0
L_k3_loop:
  s_waitcnt vmcnt(18) lgkmcnt(0)
  s_barrier
  v_mfma_f32_16x16x32_bf16 v[16:19], a[0:3], v[176:179], v[16:19]
  s_add_u32 m0, s71, 0x0
  ds_read_b64_tr_b16 a[80:81], v214
  ds_read_b64_tr_b16 a[82:83], v214 offset:5120
  v_mfma_f32_16x16x32_bf16 v[16:19], a[4:7], v[184:187], v[16:19]
  s_add_u32 s59, s69, 0x2800
  buffer_load_dwordx4 a[176:179], v1, s[28:31], s68 offen sc1
  v_mfma_f32_16x16x32_bf16 v[20:23], a[0:3], v[180:183], v[20:23]
  s_nop 0
  ds_read_b64_tr_b16 a[84:85], v214 offset:10240
  ds_read_b64_tr_b16 a[86:87], v214 offset:15360
  v_mfma_f32_16x16x32_bf16 v[20:23], a[4:7], v[188:191], v[20:23]
  s_nop 0
  ds_read_b64_tr_b16 a[88:89], v215
  ds_read_b64_tr_b16 a[90:91], v215 offset:5120
  v_mfma_f32_16x16x32_bf16 v[24:27], a[8:11], v[176:179], v[24:27]
  ds_read_b64_tr_b16 a[92:93], v215 offset:10240
  v_mfma_f32_16x16x32_bf16 v[24:27], a[12:15], v[184:187], v[24:27]
  buffer_load_dwordx4 a[180:183], v1, s[28:31], s68 offen offset:1024 sc1
  v_mfma_f32_16x16x32_bf16 v[28:31], a[8:11], v[180:183], v[28:31]
  s_nop 0
  ds_read_b64_tr_b16 a[94:95], v215 offset:15360
  ds_read_b64_tr_b16 a[96:97], v216
  v_mfma_f32_16x16x32_bf16 v[28:31], a[12:15], v[188:191], v[28:31]
  s_nop 0
  ds_read_b64_tr_b16 a[98:99], v216 offset:5120
  ds_read_b64_tr_b16 a[100:101], v216 offset:10240
  v_mfma_f32_16x16x32_bf16 v[32:35], a[16:19], v[176:179], v[32:35]
  ds_read_b64_tr_b16 a[102:103], v216 offset:15360
  v_mfma_f32_16x16x32_bf16 v[32:35], a[20:23], v[184:187], v[32:35]
  buffer_load_dwordx4 a[184:187], v13, s[28:31], s68 offen sc1
  v_mfma_f32_16x16x32_bf16 v[36:39], a[16:19], v[180:183], v[36:39]
  s_nop 0
  ds_read_b64_tr_b16 a[104:105], v217
  ds_read_b64_tr_b16 a[106:107], v217 offset:5120
  v_mfma_f32_16x16x32_bf16 v[36:39], a[20:23], v[188:191], v[36:39]
  s_nop 0
  ds_read_b64_tr_b16 a[108:109], v217 offset:10240
  ds_read_b64_tr_b16 a[110:111], v217 offset:15360
  v_mfma_f32_16x16x32_bf16 v[40:43], a[24:27], v[176:179], v[40:43]
  s_nop 0
  ds_read_b64_tr_b16 a[112:113], v214 offset:2048
  ds_read_b64_tr_b16 a[114:115], v214 offset:7168
  v_mfma_f32_16x16x32_bf16 v[40:43], a[28:31], v[184:187], v[40:43]
  buffer_load_dwordx4 a[188:191], v13, s[28:31], s68 offen offset:1024 sc1
  v_mfma_f32_16x16x32_bf16 v[44:47], a[24:27], v[180:183], v[44:47]
  s_add_u32 s68, s68, 8192
  ds_read_b64_tr_b16 a[116:117], v214 offset:12288
  ds_read_b64_tr_b16 a[118:119], v214 offset:17408
  v_mfma_f32_16x16x32_bf16 v[44:47], a[28:31], v[188:191], v[44:47]
  s_nop 0
  ds_read_b64_tr_b16 a[120:121], v215 offset:2048
  ds_read_b64_tr_b16 a[122:123], v215 offset:7168
  v_mfma_f32_16x16x32_bf16 v[48:51], a[32:35], v[176:179], v[48:51]
  ds_read_b64_tr_b16 a[124:125], v215 offset:12288
  v_mfma_f32_16x16x32_bf16 v[48:51], a[36:39], v[184:187], v[48:51]
  buffer_load_dwordx4 v12, s[8:11], s69 offen lds
  v_mfma_f32_16x16x32_bf16 v[52:55], a[32:35], v[180:183], v[52:55]
  s_add_u32 m0, s71, 0x400
  ds_read_b64_tr_b16 a[126:127], v215 offset:17408
  ds_read_b64_tr_b16 a[128:129], v216 offset:2048
  v_mfma_f32_16x16x32_bf16 v[52:55], a[36:39], v[188:191], v[52:55]
  s_nop 0
  ds_read_b64_tr_b16 a[130:131], v216 offset:7168
  ds_read_b64_tr_b16 a[132:133], v216 offset:12288
  v_mfma_f32_16x16x32_bf16 v[56:59], a[40:43], v[176:179], v[56:59]
  ds_read_b64_tr_b16 a[134:135], v216 offset:17408
  v_mfma_f32_16x16x32_bf16 v[56:59], a[44:47], v[184:187], v[56:59]
  buffer_load_dwordx4 v12, s[8:11], s59 offen lds
  v_mfma_f32_16x16x32_bf16 v[60:63], a[40:43], v[180:183], v[60:63]
  s_add_u32 m0, s71, 0x800
  ds_read_b64_tr_b16 a[136:137], v217 offset:2048
  ds_read_b64_tr_b16 a[138:139], v217 offset:7168
  v_mfma_f32_16x16x32_bf16 v[60:63], a[44:47], v[188:191], v[60:63]
  s_add_u32 s59, s69, 0x80
  ds_read_b64_tr_b16 a[140:141], v217 offset:12288
  ds_read_b64_tr_b16 a[142:143], v217 offset:17408
  v_mfma_f32_16x16x32_bf16 v[64:67], a[48:51], v[176:179], v[64:67]
  s_nop 0
  ds_read_b64_tr_b16 a[144:145], v218
  ds_read_b64_tr_b16 a[146:147], v218 offset:5120
  v_mfma_f32_16x16x32_bf16 v[64:67], a[52:55], v[184:187], v[64:67]
  buffer_load_dwordx4 v12, s[8:11], s59 offen lds
  v_mfma_f32_16x16x32_bf16 v[68:71], a[48:51], v[180:183], v[68:71]
  s_add_u32 m0, s71, 0xc00
  ds_read_b64_tr_b16 a[148:149], v218 offset:10240
  ds_read_b64_tr_b16 a[150:151], v218 offset:15360
  v_mfma_f32_16x16x32_bf16 v[68:71], a[52:55], v[188:191], v[68:71]
  s_add_u32 s59, s69, 0x2880
  ds_read_b64_tr_b16 a[152:153], v219
  ds_read_b64_tr_b16 a[154:155], v219 offset:5120
  v_mfma_f32_16x16x32_bf16 v[72:75], a[56:59], v[176:179], v[72:75]
  ds_read_b64_tr_b16 a[156:157], v219 offset:10240
  v_mfma_f32_16x16x32_bf16 v[72:75], a[60:63], v[184:187], v[72:75]
  buffer_load_dwordx4 v12, s[8:11], s59 offen lds
  v_mfma_f32_16x16x32_bf16 v[76:79], a[56:59], v[180:183], v[76:79]
  s_add_u32 m0, s71, 0x1000
  ds_read_b64_tr_b16 a[158:159], v219 offset:15360
  v_mfma_f32_16x16x32_bf16 v[76:79], a[60:63], v[188:191], v[76:79]
  s_add_u32 s59, s69, s80
  v_mfma_f32_16x16x32_bf16 v[80:83], a[64:67], v[176:179], v[80:83]
  s_add_u32 s69, s69, 81920
  v_mfma_f32_16x16x32_bf16 v[80:83], a[68:71], v[184:187], v[80:83]
  s_add_u32 s56, s69, 0x2800
  buffer_load_dwordx4 v4, s[8:11], s59 offen lds
  v_mfma_f32_16x16x32_bf16 v[84:87], a[64:67], v[180:183], v[84:87]
  s_add_u32 m0, s71, 0x20000
  v_mfma_f32_16x16x32_bf16 v[84:87], a[68:71], v[188:191], v[84:87]
  v_mfma_f32_16x16x32_bf16 v[88:91], a[72:75], v[176:179], v[88:91]
  v_mfma_f32_16x16x32_bf16 v[88:91], a[76:79], v[184:187], v[88:91]
  v_mfma_f32_16x16x32_bf16 v[92:95], a[72:75], v[180:183], v[92:95]
  v_mfma_f32_16x16x32_bf16 v[92:95], a[76:79], v[188:191], v[92:95]
  s_waitcnt vmcnt(18) lgkmcnt(0)
  s_barrier
  v_mfma_f32_16x16x32_bf16 v[16:19], a[80:83], v[192:195], v[16:19]
  s_nop 0
  ds_read_b64_tr_b16 a[0:1], v208 offset:20480
  ds_read_b64_tr_b16 a[2:3], v208 offset:25600
  v_mfma_f32_16x16x32_bf16 v[16:19], a[84:87], v[200:203], v[16:19]
  buffer_load_dwordx4 v[176:179], v1, s[28:31], s68 offen sc1
  v_mfma_f32_16x16x32_bf16 v[20:23], a[80:83], v[196:199], v[20:23]
  s_nop 0
  ds_read_b64_tr_b16 a[4:5], v208 offset:30720
  ds_read_b64_tr_b16 a[6:7], v208 offset:35840
  v_mfma_f32_16x16x32_bf16 v[20:23], a[84:87], v[204:207], v[20:23]
  s_nop 0
  ds_read_b64_tr_b16 a[8:9], v209 offset:20480
  ds_read_b64_tr_b16 a[10:11], v209 offset:25600
  v_mfma_f32_16x16x32_bf16 v[24:27], a[88:91], v[192:195], v[24:27]
  ds_read_b64_tr_b16 a[12:13], v209 offset:30720
  v_mfma_f32_16x16x32_bf16 v[24:27], a[92:95], v[200:203], v[24:27]
  buffer_load_dwordx4 v[180:183], v1, s[28:31], s68 offen offset:1024 sc1
  v_mfma_f32_16x16x32_bf16 v[28:31], a[88:91], v[196:199], v[28:31]
  s_nop 0
  ds_read_b64_tr_b16 a[14:15], v209 offset:35840
  ds_read_b64_tr_b16 a[16:17], v210 offset:20480
  v_mfma_f32_16x16x32_bf16 v[28:31], a[92:95], v[204:207], v[28:31]
  s_nop 0
  ds_read_b64_tr_b16 a[18:19], v210 offset:25600
  ds_read_b64_tr_b16 a[20:21], v210 offset:30720
  v_mfma_f32_16x16x32_bf16 v[32:35], a[96:99], v[192:195], v[32:35]
  ds_read_b64_tr_b16 a[22:23], v210 offset:35840
  v_mfma_f32_16x16x32_bf16 v[32:35], a[100:103], v[200:203], v[32:35]
  buffer_load_dwordx4 v[184:187], v13, s[28:31], s68 offen sc1
  v_mfma_f32_16x16x32_bf16 v[36:39], a[96:99], v[196:199], v[36:39]
  s_nop 0
  ds_read_b64_tr_b16 a[24:25], v211 offset:20480
  ds_read_b64_tr_b16 a[26:27], v211 offset:25600
  v_mfma_f32_16x16x32_bf16 v[36:39], a[100:103], v[204:207], v[36:39]
  s_nop 0
  ds_read_b64_tr_b16 a[28:29], v211 offset:30720
  ds_read_b64_tr_b16 a[30:31], v211 offset:35840
  v_mfma_f32_16x16x32_bf16 v[40:43], a[104:107], v[192:195], v[40:43]
  s_nop 0
  ds_read_b64_tr_b16 a[32:33], v208 offset:22528
  ds_read_b64_tr_b16 a[34:35], v208 offset:27648
  v_mfma_f32_16x16x32_bf16 v[40:43], a[108:111], v[200:203], v[40:43]
  buffer_load_dwordx4 v[188:191], v13, s[28:31], s68 offen offset:1024 sc1
  v_mfma_f32_16x16x32_bf16 v[44:47], a[104:107], v[196:199], v[44:47]
  s_add_u32 s68, s68, 8192
  ds_read_b64_tr_b16 a[36:37], v208 offset:32768
  ds_read_b64_tr_b16 a[38:39], v208 offset:37888
  v_mfma_f32_16x16x32_bf16 v[44:47], a[108:111], v[204:207], v[44:47]
  s_nop 0
  ds_read_b64_tr_b16 a[40:41], v209 offset:22528
  ds_read_b64_tr_b16 a[42:43], v209 offset:27648
  v_mfma_f32_16x16x32_bf16 v[48:51], a[112:115], v[192:195], v[48:51]
  ds_read_b64_tr_b16 a[44:45], v209 offset:32768
  v_mfma_f32_16x16x32_bf16 v[48:51], a[116:119], v[200:203], v[48:51]
  buffer_load_dwordx4 v12, s[8:11], s69 offen lds
  v_mfma_f32_16x16x32_bf16 v[52:55], a[112:115], v[196:199], v[52:55]
  s_add_u32 m0, s71, 0x20400
  ds_read_b64_tr_b16 a[46:47], v209 offset:37888
  ds_read_b64_tr_b16 a[48:49], v210 offset:22528
  v_mfma_f32_16x16x32_bf16 v[52:55], a[116:119], v[204:207], v[52:55]
  s_nop 0
  ds_read_b64_tr_b16 a[50:51], v210 offset:27648
  ds_read_b64_tr_b16 a[52:53], v210 offset:32768
  v_mfma_f32_16x16x32_bf16 v[56:59], a[120:123], v[192:195], v[56:59]
  ds_read_b64_tr_b16 a[54:55], v210 offset:37888
  v_mfma_f32_16x16x32_bf16 v[56:59], a[124:127], v[200:203], v[56:59]
  buffer_load_dwordx4 v12, s[8:11], s56 offen lds
  v_mfma_f32_16x16x32_bf16 v[60:63], a[120:123], v[196:199], v[60:63]
  s_add_u32 m0, s71, 0x20800
  ds_read_b64_tr_b16 a[56:57], v211 offset:22528
  ds_read_b64_tr_b16 a[58:59], v211 offset:27648
  v_mfma_f32_16x16x32_bf16 v[60:63], a[124:127], v[204:207], v[60:63]
  s_add_u32 s56, s69, 0x80
  ds_read_b64_tr_b16 a[60:61], v211 offset:32768
  ds_read_b64_tr_b16 a[62:63], v211 offset:37888
  v_mfma_f32_16x16x32_bf16 v[64:67], a[128:131], v[192:195], v[64:67]
  s_nop 0
  ds_read_b64_tr_b16 a[64:65], v212 offset:20480
  ds_read_b64_tr_b16 a[66:67], v212 offset:25600
  v_mfma_f32_16x16x32_bf16 v[64:67], a[132:135], v[200:203], v[64:67]
  buffer_load_dwordx4 v12, s[8:11], s56 offen lds
  v_mfma_f32_16x16x32_bf16 v[68:71], a[128:131], v[196:199], v[68:71]
  s_add_u32 m0, s71, 0x20c00
  ds_read_b64_tr_b16 a[68:69], v212 offset:30720
  ds_read_b64_tr_b16 a[70:71], v212 offset:35840
  v_mfma_f32_16x16x32_bf16 v[68:71], a[132:135], v[204:207], v[68:71]
  s_add_u32 s56, s69, 0x2880
  ds_read_b64_tr_b16 a[72:73], v213 offset:20480
  ds_read_b64_tr_b16 a[74:75], v213 offset:25600
  v_mfma_f32_16x16x32_bf16 v[72:75], a[136:139], v[192:195], v[72:75]
  ds_read_b64_tr_b16 a[76:77], v213 offset:30720
  v_mfma_f32_16x16x32_bf16 v[72:75], a[140:143], v[200:203], v[72:75]
  buffer_load_dwordx4 v12, s[8:11], s56 offen lds
  v_mfma_f32_16x16x32_bf16 v[76:79], a[136:139], v[196:199], v[76:79]
  s_add_u32 m0, s71, 0x21000
  ds_read_b64_tr_b16 a[78:79], v213 offset:35840
  v_mfma_f32_16x16x32_bf16 v[76:79], a[140:143], v[204:207], v[76:79]
  s_add_u32 s56, s69, s80
  v_mfma_f32_16x16x32_bf16 v[80:83], a[144:147], v[192:195], v[80:83]
  s_add_u32 s69, s69, 81920
  v_mfma_f32_16x16x32_bf16 v[80:83], a[148:151], v[200:203], v[80:83]
  s_add_u32 s57, s69, 0x2800
  buffer_load_dwordx4 v4, s[8:11], s56 offen lds
  v_mfma_f32_16x16x32_bf16 v[84:87], a[144:147], v[196:199], v[84:87]
  s_add_u32 m0, s71, 0x5000
  v_mfma_f32_16x16x32_bf16 v[84:87], a[148:151], v[204:207], v[84:87]
  v_mfma_f32_16x16x32_bf16 v[88:91], a[152:155], v[192:195], v[88:91]
  v_mfma_f32_16x16x32_bf16 v[88:91], a[156:159], v[200:203], v[88:91]
  v_mfma_f32_16x16x32_bf16 v[92:95], a[152:155], v[196:199], v[92:95]
  v_mfma_f32_16x16x32_bf16 v[92:95], a[156:159], v[204:207], v[92:95]
  s_waitcnt vmcnt(18) lgkmcnt(0)
  s_barrier
  v_mfma_f32_16x16x32_bf16 v[16:19], a[0:3], a[160:163], v[16:19]
  s_nop 0
  ds_read_b64_tr_b16 a[80:81], v208 offset:40960
  ds_read_b64_tr_b16 a[82:83], v208 offset:46080
  v_mfma_f32_16x16x32_bf16 v[16:19], a[4:7], a[168:171], v[16:19]
  buffer_load_dwordx4 v[192:195], v1, s[28:31], s68 offen sc1
  v_mfma_f32_16x16x32_bf16 v[20:23], a[0:3], a[164:167], v[20:23]
  s_nop 0
  ds_read_b64_tr_b16 a[84:85], v208 offset:51200
  ds_read_b64_tr_b16 a[86:87], v208 offset:56320
  v_mfma_f32_16x16x32_bf16 v[20:23], a[4:7], a[172:175], v[20:23]
  s_nop 0
  ds_read_b64_tr_b16 a[88:89], v209 offset:40960
  ds_read_b64_tr_b16 a[90:91], v209 offset:46080
  v_mfma_f32_16x16x32_bf16 v[24:27], a[8:11], a[160:163], v[24:27]
  ds_read_b64_tr_b16 a[92:93], v209 offset:51200
  v_mfma_f32_16x16x32_bf16 v[24:27], a[12:15], a[168:171], v[24:27]
  buffer_load_dwordx4 v[196:199], v1, s[28:31], s68 offen offset:1024 sc1
  v_mfma_f32_16x16x32_bf16 v[28:31], a[8:11], a[164:167], v[28:31]
  s_nop 0
  ds_read_b64_tr_b16 a[94:95], v209 offset:56320
  ds_read_b64_tr_b16 a[96:97], v210 offset:40960
  v_mfma_f32_16x16x32_bf16 v[28:31], a[12:15], a[172:175], v[28:31]
  s_nop 0
  ds_read_b64_tr_b16 a[98:99], v210 offset:46080
  ds_read_b64_tr_b16 a[100:101], v210 offset:51200
  v_mfma_f32_16x16x32_bf16 v[32:35], a[16:19], a[160:163], v[32:35]
  ds_read_b64_tr_b16 a[102:103], v210 offset:56320
  v_mfma_f32_16x16x32_bf16 v[32:35], a[20:23], a[168:171], v[32:35]
  buffer_load_dwordx4 v[200:203], v13, s[28:31], s68 offen sc1
  v_mfma_f32_16x16x32_bf16 v[36:39], a[16:19], a[164:167], v[36:39]
  s_nop 0
  ds_read_b64_tr_b16 a[104:105], v211 offset:40960
  ds_read_b64_tr_b16 a[106:107], v211 offset:46080
  v_mfma_f32_16x16x32_bf16 v[36:39], a[20:23], a[172:175], v[36:39]
  s_nop 0
  ds_read_b64_tr_b16 a[108:109], v211 offset:51200
  ds_read_b64_tr_b16 a[110:111], v211 offset:56320
  v_mfma_f32_16x16x32_bf16 v[40:43], a[24:27], a[160:163], v[40:43]
  s_nop 0
  ds_read_b64_tr_b16 a[112:113], v208 offset:43008
  ds_read_b64_tr_b16 a[114:115], v208 offset:48128
  v_mfma_f32_16x16x32_bf16 v[40:43], a[28:31], a[168:171], v[40:43]
  buffer_load_dwordx4 v[204:207], v13, s[28:31], s68 offen offset:1024 sc1
  v_mfma_f32_16x16x32_bf16 v[44:47], a[24:27], a[164:167], v[44:47]
  s_add_u32 s68, s68, 8192
  ds_read_b64_tr_b16 a[116:117], v208 offset:53248
  ds_read_b64_tr_b16 a[118:119], v208 offset:58368
  v_mfma_f32_16x16x32_bf16 v[44:47], a[28:31], a[172:175], v[44:47]
  s_nop 0
  ds_read_b64_tr_b16 a[120:121], v209 offset:43008
  ds_read_b64_tr_b16 a[122:123], v209 offset:48128
  v_mfma_f32_16x16x32_bf16 v[48:51], a[32:35], a[160:163], v[48:51]
  ds_read_b64_tr_b16 a[124:125], v209 offset:53248
  v_mfma_f32_16x16x32_bf16 v[48:51], a[36:39], a[168:171], v[48:51]
  buffer_load_dwordx4 v12, s[8:11], s69 offen lds
  v_mfma_f32_16x16x32_bf16 v[52:55], a[32:35], a[164:167], v[52:55]
  s_add_u32 m0, s71, 0x5400
  ds_read_b64_tr_b16 a[126:127], v209 offset:58368
  ds_read_b64_tr_b16 a[128:129], v210 offset:43008
  v_mfma_f32_16x16x32_bf16 v[52:55], a[36:39], a[172:175], v[52:55]
  s_nop 0
  ds_read_b64_tr_b16 a[130:131], v210 offset:48128
  ds_read_b64_tr_b16 a[132:133], v210 offset:53248
  v_mfma_f32_16x16x32_bf16 v[56:59], a[40:43], a[160:163], v[56:59]
  ds_read_b64_tr_b16 a[134:135], v210 offset:58368
  v_mfma_f32_16x16x32_bf16 v[56:59], a[44:47], a[168:171], v[56:59]
  buffer_load_dwordx4 v12, s[8:11], s57 offen lds
  v_mfma_f32_16x16x32_bf16 v[60:63], a[40:43], a[164:167], v[60:63]
  s_add_u32 m0, s71, 0x5800
  ds_read_b64_tr_b16 a[136:137], v211 offset:43008
  ds_read_b64_tr_b16 a[138:139], v211 offset:48128
  v_mfma_f32_16x16x32_bf16 v[60:63], a[44:47], a[172:175], v[60:63]
  s_add_u32 s57, s69, 0x80
  ds_read_b64_tr_b16 a[140:141], v211 offset:53248
  ds_read_b64_tr_b16 a[142:143], v211 offset:58368
  v_mfma_f32_16x16x32_bf16 v[64:67], a[48:51], a[160:163], v[64:67]
  s_nop 0
  ds_read_b64_tr_b16 a[144:145], v212 offset:40960
  ds_read_b64_tr_b16 a[146:147], v212 offset:46080
  v_mfma_f32_16x16x32_bf16 v[64:67], a[52:55], a[168:171], v[64:67]
  buffer_load_dwordx4 v12, s[8:11], s57 offen lds
  v_mfma_f32_16x16x32_bf16 v[68:71], a[48:51], a[164:167], v[68:71]
  s_add_u32 m0, s71, 0x5c00
  ds_read_b64_tr_b16 a[148:149], v212 offset:51200
  ds_read_b64_tr_b16 a[150:151], v212 offset:56320
  v_mfma_f32_16x16x32_bf16 v[68:71], a[52:55], a[172:175], v[68:71]
  s_add_u32 s57, s69, 0x2880
  ds_read_b64_tr_b16 a[152:153], v213 offset:40960
  ds_read_b64_tr_b16 a[154:155], v213 offset:46080
  v_mfma_f32_16x16x32_bf16 v[72:75], a[56:59], a[160:163], v[72:75]
  ds_read_b64_tr_b16 a[156:157], v213 offset:51200
  v_mfma_f32_16x16x32_bf16 v[72:75], a[60:63], a[168:171], v[72:75]
  buffer_load_dwordx4 v12, s[8:11], s57 offen lds
  v_mfma_f32_16x16x32_bf16 v[76:79], a[56:59], a[164:167], v[76:79]
  s_add_u32 m0, s71, 0x6000
  ds_read_b64_tr_b16 a[158:159], v213 offset:56320
  v_mfma_f32_16x16x32_bf16 v[76:79], a[60:63], a[172:175], v[76:79]
  s_add_u32 s57, s69, s80
  v_mfma_f32_16x16x32_bf16 v[80:83], a[64:67], a[160:163], v[80:83]
  s_add_u32 s69, s69, 81920
  v_mfma_f32_16x16x32_bf16 v[80:83], a[68:71], a[168:171], v[80:83]
  s_add_u32 s58, s69, 0x2800
  buffer_load_dwordx4 v4, s[8:11], s57 offen lds
  v_mfma_f32_16x16x32_bf16 v[84:87], a[64:67], a[164:167], v[84:87]
  s_add_u32 m0, s71, 0xa000
  v_mfma_f32_16x16x32_bf16 v[84:87], a[68:71], a[172:175], v[84:87]
  v_mfma_f32_16x16x32_bf16 v[88:91], a[72:75], a[160:163], v[88:91]
  v_mfma_f32_16x16x32_bf16 v[88:91], a[76:79], a[168:171], v[88:91]
  v_mfma_f32_16x16x32_bf16 v[92:95], a[72:75], a[164:167], v[92:95]
  v_mfma_f32_16x16x32_bf16 v[92:95], a[76:79], a[172:175], v[92:95]
  s_waitcnt vmcnt(18) lgkmcnt(0)
  s_barrier
  v_mfma_f32_16x16x32_bf16 v[16:19], a[80:83], a[176:179], v[16:19]
  s_nop 0
  ds_read_b64_tr_b16 a[0:1], v208
  ds_read_b64_tr_b16 a[2:3], v208 offset:5120
  v_mfma_f32_16x16x32_bf16 v[16:19], a[84:87], a[184:187], v[16:19]
  buffer_load_dwordx4 a[160:163], v1, s[28:31], s68 offen sc1
  v_mfma_f32_16x16x32_bf16 v[20:23], a[80:83], a[180:183], v[20:23]
  s_nop 0
  ds_read_b64_tr_b16 a[4:5], v208 offset:10240
  ds_read_b64_tr_b16 a[6:7], v208 offset:15360
  v_mfma_f32_16x16x32_bf16 v[20:23], a[84:87], a[188:191], v[20:23]
  s_nop 0
  ds_read_b64_tr_b16 a[8:9], v209
  ds_read_b64_tr_b16 a[10:11], v209 offset:5120
  v_mfma_f32_16x16x32_bf16 v[24:27], a[88:91], a[176:179], v[24:27]
  ds_read_b64_tr_b16 a[12:13], v209 offset:10240
  v_mfma_f32_16x16x32_bf16 v[24:27], a[92:95], a[184:187], v[24:27]
  buffer_load_dwordx4 a[164:167], v1, s[28:31], s68 offen offset:1024 sc1
  v_mfma_f32_16x16x32_bf16 v[28:31], a[88:91], a[180:183], v[28:31]
  s_nop 0
  ds_read_b64_tr_b16 a[14:15], v209 offset:15360
  ds_read_b64_tr_b16 a[16:17], v210
  v_mfma_f32_16x16x32_bf16 v[28:31], a[92:95], a[188:191], v[28:31]
  s_nop 0
  ds_read_b64_tr_b16 a[18:19], v210 offset:5120
  ds_read_b64_tr_b16 a[20:21], v210 offset:10240
  v_mfma_f32_16x16x32_bf16 v[32:35], a[96:99], a[176:179], v[32:35]
  ds_read_b64_tr_b16 a[22:23], v210 offset:15360
  v_mfma_f32_16x16x32_bf16 v[32:35], a[100:103], a[184:187], v[32:35]
  buffer_load_dwordx4 a[168:171], v13, s[28:31], s68 offen sc1
  v_mfma_f32_16x16x32_bf16 v[36:39], a[96:99], a[180:183], v[36:39]
  s_nop 0
  ds_read_b64_tr_b16 a[24:25], v211
  ds_read_b64_tr_b16 a[26:27], v211 offset:5120
  v_mfma_f32_16x16x32_bf16 v[36:39], a[100:103], a[188:191], v[36:39]
  s_nop 0
  ds_read_b64_tr_b16 a[28:29], v211 offset:10240
  ds_read_b64_tr_b16 a[30:31], v211 offset:15360
  v_mfma_f32_16x16x32_bf16 v[40:43], a[104:107], a[176:179], v[40:43]
  s_nop 0
  ds_read_b64_tr_b16 a[32:33], v208 offset:2048
  ds_read_b64_tr_b16 a[34:35], v208 offset:7168
  v_mfma_f32_16x16x32_bf16 v[40:43], a[108:111], a[184:187], v[40:43]
  buffer_load_dwordx4 a[172:175], v13, s[28:31], s68 offen offset:1024 sc1
  v_mfma_f32_16x16x32_bf16 v[44:47], a[104:107], a[180:183], v[44:47]
  s_add_u32 s68, s68, 8192
  ds_read_b64_tr_b16 a[36:37], v208 offset:12288
  ds_read_b64_tr_b16 a[38:39], v208 offset:17408
  v_mfma_f32_16x16x32_bf16 v[44:47], a[108:111], a[188:191], v[44:47]
  s_nop 0
  ds_read_b64_tr_b16 a[40:41], v209 offset:2048
  ds_read_b64_tr_b16 a[42:43], v209 offset:7168
  v_mfma_f32_16x16x32_bf16 v[48:51], a[112:115], a[176:179], v[48:51]
  ds_read_b64_tr_b16 a[44:45], v209 offset:12288
  v_mfma_f32_16x16x32_bf16 v[48:51], a[116:119], a[184:187], v[48:51]
  buffer_load_dwordx4 v12, s[8:11], s69 offen lds
  v_mfma_f32_16x16x32_bf16 v[52:55], a[112:115], a[180:183], v[52:55]
  s_add_u32 m0, s71, 0xa400
  ds_read_b64_tr_b16 a[46:47], v209 offset:17408
  ds_read_b64_tr_b16 a[48:49], v210 offset:2048
  v_mfma_f32_16x16x32_bf16 v[52:55], a[116:119], a[188:191], v[52:55]
  s_nop 0
  ds_read_b64_tr_b16 a[50:51], v210 offset:7168
  ds_read_b64_tr_b16 a[52:53], v210 offset:12288
  v_mfma_f32_16x16x32_bf16 v[56:59], a[120:123], a[176:179], v[56:59]
  ds_read_b64_tr_b16 a[54:55], v210 offset:17408
  v_mfma_f32_16x16x32_bf16 v[56:59], a[124:127], a[184:187], v[56:59]
  buffer_load_dwordx4 v12, s[8:11], s58 offen lds
  v_mfma_f32_16x16x32_bf16 v[60:63], a[120:123], a[180:183], v[60:63]
  s_add_u32 m0, s71, 0xa800
  ds_read_b64_tr_b16 a[56:57], v211 offset:2048
  ds_read_b64_tr_b16 a[58:59], v211 offset:7168
  v_mfma_f32_16x16x32_bf16 v[60:63], a[124:127], a[188:191], v[60:63]
  s_add_u32 s58, s69, 0x80
  ds_read_b64_tr_b16 a[60:61], v211 offset:12288
  ds_read_b64_tr_b16 a[62:63], v211 offset:17408
  v_mfma_f32_16x16x32_bf16 v[64:67], a[128:131], a[176:179], v[64:67]
  s_nop 0
  ds_read_b64_tr_b16 a[64:65], v212
  ds_read_b64_tr_b16 a[66:67], v212 offset:5120
  v_mfma_f32_16x16x32_bf16 v[64:67], a[132:135], a[184:187], v[64:67]
  buffer_load_dwordx4 v12, s[8:11], s58 offen lds
  v_mfma_f32_16x16x32_bf16 v[68:71], a[128:131], a[180:183], v[68:71]
  s_add_u32 m0, s71, 0xac00
  ds_read_b64_tr_b16 a[68:69], v212 offset:10240
  ds_read_b64_tr_b16 a[70:71], v212 offset:15360
  v_mfma_f32_16x16x32_bf16 v[68:71], a[132:135], a[188:191], v[68:71]
  s_add_u32 s58, s69, 0x2880
  ds_read_b64_tr_b16 a[72:73], v213
  ds_read_b64_tr_b16 a[74:75], v213 offset:5120
  v_mfma_f32_16x16x32_bf16 v[72:75], a[136:139], a[176:179], v[72:75]
  ds_read_b64_tr_b16 a[76:77], v213 offset:10240
  v_mfma_f32_16x16x32_bf16 v[72:75], a[140:143], a[184:187], v[72:75]
  buffer_load_dwordx4 v12, s[8:11], s58 offen lds
  v_mfma_f32_16x16x32_bf16 v[76:79], a[136:139], a[180:183], v[76:79]
  s_add_u32 m0, s71, 0xb000
  ds_read_b64_tr_b16 a[78:79], v213 offset:15360
  v_mfma_f32_16x16x32_bf16 v[76:79], a[140:143], a[188:191], v[76:79]
  s_add_u32 s58, s69, s80
  v_mfma_f32_16x16x32_bf16 v[80:83], a[144:147], a[176:179], v[80:83]
  s_add_u32 s69, s69, 81920
  v_mfma_f32_16x16x32_bf16 v[80:83], a[148:151], a[184:187], v[80:83]
  buffer_load_dwordx4 v4, s[8:11], s58 offen lds
  v_mfma_f32_16x16x32_bf16 v[84:87], a[144:147], a[180:183], v[84:87]
  v_mfma_f32_16x16x32_bf16 v[84:87], a[148:151], a[188:191], v[84:87]
  v_mfma_f32_16x16x32_bf16 v[88:91], a[152:155], a[176:179], v[88:91]
  v_mfma_f32_16x16x32_bf16 v[88:91], a[156:159], a[184:187], v[88:91]
  v_mfma_f32_16x16x32_bf16 v[92:95], a[152:155], a[180:183], v[92:95]
  v_mfma_f32_16x16x32_bf16 v[92:95], a[156:159], a[188:191], v[92:95]
  s_sub_u32 s65, s65, 1
  s_cmp_lg_u32 s65, 0
  s_cbranch_scc1 L_k3_loop
  s_waitcnt vmcnt(18) lgkmcnt(0)
  s_barrier
  v_mfma_f32_16x16x32_bf16 v[16:19], a[0:3], v[176:179], v[16:19]
  s_and_b32 s43, s77, 1
  ds_read_b64_tr_b16 a[80:81], v214
  ds_read_b64_tr_b16 a[82:83], v214 offset:5120
  v_mfma_f32_16x16x32_bf16 v[16:19], a[4:7], v[184:187], v[16:19]
  s_and_b32 s44, s40, 1
  ds_read_b64_tr_b16 a[84:85], v214 offset:10240
  v_and_b32 v8, 15, v0
  v_mfma_f32_16x16x32_bf16 v[20:23], a[0:3], v[180:183], v[20:23]
  s_lshl_b32 s43, s43, 1
  ds_read_b64_tr_b16 a[86:87], v214 offset:15360
  v_mfma_f32_16x16x32_bf16 v[20:23], a[4:7], v[188:191], v[20:23]
  s_mul_i32 s44, s44, 5
  ds_read_b64_tr_b16 a[88:89], v215
  ds_read_b64_tr_b16 a[90:91], v215 offset:5120
  v_mfma_f32_16x16x32_bf16 v[24:27], a[8:11], v[176:179], v[24:27]
  s_add_u32 s43, s43, s44
  ds_read_b64_tr_b16 a[92:93], v215 offset:10240
  v_mfma_f32_16x16x32_bf16 v[24:27], a[12:15], v[184:187], v[24:27]
  s_lshl_b32 s76, s76, 2
  ds_read_b64_tr_b16 a[94:95], v215 offset:15360
  v_mfma_f32_16x16x32_bf16 v[28:31], a[8:11], v[180:183], v[28:31]
  s_add_u32 s90, s43, 0
  ds_read_b64_tr_b16 a[96:97], v216
  ds_read_b64_tr_b16 a[98:99], v216 offset:5120
  v_mfma_f32_16x16x32_bf16 v[28:31], a[12:15], v[188:191], v[28:31]
  s_add_u32 s91, s43, 1
  ds_read_b64_tr_b16 a[100:101], v216 offset:10240
  v_mfma_f32_16x16x32_bf16 v[32:35], a[16:19], v[176:179], v[32:35]
  s_add_u32 s100, s43, 2
  ds_read_b64_tr_b16 a[102:103], v216 offset:15360
  v_mfma_f32_16x16x32_bf16 v[32:35], a[20:23], v[184:187], v[32:35]
  s_add_u32 s101, s43, 3
  ds_read_b64_tr_b16 a[104:105], v217
  ds_read_b64_tr_b16 a[106:107], v217 offset:5120
  v_mfma_f32_16x16x32_bf16 v[36:39], a[16:19], v[180:183], v[36:39]
  s_add_u32 s3, s43, 4
  ds_read_b64_tr_b16 a[108:109], v217 offset:10240
  v_mfma_f32_16x16x32_bf16 v[36:39], a[20:23], v[188:191], v[36:39]
  s_add_u32 s76, s76, s72
  ds_read_b64_tr_b16 a[110:111], v217 offset:15360
  v_mfma_f32_16x16x32_bf16 v[40:43], a[24:27], v[176:179], v[40:43]
  s_lshl_b32 s76, s76, 1
  ds_read_b64_tr_b16 a[112:113], v214 offset:2048
  ds_read_b64_tr_b16 a[114:115], v214 offset:7168
  v_mfma_f32_16x16x32_bf16 v[40:43], a[28:31], v[184:187], v[40:43]
  s_lshr_b32 s43, s40, 1
  ds_read_b64_tr_b16 a[116:117], v214 offset:12288
  v_mfma_f32_16x16x32_bf16 v[44:47], a[24:27], v[180:183], v[44:47]
  s_cmp_ge_u32 s90, 10
  s_cselect_b32 s44, 10, 0
  ds_read_b64_tr_b16 a[118:119], v214 offset:17408
  v_mfma_f32_16x16x32_bf16 v[44:47], a[28:31], v[188:191], v[44:47]
  s_add_u32 s76, s76, s43
  ds_read_b64_tr_b16 a[120:121], v215 offset:2048
  ds_read_b64_tr_b16 a[122:123], v215 offset:7168
  v_mfma_f32_16x16x32_bf16 v[48:51], a[32:35], v[176:179], v[48:51]
  s_sub_u32 s90, s90, s44
  ds_read_b64_tr_b16 a[124:125], v215 offset:12288
  v_mfma_f32_16x16x32_bf16 v[48:51], a[36:39], v[184:187], v[48:51]
  s_lshl_b32 s76, s76, 4
  ds_read_b64_tr_b16 a[126:127], v215 offset:17408
  v_add_u32 v8, s76, v8
  v_mfma_f32_16x16x32_bf16 v[52:55], a[32:35], v[180:183], v[52:55]
  s_cmp_ge_u32 s91, 10
  s_cselect_b32 s44, 10, 0
  ds_read_b64_tr_b16 a[128:129], v216 offset:2048
  v_mul_u32_u24 v7, 1280, v8
  v_mfma_f32_16x16x32_bf16 v[52:55], a[36:39], v[188:191], v[52:55]
  s_sub_u32 s91, s91, s44
  ds_read_b64_tr_b16 a[130:131], v216 offset:7168
  v_bfe_u32 v8, v0, 4, 2
  v_mfma_f32_16x16x32_bf16 v[56:59], a[40:43], v[176:179], v[56:59]
  s_cmp_ge_u32 s100, 10
  s_cselect_b32 s44, 10, 0
  ds_read_b64_tr_b16 a[132:133], v216 offset:12288
  v_lshl_add_u32 v7, v8, 3, v7
  v_mfma_f32_16x16x32_bf16 v[56:59], a[44:47], v[184:187], v[56:59]
  s_sub_u32 s100, s100, s44
  ds_read_b64_tr_b16 a[134:135], v216 offset:17408
  ds_read_b64_tr_b16 a[136:137], v217 offset:2048
  v_mfma_f32_16x16x32_bf16 v[60:63], a[40:43], v[180:183], v[60:63]
  s_mul_i32 s77, s77, 320
  ds_read_b64_tr_b16 a[138:139], v217 offset:7168
  v_add_u32 v7, s77, v7
  v_mfma_f32_16x16x32_bf16 v[60:63], a[44:47], v[188:191], v[60:63]
  s_lshl_b32 s90, s90, 5
  ds_read_b64_tr_b16 a[140:141], v217 offset:12288
  ds_read_b64_tr_b16 a[142:143], v217 offset:17408
  v_mfma_f32_16x16x32_bf16 v[64:67], a[48:51], v[176:179], v[64:67]
  s_cmp_ge_u32 s101, 10
  s_cselect_b32 s44, 10, 0
  ds_read_b64_tr_b16 a[144:145], v218
  ds_read_b64_tr_b16 a[146:147], v218 offset:5120
  v_mfma_f32_16x16x32_bf16 v[64:67], a[52:55], v[184:187], v[64:67]
  s_lshl_b32 s91, s91, 5
  ds_read_b64_tr_b16 a[148:149], v218 offset:10240
  v_add_u32 v8, 0x10000, v1
  v_mfma_f32_16x16x32_bf16 v[68:71], a[48:51], v[180:183], v[68:71]
  s_sub_u32 s101, s101, s44
  ds_read_b64_tr_b16 a[150:151], v218 offset:15360
  v_mfma_f32_16x16x32_bf16 v[68:71], a[52:55], v[188:191], v[68:71]
  s_lshl_b32 s100, s100, 5
  ds_read_b64_tr_b16 a[152:153], v219
  ds_read_b64_tr_b16 a[154:155], v219 offset:5120
  v_mfma_f32_16x16x32_bf16 v[72:75], a[56:59], v[176:179], v[72:75]
  s_cmp_ge_u32 s3, 10
  s_cselect_b32 s44, 10, 0
  ds_read_b64_tr_b16 a[156:157], v219 offset:10240
  v_mfma_f32_16x16x32_bf16 v[72:75], a[60:63], v[184:187], v[72:75]
  s_lshl_b32 s101, s101, 5
  ds_read_b64_tr_b16 a[158:159], v219 offset:15360
  v_mfma_f32_16x16x32_bf16 v[76:79], a[56:59], v[180:183], v[76:79]
  s_sub_u32 s3, s3, s44
  buffer_load_dwordx2 v[96:97], v7, s[4:7], s90 offen
  v_mfma_f32_16x16x32_bf16 v[76:79], a[60:63], v[188:191], v[76:79]
  s_lshl_b32 s3, s3, 5
  buffer_load_dwordx2 v[98:99], v7, s[4:7], s91 offen
  v_mfma_f32_16x16x32_bf16 v[80:83], a[64:67], v[176:179], v[80:83]
  s_sub_u32 s43, s72, s40
  buffer_load_dwordx2 v[100:101], v7, s[4:7], s100 offen
  v_mfma_f32_16x16x32_bf16 v[80:83], a[68:71], v[184:187], v[80:83]
  s_sub_u32 s43, s43, 1
  buffer_load_dwordx2 v[102:103], v7, s[4:7], s101 offen
  v_mfma_f32_16x16x32_bf16 v[84:87], a[64:67], v[180:183], v[84:87]
  s_and_b32 s43, s43, 3
  buffer_load_dwordx2 v[104:105], v7, s[4:7], s3 offen
  v_mfma_f32_16x16x32_bf16 v[84:87], a[68:71], v[188:191], v[84:87]
  s_mul_i32 s68, s43, 10240
  v_mfma_f32_16x16x32_bf16 v[88:91], a[72:75], v[176:179], v[88:91]
  s_add_u32 s68, s68, s75
  v_mfma_f32_16x16x32_bf16 v[88:91], a[76:79], v[184:187], v[88:91]
  s_lshl_b32 s44, s40, 15
  v_mfma_f32_16x16x32_bf16 v[92:95], a[72:75], v[180:183], v[92:95]
  s_add_u32 s68, s68, s44
  v_mfma_f32_16x16x32_bf16 v[92:95], a[76:79], v[188:191], v[92:95]
  s_waitcnt vmcnt(10) lgkmcnt(0)
  s_barrier
  v_mfma_f32_16x16x32_bf16 v[16:19], a[80:83], v[192:195], v[16:19]
  s_cmp_eq_u32 s43, 3
  s_cselect_b32 s68, 0x40000000, s68
  ds_read_b64_tr_b16 a[0:1], v208 offset:20480
  ds_read_b64_tr_b16 a[2:3], v208 offset:25600
  v_mfma_f32_16x16x32_bf16 v[16:19], a[84:87], v[200:203], v[16:19]
  s_add_u32 s59, s68, 0x0
  ds_read_b64_tr_b16 a[4:5], v208 offset:30720
  v_mfma_f32_16x16x32_bf16 v[20:23], a[80:83], v[196:199], v[20:23]
  s_add_u32 s56, s68, 0x1400
  ds_read_b64_tr_b16 a[6:7], v208 offset:35840
  v_mfma_f32_16x16x32_bf16 v[20:23], a[84:87], v[204:207], v[20:23]
  s_add_u32 s57, s68, 0x400
  ds_read_b64_tr_b16 a[8:9], v209 offset:20480
  ds_read_b64_tr_b16 a[10:11], v209 offset:25600
  v_mfma_f32_16x16x32_bf16 v[24:27], a[88:91], v[192:195], v[24:27]
  s_add_u32 s58, s68, 0x1800
  ds_read_b64_tr_b16 a[12:13], v209 offset:30720
  v_mfma_f32_16x16x32_bf16 v[24:27], a[92:95], v[200:203], v[24:27]
  s_lshl_b32 s70, s72, 15
  ds_read_b64_tr_b16 a[14:15], v209 offset:35840
  v_mfma_f32_16x16x32_bf16 v[28:31], a[88:91], v[196:199], v[28:31]
  s_add_u32 s70, s70, s75
  ds_read_b64_tr_b16 a[16:17], v210 offset:20480
  ds_read_b64_tr_b16 a[18:19], v210 offset:25600
  v_mfma_f32_16x16x32_bf16 v[28:31], a[92:95], v[204:207], v[28:31]
  s_mul_i32 s44, s40, 2560
  ds_read_b64_tr_b16 a[20:21], v210 offset:30720
  v_mfma_f32_16x16x32_bf16 v[32:35], a[96:99], v[192:195], v[32:35]
  s_add_u32 s70, s70, s44
  ds_read_b64_tr_b16 a[22:23], v210 offset:35840
  v_mfma_f32_16x16x32_bf16 v[32:35], a[100:103], v[200:203], v[32:35]
  s_mul_i32 s44, s40, 5120
  ds_read_b64_tr_b16 a[24:25], v211 offset:20480
  ds_read_b64_tr_b16 a[26:27], v211 offset:25600
  v_mfma_f32_16x16x32_bf16 v[36:39], a[96:99], v[196:199], v[36:39]
  s_add_u32 s44, s44, 0x10000
  ds_read_b64_tr_b16 a[28:29], v211 offset:30720
  v_add_u32 v10, s44, v1
  v_mfma_f32_16x16x32_bf16 v[36:39], a[100:103], v[204:207], v[36:39]
  s_add_u32 s81, s70, 10240
  ds_read_b64_tr_b16 a[30:31], v211 offset:35840
  v_mfma_f32_16x16x32_bf16 v[40:43], a[104:107], v[192:195], v[40:43]
  s_add_u32 s82, s70, 20480
  ds_read_b64_tr_b16 a[32:33], v208 offset:22528
  ds_read_b64_tr_b16 a[34:35], v208 offset:27648
  v_mfma_f32_16x16x32_bf16 v[40:43], a[108:111], v[200:203], v[40:43]
  ds_read_b64_tr_b16 a[36:37], v208 offset:32768
  v_mfma_f32_16x16x32_bf16 v[44:47], a[104:107], v[196:199], v[44:47]
  ds_read_b64_tr_b16 a[38:39], v208 offset:37888
  v_mfma_f32_16x16x32_bf16 v[44:47], a[108:111], v[204:207], v[44:47]
  s_nop 0
  ds_read_b64_tr_b16 a[40:41], v209 offset:22528
  ds_read_b64_tr_b16 a[42:43], v209 offset:27648
  v_mfma_f32_16x16x32_bf16 v[48:51], a[112:115], v[192:195], v[48:51]
  ds_read_b64_tr_b16 a[44:45], v209 offset:32768
  v_mfma_f32_16x16x32_bf16 v[48:51], a[116:119], v[200:203], v[48:51]
  ds_read_b64_tr_b16 a[46:47], v209 offset:37888
  v_mfma_f32_16x16x32_bf16 v[52:55], a[112:115], v[196:199], v[52:55]
  s_nop 0
  ds_read_b64_tr_b16 a[48:49], v210 offset:22528
  ds_read_b64_tr_b16 a[50:51], v210 offset:27648
  v_mfma_f32_16x16x32_bf16 v[52:55], a[116:119], v[204:207], v[52:55]
  ds_read_b64_tr_b16 a[52:53], v210 offset:32768
  v_mfma_f32_16x16x32_bf16 v[56:59], a[120:123], v[192:195], v[56:59]
  ds_read_b64_tr_b16 a[54:55], v210 offset:37888
  v_mfma_f32_16x16x32_bf16 v[56:59], a[124:127], v[200:203], v[56:59]
  s_nop 0
  ds_read_b64_tr_b16 a[56:57], v211 offset:22528
  ds_read_b64_tr_b16 a[58:59], v211 offset:27648
  v_mfma_f32_16x16x32_bf16 v[60:63], a[120:123], v[196:199], v[60:63]
  ds_read_b64_tr_b16 a[60:61], v211 offset:32768
  v_mfma_f32_16x16x32_bf16 v[60:63], a[124:127], v[204:207], v[60:63]
  ds_read_b64_tr_b16 a[62:63], v211 offset:37888
  v_mfma_f32_16x16x32_bf16 v[64:67], a[128:131], v[192:195], v[64:67]
  s_nop 0
  ds_read_b64_tr_b16 a[64:65], v212 offset:20480
  ds_read_b64_tr_b16 a[66:67], v212 offset:25600
  v_mfma_f32_16x16x32_bf16 v[64:67], a[132:135], v[200:203], v[64:67]
  ds_read_b64_tr_b16 a[68:69], v212 offset:30720
  v_mfma_f32_16x16x32_bf16 v[68:71], a[128:131], v[196:199], v[68:71]
  ds_read_b64_tr_b16 a[70:71], v212 offset:35840
  v_mfma_f32_16x16x32_bf16 v[68:71], a[132:135], v[204:207], v[68:71]
  s_nop 0
  ds_read_b64_tr_b16 a[72:73], v213 offset:20480
  ds_read_b64_tr_b16 a[74:75], v213 offset:25600
  v_mfma_f32_16x16x32_bf16 v[72:75], a[136:139], v[192:195], v[72:75]
  ds_read_b64_tr_b16 a[76:77], v213 offset:30720
  v_mfma_f32_16x16x32_bf16 v[72:75], a[140:143], v[200:203], v[72:75]
  ds_read_b64_tr_b16 a[78:79], v213 offset:35840
  v_mfma_f32_16x16x32_bf16 v[76:79], a[136:139], v[196:199], v[76:79]
  v_mfma_f32_16x16x32_bf16 v[76:79], a[140:143], v[204:207], v[76:79]
  v_mfma_f32_16x16x32_bf16 v[80:83], a[144:147], v[192:195], v[80:83]
  v_mfma_f32_16x16x32_bf16 v[80:83], a[148:151], v[200:203], v[80:83]
  v_mfma_f32_16x16x32_bf16 v[84:87], a[144:147], v[196:199], v[84:87]
  v_mfma_f32_16x16x32_bf16 v[84:87], a[148:151], v[204:207], v[84:87]
  v_mfma_f32_16x16x32_bf16 v[88:91], a[152:155], v[192:195], v[88:91]
  v_mfma_f32_16x16x32_bf16 v[88:91], a[156:159], v[200:203], v[88:91]
  v_mfma_f32_16x16x32_bf16 v[92:95], a[152:155], v[196:199], v[92:95]
  v_mfma_f32_16x16x32_bf16 v[92:95], a[156:159], v[204:207], v[92:95]
  s_waitcnt lgkmcnt(0)
  v_mfma_f32_16x16x32_bf16 v[16:19], a[0:3], a[160:163], v[16:19]
  v_mfma_f32_16x16x32_bf16 v[16:19], a[4:7], a[168:171], v[16:19]
  v_mfma_f32_16x16x32_bf16 v[20:23], a[0:3], a[164:167], v[20:23]
  v_mfma_f32_16x16x32_bf16 v[20:23], a[4:7], a[172:175], v[20:23]
  v_mfma_f32_16x16x32_bf16 v[24:27], a[8:11], a[160:163], v[24:27]
  v_mfma_f32_16x16x32_bf16 v[24:27], a[12:15], a[168:171], v[24:27]
  v_mfma_f32_16x16x32_bf16 v[28:31], a[8:11], a[164:167], v[28:31]
  v_mfma_f32_16x16x32_bf16 v[28:31], a[12:15], a[172:175], v[28:31]
  v_mfma_f32_16x16x32_bf16 v[32:35], a[16:19], a[160:163], v[32:35]
  v_mfma_f32_16x16x32_bf16 v[32:35], a[20:23], a[168:171], v[32:35]
  v_cvt_pk_bf16_f32 v112, v16, v17
  v_cvt_pk_bf16_f32 v113, v18, v19
  v_mfma_f32_16x16x32_bf16 v[36:39], a[16:19], a[164:167], v[36:39]
  v_cvt_pk_bf16_f32 v116, v20, v21
  v_cvt_pk_bf16_f32 v115, v26, v27
  v_mfma_f32_16x16x32_bf16 v[36:39], a[20:23], a[172:175], v[36:39]
  v_cvt_pk_bf16_f32 v114, v24, v25
  v_cvt_pk_bf16_f32 v119, v30, v31
  v_mfma_f32_16x16x32_bf16 v[40:43], a[24:27], a[160:163], v[40:43]
  buffer_store_dwordx4 v[112:115], v1, s[28:31], s59 offen sc1
  v_mfma_f32_16x16x32_bf16 v[40:43], a[28:31], a[168:171], v[40:43]
  s_add_u32 s59, s68, 0x800
  v_cvt_pk_bf16_f32 v118, v28, v29
  v_cvt_pk_bf16_f32 v117, v22, v23
  v_mfma_f32_16x16x32_bf16 v[44:47], a[24:27], a[164:167], v[44:47]
  buffer_store_dwordx4 v[116:119], v1, s[28:31], s56 offen sc1
  v_mfma_f32_16x16x32_bf16 v[44:47], a[28:31], a[172:175], v[44:47]
  s_add_u32 s56, s68, 0x1c00
  v_cvt_pk_bf16_f32 v120, v32, v33
  v_cvt_pk_bf16_f32 v123, v42, v43
  v_mfma_f32_16x16x32_bf16 v[48:51], a[32:35], a[160:163], v[48:51]
  v_cvt_pk_bf16_f32 v122, v40, v41
  v_cvt_pk_bf16_f32 v121, v34, v35
  v_mfma_f32_16x16x32_bf16 v[48:51], a[36:39], a[168:171], v[48:51]
  buffer_store_dwordx4 v[120:123], v1, s[28:31], s57 offen sc1
  v_mfma_f32_16x16x32_bf16 v[52:55], a[32:35], a[164:167], v[52:55]
  s_add_u32 s57, s68, 0xa00
  v_cvt_pk_bf16_f32 v127, v46, v47
  v_cvt_pk_bf16_f32 v126, v44, v45
  v_mfma_f32_16x16x32_bf16 v[52:55], a[36:39], a[172:175], v[52:55]
  v_cvt_pk_bf16_f32 v124, v36, v37
  v_cvt_pk_bf16_f32 v125, v38, v39
  v_mfma_f32_16x16x32_bf16 v[56:59], a[40:43], a[160:163], v[56:59]
  buffer_store_dwordx4 v[124:127], v1, s[28:31], s58 offen sc1
  v_mfma_f32_16x16x32_bf16 v[56:59], a[44:47], a[168:171], v[56:59]
  s_add_u32 s58, s68, 0x1e00
  v_cvt_pk_bf16_f32 v128, v48, v49
  v_cvt_pk_bf16_f32 v129, v50, v51
  v_mfma_f32_16x16x32_bf16 v[60:63], a[40:43], a[164:167], v[60:63]
  buffer_store_dwordx2 v[128:129], v9, s[28:31], s59 offen sc1
  v_mfma_f32_16x16x32_bf16 v[60:63], a[44:47], a[172:175], v[60:63]
  s_add_u32 s59, s68, 0xe00
  v_cvt_pk_bf16_f32 v132, v52, v53
  v_cvt_pk_bf16_f32 v133, v54, v55
  v_mfma_f32_16x16x32_bf16 v[64:67], a[48:51], a[160:163], v[64:67]
  buffer_store_dwordx2 v[132:133], v9, s[28:31], s56 offen sc1
  v_mfma_f32_16x16x32_bf16 v[64:67], a[52:55], a[168:171], v[64:67]
  s_add_u32 s56, s68, 0x2200
  v_cvt_pk_bf16_f32 v136, v56, v57
  v_cvt_pk_bf16_f32 v137, v58, v59
  v_mfma_f32_16x16x32_bf16 v[68:71], a[48:51], a[164:167], v[68:71]
  v_cvt_pk_bf16_f32 v140, v60, v61
  v_cvt_pk_bf16_f32 v141, v62, v63
  v_mfma_f32_16x16x32_bf16 v[68:71], a[52:55], a[172:175], v[68:71]
  v_mfma_f32_16x16x32_bf16 v[72:75], a[56:59], a[160:163], v[72:75]
  v_cvt_pk_bf16_f32 v139, v66, v67
  v_cvt_pk_bf16_f32 v138, v64, v65
  v_mfma_f32_16x16x32_bf16 v[72:75], a[60:63], a[168:171], v[72:75]
  buffer_store_dwordx4 v[136:139], v1, s[28:31], s57 offen sc1
  v_mfma_f32_16x16x32_bf16 v[76:79], a[56:59], a[164:167], v[76:79]
  s_add_u32 s57, s68, 0x1200
  v_mfma_f32_16x16x32_bf16 v[76:79], a[60:63], a[172:175], v[76:79]
  v_cvt_pk_bf16_f32 v143, v70, v71
  v_cvt_pk_bf16_f32 v142, v68, v69
  v_mfma_f32_16x16x32_bf16 v[80:83], a[64:67], a[160:163], v[80:83]
  buffer_store_dwordx4 v[140:143], v1, s[28:31], s58 offen sc1
  v_mfma_f32_16x16x32_bf16 v[80:83], a[68:71], a[168:171], v[80:83]
  s_add_u32 s58, s68, 0x2600
  v_cvt_pk_bf16_f32 v144, v72, v73
  v_cvt_pk_bf16_f32 v145, v74, v75
  v_mfma_f32_16x16x32_bf16 v[84:87], a[64:67], a[164:167], v[84:87]
  v_cvt_pk_bf16_f32 v148, v76, v77
  v_cvt_pk_bf16_f32 v149, v78, v79
  v_mfma_f32_16x16x32_bf16 v[84:87], a[68:71], a[172:175], v[84:87]
  v_mfma_f32_16x16x32_bf16 v[88:91], a[72:75], a[160:163], v[88:91]
  v_cvt_pk_bf16_f32 v147, v82, v83
  v_cvt_pk_bf16_f32 v146, v80, v81
  v_mfma_f32_16x16x32_bf16 v[88:91], a[76:79], a[168:171], v[88:91]
  buffer_store_dwordx4 v[144:147], v1, s[28:31], s59 offen sc1
  v_mfma_f32_16x16x32_bf16 v[92:95], a[72:75], a[164:167], v[92:95]
  v_mfma_f32_16x16x32_bf16 v[92:95], a[76:79], a[172:175], v[92:95]
  s_nop 0
  v_cvt_pk_bf16_f32 v151, v86, v87
  v_cvt_pk_bf16_f32 v150, v84, v85
  buffer_store_dwordx4 v[148:151], v1, s[28:31], s56 offen sc1
  s_nop 0
  v_cvt_pk_bf16_f32 v152, v88, v89
  v_cvt_pk_bf16_f32 v153, v90, v91
  buffer_store_dwordx2 v[152:153], v9, s[28:31], s57 offen sc1
  v_cvt_pk_bf16_f32 v156, v92, v93
  v_cvt_pk_bf16_f32 v157, v94, v95
  buffer_store_dwordx2 v[156:157], v9, s[28:31], s58 offen sc1
  s_cmp_eq_u32 s40, s72
  s_cbranch_scc0 L_k3_x
  ds_write_b128 v8, v[16:19]
  ds_write_b128 v8, v[20:23] offset:10240
  ds_write_b128 v8, v[24:27] offset:1024
  ds_write_b128 v8, v[28:31] offset:11264
  ds_write_b128 v8, v[32:35] offset:2048
  ds_write_b128 v8, v[36:39] offset:12288
  ds_write_b128 v8, v[40:43] offset:3072
  ds_write_b128 v8, v[44:47] offset:13312
  ds_write_b128 v8, v[48:51] offset:4096
  ds_write_b128 v8, v[52:55] offset:14336
  ds_write_b128 v8, v[56:59] offset:5120
  ds_write_b128 v8, v[60:63] offset:15360
  ds_write_b128 v8, v[64:67] offset:6144
  ds_write_b128 v8, v[68:71] offset:16384
  ds_write_b128 v8, v[72:75] offset:7168
  ds_write_b128 v8, v[76:79] offset:17408
  ds_write_b128 v8, v[80:83] offset:8192
  ds_write_b128 v8, v[84:87] offset:18432
  ds_write_b128 v8, v[88:91] offset:9216
  ds_write_b128 v8, v[92:95] offset:19456
L_k3_x:
  s_waitcnt lgkmcnt(0)
  s_barrier
  ds_read_b128 v[192:195], v10
  ds_read_b128 v[196:199], v10 offset:1024
  ds_read_b128 v[200:203], v10 offset:2048
  ds_read_b128 v[204:207], v10 offset:3072
  ds_read_b128 v[208:211], v10 offset:4096
  buffer_load_dwordx4 v[132:135], v1, s[28:31], s70 offen sc1
  buffer_load_dwordx4 v[136:139], v1, s[28:31], s70 offen offset:1024 sc1
  buffer_load_dwordx2 v[140:141], v9, s[28:31], s70 offen offset:2048 sc1
  buffer_load_dwordx4 v[144:147], v1, s[28:31], s81 offen sc1
  buffer_load_dwordx4 v[148:151], v1, s[28:31], s81 offen offset:1024 sc1
  buffer_load_dwordx2 v[152:153], v9, s[28:31], s81 offen offset:2048 sc1
  buffer_load_dwordx4 v[156:159], v1, s[28:31], s82 offen sc1
  buffer_load_dwordx4 v[160:163], v1, s[28:31], s82 offen offset:1024 sc1
  buffer_load_dwordx2 v[164:165], v9, s[28:31], s82 offen offset:2048 sc1
  s_waitcnt vmcnt(21)
  v_lshlrev_b32 v10, 16, v96
  v_and_b32 v11, 0xffff0000, v96
  s_waitcnt lgkmcnt(4)
  v_add_f32 v192, v192, v10
  v_add_f32 v193, v193, v11
  v_lshlrev_b32 v10, 16, v97
  v_and_b32 v11, 0xffff0000, v97
  v_add_f32 v194, v194, v10
  v_add_f32 v195, v195, v11
  v_lshlrev_b32 v10, 16, v98
  v_and_b32 v11, 0xffff0000, v98
  s_waitcnt lgkmcnt(3)
  v_add_f32 v196, v196, v10
  v_add_f32 v197, v197, v11
  v_lshlrev_b32 v10, 16, v99
  v_and_b32 v11, 0xffff0000, v99
  v_add_f32 v198, v198, v10
  v_add_f32 v199, v199, v11
  v_lshlrev_b32 v10, 16, v100
  v_and_b32 v11, 0xffff0000, v100
  s_waitcnt lgkmcnt(2)
  v_add_f32 v200, v200, v10
  v_add_f32 v201, v201, v11
  v_lshlrev_b32 v10, 16, v101
  v_and_b32 v11, 0xffff0000, v101
  v_add_f32 v202, v202, v10
  v_add_f32 v203, v203, v11
  v_lshlrev_b32 v10, 16, v102
  v_and_b32 v11, 0xffff0000, v102
  s_waitcnt lgkmcnt(1)
  v_add_f32 v204, v204, v10
  v_add_f32 v205, v205, v11
  v_lshlrev_b32 v10, 16, v103
  v_and_b32 v11, 0xffff0000, v103
  v_add_f32 v206, v206, v10
  v_add_f32 v207, v207, v11
  v_lshlrev_b32 v10, 16, v104
  v_and_b32 v11, 0xffff0000, v104
  s_waitcnt lgkmcnt(0)
  v_add_f32 v208, v208, v10
  v_add_f32 v209, v209, v11
  v_lshlrev_b32 v10, 16, v105
  v_and_b32 v11, 0xffff0000, v105
  v_add_f32 v210, v210, v10
  v_add_f32 v211, v211, v11
  s_mov_b32 s45, 0x186a0
L_inbox:
  s_waitcnt vmcnt(0)
  v_max3_u32 v110, v132, v133, v134
  v_max3_u32 v110, v110, v135, v136
  v_max3_u32 v110, v110, v137, v138
  v_max3_u32 v110, v110, v139, v140
  v_max3_u32 v110, v110, v141, v144
  v_max3_u32 v110, v110, v145, v146
  v_max3_u32 v110, v110, v147, v148
  v_max3_u32 v110, v110, v149, v150
  v_max3_u32 v110, v110, v151, v152
  v_max3_u32 v110, v110, v153, v156
  v_max3_u32 v110, v110, v157, v158
  v_max3_u32 v110, v110, v159, v160
  v_max3_u32 v110, v110, v161, v162
  v_max3_u32 v110, v110, v163, v164
  v_max_u32 v110, v110, v165
  v_cmp_eq_u32 vcc, -1, v110
  s_nop 3
  s_cbranch_vccz L_inbox_ok
  buffer_load_dwordx4 v[132:135], v1, s[28:31], s70 offen sc1
  buffer_load_dwordx4 v[136:139], v1, s[28:31], s70 offen offset:1024 sc1
  buffer_load_dwordx2 v[140:141], v9, s[28:31], s70 offen offset:2048 sc1
  buffer_load_dwordx4 v[144:147], v1, s[28:31], s81 offen sc1
  buffer_load_dwordx4 v[148:151], v1, s[28:31], s81 offen offset:1024 sc1
  buffer_load_dwordx2 v[152:153], v9, s[28:31], s81 offen offset:2048 sc1
  buffer_load_dwordx4 v[156:159], v1, s[28:31], s82 offen sc1
  buffer_load_dwordx4 v[160:163], v1, s[28:31], s82 offen offset:1024 sc1
  buffer_load_dwordx2 v[164:165], v9, s[28:31], s82 offen offset:2048 sc1
  s_sub_u32 s45, s45, 1
  s_cmp_lg_u32 s45, 0
  s_cbranch_scc1 L_inbox
  s_waitcnt vmcnt(0)
L_inbox_ok:
  v_lshlrev_b32 v10, 16, v132
  v_and_b32 v11, 0xffff0000, v132
  v_pk_add_f32 v[192:193], v[192:193], v[10:11]
  v_lshlrev_b32 v10, 16, v133
  v_and_b32 v11, 0xffff0000, v133
  v_pk_add_f32 v[194:195], v[194:195], v[10:11]
  v_lshlrev_b32 v10, 16, v144
  v_and_b32 v11, 0xffff0000, v144
  v_pk_add_f32 v[192:193], v[192:193], v[10:11]
  v_lshlrev_b32 v10, 16, v145
  v_and_b32 v11, 0xffff0000, v145
  v_pk_add_f32 v[194:195], v[194:195], v[10:11]
  v_lshlrev_b32 v10, 16, v156
  v_and_b32 v11, 0xffff0000, v156
  v_pk_add_f32 v[192:193], v[192:193], v[10:11]
  v_lshlrev_b32 v10, 16, v157
  v_and_b32 v11, 0xffff0000, v157
  v_pk_add_f32 v[194:195], v[194:195], v[10:11]
  v_cvt_pk_bf16_f32 v192, v192, v193
  v_cvt_pk_bf16_f32 v193, v194, v195
  buffer_store_dwordx2 v[192:193], v7, s[32:35], s90 offen
  v_lshlrev_b32 v10, 16, v134
  v_and_b32 v11, 0xffff0000, v134
  v_pk_add_f32 v[196:197], v[196:197], v[10:11]
  v_lshlrev_b32 v10, 16, v135
  v_and_b32 v11, 0xffff0000, v135
  v_pk_add_f32 v[198:199], v[198:199], v[10:11]
  v_lshlrev_b32 v10, 16, v146
  v_and_b32 v11, 0xffff0000, v146
  v_pk_add_f32 v[196:197], v[196:197], v[10:11]
  v_lshlrev_b32 v10, 16, v147
  v_and_b32 v11, 0xffff0000, v147
  v_pk_add_f32 v[198:199], v[198:199], v[10:11]
  v_lshlrev_b32 v10, 16, v158
  v_and_b32 v11, 0xffff0000, v158
  v_pk_add_f32 v[196:197], v[196:197], v[10:11]
  v_lshlrev_b32 v10, 16, v159
  v_and_b32 v11, 0xffff0000, v159
  v_pk_add_f32 v[198:199], v[198:199], v[10:11]
  v_cvt_pk_bf16_f32 v196, v196, v197
  v_cvt_pk_bf16_f32 v197, v198, v199
  buffer_store_dwordx2 v[196:197], v7, s[32:35], s91 offen
  v_lshlrev_b32 v10, 16, v136
  v_and_b32 v11, 0xffff0000, v136
  v_pk_add_f32 v[200:201], v[200:201], v[10:11]
  v_lshlrev_b32 v10, 16, v137
  v_and_b32 v11, 0xffff0000, v137
  v_pk_add_f32 v[202:203], v[202:203], v[10:11]
  v_lshlrev_b32 v10, 16, v148
  v_and_b32 v11, 0xffff0000, v148
  v_pk_add_f32 v[200:201], v[200:201], v[10:11]
  v_lshlrev_b32 v10, 16, v149
  v_and_b32 v11, 0xffff0000, v149
  v_pk_add_f32 v[202:203], v[202:203], v[10:11]
  v_lshlrev_b32 v10, 16, v160
  v_and_b32 v11, 0xffff0000, v160
  v_pk_add_f32 v[200:201], v[200:201], v[10:11]
  v_lshlrev_b32 v10, 16, v161
  v_and_b32 v11, 0xffff0000, v161
  v_pk_add_f32 v[202:203], v[202:203], v[10:11]
  v_cvt_pk_bf16_f32 v200, v200, v201
  v_cvt_pk_bf16_f32 v201, v202, v203
  buffer_store_dwordx2 v[200:201], v7, s[32:35], s100 offen
  v_lshlrev_b32 v10, 16, v138
  v_and_b32 v11, 0xffff0000, v138
  v_pk_add_f32 v[204:205], v[204:205], v[10:11]
  v_lshlrev_b32 v10, 16, v139
  v_and_b32 v11, 0xffff0000, v139
  v_pk_add_f32 v[206:207], v[206:207], v[10:11]
  v_lshlrev_b32 v10, 16, v150
  v_and_b32 v11, 0xffff0000, v150
  v_pk_add_f32 v[204:205], v[204:205], v[10:11]
  v_lshlrev_b32 v10, 16, v151
  v_and_b32 v11, 0xffff0000, v151
  v_pk_add_f32 v[206:207], v[206:207], v[10:11]
  v_lshlrev_b32 v10, 16, v162
  v_and_b32 v11, 0xffff0000, v162
  v_pk_add_f32 v[204:205], v[204:205], v[10:11]
  v_lshlrev_b32 v10, 16, v163
  v_and_b32 v11, 0xffff0000, v163
  v_pk_add_f32 v[206:207], v[206:207], v[10:11]
  v_cvt_pk_bf16_f32 v204, v204, v205
  v_cvt_pk_bf16_f32 v205, v206, v207
  buffer_store_dwordx2 v[204:205], v7, s[32:35], s101 offen
  v_lshlrev_b32 v10, 16, v140
  v_and_b32 v11, 0xffff0000, v140
  v_pk_add_f32 v[208:209], v[208:209], v[10:11]
  v_lshlrev_b32 v10, 16, v141
  v_and_b32 v11, 0xffff0000, v141
  v_pk_add_f32 v[210:211], v[210:211], v[10:11]
  v_lshlrev_b32 v10, 16, v152
  v_and_b32 v11, 0xffff0000, v152
  v_pk_add_f32 v[208:209], v[208:209], v[10:11]
  v_lshlrev_b32 v10, 16, v153
  v_and_b32 v11, 0xffff0000, v153
  v_pk_add_f32 v[210:211], v[210:211], v[10:11]
  v_lshlrev_b32 v10, 16, v164
  v_and_b32 v11, 0xffff0000, v164
  v_pk_add_f32 v[208:209], v[208:209], v[10:11]
  v_lshlrev_b32 v10, 16, v165
  v_and_b32 v11, 0xffff0000, v165
  v_pk_add_f32 v[210:211], v[210:211], v[10:11]
  v_cvt_pk_bf16_f32 v208, v208, v209
  v_cvt_pk_bf16_f32 v209, v210, v211
  buffer_store_dwordx2 v[208:209], v7, s[32:35], s3 offen
  s_endpgm
L_fallback:
  s_waitcnt vmcnt(0) lgkmcnt(0)
  v_accvgpr_write_b32 a0, 0
  v_accvgpr_write_b32 a1, 0
  v_accvgpr_write_b32 a2, 0
  v_accvgpr_write_b32 a3, 0
  v_accvgpr_write_b32 a4, 0
  v_accvgpr_write_b32 a5, 0
  v_accvgpr_write_b32 a6, 0
  v_accvgpr_write_b32 a7, 0
  v_accvgpr_write_b32 a8, 0
  v_accvgpr_write_b32 a9, 0
  v_accvgpr_write_b32 a10, 0
  v_accvgpr_write_b32 a11, 0
  v_accvgpr_write_b32 a12, 0
  v_accvgpr_write_b32 a13, 0
  v_accvgpr_write_b32 a14, 0
  v_accvgpr_write_b32 a15, 0
  v_accvgpr_write_b32 a16, 0
  v_accvgpr_write_b32 a17, 0
  v_accvgpr_write_b32 a18, 0
  v_accvgpr_write_b32 a19, 0
  v_accvgpr_write_b32 a20, 0
  v_accvgpr_write_b32 a21, 0
  v_accvgpr_write_b32 a22, 0
  v_accvgpr_write_b32 a23, 0
  v_accvgpr_write_b32 a24, 0
  v_accvgpr_write_b32 a25, 0
  v_accvgpr_write_b32 a26, 0
  v_accvgpr_write_b32 a27, 0
  v_accvgpr_write_b32 a28, 0
  v_accvgpr_write_b32 a29, 0
  v_accvgpr_write_b32 a30, 0
  v_accvgpr_write_b32 a31, 0
  v_accvgpr_write_b32 a32, 0
  v_accvgpr_write_b32 a33, 0
  v_accvgpr_write_b32 a34, 0
  v_accvgpr_write_b32 a35, 0
  v_accvgpr_write_b32 a36, 0
  v_accvgpr_write_b32 a37, 0
  v_accvgpr_write_b32 a38, 0
  v_accvgpr_write_b32 a39, 0
  v_accvgpr_write_b32 a40, 0
  v_accvgpr_write_b32 a41, 0
  v_accvgpr_write_b32 a42, 0
  v_accvgpr_write_b32 a43, 0
  v_accvgpr_write_b32 a44, 0
  v_accvgpr_write_b32 a45, 0
  v_accvgpr_write_b32 a46, 0
  v_accvgpr_write_b32 a47, 0
  v_accvgpr_write_b32 a48, 0
  v_accvgpr_write_b32 a49, 0
  v_accvgpr_write_b32 a50, 0
  v_accvgpr_write_b32 a51, 0
  v_accvgpr_write_b32 a52, 0
  v_accvgpr_write_b32 a53, 0
  v_accvgpr_write_b32 a54, 0
  v_accvgpr_write_b32 a55, 0
  v_accvgpr_write_b32 a56, 0
  v_accvgpr_write_b32 a57, 0
  v_accvgpr_write_b32 a58, 0
  v_accvgpr_write_b32 a59, 0
  v_accvgpr_write_b32 a60, 0
  v_accvgpr_write_b32 a61, 0
  v_accvgpr_write_b32 a62, 0
  v_accvgpr_write_b32 a63, 0
  v_accvgpr_write_b32 a64, 0
  v_accvgpr_write_b32 a65, 0
  v_accvgpr_write_b32 a66, 0
  v_accvgpr_write_b32 a67, 0
  v_accvgpr_write_b32 a68, 0
  v_accvgpr_write_b32 a69, 0
  v_accvgpr_write_b32 a70, 0
  v_accvgpr_write_b32 a71, 0
  v_accvgpr_write_b32 a72, 0
  v_accvgpr_write_b32 a73, 0
  v_accvgpr_write_b32 a74, 0
  v_accvgpr_write_b32 a75, 0
  v_accvgpr_write_b32 a76, 0
  v_accvgpr_write_b32 a77, 0
  v_accvgpr_write_b32 a78, 0
  v_accvgpr_write_b32 a79, 0
  v_accvgpr_write_b32 a80, 0
  v_accvgpr_write_b32 a81, 0
  v_accvgpr_write_b32 a82, 0
  v_accvgpr_write_b32 a83, 0
  v_accvgpr_write_b32 a84, 0
  v_accvgpr_write_b32 a85, 0
  v_accvgpr_write_b32 a86, 0
  v_accvgpr_write_b32 a87, 0
  v_accvgpr_write_b32 a88, 0
  v_accvgpr_write_b32 a89, 0
  v_accvgpr_write_b32 a90, 0
  v_accvgpr_write_b32 a91, 0
  v_accvgpr_write_b32 a92, 0
  v_accvgpr_write_b32 a93, 0
  v_accvgpr_write_b32 a94, 0
  v_accvgpr_write_b32 a95, 0
  v_accvgpr_write_b32 a96, 0
  v_accvgpr_write_b32 a97, 0
  v_accvgpr_write_b32 a98, 0
  v_accvgpr_write_b32 a99, 0
  v_accvgpr_write_b32 a100, 0
  v_accvgpr_write_b32 a101, 0
  v_accvgpr_write_b32 a102, 0
  v_accvgpr_write_b32 a103, 0
  v_accvgpr_write_b32 a104, 0
  v_accvgpr_write_b32 a105, 0
  v_accvgpr_write_b32 a106, 0
  v_accvgpr_write_b32 a107, 0
  v_accvgpr_write_b32 a108, 0
  v_accvgpr_write_b32 a109, 0
  v_accvgpr_write_b32 a110, 0
  v_accvgpr_write_b32 a111, 0
  v_accvgpr_write_b32 a112, 0
  v_accvgpr_write_b32 a113, 0
  v_accvgpr_write_b32 a114, 0
  v_accvgpr_write_b32 a115, 0
  v_accvgpr_write_b32 a116, 0
  v_accvgpr_write_b32 a117, 0
  v_accvgpr_write_b32 a118, 0
  v_accvgpr_write_b32 a119, 0
  v_accvgpr_write_b32 a120, 0
  v_accvgpr_write_b32 a121, 0
  v_accvgpr_write_b32 a122, 0
  v_accvgpr_write_b32 a123, 0
  v_accvgpr_write_b32 a124, 0
  v_accvgpr_write_b32 a125, 0
  v_accvgpr_write_b32 a126, 0
  v_accvgpr_write_b32 a127, 0
  v_accvgpr_write_b32 a128, 0
  v_accvgpr_write_b32 a129, 0
  v_accvgpr_write_b32 a130, 0
  v_accvgpr_write_b32 a131, 0
  v_accvgpr_write_b32 a132, 0
  v_accvgpr_write_b32 a133, 0
  v_accvgpr_write_b32 a134, 0
  v_accvgpr_write_b32 a135, 0
  v_accvgpr_write_b32 a136, 0
  v_accvgpr_write_b32 a137, 0
  v_accvgpr_write_b32 a138, 0
  v_accvgpr_write_b32 a139, 0
  v_accvgpr_write_b32 a140, 0
  v_accvgpr_write_b32 a141, 0
  v_accvgpr_write_b32 a142, 0
  v_accvgpr_write_b32 a143, 0
  v_mov_b32 v240, 0xf149f2ca
  v_mov_b32 v241, 0xf149f2ca
  v_mov_b32 v242, 0xf149f2ca
  v_mov_b32 v243, 0xf149f2ca
  s_mov_b32 s54, 0
  s_mov_b32 s55, s46
L_fb_loop:
  s_add_u32 s44, s55, 0x0
  buffer_load_dwordx4 v[80:83], v1, s[28:31], s44 offen sc1
  buffer_load_dwordx4 v[84:87], v1, s[28:31], s44 offen offset:1024 sc1
  buffer_load_dwordx4 v[88:91], v1, s[28:31], s44 offen offset:2048 sc1
  buffer_load_dwordx4 v[92:95], v1, s[28:31], s44 offen offset:3072 sc1
  s_add_u32 s44, s55, 0x1000
  buffer_load_dwordx4 v[96:99], v1, s[28:31], s44 offen sc1
  buffer_load_dwordx4 v[100:103], v1, s[28:31], s44 offen offset:1024 sc1
  buffer_load_dwordx4 v[104:107], v1, s[28:31], s44 offen offset:2048 sc1
  buffer_load_dwordx4 v[108:111], v1, s[28:31], s44 offen offset:3072 sc1
  s_add_u32 s44, s55, 0x2000
  buffer_load_dwordx4 v[112:115], v1, s[28:31], s44 offen sc1
  buffer_load_dwordx4 v[116:119], v1, s[28:31], s44 offen offset:1024 sc1
  buffer_load_dwordx4 v[120:123], v1, s[28:31], s44 offen offset:2048 sc1
  buffer_load_dwordx4 v[124:127], v1, s[28:31], s44 offen offset:3072 sc1
  s_add_u32 s44, s55, 0x3000
  buffer_load_dwordx4 v[128:131], v1, s[28:31], s44 offen sc1
  buffer_load_dwordx4 v[132:135], v1, s[28:31], s44 offen offset:1024 sc1
  buffer_load_dwordx4 v[136:139], v1, s[28:31], s44 offen offset:2048 sc1
  buffer_load_dwordx4 v[140:143], v1, s[28:31], s44 offen offset:3072 sc1
  s_waitcnt vmcnt(0)
  v_mfma_f32_16x16x32_bf16 v[16:19], v[80:83], a[144:147], 0
  v_mfma_f32_16x16x32_bf16 v[16:19], v[84:87], a[148:151], v[16:19]
  v_mfma_f32_16x16x32_bf16 v[16:19], v[88:91], a[152:155], v[16:19]
  v_mfma_f32_16x16x32_bf16 v[16:19], v[92:95], a[156:159], v[16:19]
  v_mfma_f32_16x16x32_bf16 v[20:23], v[80:83], a[160:163], 0
  v_mfma_f32_16x16x32_bf16 v[20:23], v[84:87], a[164:167], v[20:23]
  v_mfma_f32_16x16x32_bf16 v[20:23], v[88:91], a[168:171], v[20:23]
  v_mfma_f32_16x16x32_bf16 v[20:23], v[92:95], a[172:175], v[20:23]
  v_mfma_f32_16x16x32_bf16 v[24:27], v[80:83], a[176:179], 0
  v_mfma_f32_16x16x32_bf16 v[24:27], v[84:87], a[180:183], v[24:27]
  v_mfma_f32_16x16x32_bf16 v[24:27], v[88:91], a[184:187], v[24:27]
  v_mfma_f32_16x16x32_bf16 v[24:27], v[92:95], a[188:191], v[24:27]
  v_mfma_f32_16x16x32_bf16 v[28:31], v[80:83], a[192:195], 0
  v_mfma_f32_16x16x32_bf16 v[28:31], v[84:87], a[196:199], v[28:31]
  v_mfma_f32_16x16x32_bf16 v[28:31], v[88:91], a[200:203], v[28:31]
  v_mfma_f32_16x16x32_bf16 v[28:31], v[92:95], a[204:207], v[28:31]
  v_mfma_f32_16x16x32_bf16 v[32:35], v[96:99], a[144:147], 0
  v_mfma_f32_16x16x32_bf16 v[32:35], v[100:103], a[148:151], v[32:35]
  v_mfma_f32_16x16x32_bf16 v[32:35], v[104:107], a[152:155], v[32:35]
  v_mfma_f32_16x16x32_bf16 v[32:35], v[108:111], a[156:159], v[32:35]
  v_mfma_f32_16x16x32_bf16 v[36:39], v[96:99], a[160:163], 0
  v_mfma_f32_16x16x32_bf16 v[36:39], v[100:103], a[164:167], v[36:39]
  v_mfma_f32_16x16x32_bf16 v[36:39], v[104:107], a[168:171], v[36:39]
  v_mfma_f32_16x16x32_bf16 v[36:39], v[108:111], a[172:175], v[36:39]
  v_mfma_f32_16x16x32_bf16 v[40:43], v[96:99], a[176:179], 0
  v_mfma_f32_16x16x32_bf16 v[40:43], v[100:103], a[180:183], v[40:43]
  v_mfma_f32_16x16x32_bf16 v[40:43], v[104:107], a[184:187], v[40:43]
  v_mfma_f32_16x16x32_bf16 v[40:43], v[108:111], a[188:191], v[40:43]
  v_mfma_f32_16x16x32_bf16 v[44:47], v[96:99], a[192:195], 0
  v_mfma_f32_16x16x32_bf16 v[44:47], v[100:103], a[196:199], v[44:47]
  v_mfma_f32_16x16x32_bf16 v[44:47], v[104:107], a[200:203], v[44:47]
  v_mfma_f32_16x16x32_bf16 v[44:47], v[108:111], a[204:207], v[44:47]
  v_mfma_f32_16x16x32_bf16 v[48:51], v[112:115], a[144:147], 0
  v_mfma_f32_16x16x32_bf16 v[48:51], v[116:119], a[148:151], v[48:51]
  v_mfma_f32_16x16x32_bf16 v[48:51], v[120:123], a[152:155], v[48:51]
  v_mfma_f32_16x16x32_bf16 v[48:51], v[124:127], a[156:159], v[48:51]
  v_mfma_f32_16x16x32_bf16 v[52:55], v[112:115], a[160:163], 0
  v_mfma_f32_16x16x32_bf16 v[52:55], v[116:119], a[164:167], v[52:55]
  v_mfma_f32_16x16x32_bf16 v[52:55], v[120:123], a[168:171], v[52:55]
  v_mfma_f32_16x16x32_bf16 v[52:55], v[124:127], a[172:175], v[52:55]
  v_mfma_f32_16x16x32_bf16 v[56:59], v[112:115], a[176:179], 0
  v_mfma_f32_16x16x32_bf16 v[56:59], v[116:119], a[180:183], v[56:59]
  v_mfma_f32_16x16x32_bf16 v[56:59], v[120:123], a[184:187], v[56:59]
  v_mfma_f32_16x16x32_bf16 v[56:59], v[124:127], a[188:191], v[56:59]
  v_mfma_f32_16x16x32_bf16 v[60:63], v[112:115], a[192:195], 0
  v_mfma_f32_16x16x32_bf16 v[60:63], v[116:119], a[196:199], v[60:63]
  v_mfma_f32_16x16x32_bf16 v[60:63], v[120:123], a[200:203], v[60:63]
  v_mfma_f32_16x16x32_bf16 v[60:63], v[124:127], a[204:207], v[60:63]
  v_mfma_f32_16x16x32_bf16 v[64:67], v[128:131], a[144:147], 0
  v_mfma_f32_16x16x32_bf16 v[64:67], v[132:135], a[148:151], v[64:67]
  v_mfma_f32_16x16x32_bf16 v[64:67], v[136:139], a[152:155], v[64:67]
  v_mfma_f32_16x16x32_bf16 v[64:67], v[140:143], a[156:159], v[64:67]
  v_mfma_f32_16x16x32_bf16 v[68:71], v[128:131], a[160:163], 0
  v_mfma_f32_16x16x32_bf16 v[68:71], v[132:135], a[164:167], v[68:71]
  v_mfma_f32_16x16x32_bf16 v[68:71], v[136:139], a[168:171], v[68:71]
  v_mfma_f32_16x16x32_bf16 v[68:71], v[140:143], a[172:175], v[68:71]
  v_mfma_f32_16x16x32_bf16 v[72:75], v[128:131], a[176:179], 0
  v_mfma_f32_16x16x32_bf16 v[72:75], v[132:135], a[180:183], v[72:75]
  v_mfma_f32_16x16x32_bf16 v[72:75], v[136:139], a[184:187], v[72:75]
  v_mfma_f32_16x16x32_bf16 v[72:75], v[140:143], a[188:191], v[72:75]
  v_mfma_f32_16x16x32_bf16 v[76:79], v[128:131], a[192:195], 0
  v_mfma_f32_16x16x32_bf16 v[76:79], v[132:135], a[196:199], v[76:79]
  v_mfma_f32_16x16x32_bf16 v[76:79], v[136:139], a[200:203], v[76:79]
  v_mfma_f32_16x16x32_bf16 v[76:79], v[140:143], a[204:207], v[76:79]
  s_add_u32 s44, s55, 0x4000
  buffer_load_dwordx4 v[80:83], v1, s[28:31], s44 offen sc1
  buffer_load_dwordx4 v[84:87], v1, s[28:31], s44 offen offset:1024 sc1
  buffer_load_dwordx4 v[88:91], v1, s[28:31], s44 offen offset:2048 sc1
  buffer_load_dwordx4 v[92:95], v1, s[28:31], s44 offen offset:3072 sc1
  s_add_u32 s44, s55, 0x5000
  buffer_load_dwordx4 v[96:99], v1, s[28:31], s44 offen sc1
  buffer_load_dwordx4 v[100:103], v1, s[28:31], s44 offen offset:1024 sc1
  buffer_load_dwordx4 v[104:107], v1, s[28:31], s44 offen offset:2048 sc1
  buffer_load_dwordx4 v[108:111], v1, s[28:31], s44 offen offset:3072 sc1
  s_add_u32 s44, s55, 0x6000
  buffer_load_dwordx4 v[112:115], v1, s[28:31], s44 offen sc1
  buffer_load_dwordx4 v[116:119], v1, s[28:31], s44 offen offset:1024 sc1
  buffer_load_dwordx4 v[120:123], v1, s[28:31], s44 offen offset:2048 sc1
  buffer_load_dwordx4 v[124:127], v1, s[28:31], s44 offen offset:3072 sc1
  s_add_u32 s44, s55, 0x7000
  buffer_load_dwordx4 v[128:131], v1, s[28:31], s44 offen sc1
  buffer_load_dwordx4 v[132:135], v1, s[28:31], s44 offen offset:1024 sc1
  buffer_load_dwordx4 v[136:139], v1, s[28:31], s44 offen offset:2048 sc1
  buffer_load_dwordx4 v[140:143], v1, s[28:31], s44 offen offset:3072 sc1
  s_nop 7
  s_add_u32 s54, s54, 1
  s_cmp_eq_u32 s54, s94
  s_cbranch_scc0 L_fb_nomask
  v_cndmask_b32 v16, v5, v16, s[60:61]
  v_cndmask_b32 v17, v5, v17, s[62:63]
  v_cndmask_b32 v18, v5, v18, s[64:65]
  v_cndmask_b32 v19, v5, v19, s[66:67]
  v_mov_b32 v32, 0xf149f2ca
  v_mov_b32 v33, 0xf149f2ca
  v_mov_b32 v34, 0xf149f2ca
  v_mov_b32 v35, 0xf149f2ca
  v_cndmask_b32 v36, v5, v36, s[60:61]
  v_cndmask_b32 v37, v5, v37, s[62:63]
  v_cndmask_b32 v38, v5, v38, s[64:65]
  v_cndmask_b32 v39, v5, v39, s[66:67]
  v_mov_b32 v48, 0xf149f2ca
  v_mov_b32 v49, 0xf149f2ca
  v_mov_b32 v50, 0xf149f2ca
  v_mov_b32 v51, 0xf149f2ca
  v_mov_b32 v52, 0xf149f2ca
  v_mov_b32 v53, 0xf149f2ca
  v_mov_b32 v54, 0xf149f2ca
  v_mov_b32 v55, 0xf149f2ca
  v_cndmask_b32 v56, v5, v56, s[60:61]
  v_cndmask_b32 v57, v5, v57, s[62:63]
  v_cndmask_b32 v58, v5, v58, s[64:65]
  v_cndmask_b32 v59, v5, v59, s[66:67]
  v_mov_b32 v64, 0xf149f2ca
  v_mov_b32 v65, 0xf149f2ca
  v_mov_b32 v66, 0xf149f2ca
  v_mov_b32 v67, 0xf149f2ca
  v_mov_b32 v68, 0xf149f2ca
  v_mov_b32 v69, 0xf149f2ca
  v_mov_b32 v70, 0xf149f2ca
  v_mov_b32 v71, 0xf149f2ca
  v_mov_b32 v72, 0xf149f2ca
  v_mov_b32 v73, 0xf149f2ca
  v_mov_b32 v74, 0xf149f2ca
  v_mov_b32 v75, 0xf149f2ca
  v_cndmask_b32 v76, v5, v76, s[60:61]
  v_cndmask_b32 v77, v5, v77, s[62:63]
  v_cndmask_b32 v78, v5, v78, s[64:65]
  v_cndmask_b32 v79, v5, v79, s[66:67]
L_fb_nomask:
  v_max3_f32 v232, v16, v17, v18
  v_max3_f32 v232, v232, v19, v32
  v_max3_f32 v232, v232, v33, v34
  v_max3_f32 v232, v232, v35, v48
  v_max3_f32 v232, v232, v49, v50
  v_max3_f32 v232, v232, v51, v64
  v_max3_f32 v232, v232, v65, v66
  v_max_f32 v232, v232, v67
  v_max3_f32 v233, v20, v21, v22
  v_max3_f32 v233, v233, v23, v36
  v_max3_f32 v233, v233, v37, v38
  v_max3_f32 v233, v233, v39, v52
  v_max3_f32 v233, v233, v53, v54
  v_max3_f32 v233, v233, v55, v68
  v_max3_f32 v233, v233, v69, v70
  v_max_f32 v233, v233, v71
  v_max3_f32 v234, v24, v25, v26
  v_max3_f32 v234, v234, v27, v40
  v_max3_f32 v234, v234, v41, v42
  v_max3_f32 v234, v234, v43, v56
  v_max3_f32 v234, v234, v57, v58
  v_max3_f32 v234, v234, v59, v72
  v_max3_f32 v234, v234, v73, v74
  v_max_f32 v234, v234, v75
  v_max3_f32 v235, v28, v29, v30
  v_max3_f32 v235, v235, v31, v44
  v_max3_f32 v235, v235, v45, v46
  v_max3_f32 v235, v235, v47, v60
  v_max3_f32 v235, v235, v61, v62
  v_max3_f32 v235, v235, v63, v76
  v_max3_f32 v235, v235, v77, v78
  v_max_f32 v235, v235, v79
  v_mov_b32 v236, v232
  v_mov_b32 v237, v233
  v_mov_b32 v238, v234
  v_mov_b32 v239, v235
  v_permlane16_swap_b32 v232, v236
  v_permlane16_swap_b32 v233, v237
  v_permlane16_swap_b32 v234, v238
  v_permlane16_swap_b32 v235, v239
  v_max_f32 v232, v232, v236
  v_max_f32 v233, v233, v237
  v_max_f32 v234, v234, v238
  v_max_f32 v235, v235, v239
  v_mov_b32 v236, v232
  v_mov_b32 v237, v233
  v_mov_b32 v238, v234
  v_mov_b32 v239, v235
  v_permlane32_swap_b32 v232, v236
  v_permlane32_swap_b32 v233, v237
  v_permlane32_swap_b32 v234, v238
  v_permlane32_swap_b32 v235, v239
  v_max_f32 v232, v232, v236
  v_max_f32 v233, v233, v237
  v_max_f32 v234, v234, v238
  v_max_f32 v235, v235, v239
  v_max_f32 v232, v232, v240
  v_sub_f32 v244, v240, v232
  v_exp_f32 v244, v244
  v_mov_b32 v240, v232
  v_max_f32 v233, v233, v241
  v_sub_f32 v245, v241, v233
  v_exp_f32 v245, v245
  v_mov_b32 v241, v233
  v_max_f32 v234, v234, v242
  v_sub_f32 v246, v242, v234
  v_exp_f32 v246, v246
  v_mov_b32 v242, v234
  v_max_f32 v235, v235, v243
  v_sub_f32 v247, v243, v235
  v_exp_f32 v247, v247
  v_mov_b32 v243, v235
  v_accvgpr_read_b32 v228, a0
  v_mul_f32 v228, v228, v244
  v_accvgpr_write_b32 a0, v228
  v_accvgpr_read_b32 v228, a1
  v_mul_f32 v228, v228, v244
  v_accvgpr_write_b32 a1, v228
  v_accvgpr_read_b32 v228, a2
  v_mul_f32 v228, v228, v244
  v_accvgpr_write_b32 a2, v228
  v_accvgpr_read_b32 v228, a3
  v_mul_f32 v228, v228, v244
  v_accvgpr_write_b32 a3, v228
  v_accvgpr_read_b32 v228, a16
  v_mul_f32 v228, v228, v244
  v_accvgpr_write_b32 a16, v228
  v_accvgpr_read_b32 v228, a17
  v_mul_f32 v228, v228, v244
  v_accvgpr_write_b32 a17, v228
  v_accvgpr_read_b32 v228, a18
  v_mul_f32 v228, v228, v244
  v_accvgpr_write_b32 a18, v228
  v_accvgpr_read_b32 v228, a19
  v_mul_f32 v228, v228, v244
  v_accvgpr_write_b32 a19, v228
  v_accvgpr_read_b32 v228, a32
  v_mul_f32 v228, v228, v244
  v_accvgpr_write_b32 a32, v228
  v_accvgpr_read_b32 v228, a33
  v_mul_f32 v228, v228, v244
  v_accvgpr_write_b32 a33, v228
  v_accvgpr_read_b32 v228, a34
  v_mul_f32 v228, v228, v244
  v_accvgpr_write_b32 a34, v228
  v_accvgpr_read_b32 v228, a35
  v_mul_f32 v228, v228, v244
  v_accvgpr_write_b32 a35, v228
  v_accvgpr_read_b32 v228, a48
  v_mul_f32 v228, v228, v244
  v_accvgpr_write_b32 a48, v228
  v_accvgpr_read_b32 v228, a49
  v_mul_f32 v228, v228, v244
  v_accvgpr_write_b32 a49, v228
  v_accvgpr_read_b32 v228, a50
  v_mul_f32 v228, v228, v244
  v_accvgpr_write_b32 a50, v228
  v_accvgpr_read_b32 v228, a51
  v_mul_f32 v228, v228, v244
  v_accvgpr_write_b32 a51, v228
  v_accvgpr_read_b32 v228, a64
  v_mul_f32 v228, v228, v244
  v_accvgpr_write_b32 a64, v228
  v_accvgpr_read_b32 v228, a65
  v_mul_f32 v228, v228, v244
  v_accvgpr_write_b32 a65, v228
  v_accvgpr_read_b32 v228, a66
  v_mul_f32 v228, v228, v244
  v_accvgpr_write_b32 a66, v228
  v_accvgpr_read_b32 v228, a67
  v_mul_f32 v228, v228, v244
  v_accvgpr_write_b32 a67, v228
  v_accvgpr_read_b32 v228, a80
  v_mul_f32 v228, v228, v244
  v_accvgpr_write_b32 a80, v228
  v_accvgpr_read_b32 v228, a81
  v_mul_f32 v228, v228, v244
  v_accvgpr_write_b32 a81, v228
  v_accvgpr_read_b32 v228, a82
  v_mul_f32 v228, v228, v244
  v_accvgpr_write_b32 a82, v228
  v_accvgpr_read_b32 v228, a83
  v_mul_f32 v228, v228, v244
  v_accvgpr_write_b32 a83, v228
  v_accvgpr_read_b32 v228, a96
  v_mul_f32 v228, v228, v244
  v_accvgpr_write_b32 a96, v228
  v_accvgpr_read_b32 v228, a97
  v_mul_f32 v228, v228, v244
  v_accvgpr_write_b32 a97, v228
  v_accvgpr_read_b32 v228, a98
  v_mul_f32 v228, v228, v244
  v_accvgpr_write_b32 a98, v228
  v_accvgpr_read_b32 v228, a99
  v_mul_f32 v228, v228, v244
  v_accvgpr_write_b32 a99, v228
  v_accvgpr_read_b32 v228, a112
  v_mul_f32 v228, v228, v244
  v_accvgpr_write_b32 a112, v228
  v_accvgpr_read_b32 v228, a113
  v_mul_f32 v228, v228, v244
  v_accvgpr_write_b32 a113, v228
  v_accvgpr_read_b32 v228, a114
  v_mul_f32 v228, v228, v244
  v_accvgpr_write_b32 a114, v228
  v_accvgpr_read_b32 v228, a115
  v_mul_f32 v228, v228, v244
  v_accvgpr_write_b32 a115, v228
  v_accvgpr_read_b32 v228, a128
  v_mul_f32 v228, v228, v244
  v_accvgpr_write_b32 a128, v228
  v_accvgpr_read_b32 v228, a129
  v_mul_f32 v228, v228, v244
  v_accvgpr_write_b32 a129, v228
  v_accvgpr_read_b32 v228, a130
  v_mul_f32 v228, v228, v244
  v_accvgpr_write_b32 a130, v228
  v_accvgpr_read_b32 v228, a131
  v_mul_f32 v228, v228, v244
  v_accvgpr_write_b32 a131, v228
  v_accvgpr_read_b32 v228, a4
  v_mul_f32 v228, v228, v245
  v_accvgpr_write_b32 a4, v228
  v_accvgpr_read_b32 v228, a5
  v_mul_f32 v228, v228, v245
  v_accvgpr_write_b32 a5, v228
  v_accvgpr_read_b32 v228, a6
  v_mul_f32 v228, v228, v245
  v_accvgpr_write_b32 a6, v228
  v_accvgpr_read_b32 v228, a7
  v_mul_f32 v228, v228, v245
  v_accvgpr_write_b32 a7, v228
  v_accvgpr_read_b32 v228, a20
  v_mul_f32 v228, v228, v245
  v_accvgpr_write_b32 a20, v228
  v_accvgpr_read_b32 v228, a21
  v_mul_f32 v228, v228, v245
  v_accvgpr_write_b32 a21, v228
  v_accvgpr_read_b32 v228, a22
  v_mul_f32 v228, v228, v245
  v_accvgpr_write_b32 a22, v228
  v_accvgpr_read_b32 v228, a23
  v_mul_f32 v228, v228, v245
  v_accvgpr_write_b32 a23, v228
  v_accvgpr_read_b32 v228, a36
  v_mul_f32 v228, v228, v245
  v_accvgpr_write_b32 a36, v228
  v_accvgpr_read_b32 v228, a37
  v_mul_f32 v228, v228, v245
  v_accvgpr_write_b32 a37, v228
  v_accvgpr_read_b32 v228, a38
  v_mul_f32 v228, v228, v245
  v_accvgpr_write_b32 a38, v228
  v_accvgpr_read_b32 v228, a39
  v_mul_f32 v228, v228, v245
  v_accvgpr_write_b32 a39, v228
  v_accvgpr_read_b32 v228, a52
  v_mul_f32 v228, v228, v245
  v_accvgpr_write_b32 a52, v228
  v_accvgpr_read_b32 v228, a53
  v_mul_f32 v228, v228, v245
  v_accvgpr_write_b32 a53, v228
  v_accvgpr_read_b32 v228, a54
  v_mul_f32 v228, v228, v245
  v_accvgpr_write_b32 a54, v228
  v_accvgpr_read_b32 v228, a55
  v_mul_f32 v228, v228, v245
  v_accvgpr_write_b32 a55, v228
  v_accvgpr_read_b32 v228, a68
  v_mul_f32 v228, v228, v245
  v_accvgpr_write_b32 a68, v228
  v_accvgpr_read_b32 v228, a69
  v_mul_f32 v228, v228, v245
  v_accvgpr_write_b32 a69, v228
  v_accvgpr_read_b32 v228, a70
  v_mul_f32 v228, v228, v245
  v_accvgpr_write_b32 a70, v228
  v_accvgpr_read_b32 v228, a71
  v_mul_f32 v228, v228, v245
  v_accvgpr_write_b32 a71, v228
  v_accvgpr_read_b32 v228, a84
  v_mul_f32 v228, v228, v245
  v_accvgpr_write_b32 a84, v228
  v_accvgpr_read_b32 v228, a85
  v_mul_f32 v228, v228, v245
  v_accvgpr_write_b32 a85, v228
  v_accvgpr_read_b32 v228, a86
  v_mul_f32 v228, v228, v245
  v_accvgpr_write_b32 a86, v228
  v_accvgpr_read_b32 v228, a87
  v_mul_f32 v228, v228, v245
  v_accvgpr_write_b32 a87, v228
  v_accvgpr_read_b32 v228, a100
  v_mul_f32 v228, v228, v245
  v_accvgpr_write_b32 a100, v228
  v_accvgpr_read_b32 v228, a101
  v_mul_f32 v228, v228, v245
  v_accvgpr_write_b32 a101, v228
  v_accvgpr_read_b32 v228, a102
  v_mul_f32 v228, v228, v245
  v_accvgpr_write_b32 a102, v228
  v_accvgpr_read_b32 v228, a103
  v_mul_f32 v228, v228, v245
  v_accvgpr_write_b32 a103, v228
  v_accvgpr_read_b32 v228, a116
  v_mul_f32 v228, v228, v245
  v_accvgpr_write_b32 a116, v228
  v_accvgpr_read_b32 v228, a117
  v_mul_f32 v228, v228, v245
  v_accvgpr_write_b32 a117, v228
  v_accvgpr_read_b32 v228, a118
  v_mul_f32 v228, v228, v245
  v_accvgpr_write_b32 a118, v228
  v_accvgpr_read_b32 v228, a119
  v_mul_f32 v228, v228, v245
  v_accvgpr_write_b32 a119, v228
  v_accvgpr_read_b32 v228, a132
  v_mul_f32 v228, v228, v245
  v_accvgpr_write_b32 a132, v228
  v_accvgpr_read_b32 v228, a133
  v_mul_f32 v228, v228, v245
  v_accvgpr_write_b32 a133, v228
  v_accvgpr_read_b32 v228, a134
  v_mul_f32 v228, v228, v245
  v_accvgpr_write_b32 a134, v228
  v_accvgpr_read_b32 v228, a135
  v_mul_f32 v228, v228, v245
  v_accvgpr_write_b32 a135, v228
  v_accvgpr_read_b32 v228, a8
  v_mul_f32 v228, v228, v246
  v_accvgpr_write_b32 a8, v228
  v_accvgpr_read_b32 v228, a9
  v_mul_f32 v228, v228, v246
  v_accvgpr_write_b32 a9, v228
  v_accvgpr_read_b32 v228, a10
  v_mul_f32 v228, v228, v246
  v_accvgpr_write_b32 a10, v228
  v_accvgpr_read_b32 v228, a11
  v_mul_f32 v228, v228, v246
  v_accvgpr_write_b32 a11, v228
  v_accvgpr_read_b32 v228, a24
  v_mul_f32 v228, v228, v246
  v_accvgpr_write_b32 a24, v228
  v_accvgpr_read_b32 v228, a25
  v_mul_f32 v228, v228, v246
  v_accvgpr_write_b32 a25, v228
  v_accvgpr_read_b32 v228, a26
  v_mul_f32 v228, v228, v246
  v_accvgpr_write_b32 a26, v228
  v_accvgpr_read_b32 v228, a27
  v_mul_f32 v228, v228, v246
  v_accvgpr_write_b32 a27, v228
  v_accvgpr_read_b32 v228, a40
  v_mul_f32 v228, v228, v246
  v_accvgpr_write_b32 a40, v228
  v_accvgpr_read_b32 v228, a41
  v_mul_f32 v228, v228, v246
  v_accvgpr_write_b32 a41, v228
  v_accvgpr_read_b32 v228, a42
  v_mul_f32 v228, v228, v246
  v_accvgpr_write_b32 a42, v228
  v_accvgpr_read_b32 v228, a43
  v_mul_f32 v228, v228, v246
  v_accvgpr_write_b32 a43, v228
  v_accvgpr_read_b32 v228, a56
  v_mul_f32 v228, v228, v246
  v_accvgpr_write_b32 a56, v228
  v_accvgpr_read_b32 v228, a57
  v_mul_f32 v228, v228, v246
  v_accvgpr_write_b32 a57, v228
  v_accvgpr_read_b32 v228, a58
  v_mul_f32 v228, v228, v246
  v_accvgpr_write_b32 a58, v228
  v_accvgpr_read_b32 v228, a59
  v_mul_f32 v228, v228, v246
  v_accvgpr_write_b32 a59, v228
  v_accvgpr_read_b32 v228, a72
  v_mul_f32 v228, v228, v246
  v_accvgpr_write_b32 a72, v228
  v_accvgpr_read_b32 v228, a73
  v_mul_f32 v228, v228, v246
  v_accvgpr_write_b32 a73, v228
  v_accvgpr_read_b32 v228, a74
  v_mul_f32 v228, v228, v246
  v_accvgpr_write_b32 a74, v228
  v_accvgpr_read_b32 v228, a75
  v_mul_f32 v228, v228, v246
  v_accvgpr_write_b32 a75, v228
  v_accvgpr_read_b32 v228, a88
  v_mul_f32 v228, v228, v246
  v_accvgpr_write_b32 a88, v228
  v_accvgpr_read_b32 v228, a89
  v_mul_f32 v228, v228, v246
  v_accvgpr_write_b32 a89, v228
  v_accvgpr_read_b32 v228, a90
  v_mul_f32 v228, v228, v246
  v_accvgpr_write_b32 a90, v228
  v_accvgpr_read_b32 v228, a91
  v_mul_f32 v228, v228, v246
  v_accvgpr_write_b32 a91, v228
  v_accvgpr_read_b32 v228, a104
  v_mul_f32 v228, v228, v246
  v_accvgpr_write_b32 a104, v228
  v_accvgpr_read_b32 v228, a105
  v_mul_f32 v228, v228, v246
  v_accvgpr_write_b32 a105, v228
  v_accvgpr_read_b32 v228, a106
  v_mul_f32 v228, v228, v246
  v_accvgpr_write_b32 a106, v228
  v_accvgpr_read_b32 v228, a107
  v_mul_f32 v228, v228, v246
  v_accvgpr_write_b32 a107, v228
  v_accvgpr_read_b32 v228, a120
  v_mul_f32 v228, v228, v246
  v_accvgpr_write_b32 a120, v228
  v_accvgpr_read_b32 v228, a121
  v_mul_f32 v228, v228, v246
  v_accvgpr_write_b32 a121, v228
  v_accvgpr_read_b32 v228, a122
  v_mul_f32 v228, v228, v246
  v_accvgpr_write_b32 a122, v228
  v_accvgpr_read_b32 v228, a123
  v_mul_f32 v228, v228, v246
  v_accvgpr_write_b32 a123, v228
  v_accvgpr_read_b32 v228, a136
  v_mul_f32 v228, v228, v246
  v_accvgpr_write_b32 a136, v228
  v_accvgpr_read_b32 v228, a137
  v_mul_f32 v228, v228, v246
  v_accvgpr_write_b32 a137, v228
  v_accvgpr_read_b32 v228, a138
  v_mul_f32 v228, v228, v246
  v_accvgpr_write_b32 a138, v228
  v_accvgpr_read_b32 v228, a139
  v_mul_f32 v228, v228, v246
  v_accvgpr_write_b32 a139, v228
  v_accvgpr_read_b32 v228, a12
  v_mul_f32 v228, v228, v247
  v_accvgpr_write_b32 a12, v228
  v_accvgpr_read_b32 v228, a13
  v_mul_f32 v228, v228, v247
  v_accvgpr_write_b32 a13, v228
  v_accvgpr_read_b32 v228, a14
  v_mul_f32 v228, v228, v247
  v_accvgpr_write_b32 a14, v228
  v_accvgpr_read_b32 v228, a15
  v_mul_f32 v228, v228, v247
  v_accvgpr_write_b32 a15, v228
  v_accvgpr_read_b32 v228, a28
  v_mul_f32 v228, v228, v247
  v_accvgpr_write_b32 a28, v228
  v_accvgpr_read_b32 v228, a29
  v_mul_f32 v228, v228, v247
  v_accvgpr_write_b32 a29, v228
  v_accvgpr_read_b32 v228, a30
  v_mul_f32 v228, v228, v247
  v_accvgpr_write_b32 a30, v228
  v_accvgpr_read_b32 v228, a31
  v_mul_f32 v228, v228, v247
  v_accvgpr_write_b32 a31, v228
  v_accvgpr_read_b32 v228, a44
  v_mul_f32 v228, v228, v247
  v_accvgpr_write_b32 a44, v228
  v_accvgpr_read_b32 v228, a45
  v_mul_f32 v228, v228, v247
  v_accvgpr_write_b32 a45, v228
  v_accvgpr_read_b32 v228, a46
  v_mul_f32 v228, v228, v247
  v_accvgpr_write_b32 a46, v228
  v_accvgpr_read_b32 v228, a47
  v_mul_f32 v228, v228, v247
  v_accvgpr_write_b32 a47, v228
  v_accvgpr_read_b32 v228, a60
  v_mul_f32 v228, v228, v247
  v_accvgpr_write_b32 a60, v228
  v_accvgpr_read_b32 v228, a61
  v_mul_f32 v228, v228, v247
  v_accvgpr_write_b32 a61, v228
  v_accvgpr_read_b32 v228, a62
  v_mul_f32 v228, v228, v247
  v_accvgpr_write_b32 a62, v228
  v_accvgpr_read_b32 v228, a63
  v_mul_f32 v228, v228, v247
  v_accvgpr_write_b32 a63, v228
  v_accvgpr_read_b32 v228, a76
  v_mul_f32 v228, v228, v247
  v_accvgpr_write_b32 a76, v228
  v_accvgpr_read_b32 v228, a77
  v_mul_f32 v228, v228, v247
  v_accvgpr_write_b32 a77, v228
  v_accvgpr_read_b32 v228, a78
  v_mul_f32 v228, v228, v247
  v_accvgpr_write_b32 a78, v228
  v_accvgpr_read_b32 v228, a79
  v_mul_f32 v228, v228, v247
  v_accvgpr_write_b32 a79, v228
  v_accvgpr_read_b32 v228, a92
  v_mul_f32 v228, v228, v247
  v_accvgpr_write_b32 a92, v228
  v_accvgpr_read_b32 v228, a93
  v_mul_f32 v228, v228, v247
  v_accvgpr_write_b32 a93, v228
  v_accvgpr_read_b32 v228, a94
  v_mul_f32 v228, v228, v247
  v_accvgpr_write_b32 a94, v228
  v_accvgpr_read_b32 v228, a95
  v_mul_f32 v228, v228, v247
  v_accvgpr_write_b32 a95, v228
  v_accvgpr_read_b32 v228, a108
  v_mul_f32 v228, v228, v247
  v_accvgpr_write_b32 a108, v228
  v_accvgpr_read_b32 v228, a109
  v_mul_f32 v228, v228, v247
  v_accvgpr_write_b32 a109, v228
  v_accvgpr_read_b32 v228, a110
  v_mul_f32 v228, v228, v247
  v_accvgpr_write_b32 a110, v228
  v_accvgpr_read_b32 v228, a111
  v_mul_f32 v228, v228, v247
  v_accvgpr_write_b32 a111, v228
  v_accvgpr_read_b32 v228, a124
  v_mul_f32 v228, v228, v247
  v_accvgpr_write_b32 a124, v228
  v_accvgpr_read_b32 v228, a125
  v_mul_f32 v228, v228, v247
  v_accvgpr_write_b32 a125, v228
  v_accvgpr_read_b32 v228, a126
  v_mul_f32 v228, v228, v247
  v_accvgpr_write_b32 a126, v228
  v_accvgpr_read_b32 v228, a127
  v_mul_f32 v228, v228, v247
  v_accvgpr_write_b32 a127, v228
  v_accvgpr_read_b32 v228, a140
  v_mul_f32 v228, v228, v247
  v_accvgpr_write_b32 a140, v228
  v_accvgpr_read_b32 v228, a141
  v_mul_f32 v228, v228, v247
  v_accvgpr_write_b32 a141, v228
  v_accvgpr_read_b32 v228, a142
  v_mul_f32 v228, v228, v247
  v_accvgpr_write_b32 a142, v228
  v_accvgpr_read_b32 v228, a143
  v_mul_f32 v228, v228, v247
  v_accvgpr_write_b32 a143, v228
  v_sub_f32 v16, v16, v240
  v_sub_f32 v17, v17, v240
  v_sub_f32 v18, v18, v240
  v_sub_f32 v19, v19, v240
  v_sub_f32 v20, v20, v241
  v_sub_f32 v21, v21, v241
  v_sub_f32 v22, v22, v241
  v_sub_f32 v23, v23, v241
  v_sub_f32 v24, v24, v242
  v_sub_f32 v25, v25, v242
  v_sub_f32 v26, v26, v242
  v_sub_f32 v27, v27, v242
  v_sub_f32 v28, v28, v243
  v_sub_f32 v29, v29, v243
  v_sub_f32 v30, v30, v243
  v_sub_f32 v31, v31, v243
  v_sub_f32 v32, v32, v240
  v_sub_f32 v33, v33, v240
  v_sub_f32 v34, v34, v240
  v_sub_f32 v35, v35, v240
  v_sub_f32 v36, v36, v241
  v_sub_f32 v37, v37, v241
  v_sub_f32 v38, v38, v241
  v_sub_f32 v39, v39, v241
  v_sub_f32 v40, v40, v242
  v_sub_f32 v41, v41, v242
  v_sub_f32 v42, v42, v242
  v_sub_f32 v43, v43, v242
  v_sub_f32 v44, v44, v243
  v_sub_f32 v45, v45, v243
  v_sub_f32 v46, v46, v243
  v_sub_f32 v47, v47, v243
  v_sub_f32 v48, v48, v240
  v_sub_f32 v49, v49, v240
  v_sub_f32 v50, v50, v240
  v_sub_f32 v51, v51, v240
  v_sub_f32 v52, v52, v241
  v_sub_f32 v53, v53, v241
  v_sub_f32 v54, v54, v241
  v_sub_f32 v55, v55, v241
  v_sub_f32 v56, v56, v242
  v_sub_f32 v57, v57, v242
  v_sub_f32 v58, v58, v242
  v_sub_f32 v59, v59, v242
  v_sub_f32 v60, v60, v243
  v_sub_f32 v61, v61, v243
  v_sub_f32 v62, v62, v243
  v_sub_f32 v63, v63, v243
  v_sub_f32 v64, v64, v240
  v_sub_f32 v65, v65, v240
  v_sub_f32 v66, v66, v240
  v_sub_f32 v67, v67, v240
  v_sub_f32 v68, v68, v241
  v_sub_f32 v69, v69, v241
  v_sub_f32 v70, v70, v241
  v_sub_f32 v71, v71, v241
  v_sub_f32 v72, v72, v242
  v_sub_f32 v73, v73, v242
  v_sub_f32 v74, v74, v242
  v_sub_f32 v75, v75, v242
  v_sub_f32 v76, v76, v243
  v_sub_f32 v77, v77, v243
  v_sub_f32 v78, v78, v243
  v_sub_f32 v79, v79, v243
  v_exp_f32 v16, v16
  v_exp_f32 v17, v17
  s_nop 0
  v_cvt_pk_bf16_f32 v144, v16, v17
  v_exp_f32 v18, v18
  v_exp_f32 v19, v19
  s_nop 0
  v_cvt_pk_bf16_f32 v145, v18, v19
  v_exp_f32 v20, v20
  v_exp_f32 v21, v21
  s_nop 0
  v_cvt_pk_bf16_f32 v152, v20, v21
  v_exp_f32 v22, v22
  v_exp_f32 v23, v23
  s_nop 0
  v_cvt_pk_bf16_f32 v153, v22, v23
  v_exp_f32 v24, v24
  v_exp_f32 v25, v25
  s_nop 0
  v_cvt_pk_bf16_f32 v160, v24, v25
  v_exp_f32 v26, v26
  v_exp_f32 v27, v27
  s_nop 0
  v_cvt_pk_bf16_f32 v161, v26, v27
  v_exp_f32 v28, v28
  v_exp_f32 v29, v29
  s_nop 0
  v_cvt_pk_bf16_f32 v168, v28, v29
  v_exp_f32 v30, v30
  v_exp_f32 v31, v31
  s_nop 0
  v_cvt_pk_bf16_f32 v169, v30, v31
  v_exp_f32 v32, v32
  v_exp_f32 v33, v33
  s_nop 0
  v_cvt_pk_bf16_f32 v146, v32, v33
  v_exp_f32 v34, v34
  v_exp_f32 v35, v35
  s_nop 0
  v_cvt_pk_bf16_f32 v147, v34, v35
  v_exp_f32 v36, v36
  v_exp_f32 v37, v37
  s_nop 0
  v_cvt_pk_bf16_f32 v154, v36, v37
  v_exp_f32 v38, v38
  v_exp_f32 v39, v39
  s_nop 0
  v_cvt_pk_bf16_f32 v155, v38, v39
  v_exp_f32 v40, v40
  v_exp_f32 v41, v41
  s_nop 0
  v_cvt_pk_bf16_f32 v162, v40, v41
  v_exp_f32 v42, v42
  v_exp_f32 v43, v43
  s_nop 0
  v_cvt_pk_bf16_f32 v163, v42, v43
  v_exp_f32 v44, v44
  v_exp_f32 v45, v45
  s_nop 0
  v_cvt_pk_bf16_f32 v170, v44, v45
  v_exp_f32 v46, v46
  v_exp_f32 v47, v47
  s_nop 0
  v_cvt_pk_bf16_f32 v171, v46, v47
  v_exp_f32 v48, v48
  v_exp_f32 v49, v49
  s_nop 0
  v_cvt_pk_bf16_f32 v148, v48, v49
  v_exp_f32 v50, v50
  v_exp_f32 v51, v51
  s_nop 0
  v_cvt_pk_bf16_f32 v149, v50, v51
  v_exp_f32 v52, v52
  v_exp_f32 v53, v53
  s_nop 0
  v_cvt_pk_bf16_f32 v156, v52, v53
  v_exp_f32 v54, v54
  v_exp_f32 v55, v55
  s_nop 0
  v_cvt_pk_bf16_f32 v157, v54, v55
  v_exp_f32 v56, v56
  v_exp_f32 v57, v57
  s_nop 0
  v_cvt_pk_bf16_f32 v164, v56, v57
  v_exp_f32 v58, v58
  v_exp_f32 v59, v59
  s_nop 0
  v_cvt_pk_bf16_f32 v165, v58, v59
  v_exp_f32 v60, v60
  v_exp_f32 v61, v61
  s_nop 0
  v_cvt_pk_bf16_f32 v172, v60, v61
  v_exp_f32 v62, v62
  v_exp_f32 v63, v63
  s_nop 0
  v_cvt_pk_bf16_f32 v173, v62, v63
  v_exp_f32 v64, v64
  v_exp_f32 v65, v65
  s_nop 0
  v_cvt_pk_bf16_f32 v150, v64, v65
  v_exp_f32 v66, v66
  v_exp_f32 v67, v67
  s_nop 0
  v_cvt_pk_bf16_f32 v151, v66, v67
  v_exp_f32 v68, v68
  v_exp_f32 v69, v69
  s_nop 0
  v_cvt_pk_bf16_f32 v158, v68, v69
  v_exp_f32 v70, v70
  v_exp_f32 v71, v71
  s_nop 0
  v_cvt_pk_bf16_f32 v159, v70, v71
  v_exp_f32 v72, v72
  v_exp_f32 v73, v73
  s_nop 0
  v_cvt_pk_bf16_f32 v166, v72, v73
  v_exp_f32 v74, v74
  v_exp_f32 v75, v75
  s_nop 0
  v_cvt_pk_bf16_f32 v167, v74, v75
  v_exp_f32 v76, v76
  v_exp_f32 v77, v77
  s_nop 0
  v_cvt_pk_bf16_f32 v174, v76, v77
  v_exp_f32 v78, v78
  v_exp_f32 v79, v79
  s_nop 0
  v_cvt_pk_bf16_f32 v175, v78, v79
  s_waitcnt vmcnt(0)
  v_mfma_f32_16x16x32_bf16 a[128:131], v[224:227], v[144:147], a[128:131]
  v_mfma_f32_16x16x32_bf16 a[128:131], v[224:227], v[148:151], a[128:131]
  v_mfma_f32_16x16x32_bf16 a[132:135], v[224:227], v[152:155], a[132:135]
  v_mfma_f32_16x16x32_bf16 a[132:135], v[224:227], v[156:159], a[132:135]
  v_mfma_f32_16x16x32_bf16 a[136:139], v[224:227], v[160:163], a[136:139]
  v_mfma_f32_16x16x32_bf16 a[136:139], v[224:227], v[164:167], a[136:139]
  v_mfma_f32_16x16x32_bf16 a[140:143], v[224:227], v[168:171], a[140:143]
  v_mfma_f32_16x16x32_bf16 a[140:143], v[224:227], v[172:175], a[140:143]
  v_mfma_f32_16x16x32_bf16 a[0:3], v[80:83], v[144:147], a[0:3]
  v_mfma_f32_16x16x32_bf16 a[0:3], v[84:87], v[148:151], a[0:3]
  v_mfma_f32_16x16x32_bf16 a[4:7], v[80:83], v[152:155], a[4:7]
  v_mfma_f32_16x16x32_bf16 a[4:7], v[84:87], v[156:159], a[4:7]
  v_mfma_f32_16x16x32_bf16 a[8:11], v[80:83], v[160:163], a[8:11]
  v_mfma_f32_16x16x32_bf16 a[8:11], v[84:87], v[164:167], a[8:11]
  v_mfma_f32_16x16x32_bf16 a[12:15], v[80:83], v[168:171], a[12:15]
  v_mfma_f32_16x16x32_bf16 a[12:15], v[84:87], v[172:175], a[12:15]
  v_mfma_f32_16x16x32_bf16 a[16:19], v[88:91], v[144:147], a[16:19]
  v_mfma_f32_16x16x32_bf16 a[16:19], v[92:95], v[148:151], a[16:19]
  v_mfma_f32_16x16x32_bf16 a[20:23], v[88:91], v[152:155], a[20:23]
  v_mfma_f32_16x16x32_bf16 a[20:23], v[92:95], v[156:159], a[20:23]
  v_mfma_f32_16x16x32_bf16 a[24:27], v[88:91], v[160:163], a[24:27]
  v_mfma_f32_16x16x32_bf16 a[24:27], v[92:95], v[164:167], a[24:27]
  v_mfma_f32_16x16x32_bf16 a[28:31], v[88:91], v[168:171], a[28:31]
  v_mfma_f32_16x16x32_bf16 a[28:31], v[92:95], v[172:175], a[28:31]
  v_mfma_f32_16x16x32_bf16 a[32:35], v[96:99], v[144:147], a[32:35]
  v_mfma_f32_16x16x32_bf16 a[32:35], v[100:103], v[148:151], a[32:35]
  v_mfma_f32_16x16x32_bf16 a[36:39], v[96:99], v[152:155], a[36:39]
  v_mfma_f32_16x16x32_bf16 a[36:39], v[100:103], v[156:159], a[36:39]
  v_mfma_f32_16x16x32_bf16 a[40:43], v[96:99], v[160:163], a[40:43]
  v_mfma_f32_16x16x32_bf16 a[40:43], v[100:103], v[164:167], a[40:43]
  v_mfma_f32_16x16x32_bf16 a[44:47], v[96:99], v[168:171], a[44:47]
  v_mfma_f32_16x16x32_bf16 a[44:47], v[100:103], v[172:175], a[44:47]
  v_mfma_f32_16x16x32_bf16 a[48:51], v[104:107], v[144:147], a[48:51]
  v_mfma_f32_16x16x32_bf16 a[48:51], v[108:111], v[148:151], a[48:51]
  v_mfma_f32_16x16x32_bf16 a[52:55], v[104:107], v[152:155], a[52:55]
  v_mfma_f32_16x16x32_bf16 a[52:55], v[108:111], v[156:159], a[52:55]
  v_mfma_f32_16x16x32_bf16 a[56:59], v[104:107], v[160:163], a[56:59]
  v_mfma_f32_16x16x32_bf16 a[56:59], v[108:111], v[164:167], a[56:59]
  v_mfma_f32_16x16x32_bf16 a[60:63], v[104:107], v[168:171], a[60:63]
  v_mfma_f32_16x16x32_bf16 a[60:63], v[108:111], v[172:175], a[60:63]
  v_mfma_f32_16x16x32_bf16 a[64:67], v[112:115], v[144:147], a[64:67]
  v_mfma_f32_16x16x32_bf16 a[64:67], v[116:119], v[148:151], a[64:67]
  v_mfma_f32_16x16x32_bf16 a[68:71], v[112:115], v[152:155], a[68:71]
  v_mfma_f32_16x16x32_bf16 a[68:71], v[116:119], v[156:159], a[68:71]
  v_mfma_f32_16x16x32_bf16 a[72:75], v[112:115], v[160:163], a[72:75]
  v_mfma_f32_16x16x32_bf16 a[72:75], v[116:119], v[164:167], a[72:75]
  v_mfma_f32_16x16x32_bf16 a[76:79], v[112:115], v[168:171], a[76:79]
  v_mfma_f32_16x16x32_bf16 a[76:79], v[116:119], v[172:175], a[76:79]
  v_mfma_f32_16x16x32_bf16 a[80:83], v[120:123], v[144:147], a[80:83]
  v_mfma_f32_16x16x32_bf16 a[80:83], v[124:127], v[148:151], a[80:83]
  v_mfma_f32_16x16x32_bf16 a[84:87], v[120:123], v[152:155], a[84:87]
  v_mfma_f32_16x16x32_bf16 a[84:87], v[124:127], v[156:159], a[84:87]
  v_mfma_f32_16x16x32_bf16 a[88:91], v[120:123], v[160:163], a[88:91]
  v_mfma_f32_16x16x32_bf16 a[88:91], v[124:127], v[164:167], a[88:91]
  v_mfma_f32_16x16x32_bf16 a[92:95], v[120:123], v[168:171], a[92:95]
  v_mfma_f32_16x16x32_bf16 a[92:95], v[124:127], v[172:175], a[92:95]
  v_mfma_f32_16x16x32_bf16 a[96:99], v[128:131], v[144:147], a[96:99]
  v_mfma_f32_16x16x32_bf16 a[96:99], v[132:135], v[148:151], a[96:99]
  v_mfma_f32_16x16x32_bf16 a[100:103], v[128:131], v[152:155], a[100:103]
  v_mfma_f32_16x16x32_bf16 a[100:103], v[132:135], v[156:159], a[100:103]
  v_mfma_f32_16x16x32_bf16 a[104:107], v[128:131], v[160:163], a[104:107]
  v_mfma_f32_16x16x32_bf16 a[104:107], v[132:135], v[164:167], a[104:107]
  v_mfma_f32_16x16x32_bf16 a[108:111], v[128:131], v[168:171], a[108:111]
  v_mfma_f32_16x16x32_bf16 a[108:111], v[132:135], v[172:175], a[108:111]
  v_mfma_f32_16x16x32_bf16 a[112:115], v[136:139], v[144:147], a[112:115]
  v_mfma_f32_16x16x32_bf16 a[112:115], v[140:143], v[148:151], a[112:115]
  v_mfma_f32_16x16x32_bf16 a[116:119], v[136:139], v[152:155], a[116:119]
  v_mfma_f32_16x16x32_bf16 a[116:119], v[140:143], v[156:159], a[116:119]
  v_mfma_f32_16x16x32_bf16 a[120:123], v[136:139], v[160:163], a[120:123]
  v_mfma_f32_16x16x32_bf16 a[120:123], v[140:143], v[164:167], a[120:123]
  v_mfma_f32_16x16x32_bf16 a[124:127], v[136:139], v[168:171], a[124:127]
  v_mfma_f32_16x16x32_bf16 a[124:127], v[140:143], v[172:175], a[124:127]
  s_nop 7
  s_add_u32 s55, s55, 0x8000
  s_cmp_lt_u32 s54, s94
  s_cbranch_scc1 L_fb_loop
  s_cmp_eq_u32 s93, 0
  s_cbranch_scc1 L_ret_0
  s_cmp_eq_u32 s93, 1
  s_cbranch_scc1 L_ret_1
  s_cmp_eq_u32 s93, 2
  s_cbranch_scc1 L_ret_2
  s_cmp_eq_u32 s93, 3
  s_cbranch_scc1 L_ret_3
  s_endpgm
L_end:
  s_endpgm
.section .rodata,"a"
.p2align 6
.amdhsa_kernel parallel_sum__compressed_kv_cla__dense_activation_relu__prompt_kernel
  .amdhsa_next_free_vgpr 512
  .amdhsa_next_free_sgpr 102
  .amdhsa_accum_offset 256
  .amdhsa_group_segment_fixed_size 0
  .amdhsa_kernarg_size 96
  .amdhsa_user_sgpr_count 2
  .amdhsa_user_sgpr_kernarg_segment_ptr 1
  .amdhsa_system_sgpr_workgroup_id_x 1
.end_amdhsa_kernel
```
